```python
import torch

def _softmax(x, axis=-1):
    return torch.softmax(x, dim=axis)

def _gelu(x):
    return torch.nn.functional.gelu(x, approximate='tanh')

def _silu(x):
    return torch.nn.functional.silu(x)

def _sigmoid(x):
    return torch.sigmoid(x)

def _layernorm(x, axis=-1, eps=1e-05):
    m = x.mean(dim=axis, keepdim=True)
    v = x.var(dim=axis, keepdim=True, unbiased=False)
    return (x - m) / torch.sqrt(v + eps)

def _scatter_add(tgt, idx, src, axis=0):
    return tgt.clone().index_add_(axis, idx, src)

def _segment_sum(src, seg, n):
    out = torch.zeros((n,) + src.shape[1:], dtype=src.dtype)
    return out.index_add_(0, seg, src)

def _pad(x, pw):
    flat = tuple((v for pair in reversed(pw) for v in pair))
    return torch.nn.functional.pad(x, flat)
kernel_name = 'gated_mix__compressed_kv_cla__mixer_gmlp__prompt'

def setup_inputs():

    _w = lambda a: (lambda t: t.to(torch.bfloat16) if t.is_floating_point() else t)(torch.as_tensor(a))

    def _A_setup():
        B, H, Sq, Sk, D, M = (1, 32, 2048, 2048, 128, 512)
        Dc = 4 * D
        return {'x': _w((lambda *s: torch.randn(*s, dtype=torch.bfloat16) * 0.05)(B, Sq, M)), 'c_kv': _w((lambda *s: torch.randn(*s, dtype=torch.bfloat16) * 0.8)(B, Sk, Dc)), 'w_q': _w((lambda *s: torch.randn(*s, dtype=torch.bfloat16) * 6.4)(M, H, D) * M ** (-0.5)), 'w_uk': _w((lambda *s: torch.randn(*s, dtype=torch.bfloat16) * 6.4)(Dc, H, D) * Dc ** (-0.5)), 'w_uv': _w((lambda *s: torch.randn(*s, dtype=torch.bfloat16) * 0.8)(Dc, H, D) * Dc ** (-0.5)), 'w_o': _w((lambda *s: torch.randn(*s, dtype=torch.bfloat16) * 0.8)(H, D, M) * (H * D) ** (-0.5))}
    _A_in = _A_setup()

    def _B_setup():
        B, S, D, F = (1, 2048, 512, 1792)
        Fh = F // 2
        return {'x': _w((lambda *s: torch.randn(*s, dtype=torch.bfloat16) * 0.05)(B, S, D)), 'w_in': _w((lambda *s: torch.randn(*s, dtype=torch.bfloat16) * 0.4)(D, 2 * Fh)), 'w_sp': _w(0.01 * (lambda *s: torch.randn(*s, dtype=torch.bfloat16) * 0.4)(S, S)), 'b_sp': _w(1.0 + 0.01 * (lambda *s: torch.randn(*s, dtype=torch.bfloat16) * 0.05)(S)), 'w_out': _w((lambda *s: torch.randn(*s, dtype=torch.bfloat16) * 0.05)(Fh, D))}
    _B_in = _B_setup()
    return {'A_x': _A_in['x'], 'A_c_kv': _A_in['c_kv'], 'A_w_q': _A_in['w_q'], 'A_w_uk': _A_in['w_uk'], 'A_w_uv': _A_in['w_uv'], 'A_w_o': _A_in['w_o'], 'B_x': _B_in['x'], 'B_w_in': _B_in['w_in'], 'B_w_sp': _B_in['w_sp'], 'B_b_sp': _B_in['b_sp'], 'B_w_out': _B_in['w_out'], 'gate_w': _w((lambda *s: torch.randn(*s, dtype=torch.bfloat16) * 0.05)(512) * 16.0)}

def reference(A_x, A_c_kv, A_w_q, A_w_uk, A_w_uv, A_w_o, B_x, B_w_in, B_w_sp, B_b_sp, B_w_out, gate_w):

    def _A_ref(x, c_kv, w_q, w_uk, w_uv, w_o):
        B, Sq, M = (x.shape[0], x.shape[1], x.shape[2])
        Sk = c_kv.shape[1]
        H, D = (w_q.shape[1], w_q.shape[2])
        q = torch.einsum('bqm,mhd->bhqd', x, w_q)
        k = torch.einsum('bkc,chd->bhkd', c_kv, w_uk)
        v = torch.einsum('bkc,chd->bhkd', c_kv, w_uv)
        scores = torch.einsum('bhqd,bhkd->bhqk', q, k) * D ** (-0.5)
        off = Sk - Sq
        qi = torch.arange(Sq)[:, None]
        kj = torch.arange(Sk)[None, :]
        cmask = kj <= qi + off
        scores = torch.where(cmask[None, None], scores, -1000000000.0)
        p = _softmax(scores, axis=-1)
        ctx = torch.einsum('bhqk,bhkd->bhqd', p, v)
        return torch.einsum('bhqd,hdm->bqm', ctx, w_o)

    def _B_ref(x, w_in, w_sp, b_sp, w_out):
        B, S, D = x.shape
        F = w_in.shape[-1]
        Fh = F // 2
        z = _gelu(torch.einsum('bsd,df->bsf', x, w_in))
        z1 = z[..., :Fh].clone()
        z2 = _layernorm(z[..., Fh:], axis=-1)
        g = torch.einsum('ts,bsf->btf', w_sp, z2) + b_sp[None, :, None]
        return torch.einsum('bsf,fd->bsd', z1 * g, w_out)
    x = A_x
    g = _sigmoid((x * gate_w).sum(-1, keepdims=True))
    a = _A_ref(x, A_c_kv, A_w_q, A_w_uk, A_w_uv, A_w_o)
    b = _B_ref(x, B_w_in, B_w_sp, B_b_sp, B_w_out)
    return g * a + (1 - g) * b
```

```asm
; @launch kernel=fused_kernel grid=(256,1,1) block=(256,1,1) lds=163840
.amdgcn_target "amdgcn-amd-amdhsa--gfx950"
.text
.globl fused_kernel
.p2align 8
.type fused_kernel,@function
fused_kernel:
    s_load_dwordx16 s[4:19], s[0:1], 0
    s_load_dwordx8 s[20:27], s[0:1], 88
    s_load_dwordx2 s[86:87], s[0:1], 64
    s_load_dwordx2 s[92:93], s[0:1], 80
    v_lshrrev_b32 v1, 6, v0
    s_nop 0
    v_readfirstlane_b32 s44, v1
    v_and_b32 v0, 63, v0
    v_lshlrev_b32 v1, 4, v0
    v_lshrrev_b32 v28, 5, v0
    v_and_b32 v29, 31, v0
    v_lshrrev_b32 v24, 2, v0
    v_and_b32 v24, 3, v24
    v_lshlrev_b32 v24, 6, v24
    v_lshl_add_u32 v24, v28, 10, v24
    v_lshrrev_b32 v25, 4, v0
    v_and_b32 v25, 1, v25
    v_lshl_add_u32 v24, v25, 5, v24
    v_and_b32 v25, 3, v0
    v_lshl_add_u32 v6, v25, 3, v24
    v_lshrrev_b32 v24, 3, v0
    v_and_b32 v25, 7, v0
    v_lshrrev_b32 v26, 1, v24
    v_xor_b32 v27, v25, v26
    v_lshlrev_b32 v27, 4, v27
    v_lshl_add_u32 v8, v24, 10, v27
    v_xor_b32 v9, 64, v8
    s_lshl_b32 s79, s44, 13
    s_add_u32 s79, s79, 0x10000
    v_lshrrev_b32 v24, 1, v29
    v_and_b32 v24, 7, v24
    v_xor_b32 v24, v28, v24
    v_lshlrev_b32 v24, 4, v24
    v_lshl_add_u32 v24, v29, 7, v24
    v_add_u32 v10, s79, v24
    v_xor_b32 v11, 32, v10
    v_xor_b32 v12, 64, v10
    v_xor_b32 v13, 0x60, v10
    v_add_u32 v32, 0x10000, v10
    v_add_u32 v33, 0x10000, v11
    v_add_u32 v34, 0x10000, v12
    v_add_u32 v35, 0x10000, v13
    v_mov_b32 v2, 0
    v_mov_b32 v3, 0
    v_mov_b32 v4, 0
    v_mov_b32 v5, 0
    v_mov_b32 v7, 0
    s_and_b32 s55, s2, 7
    s_lshl_b32 s55, s55, 2
    s_lshr_b32 s56, s2, 3
    s_and_b32 s46, s56, 3
    s_add_u32 s46, s46, s55
    s_lshr_b32 s45, s2, 5
    s_lshl_b32 s63, s45, 3
    s_lshl_b32 s55, s44, 1
    s_add_u32 s63, s63, s55
    s_lshl_b32 s66, s63, 15
    s_mov_b32 s47, 0
    s_mov_b32 s55, 0
    s_cmp_ge_u32 s46, 13
    s_cselect_b32 s47, 1, s47
    s_cselect_b32 s55, 13, s55
    s_cmp_ge_u32 s46, 26
    s_cselect_b32 s47, 3, s47
    s_cselect_b32 s55, 26, s55
    s_cmp_ge_u32 s46, 29
    s_cselect_b32 s47, 4, s47
    s_cselect_b32 s55, 29, s55
    s_sub_u32 s55, s46, s55
    s_mul_i32 s48, s55, 5
    s_mov_b32 s49, 5
    s_cmp_eq_u32 s46, 12
    s_cselect_b32 s49, 4, s49
    s_cmp_eq_u32 s46, 25
    s_cselect_b32 s49, 4, s49
    s_cmp_eq_u32 s46, 28
    s_cselect_b32 s49, 4, s49
    s_cmp_eq_u32 s46, 31
    s_cselect_b32 s49, 4, s49
    s_cmp_eq_u32 s46, 28
    s_cselect_b32 s67, 1, 0
    s_waitcnt lgkmcnt(0)
    s_mov_b32 s28, s6
    s_mov_b32 s29, s7
    s_mov_b32 s30, 0x200000
    s_mov_b32 s31, 0x20000
    s_mov_b32 s32, s10
    s_mov_b32 s33, s11
    s_mov_b32 s34, 0x400000
    s_mov_b32 s35, 0x20000
    s_mov_b32 s36, s26
    s_mov_b32 s37, s27
    s_mov_b32 s38, 0x10000000
    s_mov_b32 s39, 0x20000
    s_mov_b32 s40, s20
    s_mov_b32 s41, s21
    s_mov_b32 s42, 0x400
    s_mov_b32 s43, 0x20000
    s_lshl_b32 s55, s2, 2
    s_add_u32 s55, s55, s44
    v_lshlrev_b32 v44, 6, v0
    s_lshl_b32 s56, s55, 12
    s_add_u32 s84, s8, s56
    s_addc_u32 s85, s9, 0
    s_add_u32 s90, s14, s56
    s_addc_u32 s91, s15, 0
    s_lshl_b32 s56, s55, 13
    s_add_u32 s86, s86, s56
    s_addc_u32 s87, s87, 0
    s_add_u32 s88, s86, 0x1000
    s_addc_u32 s89, s87, 0
    s_mul_i32 s56, s55, 0x380
    s_min_u32 s56, s56, 0xdf000
    s_add_u32 s92, s92, s56
    s_addc_u32 s93, s93, 0
    s_cmp_ge_u32 s2, 0x100
    s_cbranch_scc1 L1_end
L1_dec:
    s_lshl_b32 s72, s2, 2
    s_add_u32 s72, s72, s44
    s_lshl_b32 s72, s72, 8
    s_add_u32 s72, s72, 0x6400000
    s_getpc_b64 s[16:17]
    L1_pc:
    s_lshr_b32 s55, s2, 3
    s_lshl_b32 s55, s55, 2
    s_add_u32 s55, s55, s44
    s_mul_i32 s55, s55, 18
    s_lshr_b32 s55, s55, 7
    s_lshl_b32 s55, s55, 12
    v_lshlrev_b32 v46, 6, v0
    v_add_u32 v46, s55, v46
    v_min_u32 v46, L5_end-L1_pc, v46
    global_load_dword v47, v46, s[16:17]
    v_mov_b32 v46, 0
    s_lshl_b32 s55, s2, 8
    s_add_u32 s55, s55, 0x4e00000
    buffer_store_dword v46, v46, s[36:39], s55 offen sc1
    s_add_u32 s55, s55, 0x10000
    buffer_store_dword v46, v46, s[36:39], s55 offen sc1
    s_add_u32 s55, s55, 0x10000
    buffer_store_dword v46, v46, s[36:39], s55 offen sc1
    s_add_u32 s55, s55, 0x10000
L1_job:
    s_cmp_lt_u32 s47, 2
    s_cselect_b32 s28, s6, s4
    s_cselect_b32 s29, s7, s5
    s_mov_b32 s32, s10
    s_mov_b32 s33, s11
    s_mov_b32 s34, 0x400000
    s_mov_b32 s64, 0x1000000
    s_mov_b32 s62, 0x3e0293ee
    s_cmp_eq_u32 s47, 1
    s_cselect_b32 s32, s12, s32
    s_cselect_b32 s33, s13, s33
    s_cselect_b32 s64, 0x2000000, s64
    s_mov_b32 s76, 0x80000
    s_cmp_eq_u32 s47, 3
    s_cselect_b32 s64, 0x4400000, s64
    s_cselect_b32 s76, 0x2000, s76
    s_cselect_b32 s62, 1.0, s62
    s_cmp_eq_u32 s47, 4
    s_cselect_b32 s64, 0x4800000, s64
    s_cselect_b32 s76, 0x1000, s76
    s_mov_b32 s55, 0x2000
    s_mov_b32 s77, 0x2000
    s_mov_b32 s78, 0x1000
    s_cmp_ge_u32 s47, 3
    s_cselect_b32 s32, s18, s32
    s_cselect_b32 s33, s19, s33
    s_cselect_b32 s34, 0x1c0000, s34
    s_cselect_b32 s55, 0xe00, s55
    s_cselect_b32 s77, 0xe000, s77
    s_cselect_b32 s78, 0x7000, s78
    s_mul_i32 s56, s77, s63
    s_add_u32 s64, s64, s56
    s_mov_b32 s81, s55
    s_lshl_b32 s69, s48, 7
    s_cmp_eq_u32 s47, 4
    s_cselect_b32 s56, 0x700, 0
    s_add_u32 s69, s69, s56
    s_lshl_b32 s73, s55, 5
    s_lshl_b32 s74, s55, 8
    s_sub_u32 s75, 0x80, s74
    v_lshrrev_b32 v24, 2, v0
    v_and_b32 v24, 7, v24
    v_mul_lo_u32 v24, v24, s55
    v_lshrrev_b32 v25, 5, v0
    v_lshl_add_u32 v24, v25, 6, v24
    v_and_b32 v25, 3, v0
    v_lshl_add_u32 v2, v25, 4, v24
    s_lshl_b32 s56, s55, 3
    v_add_u32 v3, s56, v2
    v_add_u32 v4, s56, v3
    v_add_u32 v5, s56, v4
    s_lshl_b32 s51, s48, 7
    s_lshl_b32 s56, s44, 6
    s_mul_i32 s56, s56, s55
    s_add_u32 s51, s51, s56
    s_cmp_eq_u32 s47, 4
    s_cselect_b32 s56, 0x700, 0
    s_add_u32 s51, s51, s56
    s_lshl_b32 s52, s49, 1
    s_lshl_b32 s53, s44, 13
    s_mov_b32 s54, 0
    v_mov_b32 v7, v6
    s_add_u32 m0, s79, 0
    s_add_u32 s80, s66, 0
    buffer_load_dwordx4 v8, s[28:31], s80 offen lds
    s_add_u32 m0, s79, 0x400
    s_add_u32 s80, s66, 0x2000
    buffer_load_dwordx4 v9, s[28:31], s80 offen lds
    s_add_u32 m0, s79, 0x800
    s_add_u32 s80, s66, 0x4000
    buffer_load_dwordx4 v8, s[28:31], s80 offen lds
    s_add_u32 m0, s79, 0xc00
    s_add_u32 s80, s66, 0x6000
    buffer_load_dwordx4 v9, s[28:31], s80 offen lds
    s_add_u32 m0, s79, 0x1000
    s_add_u32 s80, s66, 0x8000
    buffer_load_dwordx4 v8, s[28:31], s80 offen lds
    s_add_u32 m0, s79, 0x1400
    s_add_u32 s80, s66, 0xa000
    buffer_load_dwordx4 v9, s[28:31], s80 offen lds
    s_add_u32 m0, s79, 0x1800
    s_add_u32 s80, s66, 0xc000
    buffer_load_dwordx4 v8, s[28:31], s80 offen lds
    s_add_u32 m0, s79, 0x1c00
    s_add_u32 s80, s66, 0xe000
    buffer_load_dwordx4 v9, s[28:31], s80 offen lds
    s_cmp_gt_i32 s52, 0
    s_cselect_b32 s65, s51, 0x40000000
    s_sub_u32 s52, s52, 1
    s_add_u32 s68, s65, s73
    s_add_u32 m0, s53, 0
    s_nop 0
    buffer_load_dwordx4 v2, s[32:35], s65 offen lds
    s_add_u32 m0, s53, 0x400
    s_nop 0
    buffer_load_dwordx4 v3, s[32:35], s65 offen lds
    s_add_u32 m0, s53, 0x800
    s_nop 0
    buffer_load_dwordx4 v4, s[32:35], s65 offen lds
    s_add_u32 m0, s53, 0xc00
    s_nop 0
    buffer_load_dwordx4 v5, s[32:35], s65 offen lds
    s_add_u32 m0, s53, 0x1000
    s_nop 0
    buffer_load_dwordx4 v2, s[32:35], s68 offen lds
    s_add_u32 m0, s53, 0x1400
    s_nop 0
    buffer_load_dwordx4 v3, s[32:35], s68 offen lds
    s_add_u32 m0, s53, 0x1800
    s_nop 0
    buffer_load_dwordx4 v4, s[32:35], s68 offen lds
    s_add_u32 m0, s53, 0x1c00
    s_nop 0
    buffer_load_dwordx4 v5, s[32:35], s68 offen lds
    s_add_u32 s51, s51, s74
    s_add_u32 s53, s53, 0x8000
    s_sub_u32 s57, s53, 0x28000
    s_cmp_ge_u32 s53, 0x28000
    s_cselect_b32 s53, s57, s53
    s_add_u32 m0, s79, 0x8000
    s_add_u32 s80, s66, 0x80
    buffer_load_dwordx4 v8, s[28:31], s80 offen lds
    s_add_u32 m0, s79, 0x8400
    s_add_u32 s80, s66, 0x2080
    buffer_load_dwordx4 v9, s[28:31], s80 offen lds
    s_add_u32 m0, s79, 0x8800
    s_add_u32 s80, s66, 0x4080
    buffer_load_dwordx4 v8, s[28:31], s80 offen lds
    s_add_u32 m0, s79, 0x8c00
    s_add_u32 s80, s66, 0x6080
    buffer_load_dwordx4 v9, s[28:31], s80 offen lds
    s_add_u32 m0, s79, 0x9000
    s_add_u32 s80, s66, 0x8080
    buffer_load_dwordx4 v8, s[28:31], s80 offen lds
    s_add_u32 m0, s79, 0x9400
    s_add_u32 s80, s66, 0xa080
    buffer_load_dwordx4 v9, s[28:31], s80 offen lds
    s_add_u32 m0, s79, 0x9800
    s_add_u32 s80, s66, 0xc080
    buffer_load_dwordx4 v8, s[28:31], s80 offen lds
    s_add_u32 m0, s79, 0x9c00
    s_add_u32 s80, s66, 0xe080
    buffer_load_dwordx4 v9, s[28:31], s80 offen lds
    s_add_u32 m0, s79, 0x10000
    s_add_u32 s80, s66, 0x100
    buffer_load_dwordx4 v8, s[28:31], s80 offen lds
    s_add_u32 m0, s79, 0x10400
    s_add_u32 s80, s66, 0x2100
    buffer_load_dwordx4 v9, s[28:31], s80 offen lds
    s_add_u32 m0, s79, 0x10800
    s_add_u32 s80, s66, 0x4100
    buffer_load_dwordx4 v8, s[28:31], s80 offen lds
    s_add_u32 m0, s79, 0x10c00
    s_add_u32 s80, s66, 0x6100
    buffer_load_dwordx4 v9, s[28:31], s80 offen lds
    s_add_u32 m0, s79, 0x11000
    s_add_u32 s80, s66, 0x8100
    buffer_load_dwordx4 v8, s[28:31], s80 offen lds
    s_add_u32 m0, s79, 0x11400
    s_add_u32 s80, s66, 0xa100
    buffer_load_dwordx4 v9, s[28:31], s80 offen lds
    s_add_u32 m0, s79, 0x11800
    s_add_u32 s80, s66, 0xc100
    buffer_load_dwordx4 v8, s[28:31], s80 offen lds
    s_add_u32 m0, s79, 0x11c00
    s_add_u32 s80, s66, 0xe100
    buffer_load_dwordx4 v9, s[28:31], s80 offen lds
    s_waitcnt vmcnt(24)
    ds_read_b128 a[0:3], v10
    ds_read_b128 a[4:7], v11
    ds_read_b128 a[8:11], v12
    ds_read_b128 a[12:15], v13
    ds_read_b128 a[128:131], v10 offset:4096
    ds_read_b128 a[132:135], v11 offset:4096
    ds_read_b128 a[136:139], v12 offset:4096
    ds_read_b128 a[140:143], v13 offset:4096
    s_add_u32 m0, s79, 0
    s_add_u32 s80, s66, 0x180
    s_waitcnt lgkmcnt(0)
    buffer_load_dwordx4 v8, s[28:31], s80 offen lds
    s_add_u32 m0, s79, 0x400
    s_add_u32 s80, s66, 0x2180
    buffer_load_dwordx4 v9, s[28:31], s80 offen lds
    s_add_u32 m0, s79, 0x800
    s_add_u32 s80, s66, 0x4180
    buffer_load_dwordx4 v8, s[28:31], s80 offen lds
    s_add_u32 m0, s79, 0xc00
    s_add_u32 s80, s66, 0x6180
    buffer_load_dwordx4 v9, s[28:31], s80 offen lds
    s_add_u32 m0, s79, 0x1000
    s_add_u32 s80, s66, 0x8180
    buffer_load_dwordx4 v8, s[28:31], s80 offen lds
    s_add_u32 m0, s79, 0x1400
    s_add_u32 s80, s66, 0xa180
    buffer_load_dwordx4 v9, s[28:31], s80 offen lds
    s_add_u32 m0, s79, 0x1800
    s_add_u32 s80, s66, 0xc180
    buffer_load_dwordx4 v8, s[28:31], s80 offen lds
    s_add_u32 m0, s79, 0x1c00
    s_add_u32 s80, s66, 0xe180
    buffer_load_dwordx4 v9, s[28:31], s80 offen lds
    s_waitcnt vmcnt(24)
    s_barrier
    ds_read_b64_tr_b16 v[96:97], v7
    ds_read_b64_tr_b16 v[98:99], v7 offset:256
    ds_read_b64_tr_b16 v[100:101], v7 offset:512
    ds_read_b64_tr_b16 v[102:103], v7 offset:768
    ds_read_b64_tr_b16 v[104:105], v7 offset:2048
    ds_read_b64_tr_b16 v[106:107], v7 offset:2304
    ds_read_b64_tr_b16 v[108:109], v7 offset:2560
    ds_read_b64_tr_b16 v[110:111], v7 offset:2816
    ds_read_b64_tr_b16 v[112:113], v7 offset:4096
    ds_read_b64_tr_b16 v[114:115], v7 offset:4352
    ds_read_b64_tr_b16 v[116:117], v7 offset:4608
    ds_read_b64_tr_b16 v[118:119], v7 offset:4864
    s_waitcnt lgkmcnt(0)
    s_cmp_eq_u32 s47, 1
    s_cbranch_scc1 L1_V_f
L1_d1:
    s_cmp_eq_u32 s47, 4
    s_cbranch_scc1 L1_V_f
L1_QK_f:
    v_mfma_f32_32x32x16_bf16 v[128:143], v[96:99], a[0:3], 0
    s_waitcnt vmcnt(16)
    ds_read_b128 a[16:19], v10 offset:32768
    ds_read_b128 a[20:23], v11 offset:32768
    ds_read_b64_tr_b16 v[120:121], v7 offset:6144
    v_mfma_f32_32x32x16_bf16 v[144:159], v[96:99], a[128:131], 0
    ds_read_b128 a[24:27], v12 offset:32768
    ds_read_b128 a[28:31], v13 offset:32768
    ds_read_b64_tr_b16 v[122:123], v7 offset:6400
    v_mfma_f32_32x32x16_bf16 v[160:175], v[100:103], a[0:3], 0
    ds_read_b128 a[144:147], v10 offset:36864
    ds_read_b128 a[148:151], v11 offset:36864
    ds_read_b64_tr_b16 v[124:125], v7 offset:6656
    v_mfma_f32_32x32x16_bf16 v[176:191], v[100:103], a[128:131], 0
    ds_read_b64_tr_b16 v[126:127], v7 offset:6912
    ds_read_b128 a[152:155], v12 offset:36864
    ds_read_b128 a[156:159], v13 offset:36864
    v_mfma_f32_32x32x16_bf16 v[128:143], v[104:107], a[4:7], v[128:143]
    s_add_u32 m0, s79, 0x8000
    s_add_u32 s80, s66, 0x200
    s_waitcnt lgkmcnt(0)
    buffer_load_dwordx4 v8, s[28:31], s80 offen lds
    v_mfma_f32_32x32x16_bf16 v[144:159], v[104:107], a[132:135], v[144:159]
    s_add_u32 m0, s79, 0x8400
    s_add_u32 s80, s66, 0x2200
    buffer_load_dwordx4 v9, s[28:31], s80 offen lds
    v_mfma_f32_32x32x16_bf16 v[160:175], v[108:111], a[4:7], v[160:175]
    s_add_u32 m0, s79, 0x8800
    s_add_u32 s80, s66, 0x4200
    buffer_load_dwordx4 v8, s[28:31], s80 offen lds
    v_mfma_f32_32x32x16_bf16 v[176:191], v[108:111], a[132:135], v[176:191]
    ds_read_b64_tr_b16 v[96:97], v7 offset:8192
    ds_read_b64_tr_b16 v[98:99], v7 offset:8448
    ds_read_b64_tr_b16 v[100:101], v7 offset:8704
    ds_read_b64_tr_b16 v[102:103], v7 offset:8960
    v_mfma_f32_32x32x16_bf16 v[128:143], v[112:115], a[8:11], v[128:143]
    s_add_u32 m0, s79, 0x8c00
    s_add_u32 s80, s66, 0x6200
    buffer_load_dwordx4 v9, s[28:31], s80 offen lds
    v_mfma_f32_32x32x16_bf16 v[144:159], v[112:115], a[136:139], v[144:159]
    s_add_u32 m0, s79, 0x9000
    s_add_u32 s80, s66, 0x8200
    buffer_load_dwordx4 v8, s[28:31], s80 offen lds
    v_mfma_f32_32x32x16_bf16 v[160:175], v[116:119], a[8:11], v[160:175]
    s_add_u32 m0, s79, 0x9400
    s_add_u32 s80, s66, 0xa200
    buffer_load_dwordx4 v9, s[28:31], s80 offen lds
    v_mfma_f32_32x32x16_bf16 v[176:191], v[116:119], a[136:139], v[176:191]
    ds_read_b64_tr_b16 v[104:105], v7 offset:10240
    ds_read_b64_tr_b16 v[106:107], v7 offset:10496
    ds_read_b64_tr_b16 v[108:109], v7 offset:10752
    ds_read_b64_tr_b16 v[110:111], v7 offset:11008
    v_mfma_f32_32x32x16_bf16 v[128:143], v[120:123], a[12:15], v[128:143]
    s_add_u32 m0, s79, 0x9800
    s_add_u32 s80, s66, 0xc200
    buffer_load_dwordx4 v8, s[28:31], s80 offen lds
    v_mfma_f32_32x32x16_bf16 v[144:159], v[120:123], a[140:143], v[144:159]
    s_add_u32 m0, s79, 0x9c00
    s_add_u32 s80, s66, 0xe200
    buffer_load_dwordx4 v9, s[28:31], s80 offen lds
    v_mfma_f32_32x32x16_bf16 v[160:175], v[124:127], a[12:15], v[160:175]
    s_cmp_gt_i32 s52, 0
    s_cselect_b32 s65, s51, 0x40000000
    s_sub_u32 s52, s52, 1
    s_add_u32 s68, s65, s73
    ds_read_b64_tr_b16 v[112:113], v7 offset:12288
    v_mfma_f32_32x32x16_bf16 v[176:191], v[124:127], a[140:143], v[176:191]
    s_add_u32 m0, s53, 0
    s_nop 0
    buffer_load_dwordx4 v2, s[32:35], s65 offen lds
    s_add_u32 m0, s53, 0x400
    s_nop 0
    buffer_load_dwordx4 v3, s[32:35], s65 offen lds
    s_add_u32 m0, s53, 0x800
    s_nop 0
    buffer_load_dwordx4 v4, s[32:35], s65 offen lds
    s_add_u32 m0, s53, 0xc00
    s_nop 0
    buffer_load_dwordx4 v5, s[32:35], s65 offen lds
    s_add_u32 m0, s53, 0x1000
    s_nop 0
    buffer_load_dwordx4 v2, s[32:35], s68 offen lds
    s_add_u32 m0, s53, 0x1400
    s_nop 0
    buffer_load_dwordx4 v3, s[32:35], s68 offen lds
    s_add_u32 m0, s53, 0x1800
    s_nop 0
    buffer_load_dwordx4 v4, s[32:35], s68 offen lds
    s_add_u32 m0, s53, 0x1c00
    s_nop 0
    buffer_load_dwordx4 v5, s[32:35], s68 offen lds
    s_add_u32 s51, s51, s75
    s_add_u32 s53, s53, 0x8000
    s_sub_u32 s57, s53, 0x28000
    s_cmp_ge_u32 s53, 0x28000
    s_cselect_b32 s53, s57, s53
    s_waitcnt vmcnt(24)
    ds_read_b128 a[32:35], v32
    ds_read_b128 a[36:39], v33
    ds_read_b128 a[40:43], v34
    ds_read_b128 a[44:47], v35
    ds_read_b128 a[160:163], v32 offset:4096
    ds_read_b128 a[164:167], v33 offset:4096
    ds_read_b64_tr_b16 v[114:115], v7 offset:12544
    ds_read_b64_tr_b16 v[116:117], v7 offset:12800
    ds_read_b128 a[168:171], v34 offset:4096
    ds_read_b128 a[172:175], v35 offset:4096
    ds_read_b64_tr_b16 v[118:119], v7 offset:13056
    s_waitcnt lgkmcnt(15)
    v_mfma_f32_32x32x16_bf16 v[128:143], v[96:99], a[16:19], v[128:143]
    s_add_u32 m0, s79, 0x10000
    s_add_u32 s80, s66, 0x280
    s_waitcnt lgkmcnt(1)
    buffer_load_dwordx4 v8, s[28:31], s80 offen lds
    v_mfma_f32_32x32x16_bf16 v[144:159], v[96:99], a[144:147], v[144:159]
    ds_read_b64_tr_b16 v[120:121], v7 offset:14336
    ds_read_b64_tr_b16 v[122:123], v7 offset:14592
    ds_read_b64_tr_b16 v[124:125], v7 offset:14848
    v_mfma_f32_32x32x16_bf16 v[160:175], v[100:103], a[16:19], v[160:175]
    s_add_u32 m0, s79, 0x10400
    s_add_u32 s80, s66, 0x2280
    buffer_load_dwordx4 v9, s[28:31], s80 offen lds
    v_mfma_f32_32x32x16_bf16 v[176:191], v[100:103], a[144:147], v[176:191]
    ds_read_b64_tr_b16 v[126:127], v7 offset:15104
    s_add_u32 s54, s54, 0x8000
    s_cmp_ge_u32 s54, 0x28000
    s_cselect_b32 s54, 0, s54
    v_mfma_f32_32x32x16_bf16 v[128:143], v[104:107], a[20:23], v[128:143]
    s_add_u32 m0, s79, 0x10800
    s_add_u32 s80, s66, 0x4280
    buffer_load_dwordx4 v8, s[28:31], s80 offen lds
    v_mfma_f32_32x32x16_bf16 v[144:159], v[104:107], a[148:151], v[144:159]
    s_add_u32 m0, s79, 0x10c00
    s_add_u32 s80, s66, 0x6280
    buffer_load_dwordx4 v9, s[28:31], s80 offen lds
    v_mfma_f32_32x32x16_bf16 v[160:175], v[108:111], a[20:23], v[160:175]
    s_add_u32 m0, s79, 0x11000
    s_add_u32 s80, s66, 0x8280
    buffer_load_dwordx4 v8, s[28:31], s80 offen lds
    v_mfma_f32_32x32x16_bf16 v[176:191], v[108:111], a[148:151], v[176:191]
    ds_read_b64_tr_b16 v[96:97], v7 offset:16384
    ds_read_b64_tr_b16 v[98:99], v7 offset:16640
    ds_read_b64_tr_b16 v[100:101], v7 offset:16896
    ds_read_b64_tr_b16 v[102:103], v7 offset:17152
    s_waitcnt lgkmcnt(8)
    v_mfma_f32_32x32x16_bf16 v[128:143], v[112:115], a[24:27], v[128:143]
    s_add_u32 m0, s79, 0x11400
    s_add_u32 s80, s66, 0xa280
    buffer_load_dwordx4 v9, s[28:31], s80 offen lds
    v_mfma_f32_32x32x16_bf16 v[144:159], v[112:115], a[152:155], v[144:159]
    s_add_u32 m0, s79, 0x11800
    s_add_u32 s80, s66, 0xc280
    buffer_load_dwordx4 v8, s[28:31], s80 offen lds
    s_add_u32 m0, s79, 0x11c00
    s_add_u32 s80, s66, 0xe280
    buffer_load_dwordx4 v9, s[28:31], s80 offen lds
    v_mfma_f32_32x32x16_bf16 v[160:175], v[116:119], a[24:27], v[160:175]
    ds_read_b64_tr_b16 v[104:105], v7 offset:18432
    ds_read_b64_tr_b16 v[106:107], v7 offset:18688
    ds_read_b64_tr_b16 v[108:109], v7 offset:18944
    v_mfma_f32_32x32x16_bf16 v[176:191], v[116:119], a[152:155], v[176:191]
    ds_read_b64_tr_b16 v[110:111], v7 offset:19200
    s_waitcnt vmcnt(24)
    ds_read_b128 a[48:51], v10
    ds_read_b128 a[52:55], v11
    s_waitcnt lgkmcnt(10)
    v_mfma_f32_32x32x16_bf16 v[128:143], v[120:123], a[28:31], v[128:143]
    ds_read_b128 a[56:59], v12
    ds_read_b128 a[60:63], v13
    ds_read_b64_tr_b16 v[112:113], v7 offset:20480
    v_mfma_f32_32x32x16_bf16 v[144:159], v[120:123], a[156:159], v[144:159]
    ds_read_b128 a[176:179], v10 offset:4096
    ds_read_b128 a[180:183], v11 offset:4096
    ds_read_b64_tr_b16 v[114:115], v7 offset:20736
    v_mfma_f32_32x32x16_bf16 v[160:175], v[124:127], a[28:31], v[160:175]
    ds_read_b64_tr_b16 v[116:117], v7 offset:20992
    ds_read_b128 a[184:187], v12 offset:4096
    ds_read_b128 a[188:191], v13 offset:4096
    v_mfma_f32_32x32x16_bf16 v[176:191], v[124:127], a[156:159], v[176:191]
    ds_read_b64_tr_b16 v[118:119], v7 offset:21248
    s_waitcnt lgkmcnt(15)
    v_mfma_f32_32x32x16_bf16 v[128:143], v[96:99], a[32:35], v[128:143]
    ds_read_b64_tr_b16 v[120:121], v7 offset:22528
    ds_read_b64_tr_b16 v[122:123], v7 offset:22784
    ds_read_b64_tr_b16 v[124:125], v7 offset:23040
    v_mfma_f32_32x32x16_bf16 v[144:159], v[96:99], a[160:163], v[144:159]
    ds_read_b64_tr_b16 v[126:127], v7 offset:23296
    v_mfma_f32_32x32x16_bf16 v[160:175], v[100:103], a[32:35], v[160:175]
    v_mfma_f32_32x32x16_bf16 v[176:191], v[100:103], a[160:163], v[176:191]
    s_waitcnt lgkmcnt(15)
    v_mfma_f32_32x32x16_bf16 v[128:143], v[104:107], a[36:39], v[128:143]
    ds_read_b64_tr_b16 v[96:97], v7 offset:24576
    ds_read_b64_tr_b16 v[98:99], v7 offset:24832
    ds_read_b64_tr_b16 v[100:101], v7 offset:25088
    v_mfma_f32_32x32x16_bf16 v[144:159], v[104:107], a[164:167], v[144:159]
    ds_read_b64_tr_b16 v[102:103], v7 offset:25344
    v_mfma_f32_32x32x16_bf16 v[160:175], v[108:111], a[36:39], v[160:175]
    v_mfma_f32_32x32x16_bf16 v[176:191], v[108:111], a[164:167], v[176:191]
    s_waitcnt lgkmcnt(8)
    v_mfma_f32_32x32x16_bf16 v[128:143], v[112:115], a[40:43], v[128:143]
    ds_read_b64_tr_b16 v[104:105], v7 offset:26624
    ds_read_b64_tr_b16 v[106:107], v7 offset:26880
    ds_read_b64_tr_b16 v[108:109], v7 offset:27136
    v_mfma_f32_32x32x16_bf16 v[144:159], v[112:115], a[168:171], v[144:159]
    ds_read_b64_tr_b16 v[110:111], v7 offset:27392
    v_mfma_f32_32x32x16_bf16 v[160:175], v[116:119], a[40:43], v[160:175]
    s_waitcnt vmcnt(16)
    ds_read_b128 a[64:67], v10 offset:32768
    ds_read_b128 a[68:71], v11 offset:32768
    v_mfma_f32_32x32x16_bf16 v[176:191], v[116:119], a[168:171], v[176:191]
    ds_read_b128 a[72:75], v12 offset:32768
    ds_read_b128 a[76:79], v13 offset:32768
    s_waitcnt lgkmcnt(12)
    v_mfma_f32_32x32x16_bf16 v[128:143], v[120:123], a[44:47], v[128:143]
    ds_read_b128 a[192:195], v10 offset:36864
    ds_read_b128 a[196:199], v11 offset:36864
    ds_read_b64_tr_b16 v[112:113], v7 offset:28672
    v_mfma_f32_32x32x16_bf16 v[144:159], v[120:123], a[172:175], v[144:159]
    ds_read_b128 a[200:203], v12 offset:36864
    ds_read_b128 a[204:207], v13 offset:36864
    ds_read_b64_tr_b16 v[114:115], v7 offset:28928
    v_mfma_f32_32x32x16_bf16 v[160:175], v[124:127], a[44:47], v[160:175]
    s_add_u32 m0, s79, 0x8000
    s_add_u32 s80, s66, 0x300
    s_waitcnt lgkmcnt(1)
    buffer_load_dwordx4 v8, s[28:31], s80 offen lds
    v_mfma_f32_32x32x16_bf16 v[176:191], v[124:127], a[172:175], v[176:191]
    ds_read_b64_tr_b16 v[116:117], v7 offset:29184
    ds_read_b64_tr_b16 v[118:119], v7 offset:29440
    v_mfma_f32_32x32x16_bf16 v[128:143], v[96:99], a[48:51], v[128:143]
    s_add_u32 m0, s79, 0x8400
    s_add_u32 s80, s66, 0x2300
    buffer_load_dwordx4 v9, s[28:31], s80 offen lds
    v_mfma_f32_32x32x16_bf16 v[144:159], v[96:99], a[176:179], v[144:159]
    s_add_u32 m0, s79, 0x8800
    s_add_u32 s80, s66, 0x4300
    buffer_load_dwordx4 v8, s[28:31], s80 offen lds
    v_mfma_f32_32x32x16_bf16 v[160:175], v[100:103], a[48:51], v[160:175]
    s_add_u32 m0, s79, 0x8c00
    s_add_u32 s80, s66, 0x6300
    buffer_load_dwordx4 v9, s[28:31], s80 offen lds
    v_mfma_f32_32x32x16_bf16 v[176:191], v[100:103], a[176:179], v[176:191]
    ds_read_b64_tr_b16 v[120:121], v7 offset:30720
    ds_read_b64_tr_b16 v[122:123], v7 offset:30976
    ds_read_b64_tr_b16 v[124:125], v7 offset:31232
    ds_read_b64_tr_b16 v[126:127], v7 offset:31488
    s_waitcnt vmcnt(12) lgkmcnt(0)
    s_barrier
    v_add_u32 v7, s54, v6
    v_mfma_f32_32x32x16_bf16 v[128:143], v[104:107], a[52:55], v[128:143]
    s_add_u32 m0, s79, 0x9000
    s_add_u32 s80, s66, 0x8300
    buffer_load_dwordx4 v8, s[28:31], s80 offen lds
    v_mfma_f32_32x32x16_bf16 v[144:159], v[104:107], a[180:183], v[144:159]
    s_add_u32 m0, s79, 0x9400
    s_add_u32 s80, s66, 0xa300
    buffer_load_dwordx4 v9, s[28:31], s80 offen lds
    v_mfma_f32_32x32x16_bf16 v[160:175], v[108:111], a[52:55], v[160:175]
    s_add_u32 m0, s79, 0x9800
    s_add_u32 s80, s66, 0xc300
    buffer_load_dwordx4 v8, s[28:31], s80 offen lds
    v_mfma_f32_32x32x16_bf16 v[176:191], v[108:111], a[180:183], v[176:191]
    ds_read_b64_tr_b16 v[96:97], v7
    ds_read_b64_tr_b16 v[98:99], v7 offset:256
    ds_read_b64_tr_b16 v[100:101], v7 offset:512
    ds_read_b64_tr_b16 v[102:103], v7 offset:768
    v_mfma_f32_32x32x16_bf16 v[128:143], v[112:115], a[56:59], v[128:143]
    s_add_u32 m0, s79, 0x9c00
    s_add_u32 s80, s66, 0xe300
    buffer_load_dwordx4 v9, s[28:31], s80 offen lds
    v_mfma_f32_32x32x16_bf16 v[144:159], v[112:115], a[184:187], v[144:159]
    s_cmp_gt_i32 s52, 0
    s_cselect_b32 s65, s51, 0x40000000
    s_sub_u32 s52, s52, 1
    s_add_u32 s68, s65, s73
    ds_read_b64_tr_b16 v[104:105], v7 offset:2048
    v_mfma_f32_32x32x16_bf16 v[160:175], v[116:119], a[56:59], v[160:175]
    s_add_u32 m0, s53, 0
    s_nop 0
    buffer_load_dwordx4 v2, s[32:35], s65 offen lds
    v_mfma_f32_32x32x16_bf16 v[176:191], v[116:119], a[184:187], v[176:191]
    ds_read_b64_tr_b16 v[106:107], v7 offset:2304
    ds_read_b64_tr_b16 v[108:109], v7 offset:2560
    ds_read_b64_tr_b16 v[110:111], v7 offset:2816
    v_mfma_f32_32x32x16_bf16 v[128:143], v[120:123], a[60:63], v[128:143]
    s_add_u32 m0, s53, 0x400
    s_nop 0
    buffer_load_dwordx4 v3, s[32:35], s65 offen lds
    v_mfma_f32_32x32x16_bf16 v[144:159], v[120:123], a[188:191], v[144:159]
    s_add_u32 m0, s53, 0x800
    s_nop 0
    buffer_load_dwordx4 v4, s[32:35], s65 offen lds
    v_mfma_f32_32x32x16_bf16 v[160:175], v[124:127], a[60:63], v[160:175]
    s_add_u32 m0, s53, 0xc00
    s_nop 0
    buffer_load_dwordx4 v5, s[32:35], s65 offen lds
    v_mfma_f32_32x32x16_bf16 v[176:191], v[124:127], a[188:191], v[176:191]
    s_add_u32 m0, s53, 0x1000
    s_nop 0
    buffer_load_dwordx4 v2, s[32:35], s68 offen lds
    s_add_u32 m0, s53, 0x1400
    s_nop 0
    buffer_load_dwordx4 v3, s[32:35], s68 offen lds
    s_add_u32 m0, s53, 0x1800
    s_nop 0
    buffer_load_dwordx4 v4, s[32:35], s68 offen lds
    s_add_u32 m0, s53, 0x1c00
    s_nop 0
    buffer_load_dwordx4 v5, s[32:35], s68 offen lds
    s_add_u32 s51, s51, s74
    s_add_u32 s53, s53, 0x8000
    s_sub_u32 s57, s53, 0x28000
    s_cmp_ge_u32 s53, 0x28000
    s_cselect_b32 s53, s57, s53
    s_waitcnt vmcnt(16)
    ds_read_b128 a[80:83], v32
    ds_read_b128 a[84:87], v33
    ds_read_b128 a[88:91], v34
    ds_read_b128 a[92:95], v35
    ds_read_b64_tr_b16 v[112:113], v7 offset:4096
    ds_read_b128 a[208:211], v32 offset:4096
    ds_read_b128 a[212:215], v33 offset:4096
    ds_read_b64_tr_b16 v[114:115], v7 offset:4352
    ds_read_b64_tr_b16 v[116:117], v7 offset:4608
    ds_read_b128 a[216:219], v34 offset:4096
    ds_read_b128 a[220:223], v35 offset:4096
    ds_read_b64_tr_b16 v[118:119], v7 offset:4864
    s_waitcnt lgkmcnt(15)
    v_mfma_f32_32x32x16_bf16 v[128:143], v[96:99], a[64:67], v[128:143]
    s_add_u32 m0, s79, 0x10000
    s_add_u32 s80, s66, 0x380
    s_waitcnt lgkmcnt(1)
    buffer_load_dwordx4 v8, s[28:31], s80 offen lds
    v_mfma_f32_32x32x16_bf16 v[144:159], v[96:99], a[192:195], v[144:159]
    ds_read_b64_tr_b16 v[120:121], v7 offset:6144
    ds_read_b64_tr_b16 v[122:123], v7 offset:6400
    ds_read_b64_tr_b16 v[124:125], v7 offset:6656
    v_mfma_f32_32x32x16_bf16 v[160:175], v[100:103], a[64:67], v[160:175]
    s_add_u32 m0, s79, 0x10400
    s_add_u32 s80, s66, 0x2380
    buffer_load_dwordx4 v9, s[28:31], s80 offen lds
    v_mfma_f32_32x32x16_bf16 v[176:191], v[100:103], a[192:195], v[176:191]
    ds_read_b64_tr_b16 v[126:127], v7 offset:6912
    v_mfma_f32_32x32x16_bf16 v[128:143], v[104:107], a[68:71], v[128:143]
    s_add_u32 m0, s79, 0x10800
    s_add_u32 s80, s66, 0x4380
    buffer_load_dwordx4 v8, s[28:31], s80 offen lds
    v_mfma_f32_32x32x16_bf16 v[144:159], v[104:107], a[196:199], v[144:159]
    s_add_u32 m0, s79, 0x10c00
    s_add_u32 s80, s66, 0x6380
    buffer_load_dwordx4 v9, s[28:31], s80 offen lds
    v_mfma_f32_32x32x16_bf16 v[160:175], v[108:111], a[68:71], v[160:175]
    s_add_u32 m0, s79, 0x11000
    s_add_u32 s80, s66, 0x8380
    buffer_load_dwordx4 v8, s[28:31], s80 offen lds
    v_mfma_f32_32x32x16_bf16 v[176:191], v[108:111], a[196:199], v[176:191]
    ds_read_b64_tr_b16 v[96:97], v7 offset:8192
    ds_read_b64_tr_b16 v[98:99], v7 offset:8448
    ds_read_b64_tr_b16 v[100:101], v7 offset:8704
    ds_read_b64_tr_b16 v[102:103], v7 offset:8960
    s_waitcnt lgkmcnt(8)
    v_mfma_f32_32x32x16_bf16 v[128:143], v[112:115], a[72:75], v[128:143]
    s_add_u32 m0, s79, 0x11400
    s_add_u32 s80, s66, 0xa380
    buffer_load_dwordx4 v9, s[28:31], s80 offen lds
    v_mfma_f32_32x32x16_bf16 v[144:159], v[112:115], a[200:203], v[144:159]
    s_add_u32 m0, s79, 0x11800
    s_add_u32 s80, s66, 0xc380
    buffer_load_dwordx4 v8, s[28:31], s80 offen lds
    s_add_u32 m0, s79, 0x11c00
    s_add_u32 s80, s66, 0xe380
    buffer_load_dwordx4 v9, s[28:31], s80 offen lds
    v_mfma_f32_32x32x16_bf16 v[160:175], v[116:119], a[72:75], v[160:175]
    ds_read_b64_tr_b16 v[104:105], v7 offset:10240
    ds_read_b64_tr_b16 v[106:107], v7 offset:10496
    ds_read_b64_tr_b16 v[108:109], v7 offset:10752
    v_mfma_f32_32x32x16_bf16 v[176:191], v[116:119], a[200:203], v[176:191]
    ds_read_b64_tr_b16 v[110:111], v7 offset:11008
    s_waitcnt vmcnt(16)
    ds_read_b128 a[96:99], v10 offset:32768
    ds_read_b128 a[100:103], v11 offset:32768
    s_waitcnt lgkmcnt(10)
    v_mfma_f32_32x32x16_bf16 v[128:143], v[120:123], a[76:79], v[128:143]
    ds_read_b128 a[104:107], v12 offset:32768
    ds_read_b128 a[108:111], v13 offset:32768
    ds_read_b64_tr_b16 v[112:113], v7 offset:12288
    v_mfma_f32_32x32x16_bf16 v[144:159], v[120:123], a[204:207], v[144:159]
    ds_read_b128 a[224:227], v10 offset:36864
    ds_read_b128 a[228:231], v11 offset:36864
    ds_read_b64_tr_b16 v[114:115], v7 offset:12544
    v_mfma_f32_32x32x16_bf16 v[160:175], v[124:127], a[76:79], v[160:175]
    ds_read_b64_tr_b16 v[116:117], v7 offset:12800
    ds_read_b128 a[232:235], v12 offset:36864
    ds_read_b128 a[236:239], v13 offset:36864
    v_mfma_f32_32x32x16_bf16 v[176:191], v[124:127], a[204:207], v[176:191]
    ds_read_b64_tr_b16 v[118:119], v7 offset:13056
    s_add_u32 s54, s54, 0x8000
    s_cmp_ge_u32 s54, 0x28000
    s_cselect_b32 s54, 0, s54
    s_waitcnt lgkmcnt(15)
    v_mfma_f32_32x32x16_bf16 v[128:143], v[96:99], a[80:83], v[128:143]
    ds_read_b64_tr_b16 v[120:121], v7 offset:14336
    ds_read_b64_tr_b16 v[122:123], v7 offset:14592
    ds_read_b64_tr_b16 v[124:125], v7 offset:14848
    v_mfma_f32_32x32x16_bf16 v[144:159], v[96:99], a[208:211], v[144:159]
    ds_read_b64_tr_b16 v[126:127], v7 offset:15104
    v_mfma_f32_32x32x16_bf16 v[160:175], v[100:103], a[80:83], v[160:175]
    s_waitcnt lgkmcnt(0)
    s_barrier
    v_mfma_f32_32x32x16_bf16 v[176:191], v[100:103], a[208:211], v[176:191]
    s_cmp_gt_i32 s52, 0
    s_cselect_b32 s65, s51, 0x40000000
    s_sub_u32 s52, s52, 1
    s_add_u32 s68, s65, s73
    v_mfma_f32_32x32x16_bf16 v[128:143], v[104:107], a[84:87], v[128:143]
    s_add_u32 m0, s53, 0
    s_nop 0
    buffer_load_dwordx4 v2, s[32:35], s65 offen lds
    v_mfma_f32_32x32x16_bf16 v[144:159], v[104:107], a[212:215], v[144:159]
    s_add_u32 m0, s53, 0x400
    s_nop 0
    buffer_load_dwordx4 v3, s[32:35], s65 offen lds
    v_mfma_f32_32x32x16_bf16 v[160:175], v[108:111], a[84:87], v[160:175]
    s_add_u32 m0, s53, 0x800
    s_nop 0
    buffer_load_dwordx4 v4, s[32:35], s65 offen lds
    v_mfma_f32_32x32x16_bf16 v[176:191], v[108:111], a[212:215], v[176:191]
    ds_read_b64_tr_b16 v[96:97], v7 offset:16384
    ds_read_b64_tr_b16 v[98:99], v7 offset:16640
    ds_read_b64_tr_b16 v[100:101], v7 offset:16896
    ds_read_b64_tr_b16 v[102:103], v7 offset:17152
    v_mfma_f32_32x32x16_bf16 v[128:143], v[112:115], a[88:91], v[128:143]
    s_add_u32 m0, s53, 0xc00
    s_nop 0
    buffer_load_dwordx4 v5, s[32:35], s65 offen lds
    v_mfma_f32_32x32x16_bf16 v[144:159], v[112:115], a[216:219], v[144:159]
    s_add_u32 m0, s53, 0x1000
    s_nop 0
    buffer_load_dwordx4 v2, s[32:35], s68 offen lds
    v_mfma_f32_32x32x16_bf16 v[160:175], v[116:119], a[88:91], v[160:175]
    s_add_u32 m0, s53, 0x1400
    s_nop 0
    buffer_load_dwordx4 v3, s[32:35], s68 offen lds
    v_mfma_f32_32x32x16_bf16 v[176:191], v[116:119], a[216:219], v[176:191]
    ds_read_b64_tr_b16 v[104:105], v7 offset:18432
    ds_read_b64_tr_b16 v[106:107], v7 offset:18688
    ds_read_b64_tr_b16 v[108:109], v7 offset:18944
    ds_read_b64_tr_b16 v[110:111], v7 offset:19200
    v_mfma_f32_32x32x16_bf16 v[128:143], v[120:123], a[92:95], v[128:143]
    s_add_u32 m0, s53, 0x1800
    s_nop 0
    buffer_load_dwordx4 v4, s[32:35], s68 offen lds
    v_mfma_f32_32x32x16_bf16 v[144:159], v[120:123], a[220:223], v[144:159]
    s_add_u32 m0, s53, 0x1c00
    s_nop 0
    buffer_load_dwordx4 v5, s[32:35], s68 offen lds
    v_mfma_f32_32x32x16_bf16 v[160:175], v[124:127], a[92:95], v[160:175]
    s_add_u32 s51, s51, s75
    s_add_u32 s53, s53, 0x8000
    s_sub_u32 s57, s53, 0x28000
    s_cmp_ge_u32 s53, 0x28000
    s_cselect_b32 s53, s57, s53
    v_mfma_f32_32x32x16_bf16 v[176:191], v[124:127], a[220:223], v[176:191]
    s_waitcnt vmcnt(8)
    ds_read_b128 a[112:115], v32
    ds_read_b128 a[116:119], v33
    ds_read_b128 a[120:123], v34
    ds_read_b128 a[124:127], v35
    ds_read_b64_tr_b16 v[112:113], v7 offset:20480
    ds_read_b128 a[240:243], v32 offset:4096
    ds_read_b128 a[244:247], v33 offset:4096
    ds_read_b64_tr_b16 v[114:115], v7 offset:20736
    ds_read_b64_tr_b16 v[116:117], v7 offset:20992
    ds_read_b128 a[248:251], v34 offset:4096
    ds_read_b128 a[252:255], v35 offset:4096
    ds_read_b64_tr_b16 v[118:119], v7 offset:21248
    s_waitcnt lgkmcnt(15)
    v_mfma_f32_32x32x16_bf16 v[128:143], v[96:99], a[96:99], v[128:143]
    ds_read_b64_tr_b16 v[120:121], v7 offset:22528
    ds_read_b64_tr_b16 v[122:123], v7 offset:22784
    ds_read_b64_tr_b16 v[124:125], v7 offset:23040
    v_mfma_f32_32x32x16_bf16 v[144:159], v[96:99], a[224:227], v[144:159]
    ds_read_b64_tr_b16 v[126:127], v7 offset:23296
    v_mfma_f32_32x32x16_bf16 v[160:175], v[100:103], a[96:99], v[160:175]
    v_mfma_f32_32x32x16_bf16 v[176:191], v[100:103], a[224:227], v[176:191]
    s_waitcnt lgkmcnt(15)
    v_mfma_f32_32x32x16_bf16 v[128:143], v[104:107], a[100:103], v[128:143]
    ds_read_b64_tr_b16 v[96:97], v7 offset:24576
    ds_read_b64_tr_b16 v[98:99], v7 offset:24832
    ds_read_b64_tr_b16 v[100:101], v7 offset:25088
    v_mfma_f32_32x32x16_bf16 v[144:159], v[104:107], a[228:231], v[144:159]
    ds_read_b64_tr_b16 v[102:103], v7 offset:25344
    v_mfma_f32_32x32x16_bf16 v[160:175], v[108:111], a[100:103], v[160:175]
    v_mfma_f32_32x32x16_bf16 v[176:191], v[108:111], a[228:231], v[176:191]
    s_waitcnt lgkmcnt(8)
    v_mfma_f32_32x32x16_bf16 v[128:143], v[112:115], a[104:107], v[128:143]
    ds_read_b64_tr_b16 v[104:105], v7 offset:26624
    ds_read_b64_tr_b16 v[106:107], v7 offset:26880
    ds_read_b64_tr_b16 v[108:109], v7 offset:27136
    v_mfma_f32_32x32x16_bf16 v[144:159], v[112:115], a[232:235], v[144:159]
    ds_read_b64_tr_b16 v[110:111], v7 offset:27392
    v_mfma_f32_32x32x16_bf16 v[160:175], v[116:119], a[104:107], v[160:175]
    v_mfma_f32_32x32x16_bf16 v[176:191], v[116:119], a[232:235], v[176:191]
    s_waitcnt lgkmcnt(8)
    v_mfma_f32_32x32x16_bf16 v[128:143], v[120:123], a[108:111], v[128:143]
    ds_read_b64_tr_b16 v[112:113], v7 offset:28672
    ds_read_b64_tr_b16 v[114:115], v7 offset:28928
    ds_read_b64_tr_b16 v[116:117], v7 offset:29184
    v_mfma_f32_32x32x16_bf16 v[144:159], v[120:123], a[236:239], v[144:159]
    ds_read_b64_tr_b16 v[118:119], v7 offset:29440
    v_mfma_f32_32x32x16_bf16 v[160:175], v[124:127], a[108:111], v[160:175]
    v_mfma_f32_32x32x16_bf16 v[176:191], v[124:127], a[236:239], v[176:191]
    s_waitcnt lgkmcnt(8)
    v_mfma_f32_32x32x16_bf16 v[128:143], v[96:99], a[112:115], v[128:143]
    ds_read_b64_tr_b16 v[120:121], v7 offset:30720
    ds_read_b64_tr_b16 v[122:123], v7 offset:30976
    ds_read_b64_tr_b16 v[124:125], v7 offset:31232
    v_mfma_f32_32x32x16_bf16 v[144:159], v[96:99], a[240:243], v[144:159]
    ds_read_b64_tr_b16 v[126:127], v7 offset:31488
    v_mfma_f32_32x32x16_bf16 v[160:175], v[100:103], a[112:115], v[160:175]
    v_mfma_f32_32x32x16_bf16 v[176:191], v[100:103], a[240:243], v[176:191]
    s_waitcnt lgkmcnt(0)
    s_barrier
    v_add_u32 v7, s54, v6
    v_mfma_f32_32x32x16_bf16 v[128:143], v[104:107], a[116:119], v[128:143]
    s_cmp_gt_i32 s52, 0
    s_cselect_b32 s65, s51, 0x40000000
    ds_read_b64_tr_b16 v[96:97], v7
    s_sub_u32 s52, s52, 1
    s_add_u32 s68, s65, s73
    v_mfma_f32_32x32x16_bf16 v[144:159], v[104:107], a[244:247], v[144:159]
    ds_read_b64_tr_b16 v[98:99], v7 offset:256
    ds_read_b64_tr_b16 v[100:101], v7 offset:512
    ds_read_b64_tr_b16 v[102:103], v7 offset:768
    v_mfma_f32_32x32x16_bf16 v[160:175], v[108:111], a[116:119], v[160:175]
    s_add_u32 m0, s53, 0
    s_nop 0
    buffer_load_dwordx4 v2, s[32:35], s65 offen lds
    v_mfma_f32_32x32x16_bf16 v[176:191], v[108:111], a[244:247], v[176:191]
    s_add_u32 m0, s53, 0x400
    s_nop 0
    buffer_load_dwordx4 v3, s[32:35], s65 offen lds
    v_mfma_f32_32x32x16_bf16 v[128:143], v[112:115], a[120:123], v[128:143]
    s_add_u32 m0, s53, 0x800
    s_nop 0
    buffer_load_dwordx4 v4, s[32:35], s65 offen lds
    v_mfma_f32_32x32x16_bf16 v[144:159], v[112:115], a[248:251], v[144:159]
    s_add_u32 m0, s53, 0xc00
    s_nop 0
    buffer_load_dwordx4 v5, s[32:35], s65 offen lds
    v_mfma_f32_32x32x16_bf16 v[160:175], v[116:119], a[120:123], v[160:175]
    ds_read_b64_tr_b16 v[104:105], v7 offset:2048
    ds_read_b64_tr_b16 v[106:107], v7 offset:2304
    ds_read_b64_tr_b16 v[108:109], v7 offset:2560
    ds_read_b64_tr_b16 v[110:111], v7 offset:2816
    v_mfma_f32_32x32x16_bf16 v[176:191], v[116:119], a[248:251], v[176:191]
    s_add_u32 m0, s53, 0x1000
    s_nop 0
    buffer_load_dwordx4 v2, s[32:35], s68 offen lds
    v_mfma_f32_32x32x16_bf16 v[128:143], v[120:123], a[124:127], v[128:143]
    s_add_u32 m0, s53, 0x1400
    s_nop 0
    buffer_load_dwordx4 v3, s[32:35], s68 offen lds
    ds_read_b64_tr_b16 v[112:113], v7 offset:4096
    v_mfma_f32_32x32x16_bf16 v[144:159], v[120:123], a[252:255], v[144:159]
    s_add_u32 m0, s53, 0x1800
    s_nop 0
    buffer_load_dwordx4 v4, s[32:35], s68 offen lds
    ds_read_b64_tr_b16 v[114:115], v7 offset:4352
    v_mfma_f32_32x32x16_bf16 v[160:175], v[124:127], a[124:127], v[160:175]
    s_add_u32 m0, s53, 0x1c00
    s_nop 0
    buffer_load_dwordx4 v5, s[32:35], s68 offen lds
    s_add_u32 s51, s51, s74
    s_add_u32 s53, s53, 0x8000
    v_mfma_f32_32x32x16_bf16 v[176:191], v[124:127], a[252:255], v[176:191]
    ds_read_b64_tr_b16 v[116:117], v7 offset:4608
    s_sub_u32 s57, s53, 0x28000
    s_cmp_ge_u32 s53, 0x28000
    s_cselect_b32 s53, s57, s53
    ds_read_b64_tr_b16 v[118:119], v7 offset:4864
    s_lshr_b32 s55, s48, 1
    s_mul_i32 s55, s55, s76
    s_and_b32 s56, s48, 1
    s_lshl_b32 s56, s56, 12
    s_add_u32 s55, s55, s56
    s_add_u32 s58, s55, s64
    s_add_u32 s59, s58, s77
    s_add_u32 s48, s48, 1
    s_sub_u32 s49, s49, 1
    s_waitcnt lgkmcnt(0)
    s_cmp_eq_u32 s49, 0
    s_cbranch_scc1 L1_QK_t0
    s_branch L1_QK_b1
L1_QK_b0:
    s_waitcnt lgkmcnt(8)
    v_mfma_f32_32x32x16_bf16 v[128:143], v[96:99], a[0:3], 0
    ds_read_b64_tr_b16 v[120:121], v7 offset:6144
    ds_read_b64_tr_b16 v[122:123], v7 offset:6400
    ds_read_b64_tr_b16 v[124:125], v7 offset:6656
    v_mfma_f32_32x32x16_bf16 v[144:159], v[96:99], a[128:131], 0
    ds_read_b64_tr_b16 v[126:127], v7 offset:6912
    s_cmp_gt_i32 s52, 0
    s_cselect_b32 s65, s51, 0x40000000
    s_sub_u32 s52, s52, 1
    s_add_u32 s68, s65, s73
    v_mfma_f32_32x32x16_bf16 v[160:175], v[100:103], a[0:3], 0
    s_add_u32 m0, s53, 0
    s_nop 0
    buffer_load_dwordx4 v2, s[32:35], s65 offen lds
    v_mfma_f32_32x32x16_bf16 v[176:191], v[100:103], a[128:131], 0
    s_add_u32 m0, s53, 0x400
    s_nop 0
    buffer_load_dwordx4 v3, s[32:35], s65 offen lds
    s_waitcnt lgkmcnt(8)
    v_mfma_f32_32x32x16_bf16 v[128:143], v[104:107], a[4:7], v[128:143]
    ds_read_b64_tr_b16 v[96:97], v7 offset:8192
    ds_read_b64_tr_b16 v[98:99], v7 offset:8448
    ds_read_b64_tr_b16 v[100:101], v7 offset:8704
    v_mfma_f32_32x32x16_bf16 v[144:159], v[104:107], a[132:135], v[144:159]
    ds_read_b64_tr_b16 v[102:103], v7 offset:8960
    v_mul_f32 v192, s62, v192
    v_mul_f32 v193, s62, v193
    v_mul_f32 v194, s62, v194
    v_mul_f32 v195, s62, v195
    v_mfma_f32_32x32x16_bf16 v[160:175], v[108:111], a[4:7], v[160:175]
    s_add_u32 m0, s53, 0x800
    s_nop 0
    buffer_load_dwordx4 v4, s[32:35], s65 offen lds
    v_mfma_f32_32x32x16_bf16 v[176:191], v[108:111], a[132:135], v[176:191]
    s_add_u32 m0, s53, 0xc00
    s_nop 0
    buffer_load_dwordx4 v5, s[32:35], s65 offen lds
    s_waitcnt lgkmcnt(8)
    v_mfma_f32_32x32x16_bf16 v[128:143], v[112:115], a[8:11], v[128:143]
    ds_read_b64_tr_b16 v[104:105], v7 offset:10240
    ds_read_b64_tr_b16 v[106:107], v7 offset:10496
    ds_read_b64_tr_b16 v[108:109], v7 offset:10752
    v_mfma_f32_32x32x16_bf16 v[144:159], v[112:115], a[136:139], v[144:159]
    ds_read_b64_tr_b16 v[110:111], v7 offset:11008
    v_mul_f32 v196, s62, v196
    v_mul_f32 v197, s62, v197
    v_mul_f32 v198, s62, v198
    v_mul_f32 v199, s62, v199
    v_mfma_f32_32x32x16_bf16 v[160:175], v[116:119], a[8:11], v[160:175]
    s_add_u32 m0, s53, 0x1000
    s_nop 0
    buffer_load_dwordx4 v2, s[32:35], s68 offen lds
    v_mfma_f32_32x32x16_bf16 v[176:191], v[116:119], a[136:139], v[176:191]
    s_add_u32 m0, s53, 0x1400
    s_nop 0
    buffer_load_dwordx4 v3, s[32:35], s68 offen lds
    s_waitcnt lgkmcnt(8)
    v_mfma_f32_32x32x16_bf16 v[128:143], v[120:123], a[12:15], v[128:143]
    ds_read_b64_tr_b16 v[112:113], v7 offset:12288
    ds_read_b64_tr_b16 v[114:115], v7 offset:12544
    ds_read_b64_tr_b16 v[116:117], v7 offset:12800
    v_mfma_f32_32x32x16_bf16 v[144:159], v[120:123], a[140:143], v[144:159]
    ds_read_b64_tr_b16 v[118:119], v7 offset:13056
    v_cvt_pk_bf16_f32 v16, v192, v193
    v_cvt_pk_bf16_f32 v17, v194, v195
    v_cvt_pk_bf16_f32 v18, v196, v197
    v_cvt_pk_bf16_f32 v19, v198, v199
    v_mfma_f32_32x32x16_bf16 v[160:175], v[124:127], a[12:15], v[160:175]
    s_add_u32 m0, s53, 0x1800
    s_nop 0
    buffer_load_dwordx4 v4, s[32:35], s68 offen lds
    v_mfma_f32_32x32x16_bf16 v[176:191], v[124:127], a[140:143], v[176:191]
    s_add_u32 m0, s53, 0x1c00
    s_nop 0
    buffer_load_dwordx4 v5, s[32:35], s68 offen lds
    s_waitcnt lgkmcnt(8)
    v_mfma_f32_32x32x16_bf16 v[128:143], v[96:99], a[16:19], v[128:143]
    ds_read_b64_tr_b16 v[120:121], v7 offset:14336
    ds_read_b64_tr_b16 v[122:123], v7 offset:14592
    ds_read_b64_tr_b16 v[124:125], v7 offset:14848
    v_mfma_f32_32x32x16_bf16 v[144:159], v[96:99], a[144:147], v[144:159]
    ds_read_b64_tr_b16 v[126:127], v7 offset:15104
    s_add_u32 s51, s51, s75
    s_add_u32 s53, s53, 0x8000
    v_mfma_f32_32x32x16_bf16 v[160:175], v[100:103], a[16:19], v[160:175]
    s_sub_u32 s57, s53, 0x28000
    s_cmp_ge_u32 s53, 0x28000
    s_cselect_b32 s53, s57, s53
    s_add_u32 s54, s54, 0x8000
    s_cmp_ge_u32 s54, 0x28000
    s_cselect_b32 s54, 0, s54
    v_mfma_f32_32x32x16_bf16 v[176:191], v[100:103], a[144:147], v[176:191]
    buffer_store_dwordx4 v[16:19], v1, s[36:39], s58 offen sc1
    v_mul_f32 v200, s62, v200
    v_mul_f32 v201, s62, v201
    s_waitcnt lgkmcnt(8)
    v_mfma_f32_32x32x16_bf16 v[128:143], v[104:107], a[20:23], v[128:143]
    ds_read_b64_tr_b16 v[96:97], v7 offset:16384
    ds_read_b64_tr_b16 v[98:99], v7 offset:16640
    ds_read_b64_tr_b16 v[100:101], v7 offset:16896
    v_mfma_f32_32x32x16_bf16 v[144:159], v[104:107], a[148:151], v[144:159]
    ds_read_b64_tr_b16 v[102:103], v7 offset:17152
    v_mul_f32 v202, s62, v202
    v_mul_f32 v203, s62, v203
    v_mul_f32 v204, s62, v204
    v_mul_f32 v205, s62, v205
    v_mfma_f32_32x32x16_bf16 v[160:175], v[108:111], a[20:23], v[160:175]
    v_mul_f32 v206, s62, v206
    v_mul_f32 v207, s62, v207
    v_cvt_pk_bf16_f32 v20, v200, v201
    v_cvt_pk_bf16_f32 v21, v202, v203
    v_cvt_pk_bf16_f32 v22, v204, v205
    v_cvt_pk_bf16_f32 v23, v206, v207
    v_mfma_f32_32x32x16_bf16 v[176:191], v[108:111], a[148:151], v[176:191]
    buffer_store_dwordx4 v[20:23], v1, s[36:39], s58 offen offset:1024 sc1
    v_mul_f32 v224, s62, v224
    v_mul_f32 v225, s62, v225
    s_waitcnt lgkmcnt(8)
    v_mfma_f32_32x32x16_bf16 v[128:143], v[112:115], a[24:27], v[128:143]
    ds_read_b64_tr_b16 v[104:105], v7 offset:18432
    ds_read_b64_tr_b16 v[106:107], v7 offset:18688
    ds_read_b64_tr_b16 v[108:109], v7 offset:18944
    v_mfma_f32_32x32x16_bf16 v[144:159], v[112:115], a[152:155], v[144:159]
    ds_read_b64_tr_b16 v[110:111], v7 offset:19200
    v_mul_f32 v226, s62, v226
    v_mul_f32 v227, s62, v227
    v_mul_f32 v228, s62, v228
    v_mul_f32 v229, s62, v229
    v_mfma_f32_32x32x16_bf16 v[160:175], v[116:119], a[24:27], v[160:175]
    v_mul_f32 v230, s62, v230
    v_mul_f32 v231, s62, v231
    v_cvt_pk_bf16_f32 v16, v224, v225
    v_cvt_pk_bf16_f32 v17, v226, v227
    v_cvt_pk_bf16_f32 v18, v228, v229
    v_cvt_pk_bf16_f32 v19, v230, v231
    v_mfma_f32_32x32x16_bf16 v[176:191], v[116:119], a[152:155], v[176:191]
    buffer_store_dwordx4 v[16:19], v1, s[36:39], s58 offen offset:2048 sc1
    v_mul_f32 v232, s62, v232
    v_mul_f32 v233, s62, v233
    s_waitcnt lgkmcnt(8)
    v_mfma_f32_32x32x16_bf16 v[128:143], v[120:123], a[28:31], v[128:143]
    ds_read_b64_tr_b16 v[112:113], v7 offset:20480
    ds_read_b64_tr_b16 v[114:115], v7 offset:20736
    ds_read_b64_tr_b16 v[116:117], v7 offset:20992
    v_mfma_f32_32x32x16_bf16 v[144:159], v[120:123], a[156:159], v[144:159]
    ds_read_b64_tr_b16 v[118:119], v7 offset:21248
    v_mul_f32 v234, s62, v234
    v_mul_f32 v235, s62, v235
    v_mul_f32 v236, s62, v236
    v_mul_f32 v237, s62, v237
    v_mfma_f32_32x32x16_bf16 v[160:175], v[124:127], a[28:31], v[160:175]
    v_mul_f32 v238, s62, v238
    v_mul_f32 v239, s62, v239
    v_cvt_pk_bf16_f32 v20, v232, v233
    v_cvt_pk_bf16_f32 v21, v234, v235
    v_cvt_pk_bf16_f32 v22, v236, v237
    v_cvt_pk_bf16_f32 v23, v238, v239
    v_mfma_f32_32x32x16_bf16 v[176:191], v[124:127], a[156:159], v[176:191]
    buffer_store_dwordx4 v[20:23], v1, s[36:39], s58 offen offset:3072 sc1
    v_mul_f32 v208, s62, v208
    v_mul_f32 v209, s62, v209
    s_waitcnt lgkmcnt(8)
    v_mfma_f32_32x32x16_bf16 v[128:143], v[96:99], a[32:35], v[128:143]
    ds_read_b64_tr_b16 v[120:121], v7 offset:22528
    ds_read_b64_tr_b16 v[122:123], v7 offset:22784
    ds_read_b64_tr_b16 v[124:125], v7 offset:23040
    v_mfma_f32_32x32x16_bf16 v[144:159], v[96:99], a[160:163], v[144:159]
    ds_read_b64_tr_b16 v[126:127], v7 offset:23296
    v_mul_f32 v210, s62, v210
    v_mul_f32 v211, s62, v211
    v_mul_f32 v212, s62, v212
    v_mul_f32 v213, s62, v213
    v_mfma_f32_32x32x16_bf16 v[160:175], v[100:103], a[32:35], v[160:175]
    v_mul_f32 v214, s62, v214
    v_mul_f32 v215, s62, v215
    v_cvt_pk_bf16_f32 v16, v208, v209
    v_cvt_pk_bf16_f32 v17, v210, v211
    v_cvt_pk_bf16_f32 v18, v212, v213
    v_cvt_pk_bf16_f32 v19, v214, v215
    v_mfma_f32_32x32x16_bf16 v[176:191], v[100:103], a[160:163], v[176:191]
    buffer_store_dwordx4 v[16:19], v1, s[36:39], s59 offen sc1
    v_mul_f32 v216, s62, v216
    v_mul_f32 v217, s62, v217
    s_waitcnt lgkmcnt(8)
    v_mfma_f32_32x32x16_bf16 v[128:143], v[104:107], a[36:39], v[128:143]
    ds_read_b64_tr_b16 v[96:97], v7 offset:24576
    ds_read_b64_tr_b16 v[98:99], v7 offset:24832
    ds_read_b64_tr_b16 v[100:101], v7 offset:25088
    v_mfma_f32_32x32x16_bf16 v[144:159], v[104:107], a[164:167], v[144:159]
    ds_read_b64_tr_b16 v[102:103], v7 offset:25344
    v_mul_f32 v218, s62, v218
    v_mul_f32 v219, s62, v219
    v_mul_f32 v220, s62, v220
    v_mul_f32 v221, s62, v221
    v_mfma_f32_32x32x16_bf16 v[160:175], v[108:111], a[36:39], v[160:175]
    v_mul_f32 v222, s62, v222
    v_mul_f32 v223, s62, v223
    v_cvt_pk_bf16_f32 v20, v216, v217
    v_cvt_pk_bf16_f32 v21, v218, v219
    v_cvt_pk_bf16_f32 v22, v220, v221
    v_cvt_pk_bf16_f32 v23, v222, v223
    v_mfma_f32_32x32x16_bf16 v[176:191], v[108:111], a[164:167], v[176:191]
    buffer_store_dwordx4 v[20:23], v1, s[36:39], s59 offen offset:1024 sc1
    v_mul_f32 v240, s62, v240
    v_mul_f32 v241, s62, v241
    s_waitcnt lgkmcnt(8)
    v_mfma_f32_32x32x16_bf16 v[128:143], v[112:115], a[40:43], v[128:143]
    ds_read_b64_tr_b16 v[104:105], v7 offset:26624
    ds_read_b64_tr_b16 v[106:107], v7 offset:26880
    ds_read_b64_tr_b16 v[108:109], v7 offset:27136
    v_mfma_f32_32x32x16_bf16 v[144:159], v[112:115], a[168:171], v[144:159]
    ds_read_b64_tr_b16 v[110:111], v7 offset:27392
    v_mul_f32 v242, s62, v242
    v_mul_f32 v243, s62, v243
    v_mul_f32 v244, s62, v244
    v_mul_f32 v245, s62, v245
    v_mfma_f32_32x32x16_bf16 v[160:175], v[116:119], a[40:43], v[160:175]
    v_mul_f32 v246, s62, v246
    v_mul_f32 v247, s62, v247
    v_cvt_pk_bf16_f32 v16, v240, v241
    v_cvt_pk_bf16_f32 v17, v242, v243
    v_cvt_pk_bf16_f32 v18, v244, v245
    v_cvt_pk_bf16_f32 v19, v246, v247
    v_mfma_f32_32x32x16_bf16 v[176:191], v[116:119], a[168:171], v[176:191]
    buffer_store_dwordx4 v[16:19], v1, s[36:39], s59 offen offset:2048 sc1
    v_mul_f32 v248, s62, v248
    v_mul_f32 v249, s62, v249
    s_waitcnt lgkmcnt(8)
    v_mfma_f32_32x32x16_bf16 v[128:143], v[120:123], a[44:47], v[128:143]
    ds_read_b64_tr_b16 v[112:113], v7 offset:28672
    ds_read_b64_tr_b16 v[114:115], v7 offset:28928
    ds_read_b64_tr_b16 v[116:117], v7 offset:29184
    v_mfma_f32_32x32x16_bf16 v[144:159], v[120:123], a[172:175], v[144:159]
    ds_read_b64_tr_b16 v[118:119], v7 offset:29440
    v_mul_f32 v250, s62, v250
    v_mul_f32 v251, s62, v251
    v_mul_f32 v252, s62, v252
    v_mul_f32 v253, s62, v253
    v_mfma_f32_32x32x16_bf16 v[160:175], v[124:127], a[44:47], v[160:175]
    v_mul_f32 v254, s62, v254
    v_mul_f32 v255, s62, v255
    v_cvt_pk_bf16_f32 v20, v248, v249
    v_cvt_pk_bf16_f32 v21, v250, v251
    v_cvt_pk_bf16_f32 v22, v252, v253
    v_cvt_pk_bf16_f32 v23, v254, v255
    v_mfma_f32_32x32x16_bf16 v[176:191], v[124:127], a[172:175], v[176:191]
    buffer_store_dwordx4 v[20:23], v1, s[36:39], s59 offen offset:3072 sc1
    s_waitcnt lgkmcnt(8)
    v_mfma_f32_32x32x16_bf16 v[128:143], v[96:99], a[48:51], v[128:143]
    ds_read_b64_tr_b16 v[120:121], v7 offset:30720
    ds_read_b64_tr_b16 v[122:123], v7 offset:30976
    ds_read_b64_tr_b16 v[124:125], v7 offset:31232
    v_mfma_f32_32x32x16_bf16 v[144:159], v[96:99], a[176:179], v[144:159]
    ds_read_b64_tr_b16 v[126:127], v7 offset:31488
    v_mfma_f32_32x32x16_bf16 v[160:175], v[100:103], a[48:51], v[160:175]
    v_mfma_f32_32x32x16_bf16 v[176:191], v[100:103], a[176:179], v[176:191]
    s_waitcnt vmcnt(16)
    s_barrier
    v_add_u32 v7, s54, v6
    s_waitcnt lgkmcnt(8)
    v_mfma_f32_32x32x16_bf16 v[128:143], v[104:107], a[52:55], v[128:143]
    ds_read_b64_tr_b16 v[96:97], v7
    ds_read_b64_tr_b16 v[98:99], v7 offset:256
    ds_read_b64_tr_b16 v[100:101], v7 offset:512
    v_mfma_f32_32x32x16_bf16 v[144:159], v[104:107], a[180:183], v[144:159]
    ds_read_b64_tr_b16 v[102:103], v7 offset:768
    global_load_dword v45, v44, s[84:85]
    v_mfma_f32_32x32x16_bf16 v[160:175], v[108:111], a[52:55], v[160:175]
    s_mov_b64 s[84:85], s[86:87]
    s_mov_b64 s[86:87], s[88:89]
    s_mov_b64 s[88:89], s[90:91]
    s_mov_b64 s[90:91], s[92:93]
    s_cmp_gt_i32 s52, 0
    s_cselect_b32 s65, s51, 0x40000000
    v_mfma_f32_32x32x16_bf16 v[176:191], v[108:111], a[180:183], v[176:191]
    s_sub_u32 s52, s52, 1
    s_add_u32 s68, s65, s73
    s_waitcnt lgkmcnt(8)
    v_mfma_f32_32x32x16_bf16 v[128:143], v[112:115], a[56:59], v[128:143]
    ds_read_b64_tr_b16 v[104:105], v7 offset:2048
    ds_read_b64_tr_b16 v[106:107], v7 offset:2304
    ds_read_b64_tr_b16 v[108:109], v7 offset:2560
    v_mfma_f32_32x32x16_bf16 v[144:159], v[112:115], a[184:187], v[144:159]
    ds_read_b64_tr_b16 v[110:111], v7 offset:2816
    v_mfma_f32_32x32x16_bf16 v[160:175], v[116:119], a[56:59], v[160:175]
    s_add_u32 m0, s53, 0
    s_nop 0
    buffer_load_dwordx4 v2, s[32:35], s65 offen lds
    v_mfma_f32_32x32x16_bf16 v[176:191], v[116:119], a[184:187], v[176:191]
    s_add_u32 m0, s53, 0x400
    s_nop 0
    buffer_load_dwordx4 v3, s[32:35], s65 offen lds
    s_waitcnt lgkmcnt(8)
    v_mfma_f32_32x32x16_bf16 v[128:143], v[120:123], a[60:63], v[128:143]
    ds_read_b64_tr_b16 v[112:113], v7 offset:4096
    ds_read_b64_tr_b16 v[114:115], v7 offset:4352
    ds_read_b64_tr_b16 v[116:117], v7 offset:4608
    v_mfma_f32_32x32x16_bf16 v[144:159], v[120:123], a[188:191], v[144:159]
    ds_read_b64_tr_b16 v[118:119], v7 offset:4864
    v_mfma_f32_32x32x16_bf16 v[160:175], v[124:127], a[60:63], v[160:175]
    s_add_u32 m0, s53, 0x800
    s_nop 0
    buffer_load_dwordx4 v4, s[32:35], s65 offen lds
    v_mfma_f32_32x32x16_bf16 v[176:191], v[124:127], a[188:191], v[176:191]
    s_add_u32 m0, s53, 0xc00
    s_nop 0
    buffer_load_dwordx4 v5, s[32:35], s65 offen lds
    s_waitcnt lgkmcnt(8)
    v_mfma_f32_32x32x16_bf16 v[128:143], v[96:99], a[64:67], v[128:143]
    ds_read_b64_tr_b16 v[120:121], v7 offset:6144
    ds_read_b64_tr_b16 v[122:123], v7 offset:6400
    ds_read_b64_tr_b16 v[124:125], v7 offset:6656
    v_mfma_f32_32x32x16_bf16 v[144:159], v[96:99], a[192:195], v[144:159]
    ds_read_b64_tr_b16 v[126:127], v7 offset:6912
    v_mfma_f32_32x32x16_bf16 v[160:175], v[100:103], a[64:67], v[160:175]
    s_add_u32 m0, s53, 0x1000
    s_nop 0
    buffer_load_dwordx4 v2, s[32:35], s68 offen lds
    v_mfma_f32_32x32x16_bf16 v[176:191], v[100:103], a[192:195], v[176:191]
    s_add_u32 m0, s53, 0x1400
    s_nop 0
    buffer_load_dwordx4 v3, s[32:35], s68 offen lds
    s_waitcnt lgkmcnt(8)
    v_mfma_f32_32x32x16_bf16 v[128:143], v[104:107], a[68:71], v[128:143]
    ds_read_b64_tr_b16 v[96:97], v7 offset:8192
    ds_read_b64_tr_b16 v[98:99], v7 offset:8448
    ds_read_b64_tr_b16 v[100:101], v7 offset:8704
    v_mfma_f32_32x32x16_bf16 v[144:159], v[104:107], a[196:199], v[144:159]
    ds_read_b64_tr_b16 v[102:103], v7 offset:8960
    v_mfma_f32_32x32x16_bf16 v[160:175], v[108:111], a[68:71], v[160:175]
    s_add_u32 m0, s53, 0x1800
    s_nop 0
    buffer_load_dwordx4 v4, s[32:35], s68 offen lds
    v_mfma_f32_32x32x16_bf16 v[176:191], v[108:111], a[196:199], v[176:191]
    s_add_u32 m0, s53, 0x1c00
    s_nop 0
    buffer_load_dwordx4 v5, s[32:35], s68 offen lds
    s_waitcnt lgkmcnt(8)
    v_mfma_f32_32x32x16_bf16 v[128:143], v[112:115], a[72:75], v[128:143]
    ds_read_b64_tr_b16 v[104:105], v7 offset:10240
    ds_read_b64_tr_b16 v[106:107], v7 offset:10496
    ds_read_b64_tr_b16 v[108:109], v7 offset:10752
    v_mfma_f32_32x32x16_bf16 v[144:159], v[112:115], a[200:203], v[144:159]
    ds_read_b64_tr_b16 v[110:111], v7 offset:11008
    s_add_u32 s51, s51, s74
    s_add_u32 s53, s53, 0x8000
    v_mfma_f32_32x32x16_bf16 v[160:175], v[116:119], a[72:75], v[160:175]
    s_sub_u32 s57, s53, 0x28000
    s_cmp_ge_u32 s53, 0x28000
    s_cselect_b32 s53, s57, s53
    v_mfma_f32_32x32x16_bf16 v[176:191], v[116:119], a[200:203], v[176:191]
    s_add_u32 s54, s54, 0x8000
    s_cmp_ge_u32 s54, 0x28000
    s_cselect_b32 s54, 0, s54
    s_waitcnt lgkmcnt(8)
    v_mfma_f32_32x32x16_bf16 v[128:143], v[120:123], a[76:79], v[128:143]
    ds_read_b64_tr_b16 v[112:113], v7 offset:12288
    ds_read_b64_tr_b16 v[114:115], v7 offset:12544
    ds_read_b64_tr_b16 v[116:117], v7 offset:12800
    v_mfma_f32_32x32x16_bf16 v[144:159], v[120:123], a[204:207], v[144:159]
    ds_read_b64_tr_b16 v[118:119], v7 offset:13056
    v_mfma_f32_32x32x16_bf16 v[160:175], v[124:127], a[76:79], v[160:175]
    v_mfma_f32_32x32x16_bf16 v[176:191], v[124:127], a[204:207], v[176:191]
    s_waitcnt lgkmcnt(8)
    v_mfma_f32_32x32x16_bf16 v[128:143], v[96:99], a[80:83], v[128:143]
    ds_read_b64_tr_b16 v[120:121], v7 offset:14336
    ds_read_b64_tr_b16 v[122:123], v7 offset:14592
    ds_read_b64_tr_b16 v[124:125], v7 offset:14848
    v_mfma_f32_32x32x16_bf16 v[144:159], v[96:99], a[208:211], v[144:159]
    ds_read_b64_tr_b16 v[126:127], v7 offset:15104
    v_mfma_f32_32x32x16_bf16 v[160:175], v[100:103], a[80:83], v[160:175]
    v_mfma_f32_32x32x16_bf16 v[176:191], v[100:103], a[208:211], v[176:191]
    s_waitcnt lgkmcnt(8)
    v_mfma_f32_32x32x16_bf16 v[128:143], v[104:107], a[84:87], v[128:143]
    ds_read_b64_tr_b16 v[96:97], v7 offset:16384
    ds_read_b64_tr_b16 v[98:99], v7 offset:16640
    ds_read_b64_tr_b16 v[100:101], v7 offset:16896
    v_mfma_f32_32x32x16_bf16 v[144:159], v[104:107], a[212:215], v[144:159]
    ds_read_b64_tr_b16 v[102:103], v7 offset:17152
    v_mfma_f32_32x32x16_bf16 v[160:175], v[108:111], a[84:87], v[160:175]
    v_mfma_f32_32x32x16_bf16 v[176:191], v[108:111], a[212:215], v[176:191]
    s_waitcnt lgkmcnt(8)
    v_mfma_f32_32x32x16_bf16 v[128:143], v[112:115], a[88:91], v[128:143]
    ds_read_b64_tr_b16 v[104:105], v7 offset:18432
    ds_read_b64_tr_b16 v[106:107], v7 offset:18688
    ds_read_b64_tr_b16 v[108:109], v7 offset:18944
    v_mfma_f32_32x32x16_bf16 v[144:159], v[112:115], a[216:219], v[144:159]
    ds_read_b64_tr_b16 v[110:111], v7 offset:19200
    v_mfma_f32_32x32x16_bf16 v[160:175], v[116:119], a[88:91], v[160:175]
    v_mfma_f32_32x32x16_bf16 v[176:191], v[116:119], a[216:219], v[176:191]
    s_waitcnt lgkmcnt(8)
    v_mfma_f32_32x32x16_bf16 v[128:143], v[120:123], a[92:95], v[128:143]
    ds_read_b64_tr_b16 v[112:113], v7 offset:20480
    ds_read_b64_tr_b16 v[114:115], v7 offset:20736
    ds_read_b64_tr_b16 v[116:117], v7 offset:20992
    v_mfma_f32_32x32x16_bf16 v[144:159], v[120:123], a[220:223], v[144:159]
    ds_read_b64_tr_b16 v[118:119], v7 offset:21248
    v_mfma_f32_32x32x16_bf16 v[160:175], v[124:127], a[92:95], v[160:175]
    v_mfma_f32_32x32x16_bf16 v[176:191], v[124:127], a[220:223], v[176:191]
    s_waitcnt lgkmcnt(8)
    v_mfma_f32_32x32x16_bf16 v[128:143], v[96:99], a[96:99], v[128:143]
    ds_read_b64_tr_b16 v[120:121], v7 offset:22528
    ds_read_b64_tr_b16 v[122:123], v7 offset:22784
    ds_read_b64_tr_b16 v[124:125], v7 offset:23040
    v_mfma_f32_32x32x16_bf16 v[144:159], v[96:99], a[224:227], v[144:159]
    ds_read_b64_tr_b16 v[126:127], v7 offset:23296
    v_mfma_f32_32x32x16_bf16 v[160:175], v[100:103], a[96:99], v[160:175]
    v_mfma_f32_32x32x16_bf16 v[176:191], v[100:103], a[224:227], v[176:191]
    s_waitcnt lgkmcnt(8)
    v_mfma_f32_32x32x16_bf16 v[128:143], v[104:107], a[100:103], v[128:143]
    ds_read_b64_tr_b16 v[96:97], v7 offset:24576
    ds_read_b64_tr_b16 v[98:99], v7 offset:24832
    ds_read_b64_tr_b16 v[100:101], v7 offset:25088
    v_mfma_f32_32x32x16_bf16 v[144:159], v[104:107], a[228:231], v[144:159]
    ds_read_b64_tr_b16 v[102:103], v7 offset:25344
    v_mfma_f32_32x32x16_bf16 v[160:175], v[108:111], a[100:103], v[160:175]
    v_mfma_f32_32x32x16_bf16 v[176:191], v[108:111], a[228:231], v[176:191]
    s_waitcnt lgkmcnt(8)
    v_mfma_f32_32x32x16_bf16 v[128:143], v[112:115], a[104:107], v[128:143]
    ds_read_b64_tr_b16 v[104:105], v7 offset:26624
    ds_read_b64_tr_b16 v[106:107], v7 offset:26880
    ds_read_b64_tr_b16 v[108:109], v7 offset:27136
    v_mfma_f32_32x32x16_bf16 v[144:159], v[112:115], a[232:235], v[144:159]
    ds_read_b64_tr_b16 v[110:111], v7 offset:27392
    v_mfma_f32_32x32x16_bf16 v[160:175], v[116:119], a[104:107], v[160:175]
    v_mfma_f32_32x32x16_bf16 v[176:191], v[116:119], a[232:235], v[176:191]
    s_waitcnt lgkmcnt(8)
    v_mfma_f32_32x32x16_bf16 v[128:143], v[120:123], a[108:111], v[128:143]
    ds_read_b64_tr_b16 v[112:113], v7 offset:28672
    ds_read_b64_tr_b16 v[114:115], v7 offset:28928
    ds_read_b64_tr_b16 v[116:117], v7 offset:29184
    v_mfma_f32_32x32x16_bf16 v[144:159], v[120:123], a[236:239], v[144:159]
    ds_read_b64_tr_b16 v[118:119], v7 offset:29440
    v_mfma_f32_32x32x16_bf16 v[160:175], v[124:127], a[108:111], v[160:175]
    v_mfma_f32_32x32x16_bf16 v[176:191], v[124:127], a[236:239], v[176:191]
    s_waitcnt lgkmcnt(8)
    v_mfma_f32_32x32x16_bf16 v[128:143], v[96:99], a[112:115], v[128:143]
    ds_read_b64_tr_b16 v[120:121], v7 offset:30720
    ds_read_b64_tr_b16 v[122:123], v7 offset:30976
    ds_read_b64_tr_b16 v[124:125], v7 offset:31232
    v_mfma_f32_32x32x16_bf16 v[144:159], v[96:99], a[240:243], v[144:159]
    ds_read_b64_tr_b16 v[126:127], v7 offset:31488
    v_mfma_f32_32x32x16_bf16 v[160:175], v[100:103], a[112:115], v[160:175]
    v_mfma_f32_32x32x16_bf16 v[176:191], v[100:103], a[240:243], v[176:191]
    s_waitcnt vmcnt(16)
    s_barrier
    v_add_u32 v7, s54, v6
    s_waitcnt lgkmcnt(8)
    v_mfma_f32_32x32x16_bf16 v[128:143], v[104:107], a[116:119], v[128:143]
    ds_read_b64_tr_b16 v[96:97], v7
    ds_read_b64_tr_b16 v[98:99], v7 offset:256
    ds_read_b64_tr_b16 v[100:101], v7 offset:512
    v_mfma_f32_32x32x16_bf16 v[144:159], v[104:107], a[244:247], v[144:159]
    ds_read_b64_tr_b16 v[102:103], v7 offset:768
    v_mfma_f32_32x32x16_bf16 v[160:175], v[108:111], a[116:119], v[160:175]
    v_mfma_f32_32x32x16_bf16 v[176:191], v[108:111], a[244:247], v[176:191]
    s_waitcnt lgkmcnt(8)
    v_mfma_f32_32x32x16_bf16 v[128:143], v[112:115], a[120:123], v[128:143]
    ds_read_b64_tr_b16 v[104:105], v7 offset:2048
    ds_read_b64_tr_b16 v[106:107], v7 offset:2304
    ds_read_b64_tr_b16 v[108:109], v7 offset:2560
    v_mfma_f32_32x32x16_bf16 v[144:159], v[112:115], a[248:251], v[144:159]
    ds_read_b64_tr_b16 v[110:111], v7 offset:2816
    v_mfma_f32_32x32x16_bf16 v[160:175], v[116:119], a[120:123], v[160:175]
    v_mfma_f32_32x32x16_bf16 v[176:191], v[116:119], a[248:251], v[176:191]
    s_waitcnt lgkmcnt(8)
    v_mfma_f32_32x32x16_bf16 v[128:143], v[120:123], a[124:127], v[128:143]
    ds_read_b64_tr_b16 v[112:113], v7 offset:4096
    ds_read_b64_tr_b16 v[114:115], v7 offset:4352
    ds_read_b64_tr_b16 v[116:117], v7 offset:4608
    v_mfma_f32_32x32x16_bf16 v[144:159], v[120:123], a[252:255], v[144:159]
    ds_read_b64_tr_b16 v[118:119], v7 offset:4864
    v_mfma_f32_32x32x16_bf16 v[160:175], v[124:127], a[124:127], v[160:175]
    v_mfma_f32_32x32x16_bf16 v[176:191], v[124:127], a[252:255], v[176:191]
    s_lshr_b32 s55, s48, 1
    s_mul_i32 s55, s55, s76
    s_and_b32 s56, s48, 1
    s_lshl_b32 s56, s56, 12
    s_add_u32 s55, s55, s56
    s_add_u32 s58, s55, s64
    s_add_u32 s59, s58, s77
    s_add_u32 s48, s48, 1
    s_sub_u32 s49, s49, 1
    s_cmp_eq_u32 s49, 0
    s_cbranch_scc1 L1_QK_t0
L1_QK_b1:
    s_waitcnt lgkmcnt(8)
    v_mfma_f32_32x32x16_bf16 v[192:207], v[96:99], a[0:3], 0
    ds_read_b64_tr_b16 v[120:121], v7 offset:6144
    ds_read_b64_tr_b16 v[122:123], v7 offset:6400
    ds_read_b64_tr_b16 v[124:125], v7 offset:6656
    v_mfma_f32_32x32x16_bf16 v[208:223], v[96:99], a[128:131], 0
    ds_read_b64_tr_b16 v[126:127], v7 offset:6912
    s_cmp_gt_i32 s52, 0
    s_cselect_b32 s65, s51, 0x40000000
    s_sub_u32 s52, s52, 1
    s_add_u32 s68, s65, s73
    v_mfma_f32_32x32x16_bf16 v[224:239], v[100:103], a[0:3], 0
    s_add_u32 m0, s53, 0
    s_nop 0
    buffer_load_dwordx4 v2, s[32:35], s65 offen lds
    v_mfma_f32_32x32x16_bf16 v[240:255], v[100:103], a[128:131], 0
    s_add_u32 m0, s53, 0x400
    s_nop 0
    buffer_load_dwordx4 v3, s[32:35], s65 offen lds
    s_waitcnt lgkmcnt(8)
    v_mfma_f32_32x32x16_bf16 v[192:207], v[104:107], a[4:7], v[192:207]
    ds_read_b64_tr_b16 v[96:97], v7 offset:8192
    ds_read_b64_tr_b16 v[98:99], v7 offset:8448
    ds_read_b64_tr_b16 v[100:101], v7 offset:8704
    v_mfma_f32_32x32x16_bf16 v[208:223], v[104:107], a[132:135], v[208:223]
    ds_read_b64_tr_b16 v[102:103], v7 offset:8960
    v_mul_f32 v128, s62, v128
    v_mul_f32 v129, s62, v129
    v_mul_f32 v130, s62, v130
    v_mul_f32 v131, s62, v131
    v_mfma_f32_32x32x16_bf16 v[224:239], v[108:111], a[4:7], v[224:239]
    s_add_u32 m0, s53, 0x800
    s_nop 0
    buffer_load_dwordx4 v4, s[32:35], s65 offen lds
    v_mfma_f32_32x32x16_bf16 v[240:255], v[108:111], a[132:135], v[240:255]
    s_add_u32 m0, s53, 0xc00
    s_nop 0
    buffer_load_dwordx4 v5, s[32:35], s65 offen lds
    s_waitcnt lgkmcnt(8)
    v_mfma_f32_32x32x16_bf16 v[192:207], v[112:115], a[8:11], v[192:207]
    ds_read_b64_tr_b16 v[104:105], v7 offset:10240
    ds_read_b64_tr_b16 v[106:107], v7 offset:10496
    ds_read_b64_tr_b16 v[108:109], v7 offset:10752
    v_mfma_f32_32x32x16_bf16 v[208:223], v[112:115], a[136:139], v[208:223]
    ds_read_b64_tr_b16 v[110:111], v7 offset:11008
    v_mul_f32 v132, s62, v132
    v_mul_f32 v133, s62, v133
    v_mul_f32 v134, s62, v134
    v_mul_f32 v135, s62, v135
    v_mfma_f32_32x32x16_bf16 v[224:239], v[116:119], a[8:11], v[224:239]
    s_add_u32 m0, s53, 0x1000
    s_nop 0
    buffer_load_dwordx4 v2, s[32:35], s68 offen lds
    v_mfma_f32_32x32x16_bf16 v[240:255], v[116:119], a[136:139], v[240:255]
    s_add_u32 m0, s53, 0x1400
    s_nop 0
    buffer_load_dwordx4 v3, s[32:35], s68 offen lds
    s_waitcnt lgkmcnt(8)
    v_mfma_f32_32x32x16_bf16 v[192:207], v[120:123], a[12:15], v[192:207]
    ds_read_b64_tr_b16 v[112:113], v7 offset:12288
    ds_read_b64_tr_b16 v[114:115], v7 offset:12544
    ds_read_b64_tr_b16 v[116:117], v7 offset:12800
    v_mfma_f32_32x32x16_bf16 v[208:223], v[120:123], a[140:143], v[208:223]
    ds_read_b64_tr_b16 v[118:119], v7 offset:13056
    v_cvt_pk_bf16_f32 v16, v128, v129
    v_cvt_pk_bf16_f32 v17, v130, v131
    v_cvt_pk_bf16_f32 v18, v132, v133
    v_cvt_pk_bf16_f32 v19, v134, v135
    v_mfma_f32_32x32x16_bf16 v[224:239], v[124:127], a[12:15], v[224:239]
    s_add_u32 m0, s53, 0x1800
    s_nop 0
    buffer_load_dwordx4 v4, s[32:35], s68 offen lds
    v_mfma_f32_32x32x16_bf16 v[240:255], v[124:127], a[140:143], v[240:255]
    s_add_u32 m0, s53, 0x1c00
    s_nop 0
    buffer_load_dwordx4 v5, s[32:35], s68 offen lds
    s_waitcnt lgkmcnt(8)
    v_mfma_f32_32x32x16_bf16 v[192:207], v[96:99], a[16:19], v[192:207]
    ds_read_b64_tr_b16 v[120:121], v7 offset:14336
    ds_read_b64_tr_b16 v[122:123], v7 offset:14592
    ds_read_b64_tr_b16 v[124:125], v7 offset:14848
    v_mfma_f32_32x32x16_bf16 v[208:223], v[96:99], a[144:147], v[208:223]
    ds_read_b64_tr_b16 v[126:127], v7 offset:15104
    s_add_u32 s51, s51, s75
    s_add_u32 s53, s53, 0x8000
    v_mfma_f32_32x32x16_bf16 v[224:239], v[100:103], a[16:19], v[224:239]
    s_sub_u32 s57, s53, 0x28000
    s_cmp_ge_u32 s53, 0x28000
    s_cselect_b32 s53, s57, s53
    s_add_u32 s54, s54, 0x8000
    s_cmp_ge_u32 s54, 0x28000
    s_cselect_b32 s54, 0, s54
    v_mfma_f32_32x32x16_bf16 v[240:255], v[100:103], a[144:147], v[240:255]
    buffer_store_dwordx4 v[16:19], v1, s[36:39], s58 offen sc1
    v_mul_f32 v136, s62, v136
    v_mul_f32 v137, s62, v137
    s_waitcnt lgkmcnt(8)
    v_mfma_f32_32x32x16_bf16 v[192:207], v[104:107], a[20:23], v[192:207]
    ds_read_b64_tr_b16 v[96:97], v7 offset:16384
    ds_read_b64_tr_b16 v[98:99], v7 offset:16640
    ds_read_b64_tr_b16 v[100:101], v7 offset:16896
    v_mfma_f32_32x32x16_bf16 v[208:223], v[104:107], a[148:151], v[208:223]
    ds_read_b64_tr_b16 v[102:103], v7 offset:17152
    v_mul_f32 v138, s62, v138
    v_mul_f32 v139, s62, v139
    v_mul_f32 v140, s62, v140
    v_mul_f32 v141, s62, v141
    v_mfma_f32_32x32x16_bf16 v[224:239], v[108:111], a[20:23], v[224:239]
    v_mul_f32 v142, s62, v142
    v_mul_f32 v143, s62, v143
    v_cvt_pk_bf16_f32 v20, v136, v137
    v_cvt_pk_bf16_f32 v21, v138, v139
    v_cvt_pk_bf16_f32 v22, v140, v141
    v_cvt_pk_bf16_f32 v23, v142, v143
    v_mfma_f32_32x32x16_bf16 v[240:255], v[108:111], a[148:151], v[240:255]
    buffer_store_dwordx4 v[20:23], v1, s[36:39], s58 offen offset:1024 sc1
    v_mul_f32 v160, s62, v160
    v_mul_f32 v161, s62, v161
    s_waitcnt lgkmcnt(8)
    v_mfma_f32_32x32x16_bf16 v[192:207], v[112:115], a[24:27], v[192:207]
    ds_read_b64_tr_b16 v[104:105], v7 offset:18432
    ds_read_b64_tr_b16 v[106:107], v7 offset:18688
    ds_read_b64_tr_b16 v[108:109], v7 offset:18944
    v_mfma_f32_32x32x16_bf16 v[208:223], v[112:115], a[152:155], v[208:223]
    ds_read_b64_tr_b16 v[110:111], v7 offset:19200
    v_mul_f32 v162, s62, v162
    v_mul_f32 v163, s62, v163
    v_mul_f32 v164, s62, v164
    v_mul_f32 v165, s62, v165
    v_mfma_f32_32x32x16_bf16 v[224:239], v[116:119], a[24:27], v[224:239]
    v_mul_f32 v166, s62, v166
    v_mul_f32 v167, s62, v167
    v_cvt_pk_bf16_f32 v16, v160, v161
    v_cvt_pk_bf16_f32 v17, v162, v163
    v_cvt_pk_bf16_f32 v18, v164, v165
    v_cvt_pk_bf16_f32 v19, v166, v167
    v_mfma_f32_32x32x16_bf16 v[240:255], v[116:119], a[152:155], v[240:255]
    buffer_store_dwordx4 v[16:19], v1, s[36:39], s58 offen offset:2048 sc1
    v_mul_f32 v168, s62, v168
    v_mul_f32 v169, s62, v169
    s_waitcnt lgkmcnt(8)
    v_mfma_f32_32x32x16_bf16 v[192:207], v[120:123], a[28:31], v[192:207]
    ds_read_b64_tr_b16 v[112:113], v7 offset:20480
    ds_read_b64_tr_b16 v[114:115], v7 offset:20736
    ds_read_b64_tr_b16 v[116:117], v7 offset:20992
    v_mfma_f32_32x32x16_bf16 v[208:223], v[120:123], a[156:159], v[208:223]
    ds_read_b64_tr_b16 v[118:119], v7 offset:21248
    v_mul_f32 v170, s62, v170
    v_mul_f32 v171, s62, v171
    v_mul_f32 v172, s62, v172
    v_mul_f32 v173, s62, v173
    v_mfma_f32_32x32x16_bf16 v[224:239], v[124:127], a[28:31], v[224:239]
    v_mul_f32 v174, s62, v174
    v_mul_f32 v175, s62, v175
    v_cvt_pk_bf16_f32 v20, v168, v169
    v_cvt_pk_bf16_f32 v21, v170, v171
    v_cvt_pk_bf16_f32 v22, v172, v173
    v_cvt_pk_bf16_f32 v23, v174, v175
    v_mfma_f32_32x32x16_bf16 v[240:255], v[124:127], a[156:159], v[240:255]
    buffer_store_dwordx4 v[20:23], v1, s[36:39], s58 offen offset:3072 sc1
    v_mul_f32 v144, s62, v144
    v_mul_f32 v145, s62, v145
    s_waitcnt lgkmcnt(8)
    v_mfma_f32_32x32x16_bf16 v[192:207], v[96:99], a[32:35], v[192:207]
    ds_read_b64_tr_b16 v[120:121], v7 offset:22528
    ds_read_b64_tr_b16 v[122:123], v7 offset:22784
    ds_read_b64_tr_b16 v[124:125], v7 offset:23040
    v_mfma_f32_32x32x16_bf16 v[208:223], v[96:99], a[160:163], v[208:223]
    ds_read_b64_tr_b16 v[126:127], v7 offset:23296
    v_mul_f32 v146, s62, v146
    v_mul_f32 v147, s62, v147
    v_mul_f32 v148, s62, v148
    v_mul_f32 v149, s62, v149
    v_mfma_f32_32x32x16_bf16 v[224:239], v[100:103], a[32:35], v[224:239]
    v_mul_f32 v150, s62, v150
    v_mul_f32 v151, s62, v151
    v_cvt_pk_bf16_f32 v16, v144, v145
    v_cvt_pk_bf16_f32 v17, v146, v147
    v_cvt_pk_bf16_f32 v18, v148, v149
    v_cvt_pk_bf16_f32 v19, v150, v151
    v_mfma_f32_32x32x16_bf16 v[240:255], v[100:103], a[160:163], v[240:255]
    buffer_store_dwordx4 v[16:19], v1, s[36:39], s59 offen sc1
    v_mul_f32 v152, s62, v152
    v_mul_f32 v153, s62, v153
    s_waitcnt lgkmcnt(8)
    v_mfma_f32_32x32x16_bf16 v[192:207], v[104:107], a[36:39], v[192:207]
    ds_read_b64_tr_b16 v[96:97], v7 offset:24576
    ds_read_b64_tr_b16 v[98:99], v7 offset:24832
    ds_read_b64_tr_b16 v[100:101], v7 offset:25088
    v_mfma_f32_32x32x16_bf16 v[208:223], v[104:107], a[164:167], v[208:223]
    ds_read_b64_tr_b16 v[102:103], v7 offset:25344
    v_mul_f32 v154, s62, v154
    v_mul_f32 v155, s62, v155
    v_mul_f32 v156, s62, v156
    v_mul_f32 v157, s62, v157
    v_mfma_f32_32x32x16_bf16 v[224:239], v[108:111], a[36:39], v[224:239]
    v_mul_f32 v158, s62, v158
    v_mul_f32 v159, s62, v159
    v_cvt_pk_bf16_f32 v20, v152, v153
    v_cvt_pk_bf16_f32 v21, v154, v155
    v_cvt_pk_bf16_f32 v22, v156, v157
    v_cvt_pk_bf16_f32 v23, v158, v159
    v_mfma_f32_32x32x16_bf16 v[240:255], v[108:111], a[164:167], v[240:255]
    buffer_store_dwordx4 v[20:23], v1, s[36:39], s59 offen offset:1024 sc1
    v_mul_f32 v176, s62, v176
    v_mul_f32 v177, s62, v177
    s_waitcnt lgkmcnt(8)
    v_mfma_f32_32x32x16_bf16 v[192:207], v[112:115], a[40:43], v[192:207]
    ds_read_b64_tr_b16 v[104:105], v7 offset:26624
    ds_read_b64_tr_b16 v[106:107], v7 offset:26880
    ds_read_b64_tr_b16 v[108:109], v7 offset:27136
    v_mfma_f32_32x32x16_bf16 v[208:223], v[112:115], a[168:171], v[208:223]
    ds_read_b64_tr_b16 v[110:111], v7 offset:27392
    v_mul_f32 v178, s62, v178
    v_mul_f32 v179, s62, v179
    v_mul_f32 v180, s62, v180
    v_mul_f32 v181, s62, v181
    v_mfma_f32_32x32x16_bf16 v[224:239], v[116:119], a[40:43], v[224:239]
    v_mul_f32 v182, s62, v182
    v_mul_f32 v183, s62, v183
    v_cvt_pk_bf16_f32 v16, v176, v177
    v_cvt_pk_bf16_f32 v17, v178, v179
    v_cvt_pk_bf16_f32 v18, v180, v181
    v_cvt_pk_bf16_f32 v19, v182, v183
    v_mfma_f32_32x32x16_bf16 v[240:255], v[116:119], a[168:171], v[240:255]
    buffer_store_dwordx4 v[16:19], v1, s[36:39], s59 offen offset:2048 sc1
    v_mul_f32 v184, s62, v184
    v_mul_f32 v185, s62, v185
    s_waitcnt lgkmcnt(8)
    v_mfma_f32_32x32x16_bf16 v[192:207], v[120:123], a[44:47], v[192:207]
    ds_read_b64_tr_b16 v[112:113], v7 offset:28672
    ds_read_b64_tr_b16 v[114:115], v7 offset:28928
    ds_read_b64_tr_b16 v[116:117], v7 offset:29184
    v_mfma_f32_32x32x16_bf16 v[208:223], v[120:123], a[172:175], v[208:223]
    ds_read_b64_tr_b16 v[118:119], v7 offset:29440
    v_mul_f32 v186, s62, v186
    v_mul_f32 v187, s62, v187
    v_mul_f32 v188, s62, v188
    v_mul_f32 v189, s62, v189
    v_mfma_f32_32x32x16_bf16 v[224:239], v[124:127], a[44:47], v[224:239]
    v_mul_f32 v190, s62, v190
    v_mul_f32 v191, s62, v191
    v_cvt_pk_bf16_f32 v20, v184, v185
    v_cvt_pk_bf16_f32 v21, v186, v187
    v_cvt_pk_bf16_f32 v22, v188, v189
    v_cvt_pk_bf16_f32 v23, v190, v191
    v_mfma_f32_32x32x16_bf16 v[240:255], v[124:127], a[172:175], v[240:255]
    buffer_store_dwordx4 v[20:23], v1, s[36:39], s59 offen offset:3072 sc1
    s_waitcnt lgkmcnt(8)
    v_mfma_f32_32x32x16_bf16 v[192:207], v[96:99], a[48:51], v[192:207]
    ds_read_b64_tr_b16 v[120:121], v7 offset:30720
    ds_read_b64_tr_b16 v[122:123], v7 offset:30976
    ds_read_b64_tr_b16 v[124:125], v7 offset:31232
    v_mfma_f32_32x32x16_bf16 v[208:223], v[96:99], a[176:179], v[208:223]
    ds_read_b64_tr_b16 v[126:127], v7 offset:31488
    v_mfma_f32_32x32x16_bf16 v[224:239], v[100:103], a[48:51], v[224:239]
    v_mfma_f32_32x32x16_bf16 v[240:255], v[100:103], a[176:179], v[240:255]
    s_waitcnt vmcnt(16)
    s_barrier
    v_add_u32 v7, s54, v6
    s_waitcnt lgkmcnt(8)
    v_mfma_f32_32x32x16_bf16 v[192:207], v[104:107], a[52:55], v[192:207]
    ds_read_b64_tr_b16 v[96:97], v7
    ds_read_b64_tr_b16 v[98:99], v7 offset:256
    ds_read_b64_tr_b16 v[100:101], v7 offset:512
    v_mfma_f32_32x32x16_bf16 v[208:223], v[104:107], a[180:183], v[208:223]
    ds_read_b64_tr_b16 v[102:103], v7 offset:768
    global_load_dword v45, v44, s[84:85]
    v_mfma_f32_32x32x16_bf16 v[224:239], v[108:111], a[52:55], v[224:239]
    s_mov_b64 s[84:85], s[86:87]
    s_mov_b64 s[86:87], s[88:89]
    s_mov_b64 s[88:89], s[90:91]
    s_mov_b64 s[90:91], s[92:93]
    s_cmp_gt_i32 s52, 0
    s_cselect_b32 s65, s51, 0x40000000
    v_mfma_f32_32x32x16_bf16 v[240:255], v[108:111], a[180:183], v[240:255]
    s_sub_u32 s52, s52, 1
    s_add_u32 s68, s65, s73
    s_waitcnt lgkmcnt(8)
    v_mfma_f32_32x32x16_bf16 v[192:207], v[112:115], a[56:59], v[192:207]
    ds_read_b64_tr_b16 v[104:105], v7 offset:2048
    ds_read_b64_tr_b16 v[106:107], v7 offset:2304
    ds_read_b64_tr_b16 v[108:109], v7 offset:2560
    v_mfma_f32_32x32x16_bf16 v[208:223], v[112:115], a[184:187], v[208:223]
    ds_read_b64_tr_b16 v[110:111], v7 offset:2816
    v_mfma_f32_32x32x16_bf16 v[224:239], v[116:119], a[56:59], v[224:239]
    s_add_u32 m0, s53, 0
    s_nop 0
    buffer_load_dwordx4 v2, s[32:35], s65 offen lds
    v_mfma_f32_32x32x16_bf16 v[240:255], v[116:119], a[184:187], v[240:255]
    s_add_u32 m0, s53, 0x400
    s_nop 0
    buffer_load_dwordx4 v3, s[32:35], s65 offen lds
    s_waitcnt lgkmcnt(8)
    v_mfma_f32_32x32x16_bf16 v[192:207], v[120:123], a[60:63], v[192:207]
    ds_read_b64_tr_b16 v[112:113], v7 offset:4096
    ds_read_b64_tr_b16 v[114:115], v7 offset:4352
    ds_read_b64_tr_b16 v[116:117], v7 offset:4608
    v_mfma_f32_32x32x16_bf16 v[208:223], v[120:123], a[188:191], v[208:223]
    ds_read_b64_tr_b16 v[118:119], v7 offset:4864
    v_mfma_f32_32x32x16_bf16 v[224:239], v[124:127], a[60:63], v[224:239]
    s_add_u32 m0, s53, 0x800
    s_nop 0
    buffer_load_dwordx4 v4, s[32:35], s65 offen lds
    v_mfma_f32_32x32x16_bf16 v[240:255], v[124:127], a[188:191], v[240:255]
    s_add_u32 m0, s53, 0xc00
    s_nop 0
    buffer_load_dwordx4 v5, s[32:35], s65 offen lds
    s_waitcnt lgkmcnt(8)
    v_mfma_f32_32x32x16_bf16 v[192:207], v[96:99], a[64:67], v[192:207]
    ds_read_b64_tr_b16 v[120:121], v7 offset:6144
    ds_read_b64_tr_b16 v[122:123], v7 offset:6400
    ds_read_b64_tr_b16 v[124:125], v7 offset:6656
    v_mfma_f32_32x32x16_bf16 v[208:223], v[96:99], a[192:195], v[208:223]
    ds_read_b64_tr_b16 v[126:127], v7 offset:6912
    v_mfma_f32_32x32x16_bf16 v[224:239], v[100:103], a[64:67], v[224:239]
    s_add_u32 m0, s53, 0x1000
    s_nop 0
    buffer_load_dwordx4 v2, s[32:35], s68 offen lds
    v_mfma_f32_32x32x16_bf16 v[240:255], v[100:103], a[192:195], v[240:255]
    s_add_u32 m0, s53, 0x1400
    s_nop 0
    buffer_load_dwordx4 v3, s[32:35], s68 offen lds
    s_waitcnt lgkmcnt(8)
    v_mfma_f32_32x32x16_bf16 v[192:207], v[104:107], a[68:71], v[192:207]
    ds_read_b64_tr_b16 v[96:97], v7 offset:8192
    ds_read_b64_tr_b16 v[98:99], v7 offset:8448
    ds_read_b64_tr_b16 v[100:101], v7 offset:8704
    v_mfma_f32_32x32x16_bf16 v[208:223], v[104:107], a[196:199], v[208:223]
    ds_read_b64_tr_b16 v[102:103], v7 offset:8960
    v_mfma_f32_32x32x16_bf16 v[224:239], v[108:111], a[68:71], v[224:239]
    s_add_u32 m0, s53, 0x1800
    s_nop 0
    buffer_load_dwordx4 v4, s[32:35], s68 offen lds
    v_mfma_f32_32x32x16_bf16 v[240:255], v[108:111], a[196:199], v[240:255]
    s_add_u32 m0, s53, 0x1c00
    s_nop 0
    buffer_load_dwordx4 v5, s[32:35], s68 offen lds
    s_waitcnt lgkmcnt(8)
    v_mfma_f32_32x32x16_bf16 v[192:207], v[112:115], a[72:75], v[192:207]
    ds_read_b64_tr_b16 v[104:105], v7 offset:10240
    ds_read_b64_tr_b16 v[106:107], v7 offset:10496
    ds_read_b64_tr_b16 v[108:109], v7 offset:10752
    v_mfma_f32_32x32x16_bf16 v[208:223], v[112:115], a[200:203], v[208:223]
    ds_read_b64_tr_b16 v[110:111], v7 offset:11008
    s_add_u32 s51, s51, s74
    s_add_u32 s53, s53, 0x8000
    v_mfma_f32_32x32x16_bf16 v[224:239], v[116:119], a[72:75], v[224:239]
    s_sub_u32 s57, s53, 0x28000
    s_cmp_ge_u32 s53, 0x28000
    s_cselect_b32 s53, s57, s53
    v_mfma_f32_32x32x16_bf16 v[240:255], v[116:119], a[200:203], v[240:255]
    s_add_u32 s54, s54, 0x8000
    s_cmp_ge_u32 s54, 0x28000
    s_cselect_b32 s54, 0, s54
    s_waitcnt lgkmcnt(8)
    v_mfma_f32_32x32x16_bf16 v[192:207], v[120:123], a[76:79], v[192:207]
    ds_read_b64_tr_b16 v[112:113], v7 offset:12288
    ds_read_b64_tr_b16 v[114:115], v7 offset:12544
    ds_read_b64_tr_b16 v[116:117], v7 offset:12800
    v_mfma_f32_32x32x16_bf16 v[208:223], v[120:123], a[204:207], v[208:223]
    ds_read_b64_tr_b16 v[118:119], v7 offset:13056
    v_mfma_f32_32x32x16_bf16 v[224:239], v[124:127], a[76:79], v[224:239]
    v_mfma_f32_32x32x16_bf16 v[240:255], v[124:127], a[204:207], v[240:255]
    s_waitcnt lgkmcnt(8)
    v_mfma_f32_32x32x16_bf16 v[192:207], v[96:99], a[80:83], v[192:207]
    ds_read_b64_tr_b16 v[120:121], v7 offset:14336
    ds_read_b64_tr_b16 v[122:123], v7 offset:14592
    ds_read_b64_tr_b16 v[124:125], v7 offset:14848
    v_mfma_f32_32x32x16_bf16 v[208:223], v[96:99], a[208:211], v[208:223]
    ds_read_b64_tr_b16 v[126:127], v7 offset:15104
    v_mfma_f32_32x32x16_bf16 v[224:239], v[100:103], a[80:83], v[224:239]
    v_mfma_f32_32x32x16_bf16 v[240:255], v[100:103], a[208:211], v[240:255]
    s_waitcnt lgkmcnt(8)
    v_mfma_f32_32x32x16_bf16 v[192:207], v[104:107], a[84:87], v[192:207]
    ds_read_b64_tr_b16 v[96:97], v7 offset:16384
    ds_read_b64_tr_b16 v[98:99], v7 offset:16640
    ds_read_b64_tr_b16 v[100:101], v7 offset:16896
    v_mfma_f32_32x32x16_bf16 v[208:223], v[104:107], a[212:215], v[208:223]
    ds_read_b64_tr_b16 v[102:103], v7 offset:17152
    v_mfma_f32_32x32x16_bf16 v[224:239], v[108:111], a[84:87], v[224:239]
    v_mfma_f32_32x32x16_bf16 v[240:255], v[108:111], a[212:215], v[240:255]
    s_waitcnt lgkmcnt(8)
    v_mfma_f32_32x32x16_bf16 v[192:207], v[112:115], a[88:91], v[192:207]
    ds_read_b64_tr_b16 v[104:105], v7 offset:18432
    ds_read_b64_tr_b16 v[106:107], v7 offset:18688
    ds_read_b64_tr_b16 v[108:109], v7 offset:18944
    v_mfma_f32_32x32x16_bf16 v[208:223], v[112:115], a[216:219], v[208:223]
    ds_read_b64_tr_b16 v[110:111], v7 offset:19200
    v_mfma_f32_32x32x16_bf16 v[224:239], v[116:119], a[88:91], v[224:239]
    v_mfma_f32_32x32x16_bf16 v[240:255], v[116:119], a[216:219], v[240:255]
    s_waitcnt lgkmcnt(8)
    v_mfma_f32_32x32x16_bf16 v[192:207], v[120:123], a[92:95], v[192:207]
    ds_read_b64_tr_b16 v[112:113], v7 offset:20480
    ds_read_b64_tr_b16 v[114:115], v7 offset:20736
    ds_read_b64_tr_b16 v[116:117], v7 offset:20992
    v_mfma_f32_32x32x16_bf16 v[208:223], v[120:123], a[220:223], v[208:223]
    ds_read_b64_tr_b16 v[118:119], v7 offset:21248
    v_mfma_f32_32x32x16_bf16 v[224:239], v[124:127], a[92:95], v[224:239]
    v_mfma_f32_32x32x16_bf16 v[240:255], v[124:127], a[220:223], v[240:255]
    s_waitcnt lgkmcnt(8)
    v_mfma_f32_32x32x16_bf16 v[192:207], v[96:99], a[96:99], v[192:207]
    ds_read_b64_tr_b16 v[120:121], v7 offset:22528
    ds_read_b64_tr_b16 v[122:123], v7 offset:22784
    ds_read_b64_tr_b16 v[124:125], v7 offset:23040
    v_mfma_f32_32x32x16_bf16 v[208:223], v[96:99], a[224:227], v[208:223]
    ds_read_b64_tr_b16 v[126:127], v7 offset:23296
    v_mfma_f32_32x32x16_bf16 v[224:239], v[100:103], a[96:99], v[224:239]
    v_mfma_f32_32x32x16_bf16 v[240:255], v[100:103], a[224:227], v[240:255]
    s_waitcnt lgkmcnt(8)
    v_mfma_f32_32x32x16_bf16 v[192:207], v[104:107], a[100:103], v[192:207]
    ds_read_b64_tr_b16 v[96:97], v7 offset:24576
    ds_read_b64_tr_b16 v[98:99], v7 offset:24832
    ds_read_b64_tr_b16 v[100:101], v7 offset:25088
    v_mfma_f32_32x32x16_bf16 v[208:223], v[104:107], a[228:231], v[208:223]
    ds_read_b64_tr_b16 v[102:103], v7 offset:25344
    v_mfma_f32_32x32x16_bf16 v[224:239], v[108:111], a[100:103], v[224:239]
    v_mfma_f32_32x32x16_bf16 v[240:255], v[108:111], a[228:231], v[240:255]
    s_waitcnt lgkmcnt(8)
    v_mfma_f32_32x32x16_bf16 v[192:207], v[112:115], a[104:107], v[192:207]
    ds_read_b64_tr_b16 v[104:105], v7 offset:26624
    ds_read_b64_tr_b16 v[106:107], v7 offset:26880
    ds_read_b64_tr_b16 v[108:109], v7 offset:27136
    v_mfma_f32_32x32x16_bf16 v[208:223], v[112:115], a[232:235], v[208:223]
    ds_read_b64_tr_b16 v[110:111], v7 offset:27392
    v_mfma_f32_32x32x16_bf16 v[224:239], v[116:119], a[104:107], v[224:239]
    v_mfma_f32_32x32x16_bf16 v[240:255], v[116:119], a[232:235], v[240:255]
    s_waitcnt lgkmcnt(8)
    v_mfma_f32_32x32x16_bf16 v[192:207], v[120:123], a[108:111], v[192:207]
    ds_read_b64_tr_b16 v[112:113], v7 offset:28672
    ds_read_b64_tr_b16 v[114:115], v7 offset:28928
    ds_read_b64_tr_b16 v[116:117], v7 offset:29184
    v_mfma_f32_32x32x16_bf16 v[208:223], v[120:123], a[236:239], v[208:223]
    ds_read_b64_tr_b16 v[118:119], v7 offset:29440
    v_mfma_f32_32x32x16_bf16 v[224:239], v[124:127], a[108:111], v[224:239]
    v_mfma_f32_32x32x16_bf16 v[240:255], v[124:127], a[236:239], v[240:255]
    s_waitcnt lgkmcnt(8)
    v_mfma_f32_32x32x16_bf16 v[192:207], v[96:99], a[112:115], v[192:207]
    ds_read_b64_tr_b16 v[120:121], v7 offset:30720
    ds_read_b64_tr_b16 v[122:123], v7 offset:30976
    ds_read_b64_tr_b16 v[124:125], v7 offset:31232
    v_mfma_f32_32x32x16_bf16 v[208:223], v[96:99], a[240:243], v[208:223]
    ds_read_b64_tr_b16 v[126:127], v7 offset:31488
    v_mfma_f32_32x32x16_bf16 v[224:239], v[100:103], a[112:115], v[224:239]
    v_mfma_f32_32x32x16_bf16 v[240:255], v[100:103], a[240:243], v[240:255]
    s_waitcnt vmcnt(16)
    s_barrier
    v_add_u32 v7, s54, v6
    s_waitcnt lgkmcnt(8)
    v_mfma_f32_32x32x16_bf16 v[192:207], v[104:107], a[116:119], v[192:207]
    ds_read_b64_tr_b16 v[96:97], v7
    ds_read_b64_tr_b16 v[98:99], v7 offset:256
    ds_read_b64_tr_b16 v[100:101], v7 offset:512
    v_mfma_f32_32x32x16_bf16 v[208:223], v[104:107], a[244:247], v[208:223]
    ds_read_b64_tr_b16 v[102:103], v7 offset:768
    v_mfma_f32_32x32x16_bf16 v[224:239], v[108:111], a[116:119], v[224:239]
    v_mfma_f32_32x32x16_bf16 v[240:255], v[108:111], a[244:247], v[240:255]
    s_waitcnt lgkmcnt(8)
    v_mfma_f32_32x32x16_bf16 v[192:207], v[112:115], a[120:123], v[192:207]
    ds_read_b64_tr_b16 v[104:105], v7 offset:2048
    ds_read_b64_tr_b16 v[106:107], v7 offset:2304
    ds_read_b64_tr_b16 v[108:109], v7 offset:2560
    v_mfma_f32_32x32x16_bf16 v[208:223], v[112:115], a[248:251], v[208:223]
    ds_read_b64_tr_b16 v[110:111], v7 offset:2816
    v_mfma_f32_32x32x16_bf16 v[224:239], v[116:119], a[120:123], v[224:239]
    v_mfma_f32_32x32x16_bf16 v[240:255], v[116:119], a[248:251], v[240:255]
    s_waitcnt lgkmcnt(8)
    v_mfma_f32_32x32x16_bf16 v[192:207], v[120:123], a[124:127], v[192:207]
    ds_read_b64_tr_b16 v[112:113], v7 offset:4096
    ds_read_b64_tr_b16 v[114:115], v7 offset:4352
    ds_read_b64_tr_b16 v[116:117], v7 offset:4608
    v_mfma_f32_32x32x16_bf16 v[208:223], v[120:123], a[252:255], v[208:223]
    ds_read_b64_tr_b16 v[118:119], v7 offset:4864
    v_mfma_f32_32x32x16_bf16 v[224:239], v[124:127], a[124:127], v[224:239]
    v_mfma_f32_32x32x16_bf16 v[240:255], v[124:127], a[252:255], v[240:255]
    s_lshr_b32 s55, s48, 1
    s_mul_i32 s55, s55, s76
    s_and_b32 s56, s48, 1
    s_lshl_b32 s56, s56, 12
    s_add_u32 s55, s55, s56
    s_add_u32 s58, s55, s64
    s_add_u32 s59, s58, s77
    s_add_u32 s48, s48, 1
    s_sub_u32 s49, s49, 1
    s_cmp_lg_u32 s49, 0
    s_cbranch_scc1 L1_QK_b0
L1_QK_t1:
    v_mul_f32 v192, s62, v192
    v_mul_f32 v193, s62, v193
    v_mul_f32 v194, s62, v194
    v_mul_f32 v195, s62, v195
    v_mul_f32 v196, s62, v196
    v_mul_f32 v197, s62, v197
    v_mul_f32 v198, s62, v198
    v_mul_f32 v199, s62, v199
    v_cvt_pk_bf16_f32 v16, v192, v193
    v_cvt_pk_bf16_f32 v17, v194, v195
    v_cvt_pk_bf16_f32 v18, v196, v197
    v_cvt_pk_bf16_f32 v19, v198, v199
    buffer_store_dwordx4 v[16:19], v1, s[36:39], s58 offen sc1
    v_mul_f32 v200, s62, v200
    v_mul_f32 v201, s62, v201
    v_mul_f32 v202, s62, v202
    v_mul_f32 v203, s62, v203
    v_mul_f32 v204, s62, v204
    v_mul_f32 v205, s62, v205
    v_mul_f32 v206, s62, v206
    v_mul_f32 v207, s62, v207
    v_cvt_pk_bf16_f32 v20, v200, v201
    v_cvt_pk_bf16_f32 v21, v202, v203
    v_cvt_pk_bf16_f32 v22, v204, v205
    v_cvt_pk_bf16_f32 v23, v206, v207
    buffer_store_dwordx4 v[20:23], v1, s[36:39], s58 offen offset:1024 sc1
    v_mul_f32 v224, s62, v224
    v_mul_f32 v225, s62, v225
    v_mul_f32 v226, s62, v226
    v_mul_f32 v227, s62, v227
    v_mul_f32 v228, s62, v228
    v_mul_f32 v229, s62, v229
    v_mul_f32 v230, s62, v230
    v_mul_f32 v231, s62, v231
    v_cvt_pk_bf16_f32 v16, v224, v225
    v_cvt_pk_bf16_f32 v17, v226, v227
    v_cvt_pk_bf16_f32 v18, v228, v229
    v_cvt_pk_bf16_f32 v19, v230, v231
    buffer_store_dwordx4 v[16:19], v1, s[36:39], s58 offen offset:2048 sc1
    v_mul_f32 v232, s62, v232
    v_mul_f32 v233, s62, v233
    v_mul_f32 v234, s62, v234
    v_mul_f32 v235, s62, v235
    v_mul_f32 v236, s62, v236
    v_mul_f32 v237, s62, v237
    v_mul_f32 v238, s62, v238
    v_mul_f32 v239, s62, v239
    v_cvt_pk_bf16_f32 v20, v232, v233
    v_cvt_pk_bf16_f32 v21, v234, v235
    v_cvt_pk_bf16_f32 v22, v236, v237
    v_cvt_pk_bf16_f32 v23, v238, v239
    buffer_store_dwordx4 v[20:23], v1, s[36:39], s58 offen offset:3072 sc1
    v_mul_f32 v208, s62, v208
    v_mul_f32 v209, s62, v209
    v_mul_f32 v210, s62, v210
    v_mul_f32 v211, s62, v211
    v_mul_f32 v212, s62, v212
    v_mul_f32 v213, s62, v213
    v_mul_f32 v214, s62, v214
    v_mul_f32 v215, s62, v215
    v_cvt_pk_bf16_f32 v16, v208, v209
    v_cvt_pk_bf16_f32 v17, v210, v211
    v_cvt_pk_bf16_f32 v18, v212, v213
    v_cvt_pk_bf16_f32 v19, v214, v215
    buffer_store_dwordx4 v[16:19], v1, s[36:39], s59 offen sc1
    v_mul_f32 v216, s62, v216
    v_mul_f32 v217, s62, v217
    v_mul_f32 v218, s62, v218
    v_mul_f32 v219, s62, v219
    v_mul_f32 v220, s62, v220
    v_mul_f32 v221, s62, v221
    v_mul_f32 v222, s62, v222
    v_mul_f32 v223, s62, v223
    v_cvt_pk_bf16_f32 v20, v216, v217
    v_cvt_pk_bf16_f32 v21, v218, v219
    v_cvt_pk_bf16_f32 v22, v220, v221
    v_cvt_pk_bf16_f32 v23, v222, v223
    buffer_store_dwordx4 v[20:23], v1, s[36:39], s59 offen offset:1024 sc1
    v_mul_f32 v240, s62, v240
    v_mul_f32 v241, s62, v241
    v_mul_f32 v242, s62, v242
    v_mul_f32 v243, s62, v243
    v_mul_f32 v244, s62, v244
    v_mul_f32 v245, s62, v245
    v_mul_f32 v246, s62, v246
    v_mul_f32 v247, s62, v247
    v_cvt_pk_bf16_f32 v16, v240, v241
    v_cvt_pk_bf16_f32 v17, v242, v243
    v_cvt_pk_bf16_f32 v18, v244, v245
    v_cvt_pk_bf16_f32 v19, v246, v247
    buffer_store_dwordx4 v[16:19], v1, s[36:39], s59 offen offset:2048 sc1
    v_mul_f32 v248, s62, v248
    v_mul_f32 v249, s62, v249
    v_mul_f32 v250, s62, v250
    v_mul_f32 v251, s62, v251
    v_mul_f32 v252, s62, v252
    v_mul_f32 v253, s62, v253
    v_mul_f32 v254, s62, v254
    v_mul_f32 v255, s62, v255
    v_cvt_pk_bf16_f32 v20, v248, v249
    v_cvt_pk_bf16_f32 v21, v250, v251
    v_cvt_pk_bf16_f32 v22, v252, v253
    v_cvt_pk_bf16_f32 v23, v254, v255
    buffer_store_dwordx4 v[20:23], v1, s[36:39], s59 offen offset:3072 sc1
    s_branch L1_next
L1_QK_t0:
    v_mul_f32 v128, s62, v128
    v_mul_f32 v129, s62, v129
    v_mul_f32 v130, s62, v130
    v_mul_f32 v131, s62, v131
    v_mul_f32 v132, s62, v132
    v_mul_f32 v133, s62, v133
    v_mul_f32 v134, s62, v134
    v_mul_f32 v135, s62, v135
    v_cvt_pk_bf16_f32 v16, v128, v129
    v_cvt_pk_bf16_f32 v17, v130, v131
    v_cvt_pk_bf16_f32 v18, v132, v133
    v_cvt_pk_bf16_f32 v19, v134, v135
    buffer_store_dwordx4 v[16:19], v1, s[36:39], s58 offen sc1
    v_mul_f32 v136, s62, v136
    v_mul_f32 v137, s62, v137
    v_mul_f32 v138, s62, v138
    v_mul_f32 v139, s62, v139
    v_mul_f32 v140, s62, v140
    v_mul_f32 v141, s62, v141
    v_mul_f32 v142, s62, v142
    v_mul_f32 v143, s62, v143
    v_cvt_pk_bf16_f32 v20, v136, v137
    v_cvt_pk_bf16_f32 v21, v138, v139
    v_cvt_pk_bf16_f32 v22, v140, v141
    v_cvt_pk_bf16_f32 v23, v142, v143
    buffer_store_dwordx4 v[20:23], v1, s[36:39], s58 offen offset:1024 sc1
    v_mul_f32 v160, s62, v160
    v_mul_f32 v161, s62, v161
    v_mul_f32 v162, s62, v162
    v_mul_f32 v163, s62, v163
    v_mul_f32 v164, s62, v164
    v_mul_f32 v165, s62, v165
    v_mul_f32 v166, s62, v166
    v_mul_f32 v167, s62, v167
    v_cvt_pk_bf16_f32 v16, v160, v161
    v_cvt_pk_bf16_f32 v17, v162, v163
    v_cvt_pk_bf16_f32 v18, v164, v165
    v_cvt_pk_bf16_f32 v19, v166, v167
    buffer_store_dwordx4 v[16:19], v1, s[36:39], s58 offen offset:2048 sc1
    v_mul_f32 v168, s62, v168
    v_mul_f32 v169, s62, v169
    v_mul_f32 v170, s62, v170
    v_mul_f32 v171, s62, v171
    v_mul_f32 v172, s62, v172
    v_mul_f32 v173, s62, v173
    v_mul_f32 v174, s62, v174
    v_mul_f32 v175, s62, v175
    v_cvt_pk_bf16_f32 v20, v168, v169
    v_cvt_pk_bf16_f32 v21, v170, v171
    v_cvt_pk_bf16_f32 v22, v172, v173
    v_cvt_pk_bf16_f32 v23, v174, v175
    buffer_store_dwordx4 v[20:23], v1, s[36:39], s58 offen offset:3072 sc1
    v_mul_f32 v144, s62, v144
    v_mul_f32 v145, s62, v145
    v_mul_f32 v146, s62, v146
    v_mul_f32 v147, s62, v147
    v_mul_f32 v148, s62, v148
    v_mul_f32 v149, s62, v149
    v_mul_f32 v150, s62, v150
    v_mul_f32 v151, s62, v151
    v_cvt_pk_bf16_f32 v16, v144, v145
    v_cvt_pk_bf16_f32 v17, v146, v147
    v_cvt_pk_bf16_f32 v18, v148, v149
    v_cvt_pk_bf16_f32 v19, v150, v151
    buffer_store_dwordx4 v[16:19], v1, s[36:39], s59 offen sc1
    v_mul_f32 v152, s62, v152
    v_mul_f32 v153, s62, v153
    v_mul_f32 v154, s62, v154
    v_mul_f32 v155, s62, v155
    v_mul_f32 v156, s62, v156
    v_mul_f32 v157, s62, v157
    v_mul_f32 v158, s62, v158
    v_mul_f32 v159, s62, v159
    v_cvt_pk_bf16_f32 v20, v152, v153
    v_cvt_pk_bf16_f32 v21, v154, v155
    v_cvt_pk_bf16_f32 v22, v156, v157
    v_cvt_pk_bf16_f32 v23, v158, v159
    buffer_store_dwordx4 v[20:23], v1, s[36:39], s59 offen offset:1024 sc1
    v_mul_f32 v176, s62, v176
    v_mul_f32 v177, s62, v177
    v_mul_f32 v178, s62, v178
    v_mul_f32 v179, s62, v179
    v_mul_f32 v180, s62, v180
    v_mul_f32 v181, s62, v181
    v_mul_f32 v182, s62, v182
    v_mul_f32 v183, s62, v183
    v_cvt_pk_bf16_f32 v16, v176, v177
    v_cvt_pk_bf16_f32 v17, v178, v179
    v_cvt_pk_bf16_f32 v18, v180, v181
    v_cvt_pk_bf16_f32 v19, v182, v183
    buffer_store_dwordx4 v[16:19], v1, s[36:39], s59 offen offset:2048 sc1
    v_mul_f32 v184, s62, v184
    v_mul_f32 v185, s62, v185
    v_mul_f32 v186, s62, v186
    v_mul_f32 v187, s62, v187
    v_mul_f32 v188, s62, v188
    v_mul_f32 v189, s62, v189
    v_mul_f32 v190, s62, v190
    v_mul_f32 v191, s62, v191
    v_cvt_pk_bf16_f32 v20, v184, v185
    v_cvt_pk_bf16_f32 v21, v186, v187
    v_cvt_pk_bf16_f32 v22, v188, v189
    v_cvt_pk_bf16_f32 v23, v190, v191
    buffer_store_dwordx4 v[20:23], v1, s[36:39], s59 offen offset:3072 sc1
    s_branch L1_next
L1_V_f:
    v_mfma_f32_32x32x16_bf16 v[128:143], a[0:3], v[96:99], 0
    s_waitcnt vmcnt(16)
    ds_read_b128 a[16:19], v10 offset:32768
    ds_read_b128 a[20:23], v11 offset:32768
    ds_read_b64_tr_b16 v[120:121], v7 offset:6144
    v_mfma_f32_32x32x16_bf16 v[144:159], a[128:131], v[96:99], 0
    ds_read_b128 a[24:27], v12 offset:32768
    ds_read_b128 a[28:31], v13 offset:32768
    ds_read_b64_tr_b16 v[122:123], v7 offset:6400
    v_mfma_f32_32x32x16_bf16 v[160:175], a[0:3], v[100:103], 0
    ds_read_b128 a[144:147], v10 offset:36864
    ds_read_b128 a[148:151], v11 offset:36864
    ds_read_b64_tr_b16 v[124:125], v7 offset:6656
    v_mfma_f32_32x32x16_bf16 v[176:191], a[128:131], v[100:103], 0
    ds_read_b64_tr_b16 v[126:127], v7 offset:6912
    ds_read_b128 a[152:155], v12 offset:36864
    ds_read_b128 a[156:159], v13 offset:36864
    v_mfma_f32_32x32x16_bf16 v[128:143], a[4:7], v[104:107], v[128:143]
    s_add_u32 m0, s79, 0x8000
    s_add_u32 s80, s66, 0x200
    s_waitcnt lgkmcnt(0)
    buffer_load_dwordx4 v8, s[28:31], s80 offen lds
    v_mfma_f32_32x32x16_bf16 v[144:159], a[132:135], v[104:107], v[144:159]
    s_add_u32 m0, s79, 0x8400
    s_add_u32 s80, s66, 0x2200
    buffer_load_dwordx4 v9, s[28:31], s80 offen lds
    v_mfma_f32_32x32x16_bf16 v[160:175], a[4:7], v[108:111], v[160:175]
    s_add_u32 m0, s79, 0x8800
    s_add_u32 s80, s66, 0x4200
    buffer_load_dwordx4 v8, s[28:31], s80 offen lds
    v_mfma_f32_32x32x16_bf16 v[176:191], a[132:135], v[108:111], v[176:191]
    ds_read_b64_tr_b16 v[96:97], v7 offset:8192
    ds_read_b64_tr_b16 v[98:99], v7 offset:8448
    ds_read_b64_tr_b16 v[100:101], v7 offset:8704
    ds_read_b64_tr_b16 v[102:103], v7 offset:8960
    v_mfma_f32_32x32x16_bf16 v[128:143], a[8:11], v[112:115], v[128:143]
    s_add_u32 m0, s79, 0x8c00
    s_add_u32 s80, s66, 0x6200
    buffer_load_dwordx4 v9, s[28:31], s80 offen lds
    v_mfma_f32_32x32x16_bf16 v[144:159], a[136:139], v[112:115], v[144:159]
    s_add_u32 m0, s79, 0x9000
    s_add_u32 s80, s66, 0x8200
    buffer_load_dwordx4 v8, s[28:31], s80 offen lds
    v_mfma_f32_32x32x16_bf16 v[160:175], a[8:11], v[116:119], v[160:175]
    s_add_u32 m0, s79, 0x9400
    s_add_u32 s80, s66, 0xa200
    buffer_load_dwordx4 v9, s[28:31], s80 offen lds
    v_mfma_f32_32x32x16_bf16 v[176:191], a[136:139], v[116:119], v[176:191]
    ds_read_b64_tr_b16 v[104:105], v7 offset:10240
    ds_read_b64_tr_b16 v[106:107], v7 offset:10496
    ds_read_b64_tr_b16 v[108:109], v7 offset:10752
    ds_read_b64_tr_b16 v[110:111], v7 offset:11008
    v_mfma_f32_32x32x16_bf16 v[128:143], a[12:15], v[120:123], v[128:143]
    s_add_u32 m0, s79, 0x9800
    s_add_u32 s80, s66, 0xc200
    buffer_load_dwordx4 v8, s[28:31], s80 offen lds
    v_mfma_f32_32x32x16_bf16 v[144:159], a[140:143], v[120:123], v[144:159]
    s_add_u32 m0, s79, 0x9c00
    s_add_u32 s80, s66, 0xe200
    buffer_load_dwordx4 v9, s[28:31], s80 offen lds
    v_mfma_f32_32x32x16_bf16 v[160:175], a[12:15], v[124:127], v[160:175]
    s_cmp_gt_i32 s52, 0
    s_cselect_b32 s65, s51, 0x40000000
    s_sub_u32 s52, s52, 1
    s_add_u32 s68, s65, s73
    ds_read_b64_tr_b16 v[112:113], v7 offset:12288
    v_mfma_f32_32x32x16_bf16 v[176:191], a[140:143], v[124:127], v[176:191]
    s_add_u32 m0, s53, 0
    s_nop 0
    buffer_load_dwordx4 v2, s[32:35], s65 offen lds
    s_add_u32 m0, s53, 0x400
    s_nop 0
    buffer_load_dwordx4 v3, s[32:35], s65 offen lds
    s_add_u32 m0, s53, 0x800
    s_nop 0
    buffer_load_dwordx4 v4, s[32:35], s65 offen lds
    s_add_u32 m0, s53, 0xc00
    s_nop 0
    buffer_load_dwordx4 v5, s[32:35], s65 offen lds
    s_add_u32 m0, s53, 0x1000
    s_nop 0
    buffer_load_dwordx4 v2, s[32:35], s68 offen lds
    s_add_u32 m0, s53, 0x1400
    s_nop 0
    buffer_load_dwordx4 v3, s[32:35], s68 offen lds
    s_add_u32 m0, s53, 0x1800
    s_nop 0
    buffer_load_dwordx4 v4, s[32:35], s68 offen lds
    s_add_u32 m0, s53, 0x1c00
    s_nop 0
    buffer_load_dwordx4 v5, s[32:35], s68 offen lds
    s_add_u32 s51, s51, s75
    s_add_u32 s53, s53, 0x8000
    s_sub_u32 s57, s53, 0x28000
    s_cmp_ge_u32 s53, 0x28000
    s_cselect_b32 s53, s57, s53
    s_waitcnt vmcnt(24)
    ds_read_b128 a[32:35], v32
    ds_read_b128 a[36:39], v33
    ds_read_b128 a[40:43], v34
    ds_read_b128 a[44:47], v35
    ds_read_b128 a[160:163], v32 offset:4096
    ds_read_b128 a[164:167], v33 offset:4096
    ds_read_b64_tr_b16 v[114:115], v7 offset:12544
    ds_read_b64_tr_b16 v[116:117], v7 offset:12800
    ds_read_b128 a[168:171], v34 offset:4096
    ds_read_b128 a[172:175], v35 offset:4096
    ds_read_b64_tr_b16 v[118:119], v7 offset:13056
    s_waitcnt lgkmcnt(15)
    v_mfma_f32_32x32x16_bf16 v[128:143], a[16:19], v[96:99], v[128:143]
    s_add_u32 m0, s79, 0x10000
    s_add_u32 s80, s66, 0x280
    s_waitcnt lgkmcnt(1)
    buffer_load_dwordx4 v8, s[28:31], s80 offen lds
    v_mfma_f32_32x32x16_bf16 v[144:159], a[144:147], v[96:99], v[144:159]
    ds_read_b64_tr_b16 v[120:121], v7 offset:14336
    ds_read_b64_tr_b16 v[122:123], v7 offset:14592
    ds_read_b64_tr_b16 v[124:125], v7 offset:14848
    v_mfma_f32_32x32x16_bf16 v[160:175], a[16:19], v[100:103], v[160:175]
    s_add_u32 m0, s79, 0x10400
    s_add_u32 s80, s66, 0x2280
    buffer_load_dwordx4 v9, s[28:31], s80 offen lds
    v_mfma_f32_32x32x16_bf16 v[176:191], a[144:147], v[100:103], v[176:191]
    ds_read_b64_tr_b16 v[126:127], v7 offset:15104
    s_add_u32 s54, s54, 0x8000
    s_cmp_ge_u32 s54, 0x28000
    s_cselect_b32 s54, 0, s54
    v_mfma_f32_32x32x16_bf16 v[128:143], a[20:23], v[104:107], v[128:143]
    s_add_u32 m0, s79, 0x10800
    s_add_u32 s80, s66, 0x4280
    buffer_load_dwordx4 v8, s[28:31], s80 offen lds
    v_mfma_f32_32x32x16_bf16 v[144:159], a[148:151], v[104:107], v[144:159]
    s_add_u32 m0, s79, 0x10c00
    s_add_u32 s80, s66, 0x6280
    buffer_load_dwordx4 v9, s[28:31], s80 offen lds
    v_mfma_f32_32x32x16_bf16 v[160:175], a[20:23], v[108:111], v[160:175]
    s_add_u32 m0, s79, 0x11000
    s_add_u32 s80, s66, 0x8280
    buffer_load_dwordx4 v8, s[28:31], s80 offen lds
    v_mfma_f32_32x32x16_bf16 v[176:191], a[148:151], v[108:111], v[176:191]
    ds_read_b64_tr_b16 v[96:97], v7 offset:16384
    ds_read_b64_tr_b16 v[98:99], v7 offset:16640
    ds_read_b64_tr_b16 v[100:101], v7 offset:16896
    ds_read_b64_tr_b16 v[102:103], v7 offset:17152
    s_waitcnt lgkmcnt(8)
    v_mfma_f32_32x32x16_bf16 v[128:143], a[24:27], v[112:115], v[128:143]
    s_add_u32 m0, s79, 0x11400
    s_add_u32 s80, s66, 0xa280
    buffer_load_dwordx4 v9, s[28:31], s80 offen lds
    v_mfma_f32_32x32x16_bf16 v[144:159], a[152:155], v[112:115], v[144:159]
    s_add_u32 m0, s79, 0x11800
    s_add_u32 s80, s66, 0xc280
    buffer_load_dwordx4 v8, s[28:31], s80 offen lds
    s_add_u32 m0, s79, 0x11c00
    s_add_u32 s80, s66, 0xe280
    buffer_load_dwordx4 v9, s[28:31], s80 offen lds
    v_mfma_f32_32x32x16_bf16 v[160:175], a[24:27], v[116:119], v[160:175]
    ds_read_b64_tr_b16 v[104:105], v7 offset:18432
    ds_read_b64_tr_b16 v[106:107], v7 offset:18688
    ds_read_b64_tr_b16 v[108:109], v7 offset:18944
    v_mfma_f32_32x32x16_bf16 v[176:191], a[152:155], v[116:119], v[176:191]
    ds_read_b64_tr_b16 v[110:111], v7 offset:19200
    s_waitcnt vmcnt(24)
    ds_read_b128 a[48:51], v10
    ds_read_b128 a[52:55], v11
    s_waitcnt lgkmcnt(10)
    v_mfma_f32_32x32x16_bf16 v[128:143], a[28:31], v[120:123], v[128:143]
    ds_read_b128 a[56:59], v12
    ds_read_b128 a[60:63], v13
    ds_read_b64_tr_b16 v[112:113], v7 offset:20480
    v_mfma_f32_32x32x16_bf16 v[144:159], a[156:159], v[120:123], v[144:159]
    ds_read_b128 a[176:179], v10 offset:4096
    ds_read_b128 a[180:183], v11 offset:4096
    ds_read_b64_tr_b16 v[114:115], v7 offset:20736
    v_mfma_f32_32x32x16_bf16 v[160:175], a[28:31], v[124:127], v[160:175]
    ds_read_b64_tr_b16 v[116:117], v7 offset:20992
    ds_read_b128 a[184:187], v12 offset:4096
    ds_read_b128 a[188:191], v13 offset:4096
    v_mfma_f32_32x32x16_bf16 v[176:191], a[156:159], v[124:127], v[176:191]
    ds_read_b64_tr_b16 v[118:119], v7 offset:21248
    s_waitcnt lgkmcnt(15)
    v_mfma_f32_32x32x16_bf16 v[128:143], a[32:35], v[96:99], v[128:143]
    ds_read_b64_tr_b16 v[120:121], v7 offset:22528
    ds_read_b64_tr_b16 v[122:123], v7 offset:22784
    ds_read_b64_tr_b16 v[124:125], v7 offset:23040
    v_mfma_f32_32x32x16_bf16 v[144:159], a[160:163], v[96:99], v[144:159]
    ds_read_b64_tr_b16 v[126:127], v7 offset:23296
    v_mfma_f32_32x32x16_bf16 v[160:175], a[32:35], v[100:103], v[160:175]
    v_mfma_f32_32x32x16_bf16 v[176:191], a[160:163], v[100:103], v[176:191]
    s_waitcnt lgkmcnt(15)
    v_mfma_f32_32x32x16_bf16 v[128:143], a[36:39], v[104:107], v[128:143]
    ds_read_b64_tr_b16 v[96:97], v7 offset:24576
    ds_read_b64_tr_b16 v[98:99], v7 offset:24832
    ds_read_b64_tr_b16 v[100:101], v7 offset:25088
    v_mfma_f32_32x32x16_bf16 v[144:159], a[164:167], v[104:107], v[144:159]
    ds_read_b64_tr_b16 v[102:103], v7 offset:25344
    v_mfma_f32_32x32x16_bf16 v[160:175], a[36:39], v[108:111], v[160:175]
    v_mfma_f32_32x32x16_bf16 v[176:191], a[164:167], v[108:111], v[176:191]
    s_waitcnt lgkmcnt(8)
    v_mfma_f32_32x32x16_bf16 v[128:143], a[40:43], v[112:115], v[128:143]
    ds_read_b64_tr_b16 v[104:105], v7 offset:26624
    ds_read_b64_tr_b16 v[106:107], v7 offset:26880
    ds_read_b64_tr_b16 v[108:109], v7 offset:27136
    v_mfma_f32_32x32x16_bf16 v[144:159], a[168:171], v[112:115], v[144:159]
    ds_read_b64_tr_b16 v[110:111], v7 offset:27392
    v_mfma_f32_32x32x16_bf16 v[160:175], a[40:43], v[116:119], v[160:175]
    s_waitcnt vmcnt(16)
    ds_read_b128 a[64:67], v10 offset:32768
    ds_read_b128 a[68:71], v11 offset:32768
    v_mfma_f32_32x32x16_bf16 v[176:191], a[168:171], v[116:119], v[176:191]
    ds_read_b128 a[72:75], v12 offset:32768
    ds_read_b128 a[76:79], v13 offset:32768
    s_waitcnt lgkmcnt(12)
    v_mfma_f32_32x32x16_bf16 v[128:143], a[44:47], v[120:123], v[128:143]
    ds_read_b128 a[192:195], v10 offset:36864
    ds_read_b128 a[196:199], v11 offset:36864
    ds_read_b64_tr_b16 v[112:113], v7 offset:28672
    v_mfma_f32_32x32x16_bf16 v[144:159], a[172:175], v[120:123], v[144:159]
    ds_read_b128 a[200:203], v12 offset:36864
    ds_read_b128 a[204:207], v13 offset:36864
    ds_read_b64_tr_b16 v[114:115], v7 offset:28928
    v_mfma_f32_32x32x16_bf16 v[160:175], a[44:47], v[124:127], v[160:175]
    s_add_u32 m0, s79, 0x8000
    s_add_u32 s80, s66, 0x300
    s_waitcnt lgkmcnt(1)
    buffer_load_dwordx4 v8, s[28:31], s80 offen lds
    v_mfma_f32_32x32x16_bf16 v[176:191], a[172:175], v[124:127], v[176:191]
    ds_read_b64_tr_b16 v[116:117], v7 offset:29184
    ds_read_b64_tr_b16 v[118:119], v7 offset:29440
    v_mfma_f32_32x32x16_bf16 v[128:143], a[48:51], v[96:99], v[128:143]
    s_add_u32 m0, s79, 0x8400
    s_add_u32 s80, s66, 0x2300
    buffer_load_dwordx4 v9, s[28:31], s80 offen lds
    v_mfma_f32_32x32x16_bf16 v[144:159], a[176:179], v[96:99], v[144:159]
    s_add_u32 m0, s79, 0x8800
    s_add_u32 s80, s66, 0x4300
    buffer_load_dwordx4 v8, s[28:31], s80 offen lds
    v_mfma_f32_32x32x16_bf16 v[160:175], a[48:51], v[100:103], v[160:175]
    s_add_u32 m0, s79, 0x8c00
    s_add_u32 s80, s66, 0x6300
    buffer_load_dwordx4 v9, s[28:31], s80 offen lds
    v_mfma_f32_32x32x16_bf16 v[176:191], a[176:179], v[100:103], v[176:191]
    ds_read_b64_tr_b16 v[120:121], v7 offset:30720
    ds_read_b64_tr_b16 v[122:123], v7 offset:30976
    ds_read_b64_tr_b16 v[124:125], v7 offset:31232
    ds_read_b64_tr_b16 v[126:127], v7 offset:31488
    s_waitcnt vmcnt(12) lgkmcnt(0)
    s_barrier
    v_add_u32 v7, s54, v6
    v_mfma_f32_32x32x16_bf16 v[128:143], a[52:55], v[104:107], v[128:143]
    s_add_u32 m0, s79, 0x9000
    s_add_u32 s80, s66, 0x8300
    buffer_load_dwordx4 v8, s[28:31], s80 offen lds
    v_mfma_f32_32x32x16_bf16 v[144:159], a[180:183], v[104:107], v[144:159]
    s_add_u32 m0, s79, 0x9400
    s_add_u32 s80, s66, 0xa300
    buffer_load_dwordx4 v9, s[28:31], s80 offen lds
    v_mfma_f32_32x32x16_bf16 v[160:175], a[52:55], v[108:111], v[160:175]
    s_add_u32 m0, s79, 0x9800
    s_add_u32 s80, s66, 0xc300
    buffer_load_dwordx4 v8, s[28:31], s80 offen lds
    v_mfma_f32_32x32x16_bf16 v[176:191], a[180:183], v[108:111], v[176:191]
    ds_read_b64_tr_b16 v[96:97], v7
    ds_read_b64_tr_b16 v[98:99], v7 offset:256
    ds_read_b64_tr_b16 v[100:101], v7 offset:512
    ds_read_b64_tr_b16 v[102:103], v7 offset:768
    v_mfma_f32_32x32x16_bf16 v[128:143], a[56:59], v[112:115], v[128:143]
    s_add_u32 m0, s79, 0x9c00
    s_add_u32 s80, s66, 0xe300
    buffer_load_dwordx4 v9, s[28:31], s80 offen lds
    v_mfma_f32_32x32x16_bf16 v[144:159], a[184:187], v[112:115], v[144:159]
    s_cmp_gt_i32 s52, 0
    s_cselect_b32 s65, s51, 0x40000000
    s_sub_u32 s52, s52, 1
    s_add_u32 s68, s65, s73
    ds_read_b64_tr_b16 v[104:105], v7 offset:2048
    v_mfma_f32_32x32x16_bf16 v[160:175], a[56:59], v[116:119], v[160:175]
    s_add_u32 m0, s53, 0
    s_nop 0
    buffer_load_dwordx4 v2, s[32:35], s65 offen lds
    v_mfma_f32_32x32x16_bf16 v[176:191], a[184:187], v[116:119], v[176:191]
    ds_read_b64_tr_b16 v[106:107], v7 offset:2304
    ds_read_b64_tr_b16 v[108:109], v7 offset:2560
    ds_read_b64_tr_b16 v[110:111], v7 offset:2816
    v_mfma_f32_32x32x16_bf16 v[128:143], a[60:63], v[120:123], v[128:143]
    s_add_u32 m0, s53, 0x400
    s_nop 0
    buffer_load_dwordx4 v3, s[32:35], s65 offen lds
    v_mfma_f32_32x32x16_bf16 v[144:159], a[188:191], v[120:123], v[144:159]
    s_add_u32 m0, s53, 0x800
    s_nop 0
    buffer_load_dwordx4 v4, s[32:35], s65 offen lds
    v_mfma_f32_32x32x16_bf16 v[160:175], a[60:63], v[124:127], v[160:175]
    s_add_u32 m0, s53, 0xc00
    s_nop 0
    buffer_load_dwordx4 v5, s[32:35], s65 offen lds
    v_mfma_f32_32x32x16_bf16 v[176:191], a[188:191], v[124:127], v[176:191]
    s_add_u32 m0, s53, 0x1000
    s_nop 0
    buffer_load_dwordx4 v2, s[32:35], s68 offen lds
    s_add_u32 m0, s53, 0x1400
    s_nop 0
    buffer_load_dwordx4 v3, s[32:35], s68 offen lds
    s_add_u32 m0, s53, 0x1800
    s_nop 0
    buffer_load_dwordx4 v4, s[32:35], s68 offen lds
    s_add_u32 m0, s53, 0x1c00
    s_nop 0
    buffer_load_dwordx4 v5, s[32:35], s68 offen lds
    s_add_u32 s51, s51, s74
    s_add_u32 s53, s53, 0x8000
    s_sub_u32 s57, s53, 0x28000
    s_cmp_ge_u32 s53, 0x28000
    s_cselect_b32 s53, s57, s53
    s_waitcnt vmcnt(16)
    ds_read_b128 a[80:83], v32
    ds_read_b128 a[84:87], v33
    ds_read_b128 a[88:91], v34
    ds_read_b128 a[92:95], v35
    ds_read_b64_tr_b16 v[112:113], v7 offset:4096
    ds_read_b128 a[208:211], v32 offset:4096
    ds_read_b128 a[212:215], v33 offset:4096
    ds_read_b64_tr_b16 v[114:115], v7 offset:4352
    ds_read_b64_tr_b16 v[116:117], v7 offset:4608
    ds_read_b128 a[216:219], v34 offset:4096
    ds_read_b128 a[220:223], v35 offset:4096
    ds_read_b64_tr_b16 v[118:119], v7 offset:4864
    s_waitcnt lgkmcnt(15)
    v_mfma_f32_32x32x16_bf16 v[128:143], a[64:67], v[96:99], v[128:143]
    s_add_u32 m0, s79, 0x10000
    s_add_u32 s80, s66, 0x380
    s_waitcnt lgkmcnt(1)
    buffer_load_dwordx4 v8, s[28:31], s80 offen lds
    v_mfma_f32_32x32x16_bf16 v[144:159], a[192:195], v[96:99], v[144:159]
    ds_read_b64_tr_b16 v[120:121], v7 offset:6144
    ds_read_b64_tr_b16 v[122:123], v7 offset:6400
    ds_read_b64_tr_b16 v[124:125], v7 offset:6656
    v_mfma_f32_32x32x16_bf16 v[160:175], a[64:67], v[100:103], v[160:175]
    s_add_u32 m0, s79, 0x10400
    s_add_u32 s80, s66, 0x2380
    buffer_load_dwordx4 v9, s[28:31], s80 offen lds
    v_mfma_f32_32x32x16_bf16 v[176:191], a[192:195], v[100:103], v[176:191]
    ds_read_b64_tr_b16 v[126:127], v7 offset:6912
    v_mfma_f32_32x32x16_bf16 v[128:143], a[68:71], v[104:107], v[128:143]
    s_add_u32 m0, s79, 0x10800
    s_add_u32 s80, s66, 0x4380
    buffer_load_dwordx4 v8, s[28:31], s80 offen lds
    v_mfma_f32_32x32x16_bf16 v[144:159], a[196:199], v[104:107], v[144:159]
    s_add_u32 m0, s79, 0x10c00
    s_add_u32 s80, s66, 0x6380
    buffer_load_dwordx4 v9, s[28:31], s80 offen lds
    v_mfma_f32_32x32x16_bf16 v[160:175], a[68:71], v[108:111], v[160:175]
    s_add_u32 m0, s79, 0x11000
    s_add_u32 s80, s66, 0x8380
    buffer_load_dwordx4 v8, s[28:31], s80 offen lds
    v_mfma_f32_32x32x16_bf16 v[176:191], a[196:199], v[108:111], v[176:191]
    ds_read_b64_tr_b16 v[96:97], v7 offset:8192
    ds_read_b64_tr_b16 v[98:99], v7 offset:8448
    ds_read_b64_tr_b16 v[100:101], v7 offset:8704
    ds_read_b64_tr_b16 v[102:103], v7 offset:8960
    s_waitcnt lgkmcnt(8)
    v_mfma_f32_32x32x16_bf16 v[128:143], a[72:75], v[112:115], v[128:143]
    s_add_u32 m0, s79, 0x11400
    s_add_u32 s80, s66, 0xa380
    buffer_load_dwordx4 v9, s[28:31], s80 offen lds
    v_mfma_f32_32x32x16_bf16 v[144:159], a[200:203], v[112:115], v[144:159]
    s_add_u32 m0, s79, 0x11800
    s_add_u32 s80, s66, 0xc380
    buffer_load_dwordx4 v8, s[28:31], s80 offen lds
    s_add_u32 m0, s79, 0x11c00
    s_add_u32 s80, s66, 0xe380
    buffer_load_dwordx4 v9, s[28:31], s80 offen lds
    v_mfma_f32_32x32x16_bf16 v[160:175], a[72:75], v[116:119], v[160:175]
    ds_read_b64_tr_b16 v[104:105], v7 offset:10240
    ds_read_b64_tr_b16 v[106:107], v7 offset:10496
    ds_read_b64_tr_b16 v[108:109], v7 offset:10752
    v_mfma_f32_32x32x16_bf16 v[176:191], a[200:203], v[116:119], v[176:191]
    ds_read_b64_tr_b16 v[110:111], v7 offset:11008
    s_waitcnt vmcnt(16)
    ds_read_b128 a[96:99], v10 offset:32768
    ds_read_b128 a[100:103], v11 offset:32768
    s_waitcnt lgkmcnt(10)
    v_mfma_f32_32x32x16_bf16 v[128:143], a[76:79], v[120:123], v[128:143]
    ds_read_b128 a[104:107], v12 offset:32768
    ds_read_b128 a[108:111], v13 offset:32768
    ds_read_b64_tr_b16 v[112:113], v7 offset:12288
    v_mfma_f32_32x32x16_bf16 v[144:159], a[204:207], v[120:123], v[144:159]
    ds_read_b128 a[224:227], v10 offset:36864
    ds_read_b128 a[228:231], v11 offset:36864
    ds_read_b64_tr_b16 v[114:115], v7 offset:12544
    v_mfma_f32_32x32x16_bf16 v[160:175], a[76:79], v[124:127], v[160:175]
    ds_read_b64_tr_b16 v[116:117], v7 offset:12800
    ds_read_b128 a[232:235], v12 offset:36864
    ds_read_b128 a[236:239], v13 offset:36864
    v_mfma_f32_32x32x16_bf16 v[176:191], a[204:207], v[124:127], v[176:191]
    ds_read_b64_tr_b16 v[118:119], v7 offset:13056
    s_add_u32 s54, s54, 0x8000
    s_cmp_ge_u32 s54, 0x28000
    s_cselect_b32 s54, 0, s54
    s_waitcnt lgkmcnt(15)
    v_mfma_f32_32x32x16_bf16 v[128:143], a[80:83], v[96:99], v[128:143]
    ds_read_b64_tr_b16 v[120:121], v7 offset:14336
    ds_read_b64_tr_b16 v[122:123], v7 offset:14592
    ds_read_b64_tr_b16 v[124:125], v7 offset:14848
    v_mfma_f32_32x32x16_bf16 v[144:159], a[208:211], v[96:99], v[144:159]
    ds_read_b64_tr_b16 v[126:127], v7 offset:15104
    v_mfma_f32_32x32x16_bf16 v[160:175], a[80:83], v[100:103], v[160:175]
    s_waitcnt lgkmcnt(0)
    s_barrier
    v_mfma_f32_32x32x16_bf16 v[176:191], a[208:211], v[100:103], v[176:191]
    s_cmp_gt_i32 s52, 0
    s_cselect_b32 s65, s51, 0x40000000
    s_sub_u32 s52, s52, 1
    s_add_u32 s68, s65, s73
    v_mfma_f32_32x32x16_bf16 v[128:143], a[84:87], v[104:107], v[128:143]
    s_add_u32 m0, s53, 0
    s_nop 0
    buffer_load_dwordx4 v2, s[32:35], s65 offen lds
    v_mfma_f32_32x32x16_bf16 v[144:159], a[212:215], v[104:107], v[144:159]
    s_add_u32 m0, s53, 0x400
    s_nop 0
    buffer_load_dwordx4 v3, s[32:35], s65 offen lds
    v_mfma_f32_32x32x16_bf16 v[160:175], a[84:87], v[108:111], v[160:175]
    s_add_u32 m0, s53, 0x800
    s_nop 0
    buffer_load_dwordx4 v4, s[32:35], s65 offen lds
    v_mfma_f32_32x32x16_bf16 v[176:191], a[212:215], v[108:111], v[176:191]
    ds_read_b64_tr_b16 v[96:97], v7 offset:16384
    ds_read_b64_tr_b16 v[98:99], v7 offset:16640
    ds_read_b64_tr_b16 v[100:101], v7 offset:16896
    ds_read_b64_tr_b16 v[102:103], v7 offset:17152
    v_mfma_f32_32x32x16_bf16 v[128:143], a[88:91], v[112:115], v[128:143]
    s_add_u32 m0, s53, 0xc00
    s_nop 0
    buffer_load_dwordx4 v5, s[32:35], s65 offen lds
    v_mfma_f32_32x32x16_bf16 v[144:159], a[216:219], v[112:115], v[144:159]
    s_add_u32 m0, s53, 0x1000
    s_nop 0
    buffer_load_dwordx4 v2, s[32:35], s68 offen lds
    v_mfma_f32_32x32x16_bf16 v[160:175], a[88:91], v[116:119], v[160:175]
    s_add_u32 m0, s53, 0x1400
    s_nop 0
    buffer_load_dwordx4 v3, s[32:35], s68 offen lds
    v_mfma_f32_32x32x16_bf16 v[176:191], a[216:219], v[116:119], v[176:191]
    ds_read_b64_tr_b16 v[104:105], v7 offset:18432
    ds_read_b64_tr_b16 v[106:107], v7 offset:18688
    ds_read_b64_tr_b16 v[108:109], v7 offset:18944
    ds_read_b64_tr_b16 v[110:111], v7 offset:19200
    v_mfma_f32_32x32x16_bf16 v[128:143], a[92:95], v[120:123], v[128:143]
    s_add_u32 m0, s53, 0x1800
    s_nop 0
    buffer_load_dwordx4 v4, s[32:35], s68 offen lds
    v_mfma_f32_32x32x16_bf16 v[144:159], a[220:223], v[120:123], v[144:159]
    s_add_u32 m0, s53, 0x1c00
    s_nop 0
    buffer_load_dwordx4 v5, s[32:35], s68 offen lds
    v_mfma_f32_32x32x16_bf16 v[160:175], a[92:95], v[124:127], v[160:175]
    s_add_u32 s51, s51, s75
    s_add_u32 s53, s53, 0x8000
    s_sub_u32 s57, s53, 0x28000
    s_cmp_ge_u32 s53, 0x28000
    s_cselect_b32 s53, s57, s53
    v_mfma_f32_32x32x16_bf16 v[176:191], a[220:223], v[124:127], v[176:191]
    s_waitcnt vmcnt(8)
    ds_read_b128 a[112:115], v32
    ds_read_b128 a[116:119], v33
    ds_read_b128 a[120:123], v34
    ds_read_b128 a[124:127], v35
    ds_read_b64_tr_b16 v[112:113], v7 offset:20480
    ds_read_b128 a[240:243], v32 offset:4096
    ds_read_b128 a[244:247], v33 offset:4096
    ds_read_b64_tr_b16 v[114:115], v7 offset:20736
    ds_read_b64_tr_b16 v[116:117], v7 offset:20992
    ds_read_b128 a[248:251], v34 offset:4096
    ds_read_b128 a[252:255], v35 offset:4096
    ds_read_b64_tr_b16 v[118:119], v7 offset:21248
    s_waitcnt lgkmcnt(15)
    v_mfma_f32_32x32x16_bf16 v[128:143], a[96:99], v[96:99], v[128:143]
    ds_read_b64_tr_b16 v[120:121], v7 offset:22528
    ds_read_b64_tr_b16 v[122:123], v7 offset:22784
    ds_read_b64_tr_b16 v[124:125], v7 offset:23040
    v_mfma_f32_32x32x16_bf16 v[144:159], a[224:227], v[96:99], v[144:159]
    ds_read_b64_tr_b16 v[126:127], v7 offset:23296
    v_mfma_f32_32x32x16_bf16 v[160:175], a[96:99], v[100:103], v[160:175]
    v_mfma_f32_32x32x16_bf16 v[176:191], a[224:227], v[100:103], v[176:191]
    s_waitcnt lgkmcnt(15)
    v_mfma_f32_32x32x16_bf16 v[128:143], a[100:103], v[104:107], v[128:143]
    ds_read_b64_tr_b16 v[96:97], v7 offset:24576
    ds_read_b64_tr_b16 v[98:99], v7 offset:24832
    ds_read_b64_tr_b16 v[100:101], v7 offset:25088
    v_mfma_f32_32x32x16_bf16 v[144:159], a[228:231], v[104:107], v[144:159]
    ds_read_b64_tr_b16 v[102:103], v7 offset:25344
    v_mfma_f32_32x32x16_bf16 v[160:175], a[100:103], v[108:111], v[160:175]
    v_mfma_f32_32x32x16_bf16 v[176:191], a[228:231], v[108:111], v[176:191]
    s_waitcnt lgkmcnt(8)
    v_mfma_f32_32x32x16_bf16 v[128:143], a[104:107], v[112:115], v[128:143]
    ds_read_b64_tr_b16 v[104:105], v7 offset:26624
    ds_read_b64_tr_b16 v[106:107], v7 offset:26880
    ds_read_b64_tr_b16 v[108:109], v7 offset:27136
    v_mfma_f32_32x32x16_bf16 v[144:159], a[232:235], v[112:115], v[144:159]
    ds_read_b64_tr_b16 v[110:111], v7 offset:27392
    v_mfma_f32_32x32x16_bf16 v[160:175], a[104:107], v[116:119], v[160:175]
    v_mfma_f32_32x32x16_bf16 v[176:191], a[232:235], v[116:119], v[176:191]
    s_waitcnt lgkmcnt(8)
    v_mfma_f32_32x32x16_bf16 v[128:143], a[108:111], v[120:123], v[128:143]
    ds_read_b64_tr_b16 v[112:113], v7 offset:28672
    ds_read_b64_tr_b16 v[114:115], v7 offset:28928
    ds_read_b64_tr_b16 v[116:117], v7 offset:29184
    v_mfma_f32_32x32x16_bf16 v[144:159], a[236:239], v[120:123], v[144:159]
    ds_read_b64_tr_b16 v[118:119], v7 offset:29440
    v_mfma_f32_32x32x16_bf16 v[160:175], a[108:111], v[124:127], v[160:175]
    v_mfma_f32_32x32x16_bf16 v[176:191], a[236:239], v[124:127], v[176:191]
    s_waitcnt lgkmcnt(8)
    v_mfma_f32_32x32x16_bf16 v[128:143], a[112:115], v[96:99], v[128:143]
    ds_read_b64_tr_b16 v[120:121], v7 offset:30720
    ds_read_b64_tr_b16 v[122:123], v7 offset:30976
    ds_read_b64_tr_b16 v[124:125], v7 offset:31232
    v_mfma_f32_32x32x16_bf16 v[144:159], a[240:243], v[96:99], v[144:159]
    ds_read_b64_tr_b16 v[126:127], v7 offset:31488
    v_mfma_f32_32x32x16_bf16 v[160:175], a[112:115], v[100:103], v[160:175]
    v_mfma_f32_32x32x16_bf16 v[176:191], a[240:243], v[100:103], v[176:191]
    s_waitcnt lgkmcnt(0)
    s_barrier
    v_add_u32 v7, s54, v6
    v_mfma_f32_32x32x16_bf16 v[128:143], a[116:119], v[104:107], v[128:143]
    s_cmp_gt_i32 s52, 0
    s_cselect_b32 s65, s51, 0x40000000
    ds_read_b64_tr_b16 v[96:97], v7
    s_sub_u32 s52, s52, 1
    s_add_u32 s68, s65, s73
    v_mfma_f32_32x32x16_bf16 v[144:159], a[244:247], v[104:107], v[144:159]
    ds_read_b64_tr_b16 v[98:99], v7 offset:256
    ds_read_b64_tr_b16 v[100:101], v7 offset:512
    ds_read_b64_tr_b16 v[102:103], v7 offset:768
    v_mfma_f32_32x32x16_bf16 v[160:175], a[116:119], v[108:111], v[160:175]
    s_add_u32 m0, s53, 0
    s_nop 0
    buffer_load_dwordx4 v2, s[32:35], s65 offen lds
    v_mfma_f32_32x32x16_bf16 v[176:191], a[244:247], v[108:111], v[176:191]
    s_add_u32 m0, s53, 0x400
    s_nop 0
    buffer_load_dwordx4 v3, s[32:35], s65 offen lds
    v_mfma_f32_32x32x16_bf16 v[128:143], a[120:123], v[112:115], v[128:143]
    s_add_u32 m0, s53, 0x800
    s_nop 0
    buffer_load_dwordx4 v4, s[32:35], s65 offen lds
    v_mfma_f32_32x32x16_bf16 v[144:159], a[248:251], v[112:115], v[144:159]
    s_add_u32 m0, s53, 0xc00
    s_nop 0
    buffer_load_dwordx4 v5, s[32:35], s65 offen lds
    v_mfma_f32_32x32x16_bf16 v[160:175], a[120:123], v[116:119], v[160:175]
    ds_read_b64_tr_b16 v[104:105], v7 offset:2048
    ds_read_b64_tr_b16 v[106:107], v7 offset:2304
    ds_read_b64_tr_b16 v[108:109], v7 offset:2560
    ds_read_b64_tr_b16 v[110:111], v7 offset:2816
    v_mfma_f32_32x32x16_bf16 v[176:191], a[248:251], v[116:119], v[176:191]
    s_add_u32 m0, s53, 0x1000
    s_nop 0
    buffer_load_dwordx4 v2, s[32:35], s68 offen lds
    v_mfma_f32_32x32x16_bf16 v[128:143], a[124:127], v[120:123], v[128:143]
    s_add_u32 m0, s53, 0x1400
    s_nop 0
    buffer_load_dwordx4 v3, s[32:35], s68 offen lds
    ds_read_b64_tr_b16 v[112:113], v7 offset:4096
    v_mfma_f32_32x32x16_bf16 v[144:159], a[252:255], v[120:123], v[144:159]
    s_add_u32 m0, s53, 0x1800
    s_nop 0
    buffer_load_dwordx4 v4, s[32:35], s68 offen lds
    ds_read_b64_tr_b16 v[114:115], v7 offset:4352
    v_mfma_f32_32x32x16_bf16 v[160:175], a[124:127], v[124:127], v[160:175]
    s_add_u32 m0, s53, 0x1c00
    s_nop 0
    buffer_load_dwordx4 v5, s[32:35], s68 offen lds
    s_add_u32 s51, s51, s74
    s_add_u32 s53, s53, 0x8000
    v_mfma_f32_32x32x16_bf16 v[176:191], a[252:255], v[124:127], v[176:191]
    ds_read_b64_tr_b16 v[116:117], v7 offset:4608
    s_sub_u32 s57, s53, 0x28000
    s_cmp_ge_u32 s53, 0x28000
    s_cselect_b32 s53, s57, s53
    ds_read_b64_tr_b16 v[118:119], v7 offset:4864
    s_lshr_b32 s55, s48, 1
    s_mul_i32 s55, s55, s76
    s_and_b32 s56, s48, 1
    s_lshl_b32 s56, s56, 11
    s_add_u32 s55, s55, s56
    s_add_u32 s58, s55, s64
    s_add_u32 s59, s58, s78
    s_add_u32 s60, s58, s77
    s_add_u32 s61, s59, s77
    s_add_u32 s48, s48, 1
    s_sub_u32 s49, s49, 1
    s_waitcnt lgkmcnt(0)
    s_cmp_eq_u32 s49, 0
    s_cbranch_scc1 L1_V_t0
    s_branch L1_V_b1
L1_V_b0:
    s_waitcnt lgkmcnt(8)
    v_mfma_f32_32x32x16_bf16 v[128:143], a[0:3], v[96:99], 0
    ds_read_b64_tr_b16 v[120:121], v7 offset:6144
    ds_read_b64_tr_b16 v[122:123], v7 offset:6400
    ds_read_b64_tr_b16 v[124:125], v7 offset:6656
    v_mfma_f32_32x32x16_bf16 v[144:159], a[128:131], v[96:99], 0
    ds_read_b64_tr_b16 v[126:127], v7 offset:6912
    s_cmp_gt_i32 s52, 0
    s_cselect_b32 s65, s51, 0x40000000
    s_sub_u32 s52, s52, 1
    s_add_u32 s68, s65, s73
    v_mfma_f32_32x32x16_bf16 v[160:175], a[0:3], v[100:103], 0
    s_add_u32 m0, s53, 0
    s_nop 0
    buffer_load_dwordx4 v2, s[32:35], s65 offen lds
    v_mfma_f32_32x32x16_bf16 v[176:191], a[128:131], v[100:103], 0
    s_add_u32 m0, s53, 0x400
    s_nop 0
    buffer_load_dwordx4 v3, s[32:35], s65 offen lds
    s_waitcnt lgkmcnt(8)
    v_mfma_f32_32x32x16_bf16 v[128:143], a[4:7], v[104:107], v[128:143]
    ds_read_b64_tr_b16 v[96:97], v7 offset:8192
    ds_read_b64_tr_b16 v[98:99], v7 offset:8448
    ds_read_b64_tr_b16 v[100:101], v7 offset:8704
    v_mfma_f32_32x32x16_bf16 v[144:159], a[132:135], v[104:107], v[144:159]
    ds_read_b64_tr_b16 v[102:103], v7 offset:8960
    v_cvt_pk_bf16_f32 v16, v192, v193
    v_cvt_pk_bf16_f32 v17, v194, v195
    v_cvt_pk_bf16_f32 v18, v196, v197
    v_cvt_pk_bf16_f32 v19, v198, v199
    v_mfma_f32_32x32x16_bf16 v[160:175], a[4:7], v[108:111], v[160:175]
    s_add_u32 m0, s53, 0x800
    s_nop 0
    buffer_load_dwordx4 v4, s[32:35], s65 offen lds
    v_mfma_f32_32x32x16_bf16 v[176:191], a[132:135], v[108:111], v[176:191]
    s_add_u32 m0, s53, 0xc00
    s_nop 0
    buffer_load_dwordx4 v5, s[32:35], s65 offen lds
    s_waitcnt lgkmcnt(8)
    v_mfma_f32_32x32x16_bf16 v[128:143], a[8:11], v[112:115], v[128:143]
    ds_read_b64_tr_b16 v[104:105], v7 offset:10240
    ds_read_b64_tr_b16 v[106:107], v7 offset:10496
    ds_read_b64_tr_b16 v[108:109], v7 offset:10752
    v_mfma_f32_32x32x16_bf16 v[144:159], a[136:139], v[112:115], v[144:159]
    ds_read_b64_tr_b16 v[110:111], v7 offset:11008
    buffer_store_dwordx4 v[16:19], v1, s[36:39], s58 offen sc1
    v_mfma_f32_32x32x16_bf16 v[160:175], a[8:11], v[116:119], v[160:175]
    s_add_u32 m0, s53, 0x1000
    s_nop 0
    buffer_load_dwordx4 v2, s[32:35], s68 offen lds
    v_mfma_f32_32x32x16_bf16 v[176:191], a[136:139], v[116:119], v[176:191]
    s_add_u32 m0, s53, 0x1400
    s_nop 0
    buffer_load_dwordx4 v3, s[32:35], s68 offen lds
    s_waitcnt lgkmcnt(8)
    v_mfma_f32_32x32x16_bf16 v[128:143], a[12:15], v[120:123], v[128:143]
    ds_read_b64_tr_b16 v[112:113], v7 offset:12288
    ds_read_b64_tr_b16 v[114:115], v7 offset:12544
    ds_read_b64_tr_b16 v[116:117], v7 offset:12800
    v_mfma_f32_32x32x16_bf16 v[144:159], a[140:143], v[120:123], v[144:159]
    ds_read_b64_tr_b16 v[118:119], v7 offset:13056
    v_cvt_pk_bf16_f32 v20, v200, v201
    v_cvt_pk_bf16_f32 v21, v202, v203
    v_cvt_pk_bf16_f32 v22, v204, v205
    v_cvt_pk_bf16_f32 v23, v206, v207
    v_mfma_f32_32x32x16_bf16 v[160:175], a[12:15], v[124:127], v[160:175]
    s_add_u32 m0, s53, 0x1800
    s_nop 0
    buffer_load_dwordx4 v4, s[32:35], s68 offen lds
    v_mfma_f32_32x32x16_bf16 v[176:191], a[140:143], v[124:127], v[176:191]
    s_add_u32 m0, s53, 0x1c00
    s_nop 0
    buffer_load_dwordx4 v5, s[32:35], s68 offen lds
    s_waitcnt lgkmcnt(8)
    v_mfma_f32_32x32x16_bf16 v[128:143], a[16:19], v[96:99], v[128:143]
    ds_read_b64_tr_b16 v[120:121], v7 offset:14336
    ds_read_b64_tr_b16 v[122:123], v7 offset:14592
    ds_read_b64_tr_b16 v[124:125], v7 offset:14848
    v_mfma_f32_32x32x16_bf16 v[144:159], a[144:147], v[96:99], v[144:159]
    ds_read_b64_tr_b16 v[126:127], v7 offset:15104
    s_add_u32 s51, s51, s75
    s_add_u32 s53, s53, 0x8000
    v_mfma_f32_32x32x16_bf16 v[160:175], a[16:19], v[100:103], v[160:175]
    s_sub_u32 s57, s53, 0x28000
    s_cmp_ge_u32 s53, 0x28000
    s_cselect_b32 s53, s57, s53
    s_add_u32 s54, s54, 0x8000
    s_cmp_ge_u32 s54, 0x28000
    s_cselect_b32 s54, 0, s54
    v_mfma_f32_32x32x16_bf16 v[176:191], a[144:147], v[100:103], v[176:191]
    buffer_store_dwordx4 v[20:23], v1, s[36:39], s59 offen sc1
    v_cvt_pk_bf16_f32 v16, v224, v225
    v_cvt_pk_bf16_f32 v17, v226, v227
    s_waitcnt lgkmcnt(8)
    v_mfma_f32_32x32x16_bf16 v[128:143], a[20:23], v[104:107], v[128:143]
    ds_read_b64_tr_b16 v[96:97], v7 offset:16384
    ds_read_b64_tr_b16 v[98:99], v7 offset:16640
    ds_read_b64_tr_b16 v[100:101], v7 offset:16896
    v_mfma_f32_32x32x16_bf16 v[144:159], a[148:151], v[104:107], v[144:159]
    ds_read_b64_tr_b16 v[102:103], v7 offset:17152
    v_cvt_pk_bf16_f32 v18, v228, v229
    v_cvt_pk_bf16_f32 v19, v230, v231
    v_mfma_f32_32x32x16_bf16 v[160:175], a[20:23], v[108:111], v[160:175]
    buffer_store_dwordx4 v[16:19], v1, s[36:39], s58 offen offset:1024 sc1
    v_cvt_pk_bf16_f32 v20, v232, v233
    v_cvt_pk_bf16_f32 v21, v234, v235
    v_mfma_f32_32x32x16_bf16 v[176:191], a[148:151], v[108:111], v[176:191]
    v_cvt_pk_bf16_f32 v22, v236, v237
    v_cvt_pk_bf16_f32 v23, v238, v239
    buffer_store_dwordx4 v[20:23], v1, s[36:39], s59 offen offset:1024 sc1
    s_waitcnt lgkmcnt(8)
    v_mfma_f32_32x32x16_bf16 v[128:143], a[24:27], v[112:115], v[128:143]
    ds_read_b64_tr_b16 v[104:105], v7 offset:18432
    ds_read_b64_tr_b16 v[106:107], v7 offset:18688
    ds_read_b64_tr_b16 v[108:109], v7 offset:18944
    v_mfma_f32_32x32x16_bf16 v[144:159], a[152:155], v[112:115], v[144:159]
    ds_read_b64_tr_b16 v[110:111], v7 offset:19200
    v_cvt_pk_bf16_f32 v16, v208, v209
    v_cvt_pk_bf16_f32 v17, v210, v211
    v_cvt_pk_bf16_f32 v18, v212, v213
    v_cvt_pk_bf16_f32 v19, v214, v215
    v_mfma_f32_32x32x16_bf16 v[160:175], a[24:27], v[116:119], v[160:175]
    buffer_store_dwordx4 v[16:19], v1, s[36:39], s60 offen sc1
    v_cvt_pk_bf16_f32 v20, v216, v217
    v_cvt_pk_bf16_f32 v21, v218, v219
    v_mfma_f32_32x32x16_bf16 v[176:191], a[152:155], v[116:119], v[176:191]
    v_cvt_pk_bf16_f32 v22, v220, v221
    v_cvt_pk_bf16_f32 v23, v222, v223
    buffer_store_dwordx4 v[20:23], v1, s[36:39], s61 offen sc1
    s_waitcnt lgkmcnt(8)
    v_mfma_f32_32x32x16_bf16 v[128:143], a[28:31], v[120:123], v[128:143]
    ds_read_b64_tr_b16 v[112:113], v7 offset:20480
    ds_read_b64_tr_b16 v[114:115], v7 offset:20736
    ds_read_b64_tr_b16 v[116:117], v7 offset:20992
    v_mfma_f32_32x32x16_bf16 v[144:159], a[156:159], v[120:123], v[144:159]
    ds_read_b64_tr_b16 v[118:119], v7 offset:21248
    v_cvt_pk_bf16_f32 v16, v240, v241
    v_cvt_pk_bf16_f32 v17, v242, v243
    v_cvt_pk_bf16_f32 v18, v244, v245
    v_cvt_pk_bf16_f32 v19, v246, v247
    v_mfma_f32_32x32x16_bf16 v[160:175], a[28:31], v[124:127], v[160:175]
    buffer_store_dwordx4 v[16:19], v1, s[36:39], s60 offen offset:1024 sc1
    v_cvt_pk_bf16_f32 v20, v248, v249
    v_cvt_pk_bf16_f32 v21, v250, v251
    v_mfma_f32_32x32x16_bf16 v[176:191], a[156:159], v[124:127], v[176:191]
    v_cvt_pk_bf16_f32 v22, v252, v253
    v_cvt_pk_bf16_f32 v23, v254, v255
    buffer_store_dwordx4 v[20:23], v1, s[36:39], s61 offen offset:1024 sc1
    s_waitcnt lgkmcnt(8)
    v_mfma_f32_32x32x16_bf16 v[128:143], a[32:35], v[96:99], v[128:143]
    ds_read_b64_tr_b16 v[120:121], v7 offset:22528
    ds_read_b64_tr_b16 v[122:123], v7 offset:22784
    ds_read_b64_tr_b16 v[124:125], v7 offset:23040
    v_mfma_f32_32x32x16_bf16 v[144:159], a[160:163], v[96:99], v[144:159]
    ds_read_b64_tr_b16 v[126:127], v7 offset:23296
    v_mfma_f32_32x32x16_bf16 v[160:175], a[32:35], v[100:103], v[160:175]
    v_mfma_f32_32x32x16_bf16 v[176:191], a[160:163], v[100:103], v[176:191]
    s_waitcnt lgkmcnt(8)
    v_mfma_f32_32x32x16_bf16 v[128:143], a[36:39], v[104:107], v[128:143]
    ds_read_b64_tr_b16 v[96:97], v7 offset:24576
    ds_read_b64_tr_b16 v[98:99], v7 offset:24832
    ds_read_b64_tr_b16 v[100:101], v7 offset:25088
    v_mfma_f32_32x32x16_bf16 v[144:159], a[164:167], v[104:107], v[144:159]
    ds_read_b64_tr_b16 v[102:103], v7 offset:25344
    v_mfma_f32_32x32x16_bf16 v[160:175], a[36:39], v[108:111], v[160:175]
    v_mfma_f32_32x32x16_bf16 v[176:191], a[164:167], v[108:111], v[176:191]
    s_waitcnt lgkmcnt(8)
    v_mfma_f32_32x32x16_bf16 v[128:143], a[40:43], v[112:115], v[128:143]
    ds_read_b64_tr_b16 v[104:105], v7 offset:26624
    ds_read_b64_tr_b16 v[106:107], v7 offset:26880
    ds_read_b64_tr_b16 v[108:109], v7 offset:27136
    v_mfma_f32_32x32x16_bf16 v[144:159], a[168:171], v[112:115], v[144:159]
    ds_read_b64_tr_b16 v[110:111], v7 offset:27392
    v_mfma_f32_32x32x16_bf16 v[160:175], a[40:43], v[116:119], v[160:175]
    v_mfma_f32_32x32x16_bf16 v[176:191], a[168:171], v[116:119], v[176:191]
    s_waitcnt lgkmcnt(8)
    v_mfma_f32_32x32x16_bf16 v[128:143], a[44:47], v[120:123], v[128:143]
    ds_read_b64_tr_b16 v[112:113], v7 offset:28672
    ds_read_b64_tr_b16 v[114:115], v7 offset:28928
    ds_read_b64_tr_b16 v[116:117], v7 offset:29184
    v_mfma_f32_32x32x16_bf16 v[144:159], a[172:175], v[120:123], v[144:159]
    ds_read_b64_tr_b16 v[118:119], v7 offset:29440
    v_mfma_f32_32x32x16_bf16 v[160:175], a[44:47], v[124:127], v[160:175]
    v_mfma_f32_32x32x16_bf16 v[176:191], a[172:175], v[124:127], v[176:191]
    s_waitcnt lgkmcnt(8)
    v_mfma_f32_32x32x16_bf16 v[128:143], a[48:51], v[96:99], v[128:143]
    ds_read_b64_tr_b16 v[120:121], v7 offset:30720
    ds_read_b64_tr_b16 v[122:123], v7 offset:30976
    ds_read_b64_tr_b16 v[124:125], v7 offset:31232
    v_mfma_f32_32x32x16_bf16 v[144:159], a[176:179], v[96:99], v[144:159]
    ds_read_b64_tr_b16 v[126:127], v7 offset:31488
    v_mfma_f32_32x32x16_bf16 v[160:175], a[48:51], v[100:103], v[160:175]
    v_mfma_f32_32x32x16_bf16 v[176:191], a[176:179], v[100:103], v[176:191]
    s_waitcnt vmcnt(16)
    s_barrier
    v_add_u32 v7, s54, v6
    s_waitcnt lgkmcnt(8)
    v_mfma_f32_32x32x16_bf16 v[128:143], a[52:55], v[104:107], v[128:143]
    ds_read_b64_tr_b16 v[96:97], v7
    ds_read_b64_tr_b16 v[98:99], v7 offset:256
    ds_read_b64_tr_b16 v[100:101], v7 offset:512
    v_mfma_f32_32x32x16_bf16 v[144:159], a[180:183], v[104:107], v[144:159]
    ds_read_b64_tr_b16 v[102:103], v7 offset:768
    global_load_dword v45, v44, s[84:85]
    v_mfma_f32_32x32x16_bf16 v[160:175], a[52:55], v[108:111], v[160:175]
    s_mov_b64 s[84:85], s[86:87]
    s_mov_b64 s[86:87], s[88:89]
    s_mov_b64 s[88:89], s[90:91]
    s_mov_b64 s[90:91], s[92:93]
    s_cmp_gt_i32 s52, 0
    s_cselect_b32 s65, s51, 0x40000000
    v_mfma_f32_32x32x16_bf16 v[176:191], a[180:183], v[108:111], v[176:191]
    s_sub_u32 s52, s52, 1
    s_add_u32 s68, s65, s73
    s_waitcnt lgkmcnt(8)
    v_mfma_f32_32x32x16_bf16 v[128:143], a[56:59], v[112:115], v[128:143]
    ds_read_b64_tr_b16 v[104:105], v7 offset:2048
    ds_read_b64_tr_b16 v[106:107], v7 offset:2304
    ds_read_b64_tr_b16 v[108:109], v7 offset:2560
    v_mfma_f32_32x32x16_bf16 v[144:159], a[184:187], v[112:115], v[144:159]
    ds_read_b64_tr_b16 v[110:111], v7 offset:2816
    v_mfma_f32_32x32x16_bf16 v[160:175], a[56:59], v[116:119], v[160:175]
    s_add_u32 m0, s53, 0
    s_nop 0
    buffer_load_dwordx4 v2, s[32:35], s65 offen lds
    v_mfma_f32_32x32x16_bf16 v[176:191], a[184:187], v[116:119], v[176:191]
    s_add_u32 m0, s53, 0x400
    s_nop 0
    buffer_load_dwordx4 v3, s[32:35], s65 offen lds
    s_waitcnt lgkmcnt(8)
    v_mfma_f32_32x32x16_bf16 v[128:143], a[60:63], v[120:123], v[128:143]
    ds_read_b64_tr_b16 v[112:113], v7 offset:4096
    ds_read_b64_tr_b16 v[114:115], v7 offset:4352
    ds_read_b64_tr_b16 v[116:117], v7 offset:4608
    v_mfma_f32_32x32x16_bf16 v[144:159], a[188:191], v[120:123], v[144:159]
    ds_read_b64_tr_b16 v[118:119], v7 offset:4864
    v_mfma_f32_32x32x16_bf16 v[160:175], a[60:63], v[124:127], v[160:175]
    s_add_u32 m0, s53, 0x800
    s_nop 0
    buffer_load_dwordx4 v4, s[32:35], s65 offen lds
    v_mfma_f32_32x32x16_bf16 v[176:191], a[188:191], v[124:127], v[176:191]
    s_add_u32 m0, s53, 0xc00
    s_nop 0
    buffer_load_dwordx4 v5, s[32:35], s65 offen lds
    s_waitcnt lgkmcnt(8)
    v_mfma_f32_32x32x16_bf16 v[128:143], a[64:67], v[96:99], v[128:143]
    ds_read_b64_tr_b16 v[120:121], v7 offset:6144
    ds_read_b64_tr_b16 v[122:123], v7 offset:6400
    ds_read_b64_tr_b16 v[124:125], v7 offset:6656
    v_mfma_f32_32x32x16_bf16 v[144:159], a[192:195], v[96:99], v[144:159]
    ds_read_b64_tr_b16 v[126:127], v7 offset:6912
    v_mfma_f32_32x32x16_bf16 v[160:175], a[64:67], v[100:103], v[160:175]
    s_add_u32 m0, s53, 0x1000
    s_nop 0
    buffer_load_dwordx4 v2, s[32:35], s68 offen lds
    v_mfma_f32_32x32x16_bf16 v[176:191], a[192:195], v[100:103], v[176:191]
    s_add_u32 m0, s53, 0x1400
    s_nop 0
    buffer_load_dwordx4 v3, s[32:35], s68 offen lds
    s_waitcnt lgkmcnt(8)
    v_mfma_f32_32x32x16_bf16 v[128:143], a[68:71], v[104:107], v[128:143]
    ds_read_b64_tr_b16 v[96:97], v7 offset:8192
    ds_read_b64_tr_b16 v[98:99], v7 offset:8448
    ds_read_b64_tr_b16 v[100:101], v7 offset:8704
    v_mfma_f32_32x32x16_bf16 v[144:159], a[196:199], v[104:107], v[144:159]
    ds_read_b64_tr_b16 v[102:103], v7 offset:8960
    v_mfma_f32_32x32x16_bf16 v[160:175], a[68:71], v[108:111], v[160:175]
    s_add_u32 m0, s53, 0x1800
    s_nop 0
    buffer_load_dwordx4 v4, s[32:35], s68 offen lds
    v_mfma_f32_32x32x16_bf16 v[176:191], a[196:199], v[108:111], v[176:191]
    s_add_u32 m0, s53, 0x1c00
    s_nop 0
    buffer_load_dwordx4 v5, s[32:35], s68 offen lds
    s_waitcnt lgkmcnt(8)
    v_mfma_f32_32x32x16_bf16 v[128:143], a[72:75], v[112:115], v[128:143]
    ds_read_b64_tr_b16 v[104:105], v7 offset:10240
    ds_read_b64_tr_b16 v[106:107], v7 offset:10496
    ds_read_b64_tr_b16 v[108:109], v7 offset:10752
    v_mfma_f32_32x32x16_bf16 v[144:159], a[200:203], v[112:115], v[144:159]
    ds_read_b64_tr_b16 v[110:111], v7 offset:11008
    s_add_u32 s51, s51, s74
    s_add_u32 s53, s53, 0x8000
    v_mfma_f32_32x32x16_bf16 v[160:175], a[72:75], v[116:119], v[160:175]
    s_sub_u32 s57, s53, 0x28000
    s_cmp_ge_u32 s53, 0x28000
    s_cselect_b32 s53, s57, s53
    v_mfma_f32_32x32x16_bf16 v[176:191], a[200:203], v[116:119], v[176:191]
    s_add_u32 s54, s54, 0x8000
    s_cmp_ge_u32 s54, 0x28000
    s_cselect_b32 s54, 0, s54
    s_waitcnt lgkmcnt(8)
    v_mfma_f32_32x32x16_bf16 v[128:143], a[76:79], v[120:123], v[128:143]
    ds_read_b64_tr_b16 v[112:113], v7 offset:12288
    ds_read_b64_tr_b16 v[114:115], v7 offset:12544
    ds_read_b64_tr_b16 v[116:117], v7 offset:12800
    v_mfma_f32_32x32x16_bf16 v[144:159], a[204:207], v[120:123], v[144:159]
    ds_read_b64_tr_b16 v[118:119], v7 offset:13056
    v_mfma_f32_32x32x16_bf16 v[160:175], a[76:79], v[124:127], v[160:175]
    v_mfma_f32_32x32x16_bf16 v[176:191], a[204:207], v[124:127], v[176:191]
    s_waitcnt lgkmcnt(8)
    v_mfma_f32_32x32x16_bf16 v[128:143], a[80:83], v[96:99], v[128:143]
    ds_read_b64_tr_b16 v[120:121], v7 offset:14336
    ds_read_b64_tr_b16 v[122:123], v7 offset:14592
    ds_read_b64_tr_b16 v[124:125], v7 offset:14848
    v_mfma_f32_32x32x16_bf16 v[144:159], a[208:211], v[96:99], v[144:159]
    ds_read_b64_tr_b16 v[126:127], v7 offset:15104
    v_mfma_f32_32x32x16_bf16 v[160:175], a[80:83], v[100:103], v[160:175]
    v_mfma_f32_32x32x16_bf16 v[176:191], a[208:211], v[100:103], v[176:191]
    s_waitcnt lgkmcnt(8)
    v_mfma_f32_32x32x16_bf16 v[128:143], a[84:87], v[104:107], v[128:143]
    ds_read_b64_tr_b16 v[96:97], v7 offset:16384
    ds_read_b64_tr_b16 v[98:99], v7 offset:16640
    ds_read_b64_tr_b16 v[100:101], v7 offset:16896
    v_mfma_f32_32x32x16_bf16 v[144:159], a[212:215], v[104:107], v[144:159]
    ds_read_b64_tr_b16 v[102:103], v7 offset:17152
    v_mfma_f32_32x32x16_bf16 v[160:175], a[84:87], v[108:111], v[160:175]
    v_mfma_f32_32x32x16_bf16 v[176:191], a[212:215], v[108:111], v[176:191]
    s_waitcnt lgkmcnt(8)
    v_mfma_f32_32x32x16_bf16 v[128:143], a[88:91], v[112:115], v[128:143]
    ds_read_b64_tr_b16 v[104:105], v7 offset:18432
    ds_read_b64_tr_b16 v[106:107], v7 offset:18688
    ds_read_b64_tr_b16 v[108:109], v7 offset:18944
    v_mfma_f32_32x32x16_bf16 v[144:159], a[216:219], v[112:115], v[144:159]
    ds_read_b64_tr_b16 v[110:111], v7 offset:19200
    v_mfma_f32_32x32x16_bf16 v[160:175], a[88:91], v[116:119], v[160:175]
    v_mfma_f32_32x32x16_bf16 v[176:191], a[216:219], v[116:119], v[176:191]
    s_waitcnt lgkmcnt(8)
    v_mfma_f32_32x32x16_bf16 v[128:143], a[92:95], v[120:123], v[128:143]
    ds_read_b64_tr_b16 v[112:113], v7 offset:20480
    ds_read_b64_tr_b16 v[114:115], v7 offset:20736
    ds_read_b64_tr_b16 v[116:117], v7 offset:20992
    v_mfma_f32_32x32x16_bf16 v[144:159], a[220:223], v[120:123], v[144:159]
    ds_read_b64_tr_b16 v[118:119], v7 offset:21248
    v_mfma_f32_32x32x16_bf16 v[160:175], a[92:95], v[124:127], v[160:175]
    v_mfma_f32_32x32x16_bf16 v[176:191], a[220:223], v[124:127], v[176:191]
    s_waitcnt lgkmcnt(8)
    v_mfma_f32_32x32x16_bf16 v[128:143], a[96:99], v[96:99], v[128:143]
    ds_read_b64_tr_b16 v[120:121], v7 offset:22528
    ds_read_b64_tr_b16 v[122:123], v7 offset:22784
    ds_read_b64_tr_b16 v[124:125], v7 offset:23040
    v_mfma_f32_32x32x16_bf16 v[144:159], a[224:227], v[96:99], v[144:159]
    ds_read_b64_tr_b16 v[126:127], v7 offset:23296
    v_mfma_f32_32x32x16_bf16 v[160:175], a[96:99], v[100:103], v[160:175]
    v_mfma_f32_32x32x16_bf16 v[176:191], a[224:227], v[100:103], v[176:191]
    s_waitcnt lgkmcnt(8)
    v_mfma_f32_32x32x16_bf16 v[128:143], a[100:103], v[104:107], v[128:143]
    ds_read_b64_tr_b16 v[96:97], v7 offset:24576
    ds_read_b64_tr_b16 v[98:99], v7 offset:24832
    ds_read_b64_tr_b16 v[100:101], v7 offset:25088
    v_mfma_f32_32x32x16_bf16 v[144:159], a[228:231], v[104:107], v[144:159]
    ds_read_b64_tr_b16 v[102:103], v7 offset:25344
    v_mfma_f32_32x32x16_bf16 v[160:175], a[100:103], v[108:111], v[160:175]
    v_mfma_f32_32x32x16_bf16 v[176:191], a[228:231], v[108:111], v[176:191]
    s_waitcnt lgkmcnt(8)
    v_mfma_f32_32x32x16_bf16 v[128:143], a[104:107], v[112:115], v[128:143]
    ds_read_b64_tr_b16 v[104:105], v7 offset:26624
    ds_read_b64_tr_b16 v[106:107], v7 offset:26880
    ds_read_b64_tr_b16 v[108:109], v7 offset:27136
    v_mfma_f32_32x32x16_bf16 v[144:159], a[232:235], v[112:115], v[144:159]
    ds_read_b64_tr_b16 v[110:111], v7 offset:27392
    v_mfma_f32_32x32x16_bf16 v[160:175], a[104:107], v[116:119], v[160:175]
    v_mfma_f32_32x32x16_bf16 v[176:191], a[232:235], v[116:119], v[176:191]
    s_waitcnt lgkmcnt(8)
    v_mfma_f32_32x32x16_bf16 v[128:143], a[108:111], v[120:123], v[128:143]
    ds_read_b64_tr_b16 v[112:113], v7 offset:28672
    ds_read_b64_tr_b16 v[114:115], v7 offset:28928
    ds_read_b64_tr_b16 v[116:117], v7 offset:29184
    v_mfma_f32_32x32x16_bf16 v[144:159], a[236:239], v[120:123], v[144:159]
    ds_read_b64_tr_b16 v[118:119], v7 offset:29440
    v_mfma_f32_32x32x16_bf16 v[160:175], a[108:111], v[124:127], v[160:175]
    v_mfma_f32_32x32x16_bf16 v[176:191], a[236:239], v[124:127], v[176:191]
    s_waitcnt lgkmcnt(8)
    v_mfma_f32_32x32x16_bf16 v[128:143], a[112:115], v[96:99], v[128:143]
    ds_read_b64_tr_b16 v[120:121], v7 offset:30720
    ds_read_b64_tr_b16 v[122:123], v7 offset:30976
    ds_read_b64_tr_b16 v[124:125], v7 offset:31232
    v_mfma_f32_32x32x16_bf16 v[144:159], a[240:243], v[96:99], v[144:159]
    ds_read_b64_tr_b16 v[126:127], v7 offset:31488
    v_mfma_f32_32x32x16_bf16 v[160:175], a[112:115], v[100:103], v[160:175]
    v_mfma_f32_32x32x16_bf16 v[176:191], a[240:243], v[100:103], v[176:191]
    s_waitcnt vmcnt(16)
    s_barrier
    v_add_u32 v7, s54, v6
    s_waitcnt lgkmcnt(8)
    v_mfma_f32_32x32x16_bf16 v[128:143], a[116:119], v[104:107], v[128:143]
    ds_read_b64_tr_b16 v[96:97], v7
    ds_read_b64_tr_b16 v[98:99], v7 offset:256
    ds_read_b64_tr_b16 v[100:101], v7 offset:512
    v_mfma_f32_32x32x16_bf16 v[144:159], a[244:247], v[104:107], v[144:159]
    ds_read_b64_tr_b16 v[102:103], v7 offset:768
    v_mfma_f32_32x32x16_bf16 v[160:175], a[116:119], v[108:111], v[160:175]
    v_mfma_f32_32x32x16_bf16 v[176:191], a[244:247], v[108:111], v[176:191]
    s_waitcnt lgkmcnt(8)
    v_mfma_f32_32x32x16_bf16 v[128:143], a[120:123], v[112:115], v[128:143]
    ds_read_b64_tr_b16 v[104:105], v7 offset:2048
    ds_read_b64_tr_b16 v[106:107], v7 offset:2304
    ds_read_b64_tr_b16 v[108:109], v7 offset:2560
    v_mfma_f32_32x32x16_bf16 v[144:159], a[248:251], v[112:115], v[144:159]
    ds_read_b64_tr_b16 v[110:111], v7 offset:2816
    v_mfma_f32_32x32x16_bf16 v[160:175], a[120:123], v[116:119], v[160:175]
    v_mfma_f32_32x32x16_bf16 v[176:191], a[248:251], v[116:119], v[176:191]
    s_waitcnt lgkmcnt(8)
    v_mfma_f32_32x32x16_bf16 v[128:143], a[124:127], v[120:123], v[128:143]
    ds_read_b64_tr_b16 v[112:113], v7 offset:4096
    ds_read_b64_tr_b16 v[114:115], v7 offset:4352
    ds_read_b64_tr_b16 v[116:117], v7 offset:4608
    v_mfma_f32_32x32x16_bf16 v[144:159], a[252:255], v[120:123], v[144:159]
    ds_read_b64_tr_b16 v[118:119], v7 offset:4864
    v_mfma_f32_32x32x16_bf16 v[160:175], a[124:127], v[124:127], v[160:175]
    v_mfma_f32_32x32x16_bf16 v[176:191], a[252:255], v[124:127], v[176:191]
    s_lshr_b32 s55, s48, 1
    s_mul_i32 s55, s55, s76
    s_and_b32 s56, s48, 1
    s_lshl_b32 s56, s56, 11
    s_add_u32 s55, s55, s56
    s_add_u32 s58, s55, s64
    s_add_u32 s59, s58, s78
    s_add_u32 s60, s58, s77
    s_add_u32 s61, s59, s77
    s_add_u32 s48, s48, 1
    s_sub_u32 s49, s49, 1
    s_cmp_eq_u32 s49, 0
    s_cbranch_scc1 L1_V_t0
L1_V_b1:
    s_waitcnt lgkmcnt(8)
    v_mfma_f32_32x32x16_bf16 v[192:207], a[0:3], v[96:99], 0
    ds_read_b64_tr_b16 v[120:121], v7 offset:6144
    ds_read_b64_tr_b16 v[122:123], v7 offset:6400
    ds_read_b64_tr_b16 v[124:125], v7 offset:6656
    v_mfma_f32_32x32x16_bf16 v[208:223], a[128:131], v[96:99], 0
    ds_read_b64_tr_b16 v[126:127], v7 offset:6912
    s_cmp_gt_i32 s52, 0
    s_cselect_b32 s65, s51, 0x40000000
    s_sub_u32 s52, s52, 1
    s_add_u32 s68, s65, s73
    v_mfma_f32_32x32x16_bf16 v[224:239], a[0:3], v[100:103], 0
    s_add_u32 m0, s53, 0
    s_nop 0
    buffer_load_dwordx4 v2, s[32:35], s65 offen lds
    v_mfma_f32_32x32x16_bf16 v[240:255], a[128:131], v[100:103], 0
    s_add_u32 m0, s53, 0x400
    s_nop 0
    buffer_load_dwordx4 v3, s[32:35], s65 offen lds
    s_waitcnt lgkmcnt(8)
    v_mfma_f32_32x32x16_bf16 v[192:207], a[4:7], v[104:107], v[192:207]
    ds_read_b64_tr_b16 v[96:97], v7 offset:8192
    ds_read_b64_tr_b16 v[98:99], v7 offset:8448
    ds_read_b64_tr_b16 v[100:101], v7 offset:8704
    v_mfma_f32_32x32x16_bf16 v[208:223], a[132:135], v[104:107], v[208:223]
    ds_read_b64_tr_b16 v[102:103], v7 offset:8960
    v_cvt_pk_bf16_f32 v16, v128, v129
    v_cvt_pk_bf16_f32 v17, v130, v131
    v_cvt_pk_bf16_f32 v18, v132, v133
    v_cvt_pk_bf16_f32 v19, v134, v135
    v_mfma_f32_32x32x16_bf16 v[224:239], a[4:7], v[108:111], v[224:239]
    s_add_u32 m0, s53, 0x800
    s_nop 0
    buffer_load_dwordx4 v4, s[32:35], s65 offen lds
    v_mfma_f32_32x32x16_bf16 v[240:255], a[132:135], v[108:111], v[240:255]
    s_add_u32 m0, s53, 0xc00
    s_nop 0
    buffer_load_dwordx4 v5, s[32:35], s65 offen lds
    s_waitcnt lgkmcnt(8)
    v_mfma_f32_32x32x16_bf16 v[192:207], a[8:11], v[112:115], v[192:207]
    ds_read_b64_tr_b16 v[104:105], v7 offset:10240
    ds_read_b64_tr_b16 v[106:107], v7 offset:10496
    ds_read_b64_tr_b16 v[108:109], v7 offset:10752
    v_mfma_f32_32x32x16_bf16 v[208:223], a[136:139], v[112:115], v[208:223]
    ds_read_b64_tr_b16 v[110:111], v7 offset:11008
    buffer_store_dwordx4 v[16:19], v1, s[36:39], s58 offen sc1
    v_mfma_f32_32x32x16_bf16 v[224:239], a[8:11], v[116:119], v[224:239]
    s_add_u32 m0, s53, 0x1000
    s_nop 0
    buffer_load_dwordx4 v2, s[32:35], s68 offen lds
    v_mfma_f32_32x32x16_bf16 v[240:255], a[136:139], v[116:119], v[240:255]
    s_add_u32 m0, s53, 0x1400
    s_nop 0
    buffer_load_dwordx4 v3, s[32:35], s68 offen lds
    s_waitcnt lgkmcnt(8)
    v_mfma_f32_32x32x16_bf16 v[192:207], a[12:15], v[120:123], v[192:207]
    ds_read_b64_tr_b16 v[112:113], v7 offset:12288
    ds_read_b64_tr_b16 v[114:115], v7 offset:12544
    ds_read_b64_tr_b16 v[116:117], v7 offset:12800
    v_mfma_f32_32x32x16_bf16 v[208:223], a[140:143], v[120:123], v[208:223]
    ds_read_b64_tr_b16 v[118:119], v7 offset:13056
    v_cvt_pk_bf16_f32 v20, v136, v137
    v_cvt_pk_bf16_f32 v21, v138, v139
    v_cvt_pk_bf16_f32 v22, v140, v141
    v_cvt_pk_bf16_f32 v23, v142, v143
    v_mfma_f32_32x32x16_bf16 v[224:239], a[12:15], v[124:127], v[224:239]
    s_add_u32 m0, s53, 0x1800
    s_nop 0
    buffer_load_dwordx4 v4, s[32:35], s68 offen lds
    v_mfma_f32_32x32x16_bf16 v[240:255], a[140:143], v[124:127], v[240:255]
    s_add_u32 m0, s53, 0x1c00
    s_nop 0
    buffer_load_dwordx4 v5, s[32:35], s68 offen lds
    s_waitcnt lgkmcnt(8)
    v_mfma_f32_32x32x16_bf16 v[192:207], a[16:19], v[96:99], v[192:207]
    ds_read_b64_tr_b16 v[120:121], v7 offset:14336
    ds_read_b64_tr_b16 v[122:123], v7 offset:14592
    ds_read_b64_tr_b16 v[124:125], v7 offset:14848
    v_mfma_f32_32x32x16_bf16 v[208:223], a[144:147], v[96:99], v[208:223]
    ds_read_b64_tr_b16 v[126:127], v7 offset:15104
    s_add_u32 s51, s51, s75
    s_add_u32 s53, s53, 0x8000
    v_mfma_f32_32x32x16_bf16 v[224:239], a[16:19], v[100:103], v[224:239]
    s_sub_u32 s57, s53, 0x28000
    s_cmp_ge_u32 s53, 0x28000
    s_cselect_b32 s53, s57, s53
    s_add_u32 s54, s54, 0x8000
    s_cmp_ge_u32 s54, 0x28000
    s_cselect_b32 s54, 0, s54
    v_mfma_f32_32x32x16_bf16 v[240:255], a[144:147], v[100:103], v[240:255]
    buffer_store_dwordx4 v[20:23], v1, s[36:39], s59 offen sc1
    v_cvt_pk_bf16_f32 v16, v160, v161
    v_cvt_pk_bf16_f32 v17, v162, v163
    s_waitcnt lgkmcnt(8)
    v_mfma_f32_32x32x16_bf16 v[192:207], a[20:23], v[104:107], v[192:207]
    ds_read_b64_tr_b16 v[96:97], v7 offset:16384
    ds_read_b64_tr_b16 v[98:99], v7 offset:16640
    ds_read_b64_tr_b16 v[100:101], v7 offset:16896
    v_mfma_f32_32x32x16_bf16 v[208:223], a[148:151], v[104:107], v[208:223]
    ds_read_b64_tr_b16 v[102:103], v7 offset:17152
    v_cvt_pk_bf16_f32 v18, v164, v165
    v_cvt_pk_bf16_f32 v19, v166, v167
    v_mfma_f32_32x32x16_bf16 v[224:239], a[20:23], v[108:111], v[224:239]
    buffer_store_dwordx4 v[16:19], v1, s[36:39], s58 offen offset:1024 sc1
    v_cvt_pk_bf16_f32 v20, v168, v169
    v_cvt_pk_bf16_f32 v21, v170, v171
    v_mfma_f32_32x32x16_bf16 v[240:255], a[148:151], v[108:111], v[240:255]
    v_cvt_pk_bf16_f32 v22, v172, v173
    v_cvt_pk_bf16_f32 v23, v174, v175
    buffer_store_dwordx4 v[20:23], v1, s[36:39], s59 offen offset:1024 sc1
    s_waitcnt lgkmcnt(8)
    v_mfma_f32_32x32x16_bf16 v[192:207], a[24:27], v[112:115], v[192:207]
    ds_read_b64_tr_b16 v[104:105], v7 offset:18432
    ds_read_b64_tr_b16 v[106:107], v7 offset:18688
    ds_read_b64_tr_b16 v[108:109], v7 offset:18944
    v_mfma_f32_32x32x16_bf16 v[208:223], a[152:155], v[112:115], v[208:223]
    ds_read_b64_tr_b16 v[110:111], v7 offset:19200
    v_cvt_pk_bf16_f32 v16, v144, v145
    v_cvt_pk_bf16_f32 v17, v146, v147
    v_cvt_pk_bf16_f32 v18, v148, v149
    v_cvt_pk_bf16_f32 v19, v150, v151
    v_mfma_f32_32x32x16_bf16 v[224:239], a[24:27], v[116:119], v[224:239]
    buffer_store_dwordx4 v[16:19], v1, s[36:39], s60 offen sc1
    v_cvt_pk_bf16_f32 v20, v152, v153
    v_cvt_pk_bf16_f32 v21, v154, v155
    v_mfma_f32_32x32x16_bf16 v[240:255], a[152:155], v[116:119], v[240:255]
    v_cvt_pk_bf16_f32 v22, v156, v157
    v_cvt_pk_bf16_f32 v23, v158, v159
    buffer_store_dwordx4 v[20:23], v1, s[36:39], s61 offen sc1
    s_waitcnt lgkmcnt(8)
    v_mfma_f32_32x32x16_bf16 v[192:207], a[28:31], v[120:123], v[192:207]
    ds_read_b64_tr_b16 v[112:113], v7 offset:20480
    ds_read_b64_tr_b16 v[114:115], v7 offset:20736
    ds_read_b64_tr_b16 v[116:117], v7 offset:20992
    v_mfma_f32_32x32x16_bf16 v[208:223], a[156:159], v[120:123], v[208:223]
    ds_read_b64_tr_b16 v[118:119], v7 offset:21248
    v_cvt_pk_bf16_f32 v16, v176, v177
    v_cvt_pk_bf16_f32 v17, v178, v179
    v_cvt_pk_bf16_f32 v18, v180, v181
    v_cvt_pk_bf16_f32 v19, v182, v183
    v_mfma_f32_32x32x16_bf16 v[224:239], a[28:31], v[124:127], v[224:239]
    buffer_store_dwordx4 v[16:19], v1, s[36:39], s60 offen offset:1024 sc1
    v_cvt_pk_bf16_f32 v20, v184, v185
    v_cvt_pk_bf16_f32 v21, v186, v187
    v_mfma_f32_32x32x16_bf16 v[240:255], a[156:159], v[124:127], v[240:255]
    v_cvt_pk_bf16_f32 v22, v188, v189
    v_cvt_pk_bf16_f32 v23, v190, v191
    buffer_store_dwordx4 v[20:23], v1, s[36:39], s61 offen offset:1024 sc1
    s_waitcnt lgkmcnt(8)
    v_mfma_f32_32x32x16_bf16 v[192:207], a[32:35], v[96:99], v[192:207]
    ds_read_b64_tr_b16 v[120:121], v7 offset:22528
    ds_read_b64_tr_b16 v[122:123], v7 offset:22784
    ds_read_b64_tr_b16 v[124:125], v7 offset:23040
    v_mfma_f32_32x32x16_bf16 v[208:223], a[160:163], v[96:99], v[208:223]
    ds_read_b64_tr_b16 v[126:127], v7 offset:23296
    v_mfma_f32_32x32x16_bf16 v[224:239], a[32:35], v[100:103], v[224:239]
    v_mfma_f32_32x32x16_bf16 v[240:255], a[160:163], v[100:103], v[240:255]
    s_waitcnt lgkmcnt(8)
    v_mfma_f32_32x32x16_bf16 v[192:207], a[36:39], v[104:107], v[192:207]
    ds_read_b64_tr_b16 v[96:97], v7 offset:24576
    ds_read_b64_tr_b16 v[98:99], v7 offset:24832
    ds_read_b64_tr_b16 v[100:101], v7 offset:25088
    v_mfma_f32_32x32x16_bf16 v[208:223], a[164:167], v[104:107], v[208:223]
    ds_read_b64_tr_b16 v[102:103], v7 offset:25344
    v_mfma_f32_32x32x16_bf16 v[224:239], a[36:39], v[108:111], v[224:239]
    v_mfma_f32_32x32x16_bf16 v[240:255], a[164:167], v[108:111], v[240:255]
    s_waitcnt lgkmcnt(8)
    v_mfma_f32_32x32x16_bf16 v[192:207], a[40:43], v[112:115], v[192:207]
    ds_read_b64_tr_b16 v[104:105], v7 offset:26624
    ds_read_b64_tr_b16 v[106:107], v7 offset:26880
    ds_read_b64_tr_b16 v[108:109], v7 offset:27136
    v_mfma_f32_32x32x16_bf16 v[208:223], a[168:171], v[112:115], v[208:223]
    ds_read_b64_tr_b16 v[110:111], v7 offset:27392
    v_mfma_f32_32x32x16_bf16 v[224:239], a[40:43], v[116:119], v[224:239]
    v_mfma_f32_32x32x16_bf16 v[240:255], a[168:171], v[116:119], v[240:255]
    s_waitcnt lgkmcnt(8)
    v_mfma_f32_32x32x16_bf16 v[192:207], a[44:47], v[120:123], v[192:207]
    ds_read_b64_tr_b16 v[112:113], v7 offset:28672
    ds_read_b64_tr_b16 v[114:115], v7 offset:28928
    ds_read_b64_tr_b16 v[116:117], v7 offset:29184
    v_mfma_f32_32x32x16_bf16 v[208:223], a[172:175], v[120:123], v[208:223]
    ds_read_b64_tr_b16 v[118:119], v7 offset:29440
    v_mfma_f32_32x32x16_bf16 v[224:239], a[44:47], v[124:127], v[224:239]
    v_mfma_f32_32x32x16_bf16 v[240:255], a[172:175], v[124:127], v[240:255]
    s_waitcnt lgkmcnt(8)
    v_mfma_f32_32x32x16_bf16 v[192:207], a[48:51], v[96:99], v[192:207]
    ds_read_b64_tr_b16 v[120:121], v7 offset:30720
    ds_read_b64_tr_b16 v[122:123], v7 offset:30976
    ds_read_b64_tr_b16 v[124:125], v7 offset:31232
    v_mfma_f32_32x32x16_bf16 v[208:223], a[176:179], v[96:99], v[208:223]
    ds_read_b64_tr_b16 v[126:127], v7 offset:31488
    v_mfma_f32_32x32x16_bf16 v[224:239], a[48:51], v[100:103], v[224:239]
    v_mfma_f32_32x32x16_bf16 v[240:255], a[176:179], v[100:103], v[240:255]
    s_waitcnt vmcnt(16)
    s_barrier
    v_add_u32 v7, s54, v6
    s_waitcnt lgkmcnt(8)
    v_mfma_f32_32x32x16_bf16 v[192:207], a[52:55], v[104:107], v[192:207]
    ds_read_b64_tr_b16 v[96:97], v7
    ds_read_b64_tr_b16 v[98:99], v7 offset:256
    ds_read_b64_tr_b16 v[100:101], v7 offset:512
    v_mfma_f32_32x32x16_bf16 v[208:223], a[180:183], v[104:107], v[208:223]
    ds_read_b64_tr_b16 v[102:103], v7 offset:768
    global_load_dword v45, v44, s[84:85]
    v_mfma_f32_32x32x16_bf16 v[224:239], a[52:55], v[108:111], v[224:239]
    s_mov_b64 s[84:85], s[86:87]
    s_mov_b64 s[86:87], s[88:89]
    s_mov_b64 s[88:89], s[90:91]
    s_mov_b64 s[90:91], s[92:93]
    s_cmp_gt_i32 s52, 0
    s_cselect_b32 s65, s51, 0x40000000
    v_mfma_f32_32x32x16_bf16 v[240:255], a[180:183], v[108:111], v[240:255]
    s_sub_u32 s52, s52, 1
    s_add_u32 s68, s65, s73
    s_waitcnt lgkmcnt(8)
    v_mfma_f32_32x32x16_bf16 v[192:207], a[56:59], v[112:115], v[192:207]
    ds_read_b64_tr_b16 v[104:105], v7 offset:2048
    ds_read_b64_tr_b16 v[106:107], v7 offset:2304
    ds_read_b64_tr_b16 v[108:109], v7 offset:2560
    v_mfma_f32_32x32x16_bf16 v[208:223], a[184:187], v[112:115], v[208:223]
    ds_read_b64_tr_b16 v[110:111], v7 offset:2816
    v_mfma_f32_32x32x16_bf16 v[224:239], a[56:59], v[116:119], v[224:239]
    s_add_u32 m0, s53, 0
    s_nop 0
    buffer_load_dwordx4 v2, s[32:35], s65 offen lds
    v_mfma_f32_32x32x16_bf16 v[240:255], a[184:187], v[116:119], v[240:255]
    s_add_u32 m0, s53, 0x400
    s_nop 0
    buffer_load_dwordx4 v3, s[32:35], s65 offen lds
    s_waitcnt lgkmcnt(8)
    v_mfma_f32_32x32x16_bf16 v[192:207], a[60:63], v[120:123], v[192:207]
    ds_read_b64_tr_b16 v[112:113], v7 offset:4096
    ds_read_b64_tr_b16 v[114:115], v7 offset:4352
    ds_read_b64_tr_b16 v[116:117], v7 offset:4608
    v_mfma_f32_32x32x16_bf16 v[208:223], a[188:191], v[120:123], v[208:223]
    ds_read_b64_tr_b16 v[118:119], v7 offset:4864
    v_mfma_f32_32x32x16_bf16 v[224:239], a[60:63], v[124:127], v[224:239]
    s_add_u32 m0, s53, 0x800
    s_nop 0
    buffer_load_dwordx4 v4, s[32:35], s65 offen lds
    v_mfma_f32_32x32x16_bf16 v[240:255], a[188:191], v[124:127], v[240:255]
    s_add_u32 m0, s53, 0xc00
    s_nop 0
    buffer_load_dwordx4 v5, s[32:35], s65 offen lds
    s_waitcnt lgkmcnt(8)
    v_mfma_f32_32x32x16_bf16 v[192:207], a[64:67], v[96:99], v[192:207]
    ds_read_b64_tr_b16 v[120:121], v7 offset:6144
    ds_read_b64_tr_b16 v[122:123], v7 offset:6400
    ds_read_b64_tr_b16 v[124:125], v7 offset:6656
    v_mfma_f32_32x32x16_bf16 v[208:223], a[192:195], v[96:99], v[208:223]
    ds_read_b64_tr_b16 v[126:127], v7 offset:6912
    v_mfma_f32_32x32x16_bf16 v[224:239], a[64:67], v[100:103], v[224:239]
    s_add_u32 m0, s53, 0x1000
    s_nop 0
    buffer_load_dwordx4 v2, s[32:35], s68 offen lds
    v_mfma_f32_32x32x16_bf16 v[240:255], a[192:195], v[100:103], v[240:255]
    s_add_u32 m0, s53, 0x1400
    s_nop 0
    buffer_load_dwordx4 v3, s[32:35], s68 offen lds
    s_waitcnt lgkmcnt(8)
    v_mfma_f32_32x32x16_bf16 v[192:207], a[68:71], v[104:107], v[192:207]
    ds_read_b64_tr_b16 v[96:97], v7 offset:8192
    ds_read_b64_tr_b16 v[98:99], v7 offset:8448
    ds_read_b64_tr_b16 v[100:101], v7 offset:8704
    v_mfma_f32_32x32x16_bf16 v[208:223], a[196:199], v[104:107], v[208:223]
    ds_read_b64_tr_b16 v[102:103], v7 offset:8960
    v_mfma_f32_32x32x16_bf16 v[224:239], a[68:71], v[108:111], v[224:239]
    s_add_u32 m0, s53, 0x1800
    s_nop 0
    buffer_load_dwordx4 v4, s[32:35], s68 offen lds
    v_mfma_f32_32x32x16_bf16 v[240:255], a[196:199], v[108:111], v[240:255]
    s_add_u32 m0, s53, 0x1c00
    s_nop 0
    buffer_load_dwordx4 v5, s[32:35], s68 offen lds
    s_waitcnt lgkmcnt(8)
    v_mfma_f32_32x32x16_bf16 v[192:207], a[72:75], v[112:115], v[192:207]
    ds_read_b64_tr_b16 v[104:105], v7 offset:10240
    ds_read_b64_tr_b16 v[106:107], v7 offset:10496
    ds_read_b64_tr_b16 v[108:109], v7 offset:10752
    v_mfma_f32_32x32x16_bf16 v[208:223], a[200:203], v[112:115], v[208:223]
    ds_read_b64_tr_b16 v[110:111], v7 offset:11008
    s_add_u32 s51, s51, s74
    s_add_u32 s53, s53, 0x8000
    v_mfma_f32_32x32x16_bf16 v[224:239], a[72:75], v[116:119], v[224:239]
    s_sub_u32 s57, s53, 0x28000
    s_cmp_ge_u32 s53, 0x28000
    s_cselect_b32 s53, s57, s53
    v_mfma_f32_32x32x16_bf16 v[240:255], a[200:203], v[116:119], v[240:255]
    s_add_u32 s54, s54, 0x8000
    s_cmp_ge_u32 s54, 0x28000
    s_cselect_b32 s54, 0, s54
    s_waitcnt lgkmcnt(8)
    v_mfma_f32_32x32x16_bf16 v[192:207], a[76:79], v[120:123], v[192:207]
    ds_read_b64_tr_b16 v[112:113], v7 offset:12288
    ds_read_b64_tr_b16 v[114:115], v7 offset:12544
    ds_read_b64_tr_b16 v[116:117], v7 offset:12800
    v_mfma_f32_32x32x16_bf16 v[208:223], a[204:207], v[120:123], v[208:223]
    ds_read_b64_tr_b16 v[118:119], v7 offset:13056
    v_mfma_f32_32x32x16_bf16 v[224:239], a[76:79], v[124:127], v[224:239]
    v_mfma_f32_32x32x16_bf16 v[240:255], a[204:207], v[124:127], v[240:255]
    s_waitcnt lgkmcnt(8)
    v_mfma_f32_32x32x16_bf16 v[192:207], a[80:83], v[96:99], v[192:207]
    ds_read_b64_tr_b16 v[120:121], v7 offset:14336
    ds_read_b64_tr_b16 v[122:123], v7 offset:14592
    ds_read_b64_tr_b16 v[124:125], v7 offset:14848
    v_mfma_f32_32x32x16_bf16 v[208:223], a[208:211], v[96:99], v[208:223]
    ds_read_b64_tr_b16 v[126:127], v7 offset:15104
    v_mfma_f32_32x32x16_bf16 v[224:239], a[80:83], v[100:103], v[224:239]
    v_mfma_f32_32x32x16_bf16 v[240:255], a[208:211], v[100:103], v[240:255]
    s_waitcnt lgkmcnt(8)
    v_mfma_f32_32x32x16_bf16 v[192:207], a[84:87], v[104:107], v[192:207]
    ds_read_b64_tr_b16 v[96:97], v7 offset:16384
    ds_read_b64_tr_b16 v[98:99], v7 offset:16640
    ds_read_b64_tr_b16 v[100:101], v7 offset:16896
    v_mfma_f32_32x32x16_bf16 v[208:223], a[212:215], v[104:107], v[208:223]
    ds_read_b64_tr_b16 v[102:103], v7 offset:17152
    v_mfma_f32_32x32x16_bf16 v[224:239], a[84:87], v[108:111], v[224:239]
    v_mfma_f32_32x32x16_bf16 v[240:255], a[212:215], v[108:111], v[240:255]
    s_waitcnt lgkmcnt(8)
    v_mfma_f32_32x32x16_bf16 v[192:207], a[88:91], v[112:115], v[192:207]
    ds_read_b64_tr_b16 v[104:105], v7 offset:18432
    ds_read_b64_tr_b16 v[106:107], v7 offset:18688
    ds_read_b64_tr_b16 v[108:109], v7 offset:18944
    v_mfma_f32_32x32x16_bf16 v[208:223], a[216:219], v[112:115], v[208:223]
    ds_read_b64_tr_b16 v[110:111], v7 offset:19200
    v_mfma_f32_32x32x16_bf16 v[224:239], a[88:91], v[116:119], v[224:239]
    v_mfma_f32_32x32x16_bf16 v[240:255], a[216:219], v[116:119], v[240:255]
    s_waitcnt lgkmcnt(8)
    v_mfma_f32_32x32x16_bf16 v[192:207], a[92:95], v[120:123], v[192:207]
    ds_read_b64_tr_b16 v[112:113], v7 offset:20480
    ds_read_b64_tr_b16 v[114:115], v7 offset:20736
    ds_read_b64_tr_b16 v[116:117], v7 offset:20992
    v_mfma_f32_32x32x16_bf16 v[208:223], a[220:223], v[120:123], v[208:223]
    ds_read_b64_tr_b16 v[118:119], v7 offset:21248
    v_mfma_f32_32x32x16_bf16 v[224:239], a[92:95], v[124:127], v[224:239]
    v_mfma_f32_32x32x16_bf16 v[240:255], a[220:223], v[124:127], v[240:255]
    s_waitcnt lgkmcnt(8)
    v_mfma_f32_32x32x16_bf16 v[192:207], a[96:99], v[96:99], v[192:207]
    ds_read_b64_tr_b16 v[120:121], v7 offset:22528
    ds_read_b64_tr_b16 v[122:123], v7 offset:22784
    ds_read_b64_tr_b16 v[124:125], v7 offset:23040
    v_mfma_f32_32x32x16_bf16 v[208:223], a[224:227], v[96:99], v[208:223]
    ds_read_b64_tr_b16 v[126:127], v7 offset:23296
    v_mfma_f32_32x32x16_bf16 v[224:239], a[96:99], v[100:103], v[224:239]
    v_mfma_f32_32x32x16_bf16 v[240:255], a[224:227], v[100:103], v[240:255]
    s_waitcnt lgkmcnt(8)
    v_mfma_f32_32x32x16_bf16 v[192:207], a[100:103], v[104:107], v[192:207]
    ds_read_b64_tr_b16 v[96:97], v7 offset:24576
    ds_read_b64_tr_b16 v[98:99], v7 offset:24832
    ds_read_b64_tr_b16 v[100:101], v7 offset:25088
    v_mfma_f32_32x32x16_bf16 v[208:223], a[228:231], v[104:107], v[208:223]
    ds_read_b64_tr_b16 v[102:103], v7 offset:25344
    v_mfma_f32_32x32x16_bf16 v[224:239], a[100:103], v[108:111], v[224:239]
    v_mfma_f32_32x32x16_bf16 v[240:255], a[228:231], v[108:111], v[240:255]
    s_waitcnt lgkmcnt(8)
    v_mfma_f32_32x32x16_bf16 v[192:207], a[104:107], v[112:115], v[192:207]
    ds_read_b64_tr_b16 v[104:105], v7 offset:26624
    ds_read_b64_tr_b16 v[106:107], v7 offset:26880
    ds_read_b64_tr_b16 v[108:109], v7 offset:27136
    v_mfma_f32_32x32x16_bf16 v[208:223], a[232:235], v[112:115], v[208:223]
    ds_read_b64_tr_b16 v[110:111], v7 offset:27392
    v_mfma_f32_32x32x16_bf16 v[224:239], a[104:107], v[116:119], v[224:239]
    v_mfma_f32_32x32x16_bf16 v[240:255], a[232:235], v[116:119], v[240:255]
    s_waitcnt lgkmcnt(8)
    v_mfma_f32_32x32x16_bf16 v[192:207], a[108:111], v[120:123], v[192:207]
    ds_read_b64_tr_b16 v[112:113], v7 offset:28672
    ds_read_b64_tr_b16 v[114:115], v7 offset:28928
    ds_read_b64_tr_b16 v[116:117], v7 offset:29184
    v_mfma_f32_32x32x16_bf16 v[208:223], a[236:239], v[120:123], v[208:223]
    ds_read_b64_tr_b16 v[118:119], v7 offset:29440
    v_mfma_f32_32x32x16_bf16 v[224:239], a[108:111], v[124:127], v[224:239]
    v_mfma_f32_32x32x16_bf16 v[240:255], a[236:239], v[124:127], v[240:255]
    s_waitcnt lgkmcnt(8)
    v_mfma_f32_32x32x16_bf16 v[192:207], a[112:115], v[96:99], v[192:207]
    ds_read_b64_tr_b16 v[120:121], v7 offset:30720
    ds_read_b64_tr_b16 v[122:123], v7 offset:30976
    ds_read_b64_tr_b16 v[124:125], v7 offset:31232
    v_mfma_f32_32x32x16_bf16 v[208:223], a[240:243], v[96:99], v[208:223]
    ds_read_b64_tr_b16 v[126:127], v7 offset:31488
    v_mfma_f32_32x32x16_bf16 v[224:239], a[112:115], v[100:103], v[224:239]
    v_mfma_f32_32x32x16_bf16 v[240:255], a[240:243], v[100:103], v[240:255]
    s_waitcnt vmcnt(16)
    s_barrier
    v_add_u32 v7, s54, v6
    s_waitcnt lgkmcnt(8)
    v_mfma_f32_32x32x16_bf16 v[192:207], a[116:119], v[104:107], v[192:207]
    ds_read_b64_tr_b16 v[96:97], v7
    ds_read_b64_tr_b16 v[98:99], v7 offset:256
    ds_read_b64_tr_b16 v[100:101], v7 offset:512
    v_mfma_f32_32x32x16_bf16 v[208:223], a[244:247], v[104:107], v[208:223]
    ds_read_b64_tr_b16 v[102:103], v7 offset:768
    v_mfma_f32_32x32x16_bf16 v[224:239], a[116:119], v[108:111], v[224:239]
    v_mfma_f32_32x32x16_bf16 v[240:255], a[244:247], v[108:111], v[240:255]
    s_waitcnt lgkmcnt(8)
    v_mfma_f32_32x32x16_bf16 v[192:207], a[120:123], v[112:115], v[192:207]
    ds_read_b64_tr_b16 v[104:105], v7 offset:2048
    ds_read_b64_tr_b16 v[106:107], v7 offset:2304
    ds_read_b64_tr_b16 v[108:109], v7 offset:2560
    v_mfma_f32_32x32x16_bf16 v[208:223], a[248:251], v[112:115], v[208:223]
    ds_read_b64_tr_b16 v[110:111], v7 offset:2816
    v_mfma_f32_32x32x16_bf16 v[224:239], a[120:123], v[116:119], v[224:239]
    v_mfma_f32_32x32x16_bf16 v[240:255], a[248:251], v[116:119], v[240:255]
    s_waitcnt lgkmcnt(8)
    v_mfma_f32_32x32x16_bf16 v[192:207], a[124:127], v[120:123], v[192:207]
    ds_read_b64_tr_b16 v[112:113], v7 offset:4096
    ds_read_b64_tr_b16 v[114:115], v7 offset:4352
    ds_read_b64_tr_b16 v[116:117], v7 offset:4608
    v_mfma_f32_32x32x16_bf16 v[208:223], a[252:255], v[120:123], v[208:223]
    ds_read_b64_tr_b16 v[118:119], v7 offset:4864
    v_mfma_f32_32x32x16_bf16 v[224:239], a[124:127], v[124:127], v[224:239]
    v_mfma_f32_32x32x16_bf16 v[240:255], a[252:255], v[124:127], v[240:255]
    s_lshr_b32 s55, s48, 1
    s_mul_i32 s55, s55, s76
    s_and_b32 s56, s48, 1
    s_lshl_b32 s56, s56, 11
    s_add_u32 s55, s55, s56
    s_add_u32 s58, s55, s64
    s_add_u32 s59, s58, s78
    s_add_u32 s60, s58, s77
    s_add_u32 s61, s59, s77
    s_add_u32 s48, s48, 1
    s_sub_u32 s49, s49, 1
    s_cmp_lg_u32 s49, 0
    s_cbranch_scc1 L1_V_b0
L1_V_t1:
    v_cvt_pk_bf16_f32 v16, v192, v193
    v_cvt_pk_bf16_f32 v17, v194, v195
    v_cvt_pk_bf16_f32 v18, v196, v197
    v_cvt_pk_bf16_f32 v19, v198, v199
    buffer_store_dwordx4 v[16:19], v1, s[36:39], s58 offen sc1
    v_cvt_pk_bf16_f32 v20, v200, v201
    v_cvt_pk_bf16_f32 v21, v202, v203
    v_cvt_pk_bf16_f32 v22, v204, v205
    v_cvt_pk_bf16_f32 v23, v206, v207
    buffer_store_dwordx4 v[20:23], v1, s[36:39], s59 offen sc1
    v_cvt_pk_bf16_f32 v16, v224, v225
    v_cvt_pk_bf16_f32 v17, v226, v227
    v_cvt_pk_bf16_f32 v18, v228, v229
    v_cvt_pk_bf16_f32 v19, v230, v231
    buffer_store_dwordx4 v[16:19], v1, s[36:39], s58 offen offset:1024 sc1
    v_cvt_pk_bf16_f32 v20, v232, v233
    v_cvt_pk_bf16_f32 v21, v234, v235
    v_cvt_pk_bf16_f32 v22, v236, v237
    v_cvt_pk_bf16_f32 v23, v238, v239
    buffer_store_dwordx4 v[20:23], v1, s[36:39], s59 offen offset:1024 sc1
    v_cvt_pk_bf16_f32 v16, v208, v209
    v_cvt_pk_bf16_f32 v17, v210, v211
    v_cvt_pk_bf16_f32 v18, v212, v213
    v_cvt_pk_bf16_f32 v19, v214, v215
    buffer_store_dwordx4 v[16:19], v1, s[36:39], s60 offen sc1
    v_cvt_pk_bf16_f32 v20, v216, v217
    v_cvt_pk_bf16_f32 v21, v218, v219
    v_cvt_pk_bf16_f32 v22, v220, v221
    v_cvt_pk_bf16_f32 v23, v222, v223
    buffer_store_dwordx4 v[20:23], v1, s[36:39], s61 offen sc1
    v_cvt_pk_bf16_f32 v16, v240, v241
    v_cvt_pk_bf16_f32 v17, v242, v243
    v_cvt_pk_bf16_f32 v18, v244, v245
    v_cvt_pk_bf16_f32 v19, v246, v247
    buffer_store_dwordx4 v[16:19], v1, s[36:39], s60 offen offset:1024 sc1
    v_cvt_pk_bf16_f32 v20, v248, v249
    v_cvt_pk_bf16_f32 v21, v250, v251
    v_cvt_pk_bf16_f32 v22, v252, v253
    v_cvt_pk_bf16_f32 v23, v254, v255
    buffer_store_dwordx4 v[20:23], v1, s[36:39], s61 offen offset:1024 sc1
    s_branch L1_next
L1_V_t0:
    v_cvt_pk_bf16_f32 v16, v128, v129
    v_cvt_pk_bf16_f32 v17, v130, v131
    v_cvt_pk_bf16_f32 v18, v132, v133
    v_cvt_pk_bf16_f32 v19, v134, v135
    buffer_store_dwordx4 v[16:19], v1, s[36:39], s58 offen sc1
    v_cvt_pk_bf16_f32 v20, v136, v137
    v_cvt_pk_bf16_f32 v21, v138, v139
    v_cvt_pk_bf16_f32 v22, v140, v141
    v_cvt_pk_bf16_f32 v23, v142, v143
    buffer_store_dwordx4 v[20:23], v1, s[36:39], s59 offen sc1
    v_cvt_pk_bf16_f32 v16, v160, v161
    v_cvt_pk_bf16_f32 v17, v162, v163
    v_cvt_pk_bf16_f32 v18, v164, v165
    v_cvt_pk_bf16_f32 v19, v166, v167
    buffer_store_dwordx4 v[16:19], v1, s[36:39], s58 offen offset:1024 sc1
    v_cvt_pk_bf16_f32 v20, v168, v169
    v_cvt_pk_bf16_f32 v21, v170, v171
    v_cvt_pk_bf16_f32 v22, v172, v173
    v_cvt_pk_bf16_f32 v23, v174, v175
    buffer_store_dwordx4 v[20:23], v1, s[36:39], s59 offen offset:1024 sc1
    v_cvt_pk_bf16_f32 v16, v144, v145
    v_cvt_pk_bf16_f32 v17, v146, v147
    v_cvt_pk_bf16_f32 v18, v148, v149
    v_cvt_pk_bf16_f32 v19, v150, v151
    buffer_store_dwordx4 v[16:19], v1, s[36:39], s60 offen sc1
    v_cvt_pk_bf16_f32 v20, v152, v153
    v_cvt_pk_bf16_f32 v21, v154, v155
    v_cvt_pk_bf16_f32 v22, v156, v157
    v_cvt_pk_bf16_f32 v23, v158, v159
    buffer_store_dwordx4 v[20:23], v1, s[36:39], s61 offen sc1
    v_cvt_pk_bf16_f32 v16, v176, v177
    v_cvt_pk_bf16_f32 v17, v178, v179
    v_cvt_pk_bf16_f32 v18, v180, v181
    v_cvt_pk_bf16_f32 v19, v182, v183
    buffer_store_dwordx4 v[16:19], v1, s[36:39], s60 offen offset:1024 sc1
    v_cvt_pk_bf16_f32 v20, v184, v185
    v_cvt_pk_bf16_f32 v21, v186, v187
    v_cvt_pk_bf16_f32 v22, v188, v189
    v_cvt_pk_bf16_f32 v23, v190, v191
    buffer_store_dwordx4 v[20:23], v1, s[36:39], s61 offen offset:1024 sc1
    s_branch L1_next
L1_next:
    s_cmp_eq_u32 s67, 0
    s_cbranch_scc1 L1_end0
L1_gate:
    v_lshlrev_b32 v25, 8, v0
    v_mov_b32 v48, 0
    v_mov_b32 v49, 0
    v_mov_b32 v50, 0
    v_mov_b32 v51, 0
    s_mov_b32 s55, 0x4d00000
    s_mov_b32 s56, 0x4d04000
    buffer_store_dwordx4 v[48:51], v25, s[36:39], s55 offen sc1
    buffer_store_dwordx4 v[48:51], v25, s[36:39], s56 offen sc1
    v_lshrrev_b32 v24, 5, v0
    v_lshlrev_b32 v24, 4, v24
    s_waitcnt lgkmcnt(0)
    buffer_load_dwordx4 v[128:131], v24, s[40:43], 0 offen
    buffer_load_dwordx4 v[132:135], v24, s[40:43], 0 offen offset:32
    buffer_load_dwordx4 v[136:139], v24, s[40:43], 0 offen offset:64
    buffer_load_dwordx4 v[140:143], v24, s[40:43], 0 offen offset:96
    buffer_load_dwordx4 v[144:147], v24, s[40:43], 0 offen offset:128
    buffer_load_dwordx4 v[148:151], v24, s[40:43], 0 offen offset:160
    buffer_load_dwordx4 v[152:155], v24, s[40:43], 0 offen offset:192
    buffer_load_dwordx4 v[156:159], v24, s[40:43], 0 offen offset:224
    buffer_load_dwordx4 v[160:163], v24, s[40:43], 0 offen offset:256
    buffer_load_dwordx4 v[164:167], v24, s[40:43], 0 offen offset:288
    buffer_load_dwordx4 v[168:171], v24, s[40:43], 0 offen offset:320
    buffer_load_dwordx4 v[172:175], v24, s[40:43], 0 offen offset:352
    buffer_load_dwordx4 v[176:179], v24, s[40:43], 0 offen offset:384
    buffer_load_dwordx4 v[180:183], v24, s[40:43], 0 offen offset:416
    buffer_load_dwordx4 v[184:187], v24, s[40:43], 0 offen offset:448
    buffer_load_dwordx4 v[188:191], v24, s[40:43], 0 offen offset:480
    buffer_load_dwordx4 v[192:195], v24, s[40:43], 0 offen offset:512
    buffer_load_dwordx4 v[196:199], v24, s[40:43], 0 offen offset:544
    buffer_load_dwordx4 v[200:203], v24, s[40:43], 0 offen offset:576
    buffer_load_dwordx4 v[204:207], v24, s[40:43], 0 offen offset:608
    buffer_load_dwordx4 v[208:211], v24, s[40:43], 0 offen offset:640
    buffer_load_dwordx4 v[212:215], v24, s[40:43], 0 offen offset:672
    buffer_load_dwordx4 v[216:219], v24, s[40:43], 0 offen offset:704
    buffer_load_dwordx4 v[220:223], v24, s[40:43], 0 offen offset:736
    buffer_load_dwordx4 v[224:227], v24, s[40:43], 0 offen offset:768
    buffer_load_dwordx4 v[228:231], v24, s[40:43], 0 offen offset:800
    buffer_load_dwordx4 v[232:235], v24, s[40:43], 0 offen offset:832
    buffer_load_dwordx4 v[236:239], v24, s[40:43], 0 offen offset:864
    buffer_load_dwordx4 v[240:243], v24, s[40:43], 0 offen offset:896
    buffer_load_dwordx4 v[244:247], v24, s[40:43], 0 offen offset:928
    buffer_load_dwordx4 v[248:251], v24, s[40:43], 0 offen offset:960
    buffer_load_dwordx4 v[252:255], v24, s[40:43], 0 offen offset:992
    s_waitcnt vmcnt(0)
    v_mfma_f32_32x32x16_bf16 v[96:111], v[128:131], a[0:3], 0
    v_mfma_f32_32x32x16_bf16 v[112:127], v[128:131], a[128:131], 0
    v_mfma_f32_32x32x16_bf16 v[96:111], v[132:135], a[4:7], v[96:111]
    v_mfma_f32_32x32x16_bf16 v[112:127], v[132:135], a[132:135], v[112:127]
    v_mfma_f32_32x32x16_bf16 v[96:111], v[136:139], a[8:11], v[96:111]
    v_mfma_f32_32x32x16_bf16 v[112:127], v[136:139], a[136:139], v[112:127]
    v_mfma_f32_32x32x16_bf16 v[96:111], v[140:143], a[12:15], v[96:111]
    v_mfma_f32_32x32x16_bf16 v[112:127], v[140:143], a[140:143], v[112:127]
    v_mfma_f32_32x32x16_bf16 v[96:111], v[144:147], a[16:19], v[96:111]
    v_mfma_f32_32x32x16_bf16 v[112:127], v[144:147], a[144:147], v[112:127]
    v_mfma_f32_32x32x16_bf16 v[96:111], v[148:151], a[20:23], v[96:111]
    v_mfma_f32_32x32x16_bf16 v[112:127], v[148:151], a[148:151], v[112:127]
    v_mfma_f32_32x32x16_bf16 v[96:111], v[152:155], a[24:27], v[96:111]
    v_mfma_f32_32x32x16_bf16 v[112:127], v[152:155], a[152:155], v[112:127]
    v_mfma_f32_32x32x16_bf16 v[96:111], v[156:159], a[28:31], v[96:111]
    v_mfma_f32_32x32x16_bf16 v[112:127], v[156:159], a[156:159], v[112:127]
    v_mfma_f32_32x32x16_bf16 v[96:111], v[160:163], a[32:35], v[96:111]
    v_mfma_f32_32x32x16_bf16 v[112:127], v[160:163], a[160:163], v[112:127]
    v_mfma_f32_32x32x16_bf16 v[96:111], v[164:167], a[36:39], v[96:111]
    v_mfma_f32_32x32x16_bf16 v[112:127], v[164:167], a[164:167], v[112:127]
    v_mfma_f32_32x32x16_bf16 v[96:111], v[168:171], a[40:43], v[96:111]
    v_mfma_f32_32x32x16_bf16 v[112:127], v[168:171], a[168:171], v[112:127]
    v_mfma_f32_32x32x16_bf16 v[96:111], v[172:175], a[44:47], v[96:111]
    v_mfma_f32_32x32x16_bf16 v[112:127], v[172:175], a[172:175], v[112:127]
    v_mfma_f32_32x32x16_bf16 v[96:111], v[176:179], a[48:51], v[96:111]
    v_mfma_f32_32x32x16_bf16 v[112:127], v[176:179], a[176:179], v[112:127]
    v_mfma_f32_32x32x16_bf16 v[96:111], v[180:183], a[52:55], v[96:111]
    v_mfma_f32_32x32x16_bf16 v[112:127], v[180:183], a[180:183], v[112:127]
    v_mfma_f32_32x32x16_bf16 v[96:111], v[184:187], a[56:59], v[96:111]
    v_mfma_f32_32x32x16_bf16 v[112:127], v[184:187], a[184:187], v[112:127]
    v_mfma_f32_32x32x16_bf16 v[96:111], v[188:191], a[60:63], v[96:111]
    v_mfma_f32_32x32x16_bf16 v[112:127], v[188:191], a[188:191], v[112:127]
    v_mfma_f32_32x32x16_bf16 v[96:111], v[192:195], a[64:67], v[96:111]
    v_mfma_f32_32x32x16_bf16 v[112:127], v[192:195], a[192:195], v[112:127]
    v_mfma_f32_32x32x16_bf16 v[96:111], v[196:199], a[68:71], v[96:111]
    v_mfma_f32_32x32x16_bf16 v[112:127], v[196:199], a[196:199], v[112:127]
    v_mfma_f32_32x32x16_bf16 v[96:111], v[200:203], a[72:75], v[96:111]
    v_mfma_f32_32x32x16_bf16 v[112:127], v[200:203], a[200:203], v[112:127]
    v_mfma_f32_32x32x16_bf16 v[96:111], v[204:207], a[76:79], v[96:111]
    v_mfma_f32_32x32x16_bf16 v[112:127], v[204:207], a[204:207], v[112:127]
    v_mfma_f32_32x32x16_bf16 v[96:111], v[208:211], a[80:83], v[96:111]
    v_mfma_f32_32x32x16_bf16 v[112:127], v[208:211], a[208:211], v[112:127]
    v_mfma_f32_32x32x16_bf16 v[96:111], v[212:215], a[84:87], v[96:111]
    v_mfma_f32_32x32x16_bf16 v[112:127], v[212:215], a[212:215], v[112:127]
    v_mfma_f32_32x32x16_bf16 v[96:111], v[216:219], a[88:91], v[96:111]
    v_mfma_f32_32x32x16_bf16 v[112:127], v[216:219], a[216:219], v[112:127]
    v_mfma_f32_32x32x16_bf16 v[96:111], v[220:223], a[92:95], v[96:111]
    v_mfma_f32_32x32x16_bf16 v[112:127], v[220:223], a[220:223], v[112:127]
    v_mfma_f32_32x32x16_bf16 v[96:111], v[224:227], a[96:99], v[96:111]
    v_mfma_f32_32x32x16_bf16 v[112:127], v[224:227], a[224:227], v[112:127]
    v_mfma_f32_32x32x16_bf16 v[96:111], v[228:231], a[100:103], v[96:111]
    v_mfma_f32_32x32x16_bf16 v[112:127], v[228:231], a[228:231], v[112:127]
    v_mfma_f32_32x32x16_bf16 v[96:111], v[232:235], a[104:107], v[96:111]
    v_mfma_f32_32x32x16_bf16 v[112:127], v[232:235], a[232:235], v[112:127]
    v_mfma_f32_32x32x16_bf16 v[96:111], v[236:239], a[108:111], v[96:111]
    v_mfma_f32_32x32x16_bf16 v[112:127], v[236:239], a[236:239], v[112:127]
    v_mfma_f32_32x32x16_bf16 v[96:111], v[240:243], a[112:115], v[96:111]
    v_mfma_f32_32x32x16_bf16 v[112:127], v[240:243], a[240:243], v[112:127]
    v_mfma_f32_32x32x16_bf16 v[96:111], v[244:247], a[116:119], v[96:111]
    v_mfma_f32_32x32x16_bf16 v[112:127], v[244:247], a[244:247], v[112:127]
    v_mfma_f32_32x32x16_bf16 v[96:111], v[248:251], a[120:123], v[96:111]
    v_mfma_f32_32x32x16_bf16 v[112:127], v[248:251], a[248:251], v[112:127]
    v_mfma_f32_32x32x16_bf16 v[96:111], v[252:255], a[124:127], v[96:111]
    v_mfma_f32_32x32x16_bf16 v[112:127], v[252:255], a[252:255], v[112:127]
    v_and_b32 v24, 31, v0
    v_lshlrev_b32 v24, 2, v24
    s_lshl_b32 s55, s63, 7
    s_add_u32 s55, s55, 0x4c10000
    s_nop 6
    v_mul_f32 v96, 0xbfb8aa3b, v96
    v_exp_f32 v96, v96
    s_nop 0
    v_add_f32 v96, 1.0, v96
    v_rcp_f32 v96, v96
    s_nop 0
    buffer_store_dword v96, v24, s[36:39], s55 offen sc1
    v_mul_f32 v112, 0xbfb8aa3b, v112
    v_exp_f32 v112, v112
    s_nop 0
    v_add_f32 v112, 1.0, v112
    v_rcp_f32 v112, v112
    s_nop 0
    buffer_store_dword v112, v24, s[36:39], s55 offen offset:128 sc1
L1_end0:
    global_load_dword v45, v44, s[84:85]
    s_mov_b64 s[84:85], s[86:87]
    s_mov_b64 s[86:87], s[88:89]
    s_mov_b64 s[88:89], s[90:91]
    s_mov_b64 s[90:91], s[92:93]
    global_load_dword v45, v44, s[84:85]
    v_lshl_add_u32 v0, s44, 6, v0
    s_waitcnt vmcnt(10) lgkmcnt(0)
    s_barrier
    s_branch attn_kernel
L1_end:
    s_endpgm
attn_kernel:
    s_load_dwordx2 s[4:5], s[0:1], 112
    s_load_dwordx2 s[96:97], s[0:1], 104
    v_mov_b32 v15, 0
    s_load_dwordx2 s[52:53], s[0:1], 0
    s_load_dwordx2 s[56:57], s[0:1], 16
    v_lshrrev_b32 v1, 6, v0
    s_nop 0
    v_readfirstlane_b32 s12, v1
    v_lshrrev_b32 v5, 5, v0
    v_and_b32 v6, 31, v0
    v_lshlrev_b32 v6, 4, v6
    v_lshl_add_u32 v31, v5, 10, v6
    v_and_b32 v0, 63, v0
    v_lshlrev_b32 v1, 4, v0
    v_lshrrev_b32 v5, 3, v0
    v_and_b32 v6, 7, v0
    v_lshrrev_b32 v7, 1, v5
    v_xor_b32 v8, v6, v7
    v_lshlrev_b32 v8, 4, v8
    v_lshl_add_u32 v16, v5, 10, v8
    v_xor_b32 v17, 64, v16
    v_add_u32 v17, 0x2000, v17
    v_add_u32 v18, 0x4000, v16
    v_add_u32 v19, 0x4000, v17
    v_add_u32 v20, 0x4000, v18
    v_add_u32 v21, 0x4000, v19
    v_add_u32 v22, 0x4000, v20
    v_add_u32 v23, 0x4000, v21
    v_lshrrev_b32 v5, 2, v0
    v_and_b32 v5, 7, v5
    v_lshlrev_b32 v5, 13, v5
    v_lshrrev_b32 v6, 5, v0
    v_lshl_add_u32 v5, v6, 6, v5
    v_and_b32 v6, 3, v0
    v_lshl_add_u32 v24, v6, 4, v5
    v_add_u32 v25, 0x10000, v24
    v_add_u32 v26, 0x80, v24
    v_add_u32 v27, 0x10080, v24
    s_lshl_b32 s62, s12, 14
    s_add_u32 s62, s62, 0x18000
    s_lshl_b32 s69, s12, 12
    v_and_b32 v6, 31, v0
    v_lshrrev_b32 v7, 5, v0
    v_lshrrev_b32 v5, 1, v6
    v_and_b32 v5, 7, v5
    v_xor_b32 v5, v7, v5
    v_lshlrev_b32 v5, 4, v5
    v_lshl_add_u32 v5, v6, 7, v5
    v_add_u32 v28, s62, v5
    v_xor_b32 v29, 32, v28
    v_xor_b32 v30, 64, v28
    v_xor_b32 v2, 0x60, v28
    v_lshrrev_b32 v5, 2, v0
    v_and_b32 v5, 3, v5
    v_lshlrev_b32 v5, 6, v5
    v_lshl_add_u32 v5, v7, 10, v5
    v_lshrrev_b32 v6, 4, v0
    v_and_b32 v6, 1, v6
    v_lshl_add_u32 v5, v6, 5, v5
    v_and_b32 v6, 3, v0
    v_lshl_add_u32 v5, v6, 3, v5
    v_add_u32 v3, 0x4000, v5
    v_add_u32 v4, 0x10000, v3
    s_lshr_b32 s27, s2, 1
    s_mul_i32 s27, s27, 0x7000
    s_and_b32 s28, s2, 1
    s_lshl_b32 s29, s28, 9
    s_add_u32 s82, s27, s29
    s_add_u32 s82, s82, 0x4800000
    s_add_u32 s83, s82, 0x2000
    s_add_u32 s84, s82, 0x4000
    s_add_u32 s85, s82, 0x6000
    s_lshl_b32 s29, s28, 3
    s_add_u32 s65, s27, s29
    s_add_u32 s65, s65, 0x5000000
    s_add_u32 s66, s65, 0x2000
    s_add_u32 s67, s65, 0x4000
    s_add_u32 s68, s65, 0x6000
    s_cmp_ge_u32 s12, 2
    s_cselect_b32 s85, 0x40000000, s85
    s_cselect_b32 s68, 0x40000000, s68
    s_and_b32 s27, s2, 7
    s_lshl_b32 s27, s27, 2
    s_lshr_b32 s28, s2, 3
    s_and_b32 s13, s28, 3
    s_add_u32 s13, s13, s27
    s_lshr_b32 s14, s28, 2
    s_sub_u32 s14, 7, s14
    s_lshl_b32 s16, s14, 2
    s_add_u32 s16, s16, 4
    s_lshr_b32 s17, s12, 1
    s_and_b32 s34, s12, 1
    s_lshl_b32 s31, s12, 11
    s_lshl_b32 s27, s14, 2
    s_lshl_b32 s28, s34, 1
    s_sub_u32 s35, 60, s27
    s_add_u32 s35, s35, s28
    s_add_u32 s27, s27, s28
    s_cmp_eq_u32 s17, 1
    s_cselect_b32 s32, s27, s35
    s_mov_b32 s18, s32
    s_cselect_b32 s38, s16, 0x3e8
    s_mov_b32 s86, 0x47800000
    s_mov_b32 s15, 0
    s_mov_b32 s19, 0
    s_mov_b32 s36, 0
    s_mov_b32 s37, 0
    s_mov_b32 s23, s31
    s_add_u32 s24, s31, 0x4000
    s_mov_b32 s25, 0
    s_mov_b32 s26, 0x8000
    s_sub_u32 s22, 33, s16
    s_lshl_b32 s22, s22, 13
    s_sub_u32 s33, s16, 2
    s_lshl_b32 s27, s13, 19
    s_add_u32 s27, s27, s31
    s_add_u32 s20, s27, 0x1000000
    s_add_u32 s21, s27, 0x2000000
    s_lshl_b32 s60, s32, 15
    s_lshl_b32 s61, s13, 8
    s_lshl_b32 s27, s12, 17
    s_add_u32 s61, s61, s27
    s_lshl_b32 s93, s34, 14
    s_add_u32 s93, s93, 0x20000
    s_waitcnt lgkmcnt(0)
    s_mov_b32 s8, s4
    s_mov_b32 s9, s5
    s_mov_b32 s10, 0x10000000
    s_mov_b32 s11, 0x20000
    s_mov_b32 s54, 0x200000
    s_mov_b32 s55, 0x20000
    s_mov_b32 s58, 0x400000
    s_mov_b32 s59, 0x20000
    s_mov_b32 s98, 0x100
    s_mov_b32 s99, 0x20000
L2_dec:
    s_lshl_b32 s76, s2, 2
    s_add_u32 s76, s76, s12
    s_lshl_b32 s76, s76, 8
    s_add_u32 s76, s76, 0x6400000
    s_getpc_b64 s[6:7]
    L2_pc:
    s_lshr_b32 s27, s2, 3
    s_lshl_b32 s27, s27, 2
    s_add_u32 s27, s27, s12
    s_mul_i32 s27, s27, 12
    s_lshr_b32 s27, s27, 7
    s_lshl_b32 s27, s27, 12
    v_lshlrev_b32 v5, 6, v0
    v_add_u32 v5, s27, v5
    v_min_u32 v5, L5_end-L2_pc, v5
    global_load_dword v9, v5, s[6:7]
    s_add_u32 s63, s60, 0
    s_add_u32 m0, s62, 0
    s_nop 0
    buffer_load_dwordx4 v16, s[52:55], s63 offen lds
    s_add_u32 m0, s62, 0x400
    s_nop 0
    buffer_load_dwordx4 v17, s[52:55], s63 offen lds
    s_add_u32 m0, s62, 0x800
    s_nop 0
    buffer_load_dwordx4 v18, s[52:55], s63 offen lds
    s_add_u32 m0, s62, 0xc00
    s_nop 0
    buffer_load_dwordx4 v19, s[52:55], s63 offen lds
    s_add_u32 m0, s62, 0x1000
    s_nop 0
    buffer_load_dwordx4 v20, s[52:55], s63 offen lds
    s_add_u32 m0, s62, 0x1400
    s_nop 0
    buffer_load_dwordx4 v21, s[52:55], s63 offen lds
    s_add_u32 m0, s62, 0x1800
    s_nop 0
    buffer_load_dwordx4 v22, s[52:55], s63 offen lds
    s_add_u32 m0, s62, 0x1c00
    s_nop 0
    buffer_load_dwordx4 v23, s[52:55], s63 offen lds
    s_add_u32 s64, s61, 0
    s_add_u32 m0, s69, 0x14000
    s_nop 0
    buffer_load_dwordx4 v24, s[56:59], s64 offen lds
    s_add_u32 m0, s69, 0x14400
    s_nop 0
    buffer_load_dwordx4 v25, s[56:59], s64 offen lds
    s_add_u32 m0, s69, 0x14800
    s_nop 0
    buffer_load_dwordx4 v26, s[56:59], s64 offen lds
    s_add_u32 m0, s69, 0x14c00
    s_nop 0
    buffer_load_dwordx4 v27, s[56:59], s64 offen lds
    s_add_u32 s63, s60, 0x80
    s_add_u32 m0, s62, 0x2000
    s_nop 0
    buffer_load_dwordx4 v16, s[52:55], s63 offen lds
    s_add_u32 m0, s62, 0x2400
    s_nop 0
    buffer_load_dwordx4 v17, s[52:55], s63 offen lds
    s_add_u32 m0, s62, 0x2800
    s_nop 0
    buffer_load_dwordx4 v18, s[52:55], s63 offen lds
    s_add_u32 m0, s62, 0x2c00
    s_nop 0
    buffer_load_dwordx4 v19, s[52:55], s63 offen lds
    s_add_u32 m0, s62, 0x3000
    s_nop 0
    buffer_load_dwordx4 v20, s[52:55], s63 offen lds
    s_add_u32 m0, s62, 0x3400
    s_nop 0
    buffer_load_dwordx4 v21, s[52:55], s63 offen lds
    s_add_u32 m0, s62, 0x3800
    s_nop 0
    buffer_load_dwordx4 v22, s[52:55], s63 offen lds
    s_add_u32 m0, s62, 0x3c00
    s_nop 0
    buffer_load_dwordx4 v23, s[52:55], s63 offen lds
    s_add_u32 s64, s61, 0x80000
    s_add_u32 m0, s69, 0x10000
    s_nop 0
    buffer_load_dwordx4 v24, s[56:59], s64 offen lds
    s_add_u32 m0, s69, 0x10400
    s_nop 0
    buffer_load_dwordx4 v25, s[56:59], s64 offen lds
    s_add_u32 m0, s69, 0x10800
    s_nop 0
    buffer_load_dwordx4 v26, s[56:59], s64 offen lds
    s_add_u32 m0, s69, 0x10c00
    s_nop 0
    buffer_load_dwordx4 v27, s[56:59], s64 offen lds
    s_waitcnt vmcnt(16)
    ds_read_b128 a[0:3], v28
    ds_read_b128 a[16:19], v28 offset:4096
    ds_read_b128 a[4:7], v29
    ds_read_b128 a[20:23], v29 offset:4096
    ds_read_b128 a[8:11], v30
    ds_read_b128 a[24:27], v30 offset:4096
    ds_read_b128 a[12:15], v2
    ds_read_b128 a[28:31], v2 offset:4096
    s_waitcnt vmcnt(12)
    s_barrier
    s_mov_b32 s27, 0x40000000
    s_cmp_eq_u32 s12, 0
    s_cselect_b32 s27, 0, s27
    v_mov_b32 v9, 1
    s_mov_b64 exec, 1
    buffer_atomic_add v9, v15, s[96:99], s27 offen sc0 sc1
    s_mov_b64 exec, -1
    ds_read_b64_tr_b16 a[64:65], v4
    ds_read_b64_tr_b16 a[66:67], v4 offset:256
    ds_read_b64_tr_b16 a[68:69], v4 offset:512
    ds_read_b64_tr_b16 a[70:71], v4 offset:768
    ds_read_b64_tr_b16 a[72:73], v4 offset:2048
    ds_read_b64_tr_b16 a[74:75], v4 offset:2304
    ds_read_b64_tr_b16 a[76:77], v4 offset:2560
    ds_read_b64_tr_b16 a[78:79], v4 offset:2816
    ds_read_b64_tr_b16 a[80:81], v4 offset:4096
    ds_read_b64_tr_b16 a[82:83], v4 offset:4352
    ds_read_b64_tr_b16 a[84:85], v4 offset:4608
    ds_read_b64_tr_b16 a[86:87], v4 offset:4864
    ds_read_b64_tr_b16 a[88:89], v4 offset:6144
    ds_read_b64_tr_b16 a[90:91], v4 offset:6400
    ds_read_b64_tr_b16 a[92:93], v4 offset:6656
    ds_read_b64_tr_b16 a[94:95], v4 offset:6912
    s_add_u32 s63, s60, 0x100
    s_add_u32 m0, s62, 0
    s_nop 0
    s_waitcnt lgkmcnt(15)
    buffer_load_dwordx4 v16, s[52:55], s63 offen lds
    s_add_u32 m0, s62, 0x400
    s_nop 0
    buffer_load_dwordx4 v17, s[52:55], s63 offen lds
    s_add_u32 m0, s62, 0x800
    s_nop 0
    buffer_load_dwordx4 v18, s[52:55], s63 offen lds
    s_add_u32 m0, s62, 0xc00
    s_nop 0
    buffer_load_dwordx4 v19, s[52:55], s63 offen lds
    s_add_u32 m0, s62, 0x1000
    s_nop 0
    buffer_load_dwordx4 v20, s[52:55], s63 offen lds
    s_add_u32 m0, s62, 0x1400
    s_nop 0
    buffer_load_dwordx4 v21, s[52:55], s63 offen lds
    s_add_u32 m0, s62, 0x1800
    s_nop 0
    buffer_load_dwordx4 v22, s[52:55], s63 offen lds
    s_add_u32 m0, s62, 0x1c00
    s_nop 0
    buffer_load_dwordx4 v23, s[52:55], s63 offen lds
    s_waitcnt lgkmcnt(14)
    v_mfma_f32_32x32x16_bf16 v[32:47], a[64:67], a[0:3], 0
    ds_read_b64_tr_b16 a[96:97], v4 offset:8192
    ds_read_b64_tr_b16 a[98:99], v4 offset:8448
    ds_read_b64_tr_b16 a[100:101], v4 offset:8704
    ds_read_b64_tr_b16 a[102:103], v4 offset:8960
    v_mfma_f32_32x32x16_bf16 v[48:63], a[64:67], a[16:19], 0
    s_waitcnt vmcnt(13)
    ds_read_b128 a[32:35], v28 offset:8192
    ds_read_b128 a[48:51], v28 offset:12288
    ds_read_b128 a[36:39], v29 offset:8192
    ds_read_b128 a[52:55], v29 offset:12288
    s_waitcnt lgkmcnt(15)
    v_mfma_f32_32x32x16_bf16 v[64:79], a[68:71], a[0:3], 0
    ds_read_b128 a[40:43], v30 offset:8192
    ds_read_b128 a[56:59], v30 offset:12288
    ds_read_b128 a[44:47], v2 offset:8192
    ds_read_b128 a[60:63], v2 offset:12288
    v_mfma_f32_32x32x16_bf16 v[80:95], a[68:71], a[16:19], 0
    ds_read_b64_tr_b16 a[104:105], v4 offset:10240
    ds_read_b64_tr_b16 a[106:107], v4 offset:10496
    s_add_u32 s64, s61, 0x100000
    v_mfma_f32_32x32x16_bf16 v[96:111], a[72:75], a[0:3], 0
    s_add_u32 m0, s69, 0xc000
    s_nop 0
    buffer_load_dwordx4 v24, s[56:59], s64 offen lds
    v_mfma_f32_32x32x16_bf16 v[112:127], a[72:75], a[16:19], 0
    ds_read_b64_tr_b16 a[108:109], v4 offset:10752
    ds_read_b64_tr_b16 a[110:111], v4 offset:11008
    ds_read_b64_tr_b16 a[112:113], v4 offset:12288
    ds_read_b64_tr_b16 a[114:115], v4 offset:12544
    v_mfma_f32_32x32x16_bf16 v[128:143], a[76:79], a[0:3], 0
    s_add_u32 m0, s69, 0xc400
    s_nop 0
    buffer_load_dwordx4 v25, s[56:59], s64 offen lds
    s_add_u32 s63, s60, 0x180
    v_mfma_f32_32x32x16_bf16 v[144:159], a[76:79], a[16:19], 0
    s_add_u32 m0, s69, 0xc800
    s_nop 0
    buffer_load_dwordx4 v26, s[56:59], s64 offen lds
    s_waitcnt lgkmcnt(15)
    v_mfma_f32_32x32x16_bf16 v[32:47], a[80:83], a[4:7], v[32:47]
    s_add_u32 m0, s69, 0xcc00
    s_nop 0
    buffer_load_dwordx4 v27, s[56:59], s64 offen lds
    s_add_u32 s64, s61, 0x180000
    v_mfma_f32_32x32x16_bf16 v[48:63], a[80:83], a[20:23], v[48:63]
    s_add_u32 m0, s69, 0x8000
    s_nop 0
    buffer_load_dwordx4 v24, s[56:59], s64 offen lds
    v_mfma_f32_32x32x16_bf16 v[64:79], a[84:87], a[4:7], v[64:79]
    ds_read_b64_tr_b16 a[116:117], v4 offset:12800
    ds_read_b64_tr_b16 a[118:119], v4 offset:13056
    ds_read_b64_tr_b16 a[120:121], v4 offset:14336
    ds_read_b64_tr_b16 a[122:123], v4 offset:14592
    v_mfma_f32_32x32x16_bf16 v[80:95], a[84:87], a[20:23], v[80:95]
    s_add_u32 m0, s69, 0x8400
    s_nop 0
    buffer_load_dwordx4 v25, s[56:59], s64 offen lds
    v_mfma_f32_32x32x16_bf16 v[96:111], a[88:91], a[4:7], v[96:111]
    s_add_u32 m0, s62, 0x2000
    s_nop 0
    s_waitcnt lgkmcnt(10)
    buffer_load_dwordx4 v16, s[52:55], s63 offen lds
    v_mfma_f32_32x32x16_bf16 v[112:127], a[88:91], a[20:23], v[112:127]
    s_add_u32 m0, s69, 0x8800
    s_nop 0
    buffer_load_dwordx4 v26, s[56:59], s64 offen lds
    v_mfma_f32_32x32x16_bf16 v[128:143], a[92:95], a[4:7], v[128:143]
    s_add_u32 m0, s62, 0x2400
    s_nop 0
    buffer_load_dwordx4 v17, s[52:55], s63 offen lds
    v_mfma_f32_32x32x16_bf16 v[144:159], a[92:95], a[20:23], v[144:159]
    s_waitcnt vmcnt(18)
    s_barrier
    s_waitcnt vmcnt(17)
    v_readfirstlane_b32 s27, v9
    s_nop 0
    s_cmp_eq_u32 s27, 0xff
    s_cbranch_scc1 L2_e0_bc
    L2_e0_bcr:
    v_mfma_f32_32x32x16_bf16 v[32:47], a[96:99], a[8:11], v[32:47]
    s_add_u32 m0, s69, 0x8c00
    s_nop 0
    buffer_load_dwordx4 v27, s[56:59], s64 offen lds
    s_add_u32 s64, s61, 0x200000
    v_mfma_f32_32x32x16_bf16 v[48:63], a[96:99], a[24:27], v[48:63]
    s_add_u32 m0, s62, 0x2800
    s_nop 0
    buffer_load_dwordx4 v18, s[52:55], s63 offen lds
    v_mfma_f32_32x32x16_bf16 v[64:79], a[100:103], a[8:11], v[64:79]
    ds_read_b64_tr_b16 a[124:125], v4 offset:14848
    ds_read_b64_tr_b16 a[126:127], v4 offset:15104
    ds_read_b64_tr_b16 a[64:65], v3 offset:49152
    ds_read_b64_tr_b16 a[66:67], v3 offset:49408
    v_mfma_f32_32x32x16_bf16 v[80:95], a[100:103], a[24:27], v[80:95]
    s_add_u32 m0, s62, 0x2c00
    s_nop 0
    buffer_load_dwordx4 v19, s[52:55], s63 offen lds
    s_waitcnt lgkmcnt(12)
    v_mfma_f32_32x32x16_bf16 v[96:111], a[104:107], a[8:11], v[96:111]
    s_add_u32 m0, s62, 0x3000
    s_nop 0
    buffer_load_dwordx4 v20, s[52:55], s63 offen lds
    v_mfma_f32_32x32x16_bf16 v[112:127], a[104:107], a[24:27], v[112:127]
    s_add_u32 m0, s62, 0x3400
    s_nop 0
    buffer_load_dwordx4 v21, s[52:55], s63 offen lds
    s_waitcnt lgkmcnt(10)
    v_mfma_f32_32x32x16_bf16 v[128:143], a[108:111], a[8:11], v[128:143]
    s_add_u32 m0, s62, 0x3800
    s_nop 0
    buffer_load_dwordx4 v22, s[52:55], s63 offen lds
    v_mfma_f32_32x32x16_bf16 v[144:159], a[108:111], a[24:27], v[144:159]
    ds_read_b64_tr_b16 a[68:69], v3 offset:49664
    ds_read_b64_tr_b16 a[70:71], v3 offset:49920
    ds_read_b64_tr_b16 a[72:73], v3 offset:51200
    ds_read_b64_tr_b16 a[74:75], v3 offset:51456
    s_waitcnt lgkmcnt(12)
    v_mfma_f32_32x32x16_bf16 v[32:47], a[112:115], a[12:15], v[32:47]
    s_add_u32 m0, s62, 0x3c00
    s_nop 0
    buffer_load_dwordx4 v23, s[52:55], s63 offen lds
    v_mfma_f32_32x32x16_bf16 v[48:63], a[112:115], a[28:31], v[48:63]
    ds_read_b64_tr_b16 a[76:77], v3 offset:51712
    ds_read_b64_tr_b16 a[78:79], v3 offset:51968
    ds_read_b64_tr_b16 a[80:81], v3 offset:53248
    ds_read_b64_tr_b16 a[82:83], v3 offset:53504
    s_waitcnt lgkmcnt(14)
    v_mfma_f32_32x32x16_bf16 v[64:79], a[116:119], a[12:15], v[64:79]
    s_add_u32 m0, s69, 0x4000
    s_nop 0
    buffer_load_dwordx4 v24, s[56:59], s64 offen lds
    v_mfma_f32_32x32x16_bf16 v[80:95], a[116:119], a[28:31], v[80:95]
    ds_read_b64_tr_b16 a[84:85], v3 offset:53760
    ds_read_b64_tr_b16 a[86:87], v3 offset:54016
    ds_read_b64_tr_b16 a[88:89], v3 offset:55296
    ds_read_b64_tr_b16 a[90:91], v3 offset:55552
    s_waitcnt lgkmcnt(15)
    v_mfma_f32_32x32x16_bf16 v[96:111], a[120:123], a[12:15], v[96:111]
    s_add_u32 m0, s69, 0x4400
    s_nop 0
    buffer_load_dwordx4 v25, s[56:59], s64 offen lds
    v_mfma_f32_32x32x16_bf16 v[112:127], a[120:123], a[28:31], v[112:127]
    s_add_u32 m0, s69, 0x4800
    s_nop 0
    buffer_load_dwordx4 v26, s[56:59], s64 offen lds
    s_waitcnt lgkmcnt(14)
    v_mfma_f32_32x32x16_bf16 v[128:143], a[124:127], a[12:15], v[128:143]
    s_add_u32 m0, s69, 0x4c00
    s_nop 0
    buffer_load_dwordx4 v27, s[56:59], s64 offen lds
    v_mfma_f32_32x32x16_bf16 v[144:159], a[124:127], a[28:31], v[144:159]
    ds_read_b64_tr_b16 a[92:93], v3 offset:55808
    ds_read_b64_tr_b16 a[94:95], v3 offset:56064
    ds_read_b64_tr_b16 a[96:97], v3 offset:57344
    ds_read_b64_tr_b16 a[98:99], v3 offset:57600
    s_waitcnt lgkmcnt(15)
    v_mfma_f32_32x32x16_bf16 v[32:47], a[64:67], a[32:35], v[32:47]
    ds_read_b64_tr_b16 a[100:101], v3 offset:57856
    ds_read_b64_tr_b16 a[102:103], v3 offset:58112
    v_mfma_f32_32x32x16_bf16 v[48:63], a[64:67], a[48:51], v[48:63]
    s_waitcnt vmcnt(20)
    ds_read_b128 a[0:3], v28
    ds_read_b128 a[16:19], v28 offset:4096
    ds_read_b128 a[4:7], v29
    ds_read_b128 a[20:23], v29 offset:4096
    s_waitcnt lgkmcnt(15)
    v_mfma_f32_32x32x16_bf16 v[64:79], a[68:71], a[32:35], v[64:79]
    ds_read_b128 a[8:11], v30
    ds_read_b128 a[24:27], v30 offset:4096
    ds_read_b128 a[12:15], v2
    ds_read_b128 a[28:31], v2 offset:4096
    v_mfma_f32_32x32x16_bf16 v[80:95], a[68:71], a[48:51], v[80:95]
    ds_read_b64_tr_b16 a[104:105], v3 offset:59392
    ds_read_b64_tr_b16 a[106:107], v3 offset:59648
    ds_read_b64_tr_b16 a[108:109], v3 offset:59904
    ds_read_b64_tr_b16 a[110:111], v3 offset:60160
    v_mfma_f32_32x32x16_bf16 v[96:111], a[72:75], a[32:35], v[96:111]
    v_mfma_f32_32x32x16_bf16 v[112:127], a[72:75], a[48:51], v[112:127]
    ds_read_b64_tr_b16 a[112:113], v3 offset:61440
    ds_read_b64_tr_b16 a[114:115], v3 offset:61696
    v_mfma_f32_32x32x16_bf16 v[128:143], a[76:79], a[32:35], v[128:143]
    s_add_u32 s63, s60, 0x200
    s_add_u32 m0, s62, 0
    s_nop 0
    s_waitcnt lgkmcnt(6)
    buffer_load_dwordx4 v16, s[52:55], s63 offen lds
    v_mfma_f32_32x32x16_bf16 v[144:159], a[76:79], a[48:51], v[144:159]
    ds_read_b64_tr_b16 a[116:117], v3 offset:61952
    ds_read_b64_tr_b16 a[118:119], v3 offset:62208
    v_mfma_f32_32x32x16_bf16 v[32:47], a[80:83], a[36:39], v[32:47]
    s_add_u32 m0, s62, 0x400
    s_nop 0
    buffer_load_dwordx4 v17, s[52:55], s63 offen lds
    v_mfma_f32_32x32x16_bf16 v[48:63], a[80:83], a[52:55], v[48:63]
    ds_read_b64_tr_b16 a[120:121], v3 offset:63488
    ds_read_b64_tr_b16 a[122:123], v3 offset:63744
    v_mfma_f32_32x32x16_bf16 v[64:79], a[84:87], a[36:39], v[64:79]
    s_add_u32 m0, s62, 0x800
    s_nop 0
    buffer_load_dwordx4 v18, s[52:55], s63 offen lds
    v_mfma_f32_32x32x16_bf16 v[80:95], a[84:87], a[52:55], v[80:95]
    ds_read_b64_tr_b16 a[124:125], v3 offset:64000
    ds_read_b64_tr_b16 a[126:127], v3 offset:64256
    v_mfma_f32_32x32x16_bf16 v[96:111], a[88:91], a[36:39], v[96:111]
    s_add_u32 m0, s62, 0xc00
    s_nop 0
    buffer_load_dwordx4 v19, s[52:55], s63 offen lds
    v_mfma_f32_32x32x16_bf16 v[112:127], a[88:91], a[52:55], v[112:127]
    s_add_u32 m0, s62, 0x1000
    s_nop 0
    buffer_load_dwordx4 v20, s[52:55], s63 offen lds
    v_mfma_f32_32x32x16_bf16 v[128:143], a[92:95], a[36:39], v[128:143]
    s_add_u32 m0, s62, 0x1400
    s_nop 0
    buffer_load_dwordx4 v21, s[52:55], s63 offen lds
    v_mfma_f32_32x32x16_bf16 v[144:159], a[92:95], a[52:55], v[144:159]
    s_add_u32 m0, s62, 0x1800
    s_nop 0
    buffer_load_dwordx4 v22, s[52:55], s63 offen lds
    s_waitcnt vmcnt(23)
    s_barrier
    v_mfma_f32_32x32x16_bf16 v[32:47], a[96:99], a[40:43], v[32:47]
    ds_read_b64_tr_b16 a[64:65], v3 offset:32768
    ds_read_b64_tr_b16 a[66:67], v3 offset:33024
    ds_read_b64_tr_b16 a[68:69], v3 offset:33280
    ds_read_b64_tr_b16 a[70:71], v3 offset:33536
    v_mfma_f32_32x32x16_bf16 v[48:63], a[96:99], a[56:59], v[48:63]
    s_add_u32 m0, s62, 0x1c00
    s_nop 0
    buffer_load_dwordx4 v23, s[52:55], s63 offen lds
    s_add_u32 s64, s61, 0x280000
    v_mfma_f32_32x32x16_bf16 v[64:79], a[100:103], a[40:43], v[64:79]
    ds_read_b64_tr_b16 a[72:73], v3 offset:34816
    ds_read_b64_tr_b16 a[74:75], v3 offset:35072
    v_mfma_f32_32x32x16_bf16 v[80:95], a[100:103], a[56:59], v[80:95]
    ds_read_b64_tr_b16 a[76:77], v3 offset:35328
    ds_read_b64_tr_b16 a[78:79], v3 offset:35584
    s_waitcnt lgkmcnt(15)
    v_mfma_f32_32x32x16_bf16 v[96:111], a[104:107], a[40:43], v[96:111]
    s_add_u32 m0, s69, 0x14000
    s_nop 0
    buffer_load_dwordx4 v24, s[56:59], s64 offen lds
    v_mfma_f32_32x32x16_bf16 v[112:127], a[104:107], a[56:59], v[112:127]
    ds_read_b64_tr_b16 a[80:81], v3 offset:36864
    ds_read_b64_tr_b16 a[82:83], v3 offset:37120
    v_mfma_f32_32x32x16_bf16 v[128:143], a[108:111], a[40:43], v[128:143]
    s_add_u32 m0, s69, 0x14400
    s_nop 0
    buffer_load_dwordx4 v25, s[56:59], s64 offen lds
    v_mfma_f32_32x32x16_bf16 v[144:159], a[108:111], a[56:59], v[144:159]
    s_add_u32 m0, s69, 0x14800
    s_nop 0
    buffer_load_dwordx4 v26, s[56:59], s64 offen lds
    s_waitcnt lgkmcnt(15)
    v_mfma_f32_32x32x16_bf16 v[32:47], a[112:115], a[44:47], v[32:47]
    ds_read_b64_tr_b16 a[84:85], v3 offset:37376
    ds_read_b64_tr_b16 a[86:87], v3 offset:37632
    v_mfma_f32_32x32x16_bf16 v[48:63], a[112:115], a[60:63], v[48:63]
    s_add_u32 m0, s69, 0x14c00
    s_nop 0
    buffer_load_dwordx4 v27, s[56:59], s64 offen lds
    s_waitcnt lgkmcnt(15)
    v_mfma_f32_32x32x16_bf16 v[64:79], a[116:119], a[44:47], v[64:79]
    ds_read_b64_tr_b16 a[88:89], v3 offset:38912
    ds_read_b64_tr_b16 a[90:91], v3 offset:39168
    v_mfma_f32_32x32x16_bf16 v[80:95], a[116:119], a[60:63], v[80:95]
    ds_read_b64_tr_b16 a[92:93], v3 offset:39424
    ds_read_b64_tr_b16 a[94:95], v3 offset:39680
    s_waitcnt lgkmcnt(15)
    v_mfma_f32_32x32x16_bf16 v[96:111], a[120:123], a[44:47], v[96:111]
    v_mfma_f32_32x32x16_bf16 v[112:127], a[120:123], a[60:63], v[112:127]
    ds_read_b64_tr_b16 a[96:97], v3 offset:40960
    ds_read_b64_tr_b16 a[98:99], v3 offset:41216
    v_mfma_f32_32x32x16_bf16 v[128:143], a[124:127], a[44:47], v[128:143]
    v_mfma_f32_32x32x16_bf16 v[144:159], a[124:127], a[60:63], v[144:159]
    ds_read_b64_tr_b16 a[100:101], v3 offset:41472
    ds_read_b64_tr_b16 a[102:103], v3 offset:41728
    s_waitcnt lgkmcnt(15)
    v_mfma_f32_32x32x16_bf16 v[32:47], a[64:67], a[0:3], v[32:47]
    v_mfma_f32_32x32x16_bf16 v[48:63], a[64:67], a[16:19], v[48:63]
    s_lshl_b32 s27, s2, 8
    s_add_u32 s27, s27, 0x4e00000
    buffer_load_dword v10, v15, s[8:11], s27 offen sc1
    s_waitcnt vmcnt(17)
    ds_read_b128 a[32:35], v28 offset:8192
    v_mfma_f32_32x32x16_bf16 v[64:79], a[68:71], a[0:3], v[64:79]
    ds_read_b128 a[48:51], v28 offset:12288
    ds_read_b128 a[36:39], v29 offset:8192
    ds_read_b128 a[52:55], v29 offset:12288
    ds_read_b128 a[40:43], v30 offset:8192
    v_mfma_f32_32x32x16_bf16 v[80:95], a[68:71], a[16:19], v[80:95]
    ds_read_b128 a[56:59], v30 offset:12288
    ds_read_b128 a[44:47], v2 offset:8192
    ds_read_b128 a[60:63], v2 offset:12288
    s_waitcnt lgkmcnt(15)
    v_mfma_f32_32x32x16_bf16 v[96:111], a[72:75], a[0:3], v[96:111]
    ds_read_b64_tr_b16 a[104:105], v3 offset:43008
    ds_read_b64_tr_b16 a[106:107], v3 offset:43264
    ds_read_b64_tr_b16 a[108:109], v3 offset:43520
    ds_read_b64_tr_b16 a[110:111], v3 offset:43776
    v_mfma_f32_32x32x16_bf16 v[112:127], a[72:75], a[16:19], v[112:127]
    ds_read_b64_tr_b16 a[112:113], v3 offset:45056
    ds_read_b64_tr_b16 a[114:115], v3 offset:45312
    v_mfma_f32_32x32x16_bf16 v[128:143], a[76:79], a[0:3], v[128:143]
    s_add_u32 s63, s60, 0x280
    s_add_u32 m0, s62, 0x2000
    s_nop 0
    s_waitcnt lgkmcnt(6)
    buffer_load_dwordx4 v16, s[52:55], s63 offen lds
    v_mfma_f32_32x32x16_bf16 v[144:159], a[76:79], a[16:19], v[144:159]
    ds_read_b64_tr_b16 a[116:117], v3 offset:45568
    ds_read_b64_tr_b16 a[118:119], v3 offset:45824
    v_mfma_f32_32x32x16_bf16 v[32:47], a[80:83], a[4:7], v[32:47]
    s_add_u32 m0, s62, 0x2400
    s_nop 0
    buffer_load_dwordx4 v17, s[52:55], s63 offen lds
    v_mfma_f32_32x32x16_bf16 v[48:63], a[80:83], a[20:23], v[48:63]
    ds_read_b64_tr_b16 a[120:121], v3 offset:47104
    ds_read_b64_tr_b16 a[122:123], v3 offset:47360
    v_mfma_f32_32x32x16_bf16 v[64:79], a[84:87], a[4:7], v[64:79]
    s_add_u32 m0, s62, 0x2800
    s_nop 0
    buffer_load_dwordx4 v18, s[52:55], s63 offen lds
    v_mfma_f32_32x32x16_bf16 v[80:95], a[84:87], a[20:23], v[80:95]
    ds_read_b64_tr_b16 a[124:125], v3 offset:47616
    ds_read_b64_tr_b16 a[126:127], v3 offset:47872
    v_mfma_f32_32x32x16_bf16 v[96:111], a[88:91], a[4:7], v[96:111]
    s_add_u32 m0, s62, 0x2c00
    s_nop 0
    buffer_load_dwordx4 v19, s[52:55], s63 offen lds
    v_mfma_f32_32x32x16_bf16 v[112:127], a[88:91], a[20:23], v[112:127]
    s_add_u32 m0, s62, 0x3000
    s_nop 0
    buffer_load_dwordx4 v20, s[52:55], s63 offen lds
    v_mfma_f32_32x32x16_bf16 v[128:143], a[92:95], a[4:7], v[128:143]
    s_add_u32 m0, s62, 0x3400
    s_nop 0
    buffer_load_dwordx4 v21, s[52:55], s63 offen lds
    v_mfma_f32_32x32x16_bf16 v[144:159], a[92:95], a[20:23], v[144:159]
    s_barrier
    L2_c1:
    s_waitcnt vmcnt(6)
    v_readfirstlane_b32 s27, v10
    s_nop 0
    s_cmp_eq_u32 s27, 0
    s_cbranch_scc1 L2_c1_spin
    buffer_load_dwordx4 v[160:163], v31, s[8:11], s82 offen sc1
    buffer_load_dwordx4 v[164:167], v31, s[8:11], s83 offen sc1
    buffer_load_dwordx4 v[168:171], v31, s[8:11], s84 offen sc1
    buffer_load_dwordx4 v[172:175], v31, s[8:11], s85 offen sc1
    v_mfma_f32_32x32x16_bf16 v[32:47], a[96:99], a[8:11], v[32:47]
    ds_read_b64_tr_b16 a[64:65], v3 offset:16384
    ds_read_b64_tr_b16 a[66:67], v3 offset:16640
    ds_read_b64_tr_b16 a[68:69], v3 offset:16896
    ds_read_b64_tr_b16 a[70:71], v3 offset:17152
    s_add_u32 s64, s61, 0x300000
    v_mfma_f32_32x32x16_bf16 v[48:63], a[96:99], a[24:27], v[48:63]
    s_add_u32 m0, s62, 0x3800
    s_nop 0
    buffer_load_dwordx4 v22, s[52:55], s63 offen lds
    v_mfma_f32_32x32x16_bf16 v[64:79], a[100:103], a[8:11], v[64:79]
    s_add_u32 m0, s62, 0x3c00
    s_nop 0
    buffer_load_dwordx4 v23, s[52:55], s63 offen lds
    v_mfma_f32_32x32x16_bf16 v[80:95], a[100:103], a[24:27], v[80:95]
    ds_read_b64_tr_b16 a[72:73], v3 offset:18432
    ds_read_b64_tr_b16 a[74:75], v3 offset:18688
    ds_read_b64_tr_b16 a[76:77], v3 offset:18944
    ds_read_b64_tr_b16 a[78:79], v3 offset:19200
    s_waitcnt lgkmcnt(15)
    v_mfma_f32_32x32x16_bf16 v[96:111], a[104:107], a[8:11], v[96:111]
    s_add_u32 m0, s69, 0x10000
    s_nop 0
    buffer_load_dwordx4 v24, s[56:59], s64 offen lds
    v_mfma_f32_32x32x16_bf16 v[112:127], a[104:107], a[24:27], v[112:127]
    ds_read_b64_tr_b16 a[80:81], v3 offset:20480
    ds_read_b64_tr_b16 a[82:83], v3 offset:20736
    v_mfma_f32_32x32x16_bf16 v[128:143], a[108:111], a[8:11], v[128:143]
    s_add_u32 m0, s69, 0x10400
    s_nop 0
    buffer_load_dwordx4 v25, s[56:59], s64 offen lds
    v_mfma_f32_32x32x16_bf16 v[144:159], a[108:111], a[24:27], v[144:159]
    ds_read_b64_tr_b16 a[84:85], v3 offset:20992
    ds_read_b64_tr_b16 a[86:87], v3 offset:21248
    s_waitcnt lgkmcnt(15)
    v_mfma_f32_32x32x16_bf16 v[32:47], a[112:115], a[12:15], v[32:47]
    s_add_u32 m0, s69, 0x10800
    s_nop 0
    buffer_load_dwordx4 v26, s[56:59], s64 offen lds
    v_mfma_f32_32x32x16_bf16 v[48:63], a[112:115], a[28:31], v[48:63]
    s_add_u32 m0, s69, 0x10c00
    s_nop 0
    buffer_load_dwordx4 v27, s[56:59], s64 offen lds
    v_mfma_f32_32x32x16_bf16 v[64:79], a[116:119], a[12:15], v[64:79]
    ds_read_b64_tr_b16 a[88:89], v3 offset:22528
    ds_read_b64_tr_b16 a[90:91], v3 offset:22784
    v_mfma_f32_32x32x16_bf16 v[80:95], a[116:119], a[28:31], v[80:95]
    ds_read_b64_tr_b16 a[92:93], v3 offset:23040
    ds_read_b64_tr_b16 a[94:95], v3 offset:23296
    s_waitcnt lgkmcnt(15)
    v_mfma_f32_32x32x16_bf16 v[96:111], a[120:123], a[12:15], v[96:111]
    s_add_u32 m0, s31, 0
    s_nop 0
    buffer_load_dwordx4 v1, s[8:11], s20 offen sc1 lds
    v_mfma_f32_32x32x16_bf16 v[112:127], a[120:123], a[28:31], v[112:127]
    s_add_u32 m0, s31, 0
    s_nop 0
    buffer_load_dwordx4 v1, s[8:11], s20 offen offset:1024 sc1 lds
    s_add_u32 s20, s20, 0x2000
    v_mfma_f32_32x32x16_bf16 v[128:143], a[124:127], a[12:15], v[128:143]
    ds_read_b64_tr_b16 a[96:97], v3 offset:24576
    ds_read_b64_tr_b16 a[98:99], v3 offset:24832
    v_mfma_f32_32x32x16_bf16 v[144:159], a[124:127], a[28:31], v[144:159]
    s_add_u32 m0, s31, 0x2000
    s_nop 0
    buffer_load_dwordx4 v1, s[8:11], s20 offen sc1 lds
    s_waitcnt lgkmcnt(15)
    v_mfma_f32_32x32x16_bf16 v[32:47], a[64:67], a[32:35], v[32:47]
    s_add_u32 m0, s31, 0x2000
    s_nop 0
    buffer_load_dwordx4 v1, s[8:11], s20 offen offset:1024 sc1 lds
    s_add_u32 s20, s20, 0x2000
    v_mfma_f32_32x32x16_bf16 v[48:63], a[64:67], a[48:51], v[48:63]
    ds_read_b128 a[0:3], v28
    ds_read_b128 a[16:19], v28 offset:4096
    ds_read_b128 a[4:7], v29
    ds_read_b128 a[20:23], v29 offset:4096
    v_mov_b32 v5, 0xc0135761
    s_waitcnt lgkmcnt(15)
    v_mfma_f32_32x32x16_bf16 v[64:79], a[68:71], a[32:35], v[64:79]
    ds_read_b128 a[8:11], v30
    ds_read_b128 a[24:27], v30 offset:4096
    ds_read_b128 a[12:15], v2
    ds_read_b128 a[28:31], v2 offset:4096
    v_mov_b32 v6, 0xbdd2d3e8
    v_mfma_f32_32x32x16_bf16 v[80:95], a[68:71], a[48:51], v[80:95]
    ds_read_b64_tr_b16 a[100:101], v3 offset:25088
    ds_read_b64_tr_b16 a[102:103], v3 offset:25344
    ds_read_b64_tr_b16 a[104:105], v3 offset:26624
    ds_read_b64_tr_b16 a[106:107], v3 offset:26880
    s_waitcnt vmcnt(13)
    v_lshlrev_b32 v176, 16, v160
    v_mfma_f32_32x32x16_bf16 v[96:111], a[72:75], a[32:35], v[96:111]
    ds_read_b64_tr_b16 a[108:109], v3 offset:27136
    ds_read_b64_tr_b16 a[110:111], v3 offset:27392
    v_and_b32 v177, 0xffff0000, v160
    v_lshlrev_b32 v178, 16, v161
    v_and_b32 v179, 0xffff0000, v161
    v_lshlrev_b32 v180, 16, v162
    v_and_b32 v181, 0xffff0000, v162
    v_mfma_f32_32x32x16_bf16 v[112:127], a[72:75], a[48:51], v[112:127]
    ds_read_b64_tr_b16 a[112:113], v3 offset:28672
    ds_read_b64_tr_b16 a[114:115], v3 offset:28928
    v_lshlrev_b32 v182, 16, v163
    v_and_b32 v183, 0xffff0000, v163
    s_waitcnt vmcnt(12)
    v_lshlrev_b32 v184, 16, v164
    v_and_b32 v185, 0xffff0000, v164
    v_lshlrev_b32 v186, 16, v165
    s_waitcnt lgkmcnt(15)
    v_mfma_f32_32x32x16_bf16 v[128:143], a[76:79], a[32:35], v[128:143]
    s_add_u32 s63, s60, 0x300
    s_add_u32 m0, s62, 0
    s_nop 0
    s_waitcnt lgkmcnt(8)
    buffer_load_dwordx4 v16, s[52:55], s63 offen lds
    v_and_b32 v187, 0xffff0000, v165
    v_lshlrev_b32 v188, 16, v166
    v_mfma_f32_32x32x16_bf16 v[144:159], a[76:79], a[48:51], v[144:159]
    ds_read_b64_tr_b16 a[116:117], v3 offset:29184
    ds_read_b64_tr_b16 a[118:119], v3 offset:29440
    v_and_b32 v189, 0xffff0000, v166
    v_lshlrev_b32 v190, 16, v167
    v_and_b32 v191, 0xffff0000, v167
    s_waitcnt vmcnt(12)
    v_lshlrev_b32 v192, 16, v168
    v_and_b32 v193, 0xffff0000, v168
    v_mfma_f32_32x32x16_bf16 v[32:47], a[80:83], a[36:39], v[32:47]
    s_add_u32 m0, s62, 0x400
    s_nop 0
    buffer_load_dwordx4 v17, s[52:55], s63 offen lds
    v_lshlrev_b32 v194, 16, v169
    v_and_b32 v195, 0xffff0000, v169
    v_lshlrev_b32 v196, 16, v170
    v_mfma_f32_32x32x16_bf16 v[48:63], a[80:83], a[52:55], v[48:63]
    ds_read_b64_tr_b16 a[120:121], v3 offset:30720
    ds_read_b64_tr_b16 a[122:123], v3 offset:30976
    v_and_b32 v197, 0xffff0000, v170
    v_lshlrev_b32 v198, 16, v171
    v_and_b32 v199, 0xffff0000, v171
    s_waitcnt vmcnt(12)
    v_lshlrev_b32 v200, 16, v172
    v_and_b32 v201, 0xffff0000, v172
    v_mfma_f32_32x32x16_bf16 v[64:79], a[84:87], a[36:39], v[64:79]
    s_add_u32 m0, s62, 0x800
    s_nop 0
    buffer_load_dwordx4 v18, s[52:55], s63 offen lds
    v_lshlrev_b32 v202, 16, v173
    v_and_b32 v203, 0xffff0000, v173
    v_lshlrev_b32 v204, 16, v174
    v_mfma_f32_32x32x16_bf16 v[80:95], a[84:87], a[52:55], v[80:95]
    ds_read_b64_tr_b16 a[124:125], v3 offset:31232
    ds_read_b64_tr_b16 a[126:127], v3 offset:31488
    v_and_b32 v205, 0xffff0000, v174
    v_lshlrev_b32 v206, 16, v175
    v_and_b32 v207, 0xffff0000, v175
    v_mul_f32 v208, v176, v176
    v_mul_f32 v209, v177, v177
    v_mfma_f32_32x32x16_bf16 v[96:111], a[88:91], a[36:39], v[96:111]
    s_add_u32 m0, s62, 0xc00
    s_nop 0
    buffer_load_dwordx4 v19, s[52:55], s63 offen lds
    v_mul_f32 v210, v178, v178
    v_mul_f32 v211, v179, v179
    v_mul_f32 v212, v180, v180
    v_mfma_f32_32x32x16_bf16 v[112:127], a[88:91], a[52:55], v[112:127]
    s_add_u32 m0, s62, 0x1000
    s_nop 0
    buffer_load_dwordx4 v20, s[52:55], s63 offen lds
    v_mul_f32 v213, v181, v181
    v_mul_f32 v214, v182, v182
    v_mul_f32 v215, v183, v183
    v_mfma_f32_32x32x16_bf16 v[128:143], a[92:95], a[36:39], v[128:143]
    s_add_u32 m0, s62, 0x1400
    s_nop 0
    buffer_load_dwordx4 v21, s[52:55], s63 offen lds
    v_fma_f32 v208, v208, v6, v5
    v_fma_f32 v209, v209, v6, v5
    v_fma_f32 v210, v210, v6, v5
    v_mfma_f32_32x32x16_bf16 v[144:159], a[92:95], a[52:55], v[144:159]
    s_add_u32 m0, s62, 0x1800
    s_nop 0
    buffer_load_dwordx4 v22, s[52:55], s63 offen lds
    v_fma_f32 v211, v211, v6, v5
    v_fma_f32 v212, v212, v6, v5
    s_barrier
    v_mfma_f32_32x32x16_bf16 v[32:47], a[96:99], a[40:43], v[32:47]
    ds_read_b64_tr_b16 a[64:65], v3
    ds_read_b64_tr_b16 a[66:67], v3 offset:256
    ds_read_b64_tr_b16 a[68:69], v3 offset:512
    ds_read_b64_tr_b16 a[70:71], v3 offset:768
    s_add_u32 s64, s61, 0x380000
    v_mfma_f32_32x32x16_bf16 v[48:63], a[96:99], a[56:59], v[48:63]
    s_add_u32 m0, s62, 0x1c00
    s_nop 0
    buffer_load_dwordx4 v23, s[52:55], s63 offen lds
    v_fma_f32 v213, v213, v6, v5
    v_fma_f32 v214, v214, v6, v5
    v_fma_f32 v215, v215, v6, v5
    s_waitcnt lgkmcnt(15)
    v_mfma_f32_32x32x16_bf16 v[64:79], a[100:103], a[40:43], v[64:79]
    ds_read_b64_tr_b16 a[72:73], v3 offset:2048
    ds_read_b64_tr_b16 a[74:75], v3 offset:2304
    v_mul_f32 v208, v176, v208
    v_mul_f32 v209, v177, v209
    v_mul_f32 v210, v178, v210
    v_mul_f32 v211, v179, v211
    v_mul_f32 v212, v180, v212
    v_mfma_f32_32x32x16_bf16 v[80:95], a[100:103], a[56:59], v[80:95]
    ds_read_b64_tr_b16 a[76:77], v3 offset:2560
    ds_read_b64_tr_b16 a[78:79], v3 offset:2816
    v_mul_f32 v213, v181, v213
    v_mul_f32 v214, v182, v214
    v_mul_f32 v215, v183, v215
    v_exp_f32 v208, v208
    s_waitcnt lgkmcnt(15)
    v_mfma_f32_32x32x16_bf16 v[96:111], a[104:107], a[40:43], v[96:111]
    s_add_u32 m0, s69, 0xc000
    s_nop 0
    buffer_load_dwordx4 v24, s[56:59], s64 offen lds
    v_exp_f32 v209, v209
    v_mfma_f32_32x32x16_bf16 v[112:127], a[104:107], a[56:59], v[112:127]
    ds_read_b64_tr_b16 a[80:81], v3 offset:4096
    ds_read_b64_tr_b16 a[82:83], v3 offset:4352
    v_exp_f32 v210, v210
    v_exp_f32 v211, v211
    v_mfma_f32_32x32x16_bf16 v[128:143], a[108:111], a[40:43], v[128:143]
    s_add_u32 m0, s69, 0xc400
    s_nop 0
    buffer_load_dwordx4 v25, s[56:59], s64 offen lds
    v_exp_f32 v212, v212
    v_mfma_f32_32x32x16_bf16 v[144:159], a[108:111], a[56:59], v[144:159]
    ds_read_b64_tr_b16 a[84:85], v3 offset:4608
    ds_read_b64_tr_b16 a[86:87], v3 offset:4864
    v_exp_f32 v213, v213
    v_exp_f32 v214, v214
    s_waitcnt lgkmcnt(15)
    v_mfma_f32_32x32x16_bf16 v[32:47], a[112:115], a[44:47], v[32:47]
    s_add_u32 m0, s69, 0xc800
    s_nop 0
    buffer_load_dwordx4 v26, s[56:59], s64 offen lds
    v_exp_f32 v215, v215
    v_add_f32 v208, 1.0, v208
    v_mfma_f32_32x32x16_bf16 v[48:63], a[112:115], a[60:63], v[48:63]
    s_add_u32 m0, s69, 0xcc00
    s_nop 0
    buffer_load_dwordx4 v27, s[56:59], s64 offen lds
    v_add_f32 v209, 1.0, v209
    v_add_f32 v210, 1.0, v210
    v_add_f32 v211, 1.0, v211
    v_mfma_f32_32x32x16_bf16 v[64:79], a[116:119], a[44:47], v[64:79]
    ds_read_b64_tr_b16 a[88:89], v3 offset:6144
    ds_read_b64_tr_b16 a[90:91], v3 offset:6400
    v_add_f32 v212, 1.0, v212
    v_add_f32 v213, 1.0, v213
    v_add_f32 v214, 1.0, v214
    v_add_f32 v215, 1.0, v215
    v_mfma_f32_32x32x16_bf16 v[80:95], a[116:119], a[60:63], v[80:95]
    ds_read_b64_tr_b16 a[92:93], v3 offset:6656
    ds_read_b64_tr_b16 a[94:95], v3 offset:6912
    v_rcp_f32 v208, v208
    v_rcp_f32 v209, v209
    s_waitcnt lgkmcnt(15)
    v_mfma_f32_32x32x16_bf16 v[96:111], a[120:123], a[44:47], v[96:111]
    v_rcp_f32 v210, v210
    v_rcp_f32 v211, v211
    v_rcp_f32 v212, v212
    v_rcp_f32 v213, v213
    v_mfma_f32_32x32x16_bf16 v[112:127], a[120:123], a[60:63], v[112:127]
    ds_read_b64_tr_b16 a[96:97], v3 offset:8192
    ds_read_b64_tr_b16 a[98:99], v3 offset:8448
    v_rcp_f32 v214, v214
    v_rcp_f32 v215, v215
    v_mul_f32 v176, v176, v208
    v_mfma_f32_32x32x16_bf16 v[128:143], a[124:127], a[44:47], v[128:143]
    v_mul_f32 v177, v177, v209
    v_mul_f32 v178, v178, v210
    v_mul_f32 v179, v179, v211
    v_mul_f32 v180, v180, v212
    v_mul_f32 v181, v181, v213
    v_mul_f32 v182, v182, v214
    v_mul_f32 v183, v183, v215
    v_mul_f32 v216, v184, v184
    v_mul_f32 v217, v185, v185
    v_mfma_f32_32x32x16_bf16 v[144:159], a[124:127], a[60:63], v[144:159]
    ds_read_b64_tr_b16 a[100:101], v3 offset:8704
    ds_read_b64_tr_b16 a[102:103], v3 offset:8960
    v_mul_f32 v218, v186, v186
    v_mul_f32 v219, v187, v187
    v_mul_f32 v220, v188, v188
    v_mul_f32 v221, v189, v189
    v_mul_f32 v222, v190, v190
    s_waitcnt lgkmcnt(15)
    v_mfma_f32_32x32x16_bf16 v[32:47], a[64:67], a[0:3], v[32:47]
    v_mul_f32 v223, v191, v191
    v_fma_f32 v216, v216, v6, v5
    v_fma_f32 v217, v217, v6, v5
    v_fma_f32 v218, v218, v6, v5
    v_fma_f32 v219, v219, v6, v5
    v_fma_f32 v220, v220, v6, v5
    v_fma_f32 v221, v221, v6, v5
    v_fma_f32 v222, v222, v6, v5
    v_fma_f32 v223, v223, v6, v5
    v_mfma_f32_32x32x16_bf16 v[48:63], a[64:67], a[16:19], v[48:63]
    s_waitcnt vmcnt(20)
    ds_read_b128 a[32:35], v28 offset:8192
    ds_read_b128 a[48:51], v28 offset:12288
    ds_read_b128 a[36:39], v29 offset:8192
    ds_read_b128 a[52:55], v29 offset:12288
    v_mul_f32 v216, v184, v216
    v_mfma_f32_32x32x16_bf16 v[64:79], a[68:71], a[0:3], v[64:79]
    ds_read_b128 a[40:43], v30 offset:8192
    ds_read_b128 a[56:59], v30 offset:12288
    ds_read_b128 a[44:47], v2 offset:8192
    ds_read_b128 a[60:63], v2 offset:12288
    v_mul_f32 v217, v185, v217
    v_mfma_f32_32x32x16_bf16 v[80:95], a[68:71], a[16:19], v[80:95]
    ds_read_b64_tr_b16 a[104:105], v3 offset:10240
    ds_read_b64_tr_b16 a[106:107], v3 offset:10496
    ds_read_b64_tr_b16 a[108:109], v3 offset:10752
    ds_read_b64_tr_b16 a[110:111], v3 offset:11008
    v_mul_f32 v218, v186, v218
    s_waitcnt lgkmcnt(15)
    v_mfma_f32_32x32x16_bf16 v[96:111], a[72:75], a[0:3], v[96:111]
    v_mul_f32 v219, v187, v219
    v_mul_f32 v220, v188, v220
    v_mul_f32 v221, v189, v221
    v_mul_f32 v222, v190, v222
    v_mul_f32 v223, v191, v223
    v_exp_f32 v216, v216
    v_exp_f32 v217, v217
    v_mfma_f32_32x32x16_bf16 v[112:127], a[72:75], a[16:19], v[112:127]
    ds_read_b64_tr_b16 a[112:113], v3 offset:12288
    ds_read_b64_tr_b16 a[114:115], v3 offset:12544
    v_exp_f32 v218, v218
    v_exp_f32 v219, v219
    v_mfma_f32_32x32x16_bf16 v[128:143], a[76:79], a[0:3], v[128:143]
    s_add_u32 s63, s60, 0x380
    s_add_u32 m0, s62, 0x2000
    s_nop 0
    s_waitcnt lgkmcnt(6)
    buffer_load_dwordx4 v16, s[52:55], s63 offen lds
    v_exp_f32 v220, v220
    v_mfma_f32_32x32x16_bf16 v[144:159], a[76:79], a[16:19], v[144:159]
    ds_read_b64_tr_b16 a[116:117], v3 offset:12800
    ds_read_b64_tr_b16 a[118:119], v3 offset:13056
    v_exp_f32 v221, v221
    v_exp_f32 v222, v222
    v_mfma_f32_32x32x16_bf16 v[32:47], a[80:83], a[4:7], v[32:47]
    s_add_u32 m0, s62, 0x2400
    s_nop 0
    buffer_load_dwordx4 v17, s[52:55], s63 offen lds
    v_exp_f32 v223, v223
    v_add_f32 v216, 1.0, v216
    v_mfma_f32_32x32x16_bf16 v[48:63], a[80:83], a[20:23], v[48:63]
    ds_read_b64_tr_b16 a[120:121], v3 offset:14336
    ds_read_b64_tr_b16 a[122:123], v3 offset:14592
    v_add_f32 v217, 1.0, v217
    v_add_f32 v218, 1.0, v218
    v_add_f32 v219, 1.0, v219
    v_add_f32 v220, 1.0, v220
    v_add_f32 v221, 1.0, v221
    v_mfma_f32_32x32x16_bf16 v[64:79], a[84:87], a[4:7], v[64:79]
    s_add_u32 m0, s62, 0x2800
    s_nop 0
    buffer_load_dwordx4 v18, s[52:55], s63 offen lds
    v_add_f32 v222, 1.0, v222
    v_add_f32 v223, 1.0, v223
    v_mfma_f32_32x32x16_bf16 v[80:95], a[84:87], a[20:23], v[80:95]
    ds_read_b64_tr_b16 a[124:125], v3 offset:14848
    ds_read_b64_tr_b16 a[126:127], v3 offset:15104
    v_rcp_f32 v216, v216
    v_rcp_f32 v217, v217
    v_mfma_f32_32x32x16_bf16 v[96:111], a[88:91], a[4:7], v[96:111]
    s_add_u32 m0, s62, 0x2c00
    s_nop 0
    buffer_load_dwordx4 v19, s[52:55], s63 offen lds
    v_rcp_f32 v218, v218
    v_mfma_f32_32x32x16_bf16 v[112:127], a[88:91], a[20:23], v[112:127]
    s_add_u32 m0, s62, 0x3000
    s_nop 0
    buffer_load_dwordx4 v20, s[52:55], s63 offen lds
    v_rcp_f32 v219, v219
    v_mfma_f32_32x32x16_bf16 v[128:143], a[92:95], a[4:7], v[128:143]
    s_add_u32 m0, s62, 0x3400
    s_nop 0
    buffer_load_dwordx4 v21, s[52:55], s63 offen lds
    v_rcp_f32 v220, v220
    v_mfma_f32_32x32x16_bf16 v[144:159], a[92:95], a[20:23], v[144:159]
    s_add_u32 m0, s62, 0x3800
    s_nop 0
    buffer_load_dwordx4 v22, s[52:55], s63 offen lds
    v_rcp_f32 v221, v221
    s_barrier
    v_mfma_f32_32x32x16_bf16 v[32:47], a[96:99], a[8:11], v[32:47]
    ds_read_b64_tr_b16 a[64:65], v4
    ds_read_b64_tr_b16 a[66:67], v4 offset:256
    ds_read_b64_tr_b16 a[68:69], v4 offset:512
    ds_read_b64_tr_b16 a[70:71], v4 offset:768
    v_mfma_f32_32x32x16_bf16 v[48:63], a[96:99], a[24:27], v[48:63]
    s_add_u32 m0, s62, 0x3c00
    s_nop 0
    buffer_load_dwordx4 v23, s[52:55], s63 offen lds
    v_rcp_f32 v222, v222
    v_mfma_f32_32x32x16_bf16 v[64:79], a[100:103], a[8:11], v[64:79]
    ds_read_b64_tr_b16 a[72:73], v4 offset:2048
    ds_read_b64_tr_b16 a[74:75], v4 offset:2304
    v_rcp_f32 v223, v223
    v_mul_f32 v184, v184, v216
    v_mul_f32 v185, v185, v217
    v_mul_f32 v186, v186, v218
    v_mfma_f32_32x32x16_bf16 v[80:95], a[100:103], a[24:27], v[80:95]
    ds_read_b64_tr_b16 a[76:77], v4 offset:2560
    ds_read_b64_tr_b16 a[78:79], v4 offset:2816
    v_mul_f32 v187, v187, v219
    v_mul_f32 v188, v188, v220
    v_mul_f32 v189, v189, v221
    v_mul_f32 v190, v190, v222
    v_mul_f32 v191, v191, v223
    s_waitcnt lgkmcnt(15)
    v_mfma_f32_32x32x16_bf16 v[96:111], a[104:107], a[8:11], v[96:111]
    s_lshl_b32 s29, s32, 7
    s_add_u32 s29, s29, 0x4c10000
    v_and_b32 v10, 31, v0
    v_lshlrev_b32 v10, 2, v10
    buffer_load_dword v13, v10, s[8:11], s29 offen sc1
    v_mul_f32 v224, v192, v192
    v_mfma_f32_32x32x16_bf16 v[112:127], a[104:107], a[24:27], v[112:127]
    ds_read_b64_tr_b16 a[80:81], v4 offset:4096
    ds_read_b64_tr_b16 a[82:83], v4 offset:4352
    buffer_load_dword v14, v10, s[8:11], s29 offen offset:128 sc1
    v_mul_f32 v225, v193, v193
    v_mfma_f32_32x32x16_bf16 v[128:143], a[108:111], a[8:11], v[128:143]
    v_mul_f32 v226, v194, v194
    v_mul_f32 v227, v195, v195
    v_mul_f32 v228, v196, v196
    v_mul_f32 v229, v197, v197
    v_mul_f32 v230, v198, v198
    v_mul_f32 v231, v199, v199
    v_fma_f32 v224, v224, v6, v5
    v_fma_f32 v225, v225, v6, v5
    v_fma_f32 v226, v226, v6, v5
    v_mfma_f32_32x32x16_bf16 v[144:159], a[108:111], a[24:27], v[144:159]
    ds_read_b64_tr_b16 a[84:85], v4 offset:4608
    ds_read_b64_tr_b16 a[86:87], v4 offset:4864
    v_fma_f32 v227, v227, v6, v5
    v_fma_f32 v228, v228, v6, v5
    v_fma_f32 v229, v229, v6, v5
    v_fma_f32 v230, v230, v6, v5
    v_fma_f32 v231, v231, v6, v5
    s_waitcnt lgkmcnt(15)
    v_mfma_f32_32x32x16_bf16 v[32:47], a[112:115], a[12:15], v[32:47]
    v_mul_f32 v224, v192, v224
    v_mul_f32 v225, v193, v225
    v_mul_f32 v226, v194, v226
    v_mul_f32 v227, v195, v227
    v_mul_f32 v228, v196, v228
    v_mul_f32 v229, v197, v229
    v_mul_f32 v230, v198, v230
    v_mul_f32 v231, v199, v231
    v_mfma_f32_32x32x16_bf16 v[48:63], a[112:115], a[28:31], v[48:63]
    ds_read_b64_tr_b16 a[88:89], v4 offset:6144
    ds_read_b64_tr_b16 a[90:91], v4 offset:6400
    v_exp_f32 v224, v224
    v_exp_f32 v225, v225
    v_mfma_f32_32x32x16_bf16 v[64:79], a[116:119], a[12:15], v[64:79]
    v_exp_f32 v226, v226
    v_exp_f32 v227, v227
    v_exp_f32 v228, v228
    v_exp_f32 v229, v229
    v_mfma_f32_32x32x16_bf16 v[80:95], a[116:119], a[28:31], v[80:95]
    ds_read_b64_tr_b16 a[92:93], v4 offset:6656
    ds_read_b64_tr_b16 a[94:95], v4 offset:6912
    v_exp_f32 v230, v230
    v_exp_f32 v231, v231
    v_add_f32 v224, 1.0, v224
    s_waitcnt lgkmcnt(15)
    v_mfma_f32_32x32x16_bf16 v[96:111], a[120:123], a[12:15], v[96:111]
    v_add_f32 v225, 1.0, v225
    v_add_f32 v226, 1.0, v226
    v_add_f32 v227, 1.0, v227
    v_add_f32 v228, 1.0, v228
    v_add_f32 v229, 1.0, v229
    v_add_f32 v230, 1.0, v230
    v_add_f32 v231, 1.0, v231
    v_rcp_f32 v224, v224
    v_mfma_f32_32x32x16_bf16 v[112:127], a[120:123], a[28:31], v[112:127]
    ds_read_b64_tr_b16 a[96:97], v4 offset:8192
    ds_read_b64_tr_b16 a[98:99], v4 offset:8448
    v_rcp_f32 v225, v225
    v_rcp_f32 v226, v226
    v_mfma_f32_32x32x16_bf16 v[128:143], a[124:127], a[12:15], v[128:143]
    v_rcp_f32 v227, v227
    v_rcp_f32 v228, v228
    v_rcp_f32 v229, v229
    v_rcp_f32 v230, v230
    v_rcp_f32 v231, v231
    v_mfma_f32_32x32x16_bf16 v[144:159], a[124:127], a[28:31], v[144:159]
    ds_read_b64_tr_b16 a[100:101], v4 offset:8704
    ds_read_b64_tr_b16 a[102:103], v4 offset:8960
    v_mul_f32 v192, v192, v224
    v_mul_f32 v193, v193, v225
    v_mul_f32 v194, v194, v226
    v_mul_f32 v195, v195, v227
    v_mul_f32 v196, v196, v228
    v_mul_f32 v197, v197, v229
    s_waitcnt lgkmcnt(15)
    v_mfma_f32_32x32x16_bf16 v[32:47], a[64:67], a[32:35], v[32:47]
    v_mul_f32 v198, v198, v230
    v_mul_f32 v199, v199, v231
    v_mul_f32 v232, v200, v200
    v_mul_f32 v233, v201, v201
    v_mul_f32 v234, v202, v202
    v_mul_f32 v235, v203, v203
    v_mul_f32 v236, v204, v204
    v_mul_f32 v237, v205, v205
    v_mul_f32 v238, v206, v206
    v_mul_f32 v239, v207, v207
    v_mfma_f32_32x32x16_bf16 v[48:63], a[64:67], a[48:51], v[48:63]
    s_waitcnt vmcnt(14)
    ds_read_b128 a[0:3], v28
    ds_read_b128 a[16:19], v28 offset:4096
    ds_read_b128 a[4:7], v29
    ds_read_b128 a[20:23], v29 offset:4096
    v_fma_f32 v232, v232, v6, v5
    v_mfma_f32_32x32x16_bf16 v[64:79], a[68:71], a[32:35], v[64:79]
    ds_read_b128 a[8:11], v30
    ds_read_b128 a[24:27], v30 offset:4096
    ds_read_b128 a[12:15], v2
    ds_read_b128 a[28:31], v2 offset:4096
    v_fma_f32 v233, v233, v6, v5
    v_fma_f32 v234, v234, v6, v5
    v_mfma_f32_32x32x16_bf16 v[80:95], a[68:71], a[48:51], v[80:95]
    ds_read_b64_tr_b16 a[104:105], v4 offset:10240
    ds_read_b64_tr_b16 a[106:107], v4 offset:10496
    ds_read_b64_tr_b16 a[108:109], v4 offset:10752
    ds_read_b64_tr_b16 a[110:111], v4 offset:11008
    v_fma_f32 v235, v235, v6, v5
    s_waitcnt lgkmcnt(15)
    v_mfma_f32_32x32x16_bf16 v[96:111], a[72:75], a[32:35], v[96:111]
    v_fma_f32 v236, v236, v6, v5
    v_fma_f32 v237, v237, v6, v5
    v_fma_f32 v238, v238, v6, v5
    v_fma_f32 v239, v239, v6, v5
    v_mul_f32 v232, v200, v232
    v_mul_f32 v233, v201, v233
    v_mul_f32 v234, v202, v234
    v_mul_f32 v235, v203, v235
    v_mul_f32 v236, v204, v236
    v_mul_f32 v237, v205, v237
    v_mfma_f32_32x32x16_bf16 v[112:127], a[72:75], a[48:51], v[112:127]
    ds_read_b64_tr_b16 a[112:113], v4 offset:12288
    ds_read_b64_tr_b16 a[114:115], v4 offset:12544
    v_mul_f32 v238, v206, v238
    v_mul_f32 v239, v207, v239
    v_exp_f32 v232, v232
    v_mfma_f32_32x32x16_bf16 v[128:143], a[76:79], a[32:35], v[128:143]
    v_exp_f32 v233, v233
    v_exp_f32 v234, v234
    v_exp_f32 v235, v235
    v_exp_f32 v236, v236
    v_exp_f32 v237, v237
    v_mfma_f32_32x32x16_bf16 v[144:159], a[76:79], a[48:51], v[144:159]
    ds_read_b64_tr_b16 a[116:117], v4 offset:12800
    ds_read_b64_tr_b16 a[118:119], v4 offset:13056
    v_exp_f32 v238, v238
    v_exp_f32 v239, v239
    v_add_f32 v232, 1.0, v232
    v_add_f32 v233, 1.0, v233
    v_mfma_f32_32x32x16_bf16 v[32:47], a[80:83], a[36:39], v[32:47]
    v_add_f32 v234, 1.0, v234
    v_add_f32 v235, 1.0, v235
    v_add_f32 v236, 1.0, v236
    v_add_f32 v237, 1.0, v237
    v_add_f32 v238, 1.0, v238
    v_add_f32 v239, 1.0, v239
    v_rcp_f32 v232, v232
    v_rcp_f32 v233, v233
    v_mfma_f32_32x32x16_bf16 v[48:63], a[80:83], a[52:55], v[48:63]
    ds_read_b64_tr_b16 a[120:121], v4 offset:14336
    ds_read_b64_tr_b16 a[122:123], v4 offset:14592
    v_rcp_f32 v234, v234
    v_rcp_f32 v235, v235
    v_mfma_f32_32x32x16_bf16 v[64:79], a[84:87], a[36:39], v[64:79]
    v_rcp_f32 v236, v236
    v_rcp_f32 v237, v237
    v_rcp_f32 v238, v238
    v_rcp_f32 v239, v239
    v_mul_f32 v200, v200, v232
    v_mul_f32 v201, v201, v233
    v_mfma_f32_32x32x16_bf16 v[80:95], a[84:87], a[52:55], v[80:95]
    ds_read_b64_tr_b16 a[124:125], v4 offset:14848
    ds_read_b64_tr_b16 a[126:127], v4 offset:15104
    v_mul_f32 v202, v202, v234
    v_mul_f32 v203, v203, v235
    v_mul_f32 v204, v204, v236
    v_mul_f32 v205, v205, v237
    v_mul_f32 v206, v206, v238
    v_mul_f32 v207, v207, v239
    v_mfma_f32_32x32x16_bf16 v[96:111], a[88:91], a[36:39], v[96:111]
    v_add_f32 v240, v176, v184
    v_mul_f32 v248, v176, v176
    v_add_f32 v241, v177, v185
    v_mul_f32 v249, v177, v177
    v_add_f32 v242, v178, v186
    v_mul_f32 v250, v178, v178
    v_add_f32 v243, v179, v187
    v_mul_f32 v251, v179, v179
    v_add_f32 v244, v180, v188
    v_mul_f32 v252, v180, v180
    v_mfma_f32_32x32x16_bf16 v[112:127], a[88:91], a[52:55], v[112:127]
    v_add_f32 v245, v181, v189
    v_mul_f32 v253, v181, v181
    v_add_f32 v246, v182, v190
    v_mul_f32 v254, v182, v182
    v_add_f32 v247, v183, v191
    v_mul_f32 v255, v183, v183
    v_fmac_f32 v248, v184, v184
    v_fmac_f32 v249, v185, v185
    v_fmac_f32 v250, v186, v186
    v_mfma_f32_32x32x16_bf16 v[128:143], a[92:95], a[36:39], v[128:143]
    v_fmac_f32 v251, v187, v187
    v_fmac_f32 v252, v188, v188
    v_fmac_f32 v253, v189, v189
    v_fmac_f32 v254, v190, v190
    v_fmac_f32 v255, v191, v191
    v_add_f32 v240, v240, v192
    v_fmac_f32 v248, v192, v192
    v_add_f32 v241, v241, v193
    v_fmac_f32 v249, v193, v193
    v_add_f32 v242, v242, v194
    v_mfma_f32_32x32x16_bf16 v[144:159], a[92:95], a[52:55], v[144:159]
    v_fmac_f32 v250, v194, v194
    v_add_f32 v243, v243, v195
    v_fmac_f32 v251, v195, v195
    v_add_f32 v244, v244, v196
    v_fmac_f32 v252, v196, v196
    v_add_f32 v245, v245, v197
    v_fmac_f32 v253, v197, v197
    v_add_f32 v246, v246, v198
    s_barrier
    s_waitcnt lgkmcnt(15)
    v_mfma_f32_32x32x16_bf16 v[32:47], a[96:99], a[40:43], v[32:47]
    ds_read_b64_tr_b16 a[64:65], v3 offset:49152
    ds_read_b64_tr_b16 a[66:67], v3 offset:49408
    ds_read_b64_tr_b16 a[68:69], v3 offset:49664
    ds_read_b64_tr_b16 a[70:71], v3 offset:49920
    v_fmac_f32 v254, v198, v198
    v_add_f32 v247, v247, v199
    v_mfma_f32_32x32x16_bf16 v[48:63], a[96:99], a[56:59], v[48:63]
    ds_read_b64_tr_b16 a[72:73], v3 offset:51200
    ds_read_b64_tr_b16 a[74:75], v3 offset:51456
    v_fmac_f32 v255, v199, v199
    v_add_f32 v240, v240, v200
    v_fmac_f32 v248, v200, v200
    v_add_f32 v241, v241, v201
    v_fmac_f32 v249, v201, v201
    v_mfma_f32_32x32x16_bf16 v[64:79], a[100:103], a[40:43], v[64:79]
    s_add_u32 m0, s31, 0x4000
    s_nop 0
    buffer_load_dwordx4 v1, s[8:11], s20 offen sc1 lds
    v_add_f32 v242, v242, v202
    v_fmac_f32 v250, v202, v202
    v_add_f32 v243, v243, v203
    v_fmac_f32 v251, v203, v203
    v_mfma_f32_32x32x16_bf16 v[80:95], a[100:103], a[56:59], v[80:95]
    ds_read_b64_tr_b16 a[76:77], v3 offset:51712
    ds_read_b64_tr_b16 a[78:79], v3 offset:51968
    v_add_f32 v244, v244, v204
    v_fmac_f32 v252, v204, v204
    v_add_f32 v245, v245, v205
    v_fmac_f32 v253, v205, v205
    v_add_f32 v246, v246, v206
    s_waitcnt lgkmcnt(15)
    v_mfma_f32_32x32x16_bf16 v[96:111], a[104:107], a[40:43], v[96:111]
    s_add_u32 m0, s31, 0x4000
    s_nop 0
    buffer_load_dwordx4 v1, s[8:11], s20 offen offset:1024 sc1 lds
    s_add_u32 s20, s20, 0x2000
    v_fmac_f32 v254, v206, v206
    v_add_f32 v247, v247, v207
    v_fmac_f32 v255, v207, v207
    v_mfma_f32_32x32x16_bf16 v[112:127], a[104:107], a[56:59], v[112:127]
    ds_read_b64_tr_b16 a[80:81], v3 offset:53248
    ds_read_b64_tr_b16 a[82:83], v3 offset:53504
    v_add_f32_dpp v240, v240, v240 quad_perm:[1,0,3,2] row_mask:0xf bank_mask:0xf
    v_add_f32_dpp v241, v241, v241 quad_perm:[1,0,3,2] row_mask:0xf bank_mask:0xf
    v_add_f32_dpp v242, v242, v242 quad_perm:[1,0,3,2] row_mask:0xf bank_mask:0xf
    v_add_f32_dpp v243, v243, v243 quad_perm:[1,0,3,2] row_mask:0xf bank_mask:0xf
    v_add_f32_dpp v244, v244, v244 quad_perm:[1,0,3,2] row_mask:0xf bank_mask:0xf
    v_mfma_f32_32x32x16_bf16 v[128:143], a[108:111], a[40:43], v[128:143]
    s_add_u32 m0, s31, 0x8000
    s_nop 0
    buffer_load_dwordx4 v1, s[8:11], s21 offen sc1 lds
    v_add_f32_dpp v245, v245, v245 quad_perm:[1,0,3,2] row_mask:0xf bank_mask:0xf
    v_add_f32_dpp v246, v246, v246 quad_perm:[1,0,3,2] row_mask:0xf bank_mask:0xf
    v_add_f32_dpp v247, v247, v247 quad_perm:[1,0,3,2] row_mask:0xf bank_mask:0xf
    v_add_f32_dpp v248, v248, v248 quad_perm:[1,0,3,2] row_mask:0xf bank_mask:0xf
    v_mfma_f32_32x32x16_bf16 v[144:159], a[108:111], a[56:59], v[144:159]
    ds_read_b64_tr_b16 a[84:85], v3 offset:53760
    ds_read_b64_tr_b16 a[86:87], v3 offset:54016
    v_add_f32_dpp v249, v249, v249 quad_perm:[1,0,3,2] row_mask:0xf bank_mask:0xf
    v_add_f32_dpp v250, v250, v250 quad_perm:[1,0,3,2] row_mask:0xf bank_mask:0xf
    v_add_f32_dpp v251, v251, v251 quad_perm:[1,0,3,2] row_mask:0xf bank_mask:0xf
    v_add_f32_dpp v252, v252, v252 quad_perm:[1,0,3,2] row_mask:0xf bank_mask:0xf
    v_add_f32_dpp v253, v253, v253 quad_perm:[1,0,3,2] row_mask:0xf bank_mask:0xf
    s_waitcnt lgkmcnt(15)
    v_mfma_f32_32x32x16_bf16 v[32:47], a[112:115], a[44:47], v[32:47]
    s_add_u32 m0, s31, 0x8000
    s_nop 0
    buffer_load_dwordx4 v1, s[8:11], s21 offen offset:1024 sc1 lds
    s_add_u32 s21, s21, 0x2000
    v_add_f32_dpp v254, v254, v254 quad_perm:[1,0,3,2] row_mask:0xf bank_mask:0xf
    v_add_f32_dpp v255, v255, v255 quad_perm:[1,0,3,2] row_mask:0xf bank_mask:0xf
    v_add_f32_dpp v240, v240, v240 quad_perm:[2,3,0,1] row_mask:0xf bank_mask:0xf
    v_mfma_f32_32x32x16_bf16 v[48:63], a[112:115], a[60:63], v[48:63]
    ds_read_b64_tr_b16 a[88:89], v3 offset:55296
    ds_read_b64_tr_b16 a[90:91], v3 offset:55552
    v_add_f32_dpp v241, v241, v241 quad_perm:[2,3,0,1] row_mask:0xf bank_mask:0xf
    v_add_f32_dpp v242, v242, v242 quad_perm:[2,3,0,1] row_mask:0xf bank_mask:0xf
    v_add_f32_dpp v243, v243, v243 quad_perm:[2,3,0,1] row_mask:0xf bank_mask:0xf
    v_add_f32_dpp v244, v244, v244 quad_perm:[2,3,0,1] row_mask:0xf bank_mask:0xf
    v_add_f32_dpp v245, v245, v245 quad_perm:[2,3,0,1] row_mask:0xf bank_mask:0xf
    v_mfma_f32_32x32x16_bf16 v[64:79], a[116:119], a[44:47], v[64:79]
    s_add_u32 m0, s31, 0x6000
    s_nop 0
    buffer_load_dwordx4 v1, s[8:11], s20 offen sc1 lds
    v_add_f32_dpp v246, v246, v246 quad_perm:[2,3,0,1] row_mask:0xf bank_mask:0xf
    v_add_f32_dpp v247, v247, v247 quad_perm:[2,3,0,1] row_mask:0xf bank_mask:0xf
    v_add_f32_dpp v248, v248, v248 quad_perm:[2,3,0,1] row_mask:0xf bank_mask:0xf
    v_add_f32_dpp v249, v249, v249 quad_perm:[2,3,0,1] row_mask:0xf bank_mask:0xf
    v_mfma_f32_32x32x16_bf16 v[80:95], a[116:119], a[60:63], v[80:95]
    ds_read_b64_tr_b16 a[92:93], v3 offset:55808
    ds_read_b64_tr_b16 a[94:95], v3 offset:56064
    v_add_f32_dpp v250, v250, v250 quad_perm:[2,3,0,1] row_mask:0xf bank_mask:0xf
    v_add_f32_dpp v251, v251, v251 quad_perm:[2,3,0,1] row_mask:0xf bank_mask:0xf
    v_add_f32_dpp v252, v252, v252 quad_perm:[2,3,0,1] row_mask:0xf bank_mask:0xf
    v_add_f32_dpp v253, v253, v253 quad_perm:[2,3,0,1] row_mask:0xf bank_mask:0xf
    v_add_f32_dpp v254, v254, v254 quad_perm:[2,3,0,1] row_mask:0xf bank_mask:0xf
    s_waitcnt lgkmcnt(15)
    v_mfma_f32_32x32x16_bf16 v[96:111], a[120:123], a[44:47], v[96:111]
    s_add_u32 m0, s31, 0x6000
    s_nop 0
    buffer_load_dwordx4 v1, s[8:11], s20 offen offset:1024 sc1 lds
    s_add_u32 s20, s20, 0x2000
    v_add_f32_dpp v255, v255, v255 quad_perm:[2,3,0,1] row_mask:0xf bank_mask:0xf
    v_add_f32_dpp v240, v240, v240 row_half_mirror row_mask:0xf bank_mask:0xf
    v_add_f32_dpp v241, v241, v241 row_half_mirror row_mask:0xf bank_mask:0xf
    v_mfma_f32_32x32x16_bf16 v[112:127], a[120:123], a[60:63], v[112:127]
    ds_read_b64_tr_b16 a[96:97], v3 offset:57344
    ds_read_b64_tr_b16 a[98:99], v3 offset:57600
    v_add_f32_dpp v242, v242, v242 row_half_mirror row_mask:0xf bank_mask:0xf
    v_add_f32_dpp v243, v243, v243 row_half_mirror row_mask:0xf bank_mask:0xf
    v_add_f32_dpp v244, v244, v244 row_half_mirror row_mask:0xf bank_mask:0xf
    v_add_f32_dpp v245, v245, v245 row_half_mirror row_mask:0xf bank_mask:0xf
    v_add_f32_dpp v246, v246, v246 row_half_mirror row_mask:0xf bank_mask:0xf
    v_mfma_f32_32x32x16_bf16 v[128:143], a[124:127], a[44:47], v[128:143]
    s_add_u32 m0, s31, 0xa000
    s_nop 0
    buffer_load_dwordx4 v1, s[8:11], s21 offen sc1 lds
    v_add_f32_dpp v247, v247, v247 row_half_mirror row_mask:0xf bank_mask:0xf
    v_add_f32_dpp v248, v248, v248 row_half_mirror row_mask:0xf bank_mask:0xf
    v_add_f32_dpp v249, v249, v249 row_half_mirror row_mask:0xf bank_mask:0xf
    v_add_f32_dpp v250, v250, v250 row_half_mirror row_mask:0xf bank_mask:0xf
    v_mfma_f32_32x32x16_bf16 v[144:159], a[124:127], a[60:63], v[144:159]
    v_add_f32_dpp v251, v251, v251 row_half_mirror row_mask:0xf bank_mask:0xf
    v_add_f32_dpp v252, v252, v252 row_half_mirror row_mask:0xf bank_mask:0xf
    v_add_f32_dpp v253, v253, v253 row_half_mirror row_mask:0xf bank_mask:0xf
    v_add_f32_dpp v254, v254, v254 row_half_mirror row_mask:0xf bank_mask:0xf
    v_add_f32_dpp v255, v255, v255 row_half_mirror row_mask:0xf bank_mask:0xf
    v_add_f32_dpp v240, v240, v240 row_mirror row_mask:0xf bank_mask:0xf
    v_add_f32_dpp v241, v241, v241 row_mirror row_mask:0xf bank_mask:0xf
    v_add_f32_dpp v242, v242, v242 row_mirror row_mask:0xf bank_mask:0xf
    v_add_f32_dpp v243, v243, v243 row_mirror row_mask:0xf bank_mask:0xf
    s_waitcnt lgkmcnt(15)
    v_mfma_f32_32x32x16_bf16 v[32:47], a[64:67], a[0:3], v[32:47]
    v_add_f32_dpp v244, v244, v244 row_mirror row_mask:0xf bank_mask:0xf
    v_add_f32_dpp v245, v245, v245 row_mirror row_mask:0xf bank_mask:0xf
    v_add_f32_dpp v246, v246, v246 row_mirror row_mask:0xf bank_mask:0xf
    v_add_f32_dpp v247, v247, v247 row_mirror row_mask:0xf bank_mask:0xf
    v_add_f32_dpp v248, v248, v248 row_mirror row_mask:0xf bank_mask:0xf
    v_add_f32_dpp v249, v249, v249 row_mirror row_mask:0xf bank_mask:0xf
    v_add_f32_dpp v250, v250, v250 row_mirror row_mask:0xf bank_mask:0xf
    v_add_f32_dpp v251, v251, v251 row_mirror row_mask:0xf bank_mask:0xf
    v_add_f32_dpp v252, v252, v252 row_mirror row_mask:0xf bank_mask:0xf
    v_add_f32_dpp v253, v253, v253 row_mirror row_mask:0xf bank_mask:0xf
    v_mfma_f32_32x32x16_bf16 v[48:63], a[64:67], a[16:19], v[48:63]
    s_waitcnt vmcnt(9)
    ds_read_b128 a[32:35], v28 offset:8192
    ds_read_b128 a[48:51], v28 offset:12288
    ds_read_b128 a[36:39], v29 offset:8192
    ds_read_b128 a[52:55], v29 offset:12288
    v_add_f32_dpp v254, v254, v254 row_mirror row_mask:0xf bank_mask:0xf
    s_waitcnt lgkmcnt(15)
    v_mfma_f32_32x32x16_bf16 v[64:79], a[68:71], a[0:3], v[64:79]
    ds_read_b128 a[40:43], v30 offset:8192
    ds_read_b128 a[56:59], v30 offset:12288
    ds_read_b128 a[44:47], v2 offset:8192
    ds_read_b128 a[60:63], v2 offset:12288
    v_add_f32_dpp v255, v255, v255 row_mirror row_mask:0xf bank_mask:0xf
    v_mov_b32 v208, v240
    v_mfma_f32_32x32x16_bf16 v[80:95], a[68:71], a[16:19], v[80:95]
    v_mov_b32 v209, v241
    v_mov_b32 v210, v242
    v_mov_b32 v211, v243
    v_mov_b32 v212, v244
    v_mov_b32 v213, v245
    v_mov_b32 v214, v246
    v_mov_b32 v215, v247
    v_mov_b32 v216, v248
    v_mov_b32 v217, v249
    v_mfma_f32_32x32x16_bf16 v[96:111], a[72:75], a[0:3], v[96:111]
    v_mov_b32 v218, v250
    v_mov_b32 v219, v251
    v_mov_b32 v220, v252
    v_mov_b32 v221, v253
    v_mov_b32 v222, v254
    v_mov_b32 v223, v255
    v_permlane16_swap_b32 v208, v240
    v_permlane16_swap_b32 v209, v241
    v_mfma_f32_32x32x16_bf16 v[112:127], a[72:75], a[16:19], v[112:127]
    v_permlane16_swap_b32 v210, v242
    v_permlane16_swap_b32 v211, v243
    v_permlane16_swap_b32 v212, v244
    v_permlane16_swap_b32 v213, v245
    s_waitcnt lgkmcnt(15)
    v_mfma_f32_32x32x16_bf16 v[128:143], a[76:79], a[0:3], v[128:143]
    v_permlane16_swap_b32 v214, v246
    v_permlane16_swap_b32 v215, v247
    v_permlane16_swap_b32 v216, v248
    v_permlane16_swap_b32 v217, v249
    v_permlane16_swap_b32 v218, v250
    v_mfma_f32_32x32x16_bf16 v[144:159], a[76:79], a[16:19], v[144:159]
    v_permlane16_swap_b32 v219, v251
    v_permlane16_swap_b32 v220, v252
    v_permlane16_swap_b32 v221, v253
    v_permlane16_swap_b32 v222, v254
    v_permlane16_swap_b32 v223, v255
    v_mfma_f32_32x32x16_bf16 v[32:47], a[80:83], a[4:7], v[32:47]
    v_add_f32 v240, v240, v208
    v_add_f32 v241, v241, v209
    v_add_f32 v242, v242, v210
    s_add_u32 m0, s31, 0xa000
    s_nop 0
    buffer_load_dwordx4 v1, s[8:11], s21 offen offset:1024 sc1 lds
    s_add_u32 s21, s21, 0x2000
    v_mfma_f32_32x32x16_bf16 v[48:63], a[80:83], a[20:23], v[48:63]
    v_add_f32 v243, v243, v211
    v_add_f32 v244, v244, v212
    v_add_f32 v245, v245, v213
    ds_read_b64_tr_b16 a[100:101], v3 offset:57856
    ds_read_b64_tr_b16 a[102:103], v3 offset:58112
    v_add_f32 v246, v246, v214
    v_add_f32 v247, v247, v215
    s_waitcnt lgkmcnt(15)
    v_mfma_f32_32x32x16_bf16 v[64:79], a[84:87], a[4:7], v[64:79]
    v_add_f32 v248, v248, v216
    v_add_f32 v249, v249, v217
    v_add_f32 v250, v250, v218
    v_add_f32 v251, v251, v219
    v_add_f32 v252, v252, v220
    v_add_f32 v253, v253, v221
    v_add_f32 v254, v254, v222
    v_add_f32 v255, v255, v223
    v_mov_b32 v208, v240
    v_mov_b32 v209, v241
    v_mfma_f32_32x32x16_bf16 v[80:95], a[84:87], a[20:23], v[80:95]
    ds_read_b64_tr_b16 a[104:105], v3 offset:59392
    ds_read_b64_tr_b16 a[106:107], v3 offset:59648
    v_mov_b32 v210, v242
    v_mov_b32 v211, v243
    v_mov_b32 v212, v244
    v_mov_b32 v213, v245
    v_mov_b32 v214, v246
    s_waitcnt lgkmcnt(15)
    v_mfma_f32_32x32x16_bf16 v[96:111], a[88:91], a[4:7], v[96:111]
    v_mov_b32 v215, v247
    v_mov_b32 v216, v248
    v_mov_b32 v217, v249
    v_mov_b32 v218, v250
    v_mov_b32 v219, v251
    v_mov_b32 v220, v252
    v_mov_b32 v221, v253
    v_mov_b32 v222, v254
    v_mov_b32 v223, v255
    v_mfma_f32_32x32x16_bf16 v[112:127], a[88:91], a[20:23], v[112:127]
    ds_read_b64_tr_b16 a[108:109], v3 offset:59904
    ds_read_b64_tr_b16 a[110:111], v3 offset:60160
    v_permlane32_swap_b32 v208, v240
    v_permlane32_swap_b32 v209, v241
    v_permlane32_swap_b32 v210, v242
    s_waitcnt lgkmcnt(15)
    v_mfma_f32_32x32x16_bf16 v[128:143], a[92:95], a[4:7], v[128:143]
    v_permlane32_swap_b32 v211, v243
    v_permlane32_swap_b32 v212, v244
    ds_read_b64_tr_b16 a[112:113], v3 offset:61440
    ds_read_b64_tr_b16 a[114:115], v3 offset:61696
    v_permlane32_swap_b32 v213, v245
    v_mfma_f32_32x32x16_bf16 v[144:159], a[92:95], a[20:23], v[144:159]
    v_permlane32_swap_b32 v214, v246
    v_permlane32_swap_b32 v215, v247
    v_permlane32_swap_b32 v216, v248
    v_permlane32_swap_b32 v217, v249
    s_barrier
    s_waitcnt lgkmcnt(15)
    v_mfma_f32_32x32x16_bf16 v[32:47], a[96:99], a[8:11], v[32:47]
    v_permlane32_swap_b32 v218, v250
    ds_read_b64_tr_b16 a[116:117], v3 offset:61952
    ds_read_b64_tr_b16 a[118:119], v3 offset:62208
    v_permlane32_swap_b32 v219, v251
    v_permlane32_swap_b32 v220, v252
    v_mfma_f32_32x32x16_bf16 v[48:63], a[96:99], a[24:27], v[48:63]
    v_permlane32_swap_b32 v221, v253
    v_permlane32_swap_b32 v222, v254
    v_permlane32_swap_b32 v223, v255
    v_add_f32 v240, v240, v208
    v_add_f32 v241, v241, v209
    v_add_f32 v242, v242, v210
    s_waitcnt lgkmcnt(8)
    v_mfma_f32_32x32x16_bf16 v[64:79], a[100:103], a[8:11], v[64:79]
    ds_read_b64_tr_b16 a[120:121], v3 offset:63488
    ds_read_b64_tr_b16 a[122:123], v3 offset:63744
    v_add_f32 v243, v243, v211
    v_add_f32 v244, v244, v212
    v_add_f32 v245, v245, v213
    v_add_f32 v246, v246, v214
    v_add_f32 v247, v247, v215
    v_add_f32 v248, v248, v216
    v_mfma_f32_32x32x16_bf16 v[80:95], a[100:103], a[24:27], v[80:95]
    v_add_f32 v249, v249, v217
    v_add_f32 v250, v250, v218
    v_add_f32 v251, v251, v219
    v_add_f32 v252, v252, v220
    v_add_f32 v253, v253, v221
    ds_read_b64_tr_b16 a[124:125], v3 offset:64000
    ds_read_b64_tr_b16 a[126:127], v3 offset:64256
    s_waitcnt lgkmcnt(10)
    v_mfma_f32_32x32x16_bf16 v[96:111], a[104:107], a[8:11], v[96:111]
    v_add_f32 v254, v254, v222
    v_add_f32 v255, v255, v223
    v_mov_b32 v8, 0x18000
    v_lshl_add_u32 v7, s12, 6, v8
    ds_read_b64_tr_b16 a[64:65], v3 offset:32768
    ds_read_b64_tr_b16 a[66:67], v3 offset:33024
    ds_write_b128 v7, v[240:243]
    v_mfma_f32_32x32x16_bf16 v[112:127], a[104:107], a[24:27], v[112:127]
    ds_write_b128 v7, v[244:247] offset:16
    ds_read_b64_tr_b16 a[80:81], v3 offset:36864
    ds_read_b64_tr_b16 a[82:83], v3 offset:37120
    ds_write_b128 v7, v[248:251] offset:32
    s_waitcnt lgkmcnt(15)
    v_mfma_f32_32x32x16_bf16 v[128:143], a[108:111], a[8:11], v[128:143]
    ds_write_b128 v7, v[252:255] offset:48
    ds_read_b64_tr_b16 a[96:97], v3 offset:40960
    ds_read_b64_tr_b16 a[98:99], v3 offset:41216
    v_mfma_f32_32x32x16_bf16 v[144:159], a[108:111], a[24:27], v[144:159]
    s_waitcnt lgkmcnt(15)
    v_mfma_f32_32x32x16_bf16 v[32:47], a[112:115], a[12:15], v[32:47]
    v_mfma_f32_32x32x16_bf16 v[48:63], a[112:115], a[28:31], v[48:63]
    ds_read_b64_tr_b16 a[112:113], v3 offset:45056
    ds_read_b64_tr_b16 a[114:115], v3 offset:45312
    ds_read_b64_tr_b16 a[68:69], v3 offset:33280
    ds_read_b64_tr_b16 a[70:71], v3 offset:33536
    s_waitcnt lgkmcnt(15)
    v_mfma_f32_32x32x16_bf16 v[64:79], a[116:119], a[12:15], v[64:79]
    ds_read_b64_tr_b16 a[84:85], v3 offset:37376
    ds_read_b64_tr_b16 a[86:87], v3 offset:37632
    ds_read_b64_tr_b16 a[100:101], v3 offset:41472
    ds_read_b64_tr_b16 a[102:103], v3 offset:41728
    v_mfma_f32_32x32x16_bf16 v[80:95], a[116:119], a[28:31], v[80:95]
    ds_read_b64_tr_b16 a[116:117], v3 offset:45568
    ds_read_b64_tr_b16 a[118:119], v3 offset:45824
    v_mfma_f32_32x32x16_bf16 v[96:111], a[120:123], a[12:15], v[96:111]
    v_mfma_f32_32x32x16_bf16 v[112:127], a[120:123], a[28:31], v[112:127]
    ds_read_b64_tr_b16 a[72:73], v3 offset:34816
    ds_read_b64_tr_b16 a[74:75], v3 offset:35072
    s_waitcnt lgkmcnt(15)
    v_mfma_f32_32x32x16_bf16 v[128:143], a[124:127], a[12:15], v[128:143]
    v_mfma_f32_32x32x16_bf16 v[144:159], a[124:127], a[28:31], v[144:159]
    ds_read_b64_tr_b16 a[88:89], v3 offset:38912
    ds_read_b64_tr_b16 a[90:91], v3 offset:39168
    s_waitcnt lgkmcnt(0)
    s_barrier
    v_mfma_f32_32x32x16_bf16 v[32:47], a[64:67], a[32:35], v[32:47]
    ds_read_b128 v[208:211], v8
    ds_read_b128 v[212:215], v8 offset:16
    ds_read_b128 v[216:219], v8 offset:32
    ds_read_b128 v[220:223], v8 offset:48
    ds_read_b128 v[224:227], v8 offset:64
    v_mfma_f32_32x32x16_bf16 v[48:63], a[64:67], a[48:51], v[48:63]
    ds_read_b64_tr_b16 a[104:105], v3 offset:43008
    ds_read_b64_tr_b16 a[106:107], v3 offset:43264
    ds_read_b128 v[228:231], v8 offset:80
    ds_read_b128 v[232:235], v8 offset:96
    ds_read_b128 v[236:239], v8 offset:112
    v_mfma_f32_32x32x16_bf16 v[32:47], a[80:83], a[36:39], v[32:47]
    ds_read_b128 v[160:163], v8 offset:128
    ds_read_b128 v[164:167], v8 offset:144
    ds_read_b128 v[168:171], v8 offset:160
    ds_read_b128 v[172:175], v8 offset:176
    ds_read_b128 v[240:243], v8 offset:192
    v_mfma_f32_32x32x16_bf16 v[48:63], a[80:83], a[52:55], v[48:63]
    ds_read_b64_tr_b16 a[120:121], v3 offset:47104
    ds_read_b64_tr_b16 a[122:123], v3 offset:47360
    ds_read_b128 v[244:247], v8 offset:208
    ds_read_b128 v[248:251], v8 offset:224
    ds_read_b128 v[252:255], v8 offset:240
    s_waitcnt lgkmcnt(15)
    v_add_f32 v208, v208, v224
    v_add_f32 v209, v209, v225
    v_mfma_f32_32x32x16_bf16 v[32:47], a[96:99], a[40:43], v[32:47]
    v_add_f32 v210, v210, v226
    v_add_f32 v211, v211, v227
    s_waitcnt lgkmcnt(12)
    v_add_f32 v212, v212, v228
    v_add_f32 v213, v213, v229
    v_add_f32 v214, v214, v230
    v_add_f32 v215, v215, v231
    s_waitcnt lgkmcnt(11)
    v_add_f32 v216, v216, v232
    v_add_f32 v217, v217, v233
    v_add_f32 v218, v218, v234
    v_add_f32 v219, v219, v235
    s_waitcnt lgkmcnt(10)
    v_add_f32 v220, v220, v236
    v_add_f32 v221, v221, v237
    v_mfma_f32_32x32x16_bf16 v[48:63], a[96:99], a[56:59], v[48:63]
    ds_read_b64_tr_b16 a[76:77], v3 offset:35328
    ds_read_b64_tr_b16 a[78:79], v3 offset:35584
    v_add_f32 v222, v222, v238
    v_add_f32 v223, v223, v239
    s_waitcnt lgkmcnt(7)
    v_add_f32 v160, v160, v240
    v_add_f32 v161, v161, v241
    v_add_f32 v162, v162, v242
    v_add_f32 v163, v163, v243
    s_waitcnt lgkmcnt(4)
    v_add_f32 v164, v164, v244
    v_mfma_f32_32x32x16_bf16 v[32:47], a[112:115], a[44:47], v[32:47]
    v_add_f32 v165, v165, v245
    v_add_f32 v166, v166, v246
    v_add_f32 v167, v167, v247
    s_waitcnt lgkmcnt(3)
    v_add_f32 v168, v168, v248
    v_add_f32 v169, v169, v249
    v_add_f32 v170, v170, v250
    v_add_f32 v171, v171, v251
    s_waitcnt lgkmcnt(2)
    v_add_f32 v172, v172, v252
    v_add_f32 v173, v173, v253
    v_add_f32 v174, v174, v254
    v_add_f32 v175, v175, v255
    v_add_f32 v208, v208, v160
    v_mfma_f32_32x32x16_bf16 v[48:63], a[112:115], a[60:63], v[48:63]
    v_add_f32 v209, v209, v161
    v_add_f32 v210, v210, v162
    v_add_f32 v211, v211, v163
    v_add_f32 v212, v212, v164
    v_add_f32 v213, v213, v165
    v_add_f32 v214, v214, v166
    v_add_f32 v215, v215, v167
    v_add_f32 v216, v216, v168
    v_add_f32 v217, v217, v169
    v_add_f32 v218, v218, v170
    v_add_f32 v219, v219, v171
    v_mfma_f32_32x32x16_bf16 v[64:79], a[68:71], a[32:35], v[64:79]
    v_add_f32 v220, v220, v172
    v_add_f32 v221, v221, v173
    v_add_f32 v222, v222, v174
    v_add_f32 v223, v223, v175
    v_mul_f32 v208, 0x3a924925, v208
    v_mul_f32 v209, 0x3a924925, v209
    v_mul_f32 v210, 0x3a924925, v210
    v_mul_f32 v211, 0x3a924925, v211
    v_mul_f32 v212, 0x3a924925, v212
    v_mul_f32 v213, 0x3a924925, v213
    v_mul_f32 v214, 0x3a924925, v214
    v_mul_f32 v215, 0x3a924925, v215
    v_mfma_f32_32x32x16_bf16 v[80:95], a[68:71], a[48:51], v[80:95]
    v_mul_f32 v216, 0x3a924925, v216
    v_mul_f32 v217, 0x3a924925, v217
    v_mul_f32 v218, 0x3a924925, v218
    v_mul_f32 v219, 0x3a924925, v219
    v_mul_f32 v220, 0x3a924925, v220
    v_mul_f32 v221, 0x3a924925, v221
    v_mul_f32 v222, 0x3a924925, v222
    v_mul_f32 v223, 0x3a924925, v223
    v_fma_f32 v216, -v208, v208, v216
    v_fma_f32 v217, -v209, v209, v217
    v_fma_f32 v218, -v210, v210, v218
    v_mfma_f32_32x32x16_bf16 v[64:79], a[84:87], a[36:39], v[64:79]
    v_fma_f32 v219, -v211, v211, v219
    v_fma_f32 v220, -v212, v212, v220
    v_fma_f32 v221, -v213, v213, v221
    v_fma_f32 v222, -v214, v214, v222
    v_fma_f32 v223, -v215, v215, v223
    v_max_f32 v216, 0, v216
    v_max_f32 v217, 0, v217
    v_max_f32 v218, 0, v218
    v_max_f32 v219, 0, v219
    v_max_f32 v220, 0, v220
    v_max_f32 v221, 0, v221
    v_max_f32 v222, 0, v222
    v_mfma_f32_32x32x16_bf16 v[80:95], a[84:87], a[52:55], v[80:95]
    v_max_f32 v223, 0, v223
    v_add_f32 v216, 0x3727c5ac, v216
    v_add_f32 v217, 0x3727c5ac, v217
    v_add_f32 v218, 0x3727c5ac, v218
    v_add_f32 v219, 0x3727c5ac, v219
    v_add_f32 v220, 0x3727c5ac, v220
    v_add_f32 v221, 0x3727c5ac, v221
    v_add_f32 v222, 0x3727c5ac, v222
    v_add_f32 v223, 0x3727c5ac, v223
    v_rsq_f32 v216, v216
    v_mfma_f32_32x32x16_bf16 v[64:79], a[100:103], a[40:43], v[64:79]
    v_rsq_f32 v217, v217
    v_rsq_f32 v218, v218
    v_rsq_f32 v219, v219
    v_rsq_f32 v220, v220
    v_rsq_f32 v221, v221
    v_rsq_f32 v222, v222
    v_mfma_f32_32x32x16_bf16 v[80:95], a[100:103], a[56:59], v[80:95]
    v_rsq_f32 v223, v223
    v_mul_f32 v208, v208, v216
    v_mul_f32 v209, v209, v217
    v_mul_f32 v210, v210, v218
    v_mul_f32 v211, v211, v219
    v_mul_f32 v212, v212, v220
    v_mul_f32 v213, v213, v221
    v_mul_f32 v214, v214, v222
    v_mul_f32 v215, v215, v223
    v_fma_f32 v176, v176, v216, -v208
    v_mfma_f32_32x32x16_bf16 v[64:79], a[116:119], a[44:47], v[64:79]
    v_fma_f32 v177, v177, v217, -v209
    v_fma_f32 v178, v178, v218, -v210
    v_fma_f32 v179, v179, v219, -v211
    v_fma_f32 v180, v180, v220, -v212
    v_fma_f32 v181, v181, v221, -v213
    v_fma_f32 v182, v182, v222, -v214
    v_fma_f32 v183, v183, v223, -v215
    v_cvt_pk_bf16_f32 v160, v176, v177
    v_cvt_pk_bf16_f32 v161, v178, v179
    v_cvt_pk_bf16_f32 v162, v180, v181
    v_cvt_pk_bf16_f32 v163, v182, v183
    v_cvt_pk_bf16_f32 v32, v32, v33
    v_mfma_f32_32x32x16_bf16 v[80:95], a[116:119], a[60:63], v[80:95]
    buffer_store_dwordx2 v[160:161], v31, s[8:11], s65 offen sc1
    buffer_store_dwordx2 v[162:163], v31, s[8:11], s65 offen offset:512 sc1
    v_cvt_pk_bf16_f32 v33, v34, v35
    v_cvt_pk_bf16_f32 v34, v36, v37
    v_mfma_f32_32x32x16_bf16 v[96:111], a[72:75], a[32:35], v[96:111]
    ds_read_b64_tr_b16 a[92:93], v3 offset:39424
    ds_read_b64_tr_b16 a[94:95], v3 offset:39680
    v_cvt_pk_bf16_f32 v35, v38, v39
    v_cvt_pk_bf16_f32 v40, v40, v41
    v_cvt_pk_bf16_f32 v41, v42, v43
    v_cvt_pk_bf16_f32 v42, v44, v45
    v_cvt_pk_bf16_f32 v43, v46, v47
    v_accvgpr_write_b32 a128, v32
    v_accvgpr_write_b32 a129, v33
    v_accvgpr_write_b32 a130, v34
    v_mfma_f32_32x32x16_bf16 v[112:127], a[72:75], a[48:51], v[112:127]
    v_accvgpr_write_b32 a131, v35
    v_accvgpr_write_b32 a132, v40
    v_accvgpr_write_b32 a133, v41
    v_accvgpr_write_b32 a134, v42
    v_accvgpr_write_b32 a135, v43
    v_cvt_pk_bf16_f32 v48, v48, v49
    v_cvt_pk_bf16_f32 v49, v50, v51
    v_cvt_pk_bf16_f32 v50, v52, v53
    v_cvt_pk_bf16_f32 v51, v54, v55
    v_cvt_pk_bf16_f32 v56, v56, v57
    v_cvt_pk_bf16_f32 v57, v58, v59
    v_mfma_f32_32x32x16_bf16 v[96:111], a[88:91], a[36:39], v[96:111]
    v_cvt_pk_bf16_f32 v58, v60, v61
    v_cvt_pk_bf16_f32 v59, v62, v63
    v_accvgpr_write_b32 a160, v48
    v_accvgpr_write_b32 a161, v49
    v_accvgpr_write_b32 a162, v50
    v_accvgpr_write_b32 a163, v51
    v_accvgpr_write_b32 a164, v56
    v_accvgpr_write_b32 a165, v57
    v_accvgpr_write_b32 a166, v58
    v_accvgpr_write_b32 a167, v59
    v_cvt_pk_bf16_f32 v64, v64, v65
    v_fma_f32 v184, v184, v216, -v208
    v_mfma_f32_32x32x16_bf16 v[112:127], a[88:91], a[52:55], v[112:127]
    v_cvt_pk_bf16_f32 v65, v66, v67
    v_fma_f32 v185, v185, v217, -v209
    v_cvt_pk_bf16_f32 v66, v68, v69
    v_fma_f32 v186, v186, v218, -v210
    v_cvt_pk_bf16_f32 v67, v70, v71
    v_fma_f32 v187, v187, v219, -v211
    v_cvt_pk_bf16_f32 v72, v72, v73
    v_fma_f32 v188, v188, v220, -v212
    v_cvt_pk_bf16_f32 v73, v74, v75
    v_fma_f32 v189, v189, v221, -v213
    v_cvt_pk_bf16_f32 v74, v76, v77
    v_mfma_f32_32x32x16_bf16 v[96:111], a[104:107], a[40:43], v[96:111]
    v_fma_f32 v190, v190, v222, -v214
    v_cvt_pk_bf16_f32 v75, v78, v79
    v_fma_f32 v191, v191, v223, -v215
    v_accvgpr_write_b32 a136, v64
    v_cvt_pk_bf16_f32 v164, v184, v185
    v_accvgpr_write_b32 a137, v65
    v_cvt_pk_bf16_f32 v165, v186, v187
    v_accvgpr_write_b32 a138, v66
    v_cvt_pk_bf16_f32 v166, v188, v189
    v_accvgpr_write_b32 a139, v67
    v_cvt_pk_bf16_f32 v167, v190, v191
    v_accvgpr_write_b32 a140, v72
    v_mfma_f32_32x32x16_bf16 v[112:127], a[104:107], a[56:59], v[112:127]
    ds_read_b64_tr_b16 a[108:109], v3 offset:43520
    ds_read_b64_tr_b16 a[110:111], v3 offset:43776
    buffer_store_dwordx2 v[164:165], v31, s[8:11], s66 offen sc1
    v_accvgpr_write_b32 a141, v73
    v_accvgpr_write_b32 a142, v74
    v_accvgpr_write_b32 a143, v75
    v_mfma_f32_32x32x16_bf16 v[96:111], a[120:123], a[44:47], v[96:111]
    v_cvt_pk_bf16_f32 v80, v80, v81
    v_cvt_pk_bf16_f32 v81, v82, v83
    buffer_store_dwordx2 v[166:167], v31, s[8:11], s66 offen offset:512 sc1
    v_cvt_pk_bf16_f32 v82, v84, v85
    v_cvt_pk_bf16_f32 v83, v86, v87
    v_cvt_pk_bf16_f32 v88, v88, v89
    v_cvt_pk_bf16_f32 v89, v90, v91
    v_fma_f32 v192, v192, v216, -v208
    v_mfma_f32_32x32x16_bf16 v[112:127], a[120:123], a[60:63], v[112:127]
    v_cvt_pk_bf16_f32 v90, v92, v93
    v_fma_f32 v193, v193, v217, -v209
    v_cvt_pk_bf16_f32 v91, v94, v95
    v_fma_f32 v194, v194, v218, -v210
    v_accvgpr_write_b32 a168, v80
    ds_read_b64_tr_b16 a[124:125], v3 offset:47616
    ds_read_b64_tr_b16 a[126:127], v3 offset:47872
    v_fma_f32 v195, v195, v219, -v211
    v_accvgpr_write_b32 a169, v81
    s_waitcnt lgkmcnt(6)
    v_mfma_f32_32x32x16_bf16 v[128:143], a[76:79], a[32:35], v[128:143]
    v_fma_f32 v196, v196, v220, -v212
    v_accvgpr_write_b32 a170, v82
    v_fma_f32 v197, v197, v221, -v213
    v_accvgpr_write_b32 a171, v83
    v_fma_f32 v198, v198, v222, -v214
    v_accvgpr_write_b32 a172, v88
    v_fma_f32 v199, v199, v223, -v215
    v_accvgpr_write_b32 a173, v89
    v_cvt_pk_bf16_f32 v168, v192, v193
    v_accvgpr_write_b32 a174, v90
    ds_read_b128 a[192:195], v1
    v_mfma_f32_32x32x16_bf16 v[144:159], a[76:79], a[48:51], v[144:159]
    v_cvt_pk_bf16_f32 v169, v194, v195
    v_accvgpr_write_b32 a175, v91
    ds_read_b128 a[196:199], v1 offset:1024
    v_cvt_pk_bf16_f32 v170, v196, v197
    v_cvt_pk_bf16_f32 v171, v198, v199
    buffer_store_dwordx2 v[168:169], v31, s[8:11], s67 offen sc1
    s_waitcnt lgkmcnt(6)
    v_mfma_f32_32x32x16_bf16 v[128:143], a[92:95], a[36:39], v[128:143]
    v_cvt_pk_bf16_f32 v96, v96, v97
    v_cvt_pk_bf16_f32 v97, v98, v99
    ds_read_b128 a[200:203], v1 offset:2048
    v_cvt_pk_bf16_f32 v98, v100, v101
    v_cvt_pk_bf16_f32 v99, v102, v103
    v_cvt_pk_bf16_f32 v104, v104, v105
    ds_read_b128 a[204:207], v1 offset:3072
    v_cvt_pk_bf16_f32 v105, v106, v107
    ds_read_b128 a[208:211], v1 offset:4096
    v_mfma_f32_32x32x16_bf16 v[144:159], a[92:95], a[52:55], v[144:159]
    v_cvt_pk_bf16_f32 v106, v108, v109
    buffer_store_dwordx2 v[170:171], v31, s[8:11], s67 offen offset:512 sc1
    v_cvt_pk_bf16_f32 v107, v110, v111
    ds_read_b128 a[212:215], v1 offset:5120
    v_accvgpr_write_b32 a144, v96
    v_accvgpr_write_b32 a145, v97
    v_accvgpr_write_b32 a146, v98
    s_waitcnt lgkmcnt(8)
    v_mfma_f32_32x32x16_bf16 v[128:143], a[108:111], a[40:43], v[128:143]
    ds_read_b128 a[216:219], v1 offset:6144
    ds_read_b128 a[220:223], v1 offset:7168
    v_fma_f32 v200, v200, v216, -v208
    v_accvgpr_write_b32 a147, v99
    v_fma_f32 v201, v201, v217, -v209
    v_accvgpr_write_b32 a148, v104
    v_fma_f32 v202, v202, v218, -v210
    v_accvgpr_write_b32 a149, v105
    v_fma_f32 v203, v203, v219, -v211
    v_accvgpr_write_b32 a150, v106
    v_mfma_f32_32x32x16_bf16 v[144:159], a[108:111], a[56:59], v[144:159]
    v_fma_f32 v204, v204, v220, -v212
    v_accvgpr_write_b32 a151, v107
    v_fma_f32 v205, v205, v221, -v213
    v_cvt_pk_bf16_f32 v112, v112, v113
    v_fma_f32 v206, v206, v222, -v214
    v_cvt_pk_bf16_f32 v113, v114, v115
    v_fma_f32 v207, v207, v223, -v215
    v_cvt_pk_bf16_f32 v114, v116, v117
    v_cvt_pk_bf16_f32 v172, v200, v201
    v_cvt_pk_bf16_f32 v115, v118, v119
    v_cvt_pk_bf16_f32 v173, v202, v203
    s_waitcnt lgkmcnt(8)
    v_mfma_f32_32x32x16_bf16 v[128:143], a[124:127], a[44:47], v[128:143]
    v_cvt_pk_bf16_f32 v120, v120, v121
    v_cvt_pk_bf16_f32 v174, v204, v205
    v_cvt_pk_bf16_f32 v121, v122, v123
    v_cvt_pk_bf16_f32 v175, v206, v207
    v_cvt_pk_bf16_f32 v122, v124, v125
    buffer_store_dwordx2 v[172:173], v31, s[8:11], s68 offen sc1
    v_cvt_pk_bf16_f32 v123, v126, v127
    v_accvgpr_write_b32 a176, v112
    v_mfma_f32_32x32x16_bf16 v[144:159], a[124:127], a[60:63], v[144:159]
    v_accvgpr_write_b32 a177, v113
    v_accvgpr_write_b32 a178, v114
    v_accvgpr_write_b32 a179, v115
    buffer_store_dwordx2 v[174:175], v31, s[8:11], s68 offen offset:512 sc1
    v_accvgpr_write_b32 a180, v120
    v_accvgpr_write_b32 a181, v121
    v_accvgpr_write_b32 a182, v122
    v_accvgpr_write_b32 a183, v123
    v_cvt_pk_bf16_f32 v128, v128, v129
    v_cvt_pk_bf16_f32 v129, v130, v131
    v_cvt_pk_bf16_f32 v130, v132, v133
    v_cvt_pk_bf16_f32 v131, v134, v135
    v_cvt_pk_bf16_f32 v136, v136, v137
    v_cvt_pk_bf16_f32 v137, v138, v139
    v_cvt_pk_bf16_f32 v138, v140, v141
    v_cvt_pk_bf16_f32 v139, v142, v143
    v_accvgpr_write_b32 a152, v128
    v_accvgpr_write_b32 a153, v129
    v_accvgpr_write_b32 a154, v130
    v_accvgpr_write_b32 a155, v131
    v_accvgpr_write_b32 a156, v136
    v_accvgpr_write_b32 a157, v137
    v_accvgpr_write_b32 a158, v138
    v_accvgpr_write_b32 a159, v139
    v_cvt_pk_bf16_f32 v144, v144, v145
    v_cvt_pk_bf16_f32 v145, v146, v147
    v_cvt_pk_bf16_f32 v146, v148, v149
    v_cvt_pk_bf16_f32 v147, v150, v151
    v_cvt_pk_bf16_f32 v152, v152, v153
    v_cvt_pk_bf16_f32 v153, v154, v155
    v_cvt_pk_bf16_f32 v154, v156, v157
    v_cvt_pk_bf16_f32 v155, v158, v159
    v_accvgpr_write_b32 a184, v144
    v_accvgpr_write_b32 a185, v145
    v_accvgpr_write_b32 a186, v146
    v_accvgpr_write_b32 a187, v147
    v_accvgpr_write_b32 a188, v152
    v_accvgpr_write_b32 a189, v153
    v_accvgpr_write_b32 a190, v154
    v_accvgpr_write_b32 a191, v155
    v_subrev_u32 v4, s31, v1
    v_and_b32 v16, 31, v0
    v_lshrrev_b32 v17, 5, v0
    v_lshlrev_b32 v17, 2, v17
    v_sub_u32 v16, v16, v17
    v_mov_b32 v15, 0xff800000
    v_mov_b32 v128, 0
    v_mov_b32 v129, 0
    v_mov_b32 v130, 0
    v_mov_b32 v131, 0
    v_mov_b32 v132, 0
    v_mov_b32 v133, 0
    v_mov_b32 v134, 0
    v_mov_b32 v135, 0
    v_mov_b32 v136, 0
    v_mov_b32 v137, 0
    v_mov_b32 v138, 0
    v_mov_b32 v139, 0
    v_mov_b32 v140, 0
    v_mov_b32 v141, 0
    v_mov_b32 v142, 0
    v_mov_b32 v143, 0
    v_mov_b32 v144, 0
    v_mov_b32 v145, 0
    v_mov_b32 v146, 0
    v_mov_b32 v147, 0
    v_mov_b32 v148, 0
    v_mov_b32 v149, 0
    v_mov_b32 v150, 0
    v_mov_b32 v151, 0
    v_mov_b32 v152, 0
    v_mov_b32 v153, 0
    v_mov_b32 v154, 0
    v_mov_b32 v155, 0
    v_mov_b32 v156, 0
    v_mov_b32 v157, 0
    v_mov_b32 v158, 0
    v_mov_b32 v159, 0
    v_mov_b32 v5, 0
    v_mov_b32 v6, 0
    v_mov_b32 v7, 0
    v_mov_b32 v8, 0
    v_mov_b32 v9, 0
    v_mov_b32 v10, 0
    v_mov_b32 v11, 0
    v_mov_b32 v12, 0
    v_mov_b32 v236, 0
    v_mov_b32 v237, 0
    v_mov_b32 v238, 0
    v_mov_b32 v239, 0
    v_mov_b32 v25, v16
    s_sub_u32 s27, s93, 0x10000
    s_cmp_eq_u32 s17, 1
    s_cselect_b32 s27, s27, s93
    v_add_u32 v26, s27, v1
    s_sub_u32 s19, 0, s18
    s_min_u32 s36, s38, 36
L2_h0:
    s_waitcnt lgkmcnt(0)
    v_mfma_f32_32x32x16_bf16 v[32:47], a[192:195], a[128:131], v[128:143]
    v_cmp_gt_i32 s[42:43], 0, v25
    v_cmp_gt_i32 s[44:45], 1, v25
    v_cmp_gt_i32 s[46:47], 2, v25
    v_cmp_gt_i32 s[48:49], 3, v25
    v_cmp_gt_i32 s[50:51], 8, v25
    v_cmp_gt_i32 s[52:53], 9, v25
    v_mfma_f32_32x32x16_bf16 v[48:63], a[192:195], a[160:163], v[144:159]
    v_cmp_gt_i32 s[54:55], 10, v25
    v_cmp_gt_i32 s[56:57], 11, v25
    v_cmp_gt_i32 s[58:59], 16, v25
    v_cmp_gt_i32 s[60:61], 17, v25
    v_cmp_gt_i32 s[62:63], 18, v25
    v_cmp_gt_i32 s[64:65], 19, v25
    v_mfma_f32_32x32x16_bf16 v[32:47], a[196:199], a[132:135], v[32:47]
    v_cmp_gt_i32 s[66:67], 24, v25
    v_cmp_gt_i32 s[68:69], 25, v25
    v_cmp_gt_i32 s[70:71], 26, v25
    v_cmp_gt_i32 s[72:73], 27, v25
    ds_write_b128 v26, a[128:131]
    v_mfma_f32_32x32x16_bf16 v[48:63], a[196:199], a[164:167], v[48:63]
    ds_write_b128 v26, a[132:135] offset:1024
    ds_write_b128 v26, a[136:139] offset:2048
    ds_write_b128 v26, a[140:143] offset:3072
    v_mfma_f32_32x32x16_bf16 v[32:47], a[200:203], a[136:139], v[32:47]
    ds_write_b128 v26, a[144:147] offset:4096
    ds_write_b128 v26, a[148:151] offset:5120
    ds_write_b128 v26, a[152:155] offset:6144
    v_mfma_f32_32x32x16_bf16 v[48:63], a[200:203], a[168:171], v[48:63]
    ds_write_b128 v26, a[156:159] offset:7168
    ds_write_b128 v26, a[160:163] offset:8192
    ds_write_b128 v26, a[164:167] offset:9216
    v_mfma_f32_32x32x16_bf16 v[32:47], a[204:207], a[140:143], v[32:47]
    ds_write_b128 v26, a[168:171] offset:10240
    s_mov_b32 s87, s20
    s_mov_b32 s89, s21
    ds_write_b128 v26, a[172:175] offset:11264
    v_mfma_f32_32x32x16_bf16 v[48:63], a[204:207], a[172:175], v[48:63]
    s_mov_b32 s91, s23
    s_mov_b32 s92, s24
    ds_write_b128 v26, a[176:179] offset:12288
    ds_write_b128 v26, a[180:183] offset:13312
    v_mfma_f32_32x32x16_bf16 v[32:47], a[208:211], a[144:147], v[32:47]
    s_add_u32 s20, s20, 0x2000
    s_add_u32 s21, s21, 0x2000
    s_add_u32 s15, s15, 1
    ds_write_b128 v26, a[184:187] offset:14336
    v_add_f32 v5, v5, v9
    v_mfma_f32_32x32x16_bf16 v[48:63], a[208:211], a[176:179], v[48:63]
    s_add_u32 s23, s23, 0x2000
    s_and_b32 s23, s23, 0x7fff
    s_add_u32 s30, s23, s25
    v_add_u32 v2, s30, v4
    ds_write_b128 v26, a[188:191] offset:15360
    v_mfma_f32_32x32x16_bf16 v[32:47], a[212:215], a[148:151], v[32:47]
    v_add_f32 v6, v6, v10
    v_mov_b32 v9, 0
    v_mov_b32 v10, 0
    v_mfma_f32_32x32x16_bf16 v[48:63], a[212:215], a[180:183], v[48:63]
    v_mfma_f32_32x32x16_bf16 v[32:47], a[216:219], a[152:155], v[32:47]
    v_mfma_f32_32x32x16_bf16 v[48:63], a[216:219], a[184:187], v[48:63]
    v_mfma_f32_32x32x16_bf16 v[32:47], a[220:223], a[156:159], v[32:47]
    v_mfma_f32_32x32x16_bf16 v[48:63], a[220:223], a[188:191], v[48:63]
    s_waitcnt vmcnt(16) lgkmcnt(0)
    s_barrier
    v_mfma_f32_32x32x16_bf16 a[0:15], v[236:239], v[236:239], 0
    ds_read_b128 a[192:195], v2
    ds_read_b128 a[196:199], v2 offset:1024
    ds_read_b128 a[200:203], v2 offset:2048
    v_mfma_f32_32x32x16_bf16 a[16:31], v[236:239], v[236:239], 0
    ds_read_b128 a[204:207], v2 offset:3072
    ds_read_b128 a[208:211], v2 offset:4096
    ds_read_b128 a[212:215], v2 offset:5120
    v_mfma_f32_32x32x16_bf16 a[32:47], v[236:239], v[236:239], 0
    s_xor_b32 s24, s23, 0x4000
    s_add_u32 s30, s24, s26
    v_add_u32 v3, s30, v4
    ds_read_b128 a[216:219], v2 offset:6144
    v_mfma_f32_32x32x16_bf16 a[48:63], v[236:239], v[236:239], 0
    ds_read_b128 a[220:223], v2 offset:7168
    s_cmp_ge_i32 s19, 0
    s_cbranch_scc1 L2_h0_ms
    L2_h0_mr:
    s_add_u32 s19, s19, 1
    v_mfma_f32_32x32x16_bf16 a[64:79], v[236:239], v[236:239], 0
    s_add_u32 m0, s91, 0
    s_nop 0
    buffer_load_dwordx4 v1, s[8:11], s87 offen sc1 lds
    v_mfma_f32_32x32x16_bf16 a[80:95], v[236:239], v[236:239], 0
    buffer_load_dwordx4 v1, s[8:11], s87 offen offset:1024 sc1 lds
    v_mfma_f32_32x32x16_bf16 a[96:111], v[236:239], v[236:239], 0
    s_add_u32 m0, s92, 0x8000
    s_nop 0
    buffer_load_dwordx4 v1, s[8:11], s89 offen sc1 lds
    v_mfma_f32_32x32x16_bf16 a[112:127], v[236:239], v[236:239], 0
    buffer_load_dwordx4 v1, s[8:11], s89 offen offset:1024 sc1 lds
L2_h1:
    s_waitcnt lgkmcnt(0)
    s_mov_b32 s37, 1
    s_mov_b32 s94, 0x2b800000
    s_mov_b32 s95, 0x2b800000
    s_cmp_ge_i32 s19, 2
    s_cselect_b32 s94, -1.0, s94
    s_cmp_ge_i32 s19, 3
    s_cselect_b32 s95, -1.0, s95
    v_mfma_f32_32x32x16_bf16 v[64:79], a[192:195], a[128:131], v[128:143]
    v_add_f32 v5, v5, v9
    v_add_f32 v6, v6, v10
    v_exp_f32 v16, v32
    v_exp_f32 v17, v33
    v_exp_f32 v18, v34
    v_add_f32 v9, v16, v17
    v_mfma_f32_32x32x16_bf16 v[80:95], a[192:195], a[160:163], v[144:159]
    v_exp_f32 v19, v35
    v_cvt_pk_bf16_f32 v96, v16, v17
    v_exp_f32 v20, v36
    v_add_f32 v9, v9, v18
    v_exp_f32 v21, v37
    v_add_f32 v9, v9, v19
    v_mfma_f32_32x32x16_bf16 v[64:79], a[196:199], a[132:135], v[64:79]
    v_cvt_pk_bf16_f32 v97, v18, v19
    v_exp_f32 v22, v38
    v_add_f32 v9, v9, v20
    v_exp_f32 v23, v39
    v_add_f32 v9, v9, v21
    v_cvt_pk_bf16_f32 v98, v20, v21
    v_mfma_f32_32x32x16_bf16 v[80:95], a[196:199], a[164:167], v[80:95]
    v_exp_f32 v16, v48
    v_add_f32 v9, v9, v22
    v_exp_f32 v17, v49
    v_add_f32 v9, v9, v23
    v_cvt_pk_bf16_f32 v99, v22, v23
    v_exp_f32 v18, v50
    v_mfma_f32_32x32x16_bf16 v[64:79], a[200:203], a[136:139], v[64:79]
    v_add_f32 v10, v16, v17
    v_exp_f32 v19, v51
    v_cvt_pk_bf16_f32 v104, v16, v17
    v_exp_f32 v20, v52
    v_add_f32 v10, v10, v18
    v_exp_f32 v21, v53
    v_mfma_f32_32x32x16_bf16 v[80:95], a[200:203], a[168:171], v[80:95]
    v_add_f32 v10, v10, v19
    v_cvt_pk_bf16_f32 v105, v18, v19
    v_exp_f32 v22, v54
    v_add_f32 v10, v10, v20
    v_exp_f32 v23, v55
    v_add_f32 v10, v10, v21
    v_cvt_pk_bf16_f32 v106, v20, v21
    v_mfma_f32_32x32x16_bf16 v[64:79], a[204:207], a[140:143], v[64:79]
    v_exp_f32 v16, v40
    v_add_f32 v10, v10, v22
    v_exp_f32 v17, v41
    v_add_f32 v10, v10, v23
    v_cvt_pk_bf16_f32 v107, v22, v23
    v_exp_f32 v18, v42
    v_mfma_f32_32x32x16_bf16 v[80:95], a[204:207], a[172:175], v[80:95]
    v_add_f32 v9, v9, v16
    v_exp_f32 v19, v43
    v_add_f32 v9, v9, v17
    v_cvt_pk_bf16_f32 v100, v16, v17
    v_exp_f32 v20, v44
    v_add_f32 v9, v9, v18
    v_mfma_f32_32x32x16_bf16 v[64:79], a[208:211], a[144:147], v[64:79]
    v_exp_f32 v21, v45
    v_add_f32 v9, v9, v19
    v_cvt_pk_bf16_f32 v101, v18, v19
    v_exp_f32 v22, v46
    v_add_f32 v9, v9, v20
    v_exp_f32 v23, v47
    v_mfma_f32_32x32x16_bf16 v[80:95], a[208:211], a[176:179], v[80:95]
    v_add_f32 v9, v9, v21
    v_cvt_pk_bf16_f32 v102, v20, v21
    v_exp_f32 v16, v56
    v_add_f32 v9, v9, v22
    v_exp_f32 v17, v57
    v_add_f32 v9, v9, v23
    v_cvt_pk_bf16_f32 v103, v22, v23
    v_mfma_f32_32x32x16_bf16 v[64:79], a[212:215], a[148:151], v[64:79]
    v_exp_f32 v18, v58
    v_add_f32 v10, v10, v16
    v_exp_f32 v19, v59
    v_add_f32 v10, v10, v17
    v_cvt_pk_bf16_f32 v108, v16, v17
    v_exp_f32 v20, v60
    v_mfma_f32_32x32x16_bf16 v[80:95], a[212:215], a[180:183], v[80:95]
    v_add_f32 v10, v10, v18
    v_exp_f32 v21, v61
    v_add_f32 v10, v10, v19
    v_cvt_pk_bf16_f32 v109, v18, v19
    v_exp_f32 v22, v62
    v_add_f32 v10, v10, v20
    v_mfma_f32_32x32x16_bf16 v[64:79], a[216:219], a[152:155], v[64:79]
    v_exp_f32 v23, v63
    v_add_f32 v10, v10, v21
    v_cvt_pk_bf16_f32 v110, v20, v21
    v_add_f32 v10, v10, v22
    v_add_f32 v10, v10, v23
    v_cvt_pk_bf16_f32 v111, v22, v23
    v_max_f32 v24, v9, v10
    v_cmp_lt_f32 vcc, s86, v24
    v_mfma_f32_32x32x16_bf16 v[80:95], a[216:219], a[184:187], v[80:95]
    v_mov_b32 v25, v9
    v_mov_b32 v28, v25
    s_nop 1
    v_permlane32_swap_b32 v28, v25
    v_add_f32 v25, v25, v28
    v_cmp_gt_f32 s[40:41], s94, v25
    s_nop 0
    s_or_b64 vcc, vcc, s[40:41]
    v_mov_b32 v26, v10
    v_mfma_f32_32x32x16_bf16 v[64:79], a[220:223], a[156:159], v[64:79]
    v_mov_b32 v29, v26
    s_nop 1
    v_permlane32_swap_b32 v29, v26
    v_add_f32 v26, v26, v29
    v_cmp_gt_f32 s[40:41], s95, v26
    s_nop 0
    s_or_b64 vcc, vcc, s[40:41]
    s_mov_b32 s87, s20
    s_mov_b32 s89, s21
    v_mfma_f32_32x32x16_bf16 v[80:95], a[220:223], a[188:191], v[80:95]
    s_mov_b32 s91, s23
    s_mov_b32 s92, s24
    s_add_u32 s20, s20, 0x2000
    s_add_u32 s21, s21, 0x2000
    s_add_u32 s15, s15, 1
    s_add_u32 s23, s23, 0x2000
    s_and_b32 s23, s23, 0x7fff
    s_add_u32 s30, s23, s25
    v_add_u32 v2, s30, v4
    s_waitcnt vmcnt(4) lgkmcnt(0)
    s_barrier
    ds_read_b128 a[192:195], v2
    ds_read_b128 a[196:199], v2 offset:1024
    ds_read_b128 a[200:203], v2 offset:2048
    ds_read_b128 a[204:207], v2 offset:3072
    ds_read_b128 a[208:211], v2 offset:4096
    ds_read_b128 a[212:215], v2 offset:5120
    ds_read_b128 a[216:219], v2 offset:6144
    ds_read_b128 a[220:223], v2 offset:7168
    s_xor_b32 s24, s23, 0x4000
    s_add_u32 s30, s24, s26
    v_add_u32 v3, s30, v4
    s_add_u32 m0, s91, 0
    s_nop 0
    buffer_load_dwordx4 v1, s[8:11], s87 offen sc1 lds
    buffer_load_dwordx4 v1, s[8:11], s87 offen offset:1024 sc1 lds
    s_add_u32 m0, s92, 0x8000
    s_nop 0
    buffer_load_dwordx4 v1, s[8:11], s89 offen sc1 lds
    buffer_load_dwordx4 v1, s[8:11], s89 offen offset:1024 sc1 lds
    s_cmp_ge_i32 s19, 0
    s_cbranch_scc1 L2_h1_ms
    L2_h1_mr:
    s_add_u32 s19, s19, 1
    s_mov_b32 s27, 0x40000000
    s_cmp_eq_u32 s12, 0
    s_cselect_b32 s27, 64, s27
    v_mov_b32 v235, 1
    s_mov_b64 exec, 1
    buffer_atomic_add v235, v236, s[96:99], s27 offen sc0 sc1
    s_mov_b64 exec, -1
    s_cbranch_vccnz L2_h1_ss
    L2_h1_sr:
    s_mov_b32 s37, 0
    s_cmp_eq_u32 s15, s33
    s_cbranch_scc1 L2_tr0
L2_s0:
    s_waitcnt lgkmcnt(0)
    v_mfma_f32_32x32x16_bf16 v[32:47], a[192:195], a[128:131], v[128:143]
    ds_read_b128 a[224:227], v3
    ds_read_b128 a[228:231], v3 offset:1024
    ds_read_b128 a[232:235], v3 offset:2048
    v_mfma_f32_32x32x16_bf16 v[48:63], a[192:195], a[160:163], v[144:159]
    ds_read_b128 a[236:239], v3 offset:3072
    ds_read_b128 a[240:243], v3 offset:4096
    ds_read_b128 a[244:247], v3 offset:5120
    v_mfma_f32_32x32x16_bf16 v[32:47], a[196:199], a[132:135], v[32:47]
    ds_read_b128 a[248:251], v3 offset:6144
    ds_read_b128 a[252:255], v3 offset:7168
    s_mov_b32 s87, s20
    s_mov_b32 s89, s21
    v_mfma_f32_32x32x16_bf16 v[48:63], a[196:199], a[164:167], v[48:63]
    s_mov_b32 s91, s23
    s_mov_b32 s92, s24
    s_add_u32 s20, s20, 0x2000
    s_add_u32 s21, s21, 0x2000
    s_add_u32 s15, s15, 1
    v_add_f32 v5, v5, v9
    v_mfma_f32_32x32x16_bf16 v[32:47], a[200:203], a[136:139], v[32:47]
    s_add_u32 s23, s23, 0x2000
    s_and_b32 s23, s23, 0x7fff
    s_add_u32 s30, s23, s25
    v_add_u32 v2, s30, v4
    v_add_f32 v6, v6, v10
    v_mfma_f32_32x32x16_bf16 v[48:63], a[200:203], a[168:171], v[48:63]
    v_exp_f32 v16, v64
    v_exp_f32 v17, v65
    v_exp_f32 v18, v66
    v_mfma_f32_32x32x16_bf16 v[32:47], a[204:207], a[140:143], v[32:47]
    v_add_f32 v9, v16, v17
    v_exp_f32 v19, v67
    v_cvt_pk_bf16_f32 v112, v16, v17
    v_exp_f32 v20, v68
    v_mfma_f32_32x32x16_bf16 v[48:63], a[204:207], a[172:175], v[48:63]
    v_add_f32 v9, v9, v18
    v_exp_f32 v21, v69
    v_add_f32 v9, v9, v19
    v_cvt_pk_bf16_f32 v113, v18, v19
    v_mfma_f32_32x32x16_bf16 v[32:47], a[208:211], a[144:147], v[32:47]
    v_exp_f32 v22, v70
    v_add_f32 v9, v9, v20
    v_exp_f32 v23, v71
    v_add_f32 v9, v9, v21
    v_mfma_f32_32x32x16_bf16 v[48:63], a[208:211], a[176:179], v[48:63]
    v_cvt_pk_bf16_f32 v114, v20, v21
    v_exp_f32 v16, v80
    v_add_f32 v9, v9, v22
    v_exp_f32 v17, v81
    v_mfma_f32_32x32x16_bf16 v[32:47], a[212:215], a[148:151], v[32:47]
    v_add_f32 v9, v9, v23
    v_cvt_pk_bf16_f32 v115, v22, v23
    v_exp_f32 v18, v82
    v_add_f32 v10, v16, v17
    v_mfma_f32_32x32x16_bf16 v[48:63], a[212:215], a[180:183], v[48:63]
    v_exp_f32 v19, v83
    v_cvt_pk_bf16_f32 v120, v16, v17
    v_exp_f32 v20, v84
    v_add_f32 v10, v10, v18
    v_mfma_f32_32x32x16_bf16 v[32:47], a[216:219], a[152:155], v[32:47]
    v_exp_f32 v21, v85
    v_add_f32 v10, v10, v19
    v_cvt_pk_bf16_f32 v121, v18, v19
    v_exp_f32 v22, v86
    v_mfma_f32_32x32x16_bf16 v[48:63], a[216:219], a[184:187], v[48:63]
    v_add_f32 v10, v10, v20
    v_exp_f32 v23, v87
    v_add_f32 v10, v10, v21
    v_cvt_pk_bf16_f32 v122, v20, v21
    v_mfma_f32_32x32x16_bf16 v[32:47], a[220:223], a[156:159], v[32:47]
    v_exp_f32 v16, v72
    v_add_f32 v10, v10, v22
    v_exp_f32 v17, v73
    v_add_f32 v10, v10, v23
    v_mfma_f32_32x32x16_bf16 v[48:63], a[220:223], a[188:191], v[48:63]
    v_cvt_pk_bf16_f32 v123, v22, v23
    v_exp_f32 v18, v74
    v_add_f32 v9, v9, v16
    s_waitcnt vmcnt(8) lgkmcnt(0)
    s_barrier
    v_mfma_f32_32x32x16_bf16 a[0:15], a[224:227], v[96:99], a[0:15]
    v_exp_f32 v19, v75
    v_add_f32 v9, v9, v17
    v_cvt_pk_bf16_f32 v116, v16, v17
    v_exp_f32 v20, v76
    v_mfma_f32_32x32x16_bf16 a[64:79], a[224:227], v[104:107], a[64:79]
    v_add_f32 v9, v9, v18
    v_exp_f32 v21, v77
    v_add_f32 v9, v9, v19
    v_cvt_pk_bf16_f32 v117, v18, v19
    v_mfma_f32_32x32x16_bf16 a[16:31], a[228:231], v[96:99], a[16:31]
    v_exp_f32 v22, v78
    v_add_f32 v9, v9, v20
    v_exp_f32 v23, v79
    v_add_f32 v9, v9, v21
    v_mfma_f32_32x32x16_bf16 a[80:95], a[228:231], v[104:107], a[80:95]
    v_cvt_pk_bf16_f32 v118, v20, v21
    s_cmp_ge_i32 s19, 0
    s_cbranch_scc1 L2_s0_ms
    L2_s0_mr:
    s_add_u32 s19, s19, 1
    v_mfma_f32_32x32x16_bf16 a[32:47], a[232:235], v[96:99], a[32:47]
    v_exp_f32 v16, v88
    v_add_f32 v9, v9, v22
    v_exp_f32 v17, v89
    v_add_f32 v9, v9, v23
    v_mfma_f32_32x32x16_bf16 a[96:111], a[232:235], v[104:107], a[96:111]
    ds_read_b128 a[192:195], v2
    v_cvt_pk_bf16_f32 v119, v22, v23
    ds_read_b128 a[196:199], v2 offset:1024
    v_mfma_f32_32x32x16_bf16 a[48:63], a[236:239], v[96:99], a[48:63]
    v_exp_f32 v18, v90
    v_add_f32 v10, v10, v16
    ds_read_b128 a[200:203], v2 offset:2048
    v_mfma_f32_32x32x16_bf16 a[112:127], a[236:239], v[104:107], a[112:127]
    v_exp_f32 v19, v91
    ds_read_b128 a[204:207], v2 offset:3072
    v_add_f32 v10, v10, v17
    v_cvt_pk_bf16_f32 v124, v16, v17
    v_mfma_f32_32x32x16_bf16 a[0:15], a[240:243], v[100:103], a[0:15]
    ds_read_b128 a[208:211], v2 offset:4096
    v_exp_f32 v20, v92
    ds_read_b128 a[212:215], v2 offset:5120
    v_mfma_f32_32x32x16_bf16 a[64:79], a[240:243], v[108:111], a[64:79]
    v_add_f32 v10, v10, v18
    s_xor_b32 s24, s23, 0x4000
    s_add_u32 s30, s24, s26
    v_add_u32 v3, s30, v4
    v_exp_f32 v21, v93
    v_mfma_f32_32x32x16_bf16 a[16:31], a[244:247], v[100:103], a[16:31]
    ds_read_b128 a[216:219], v2 offset:6144
    v_add_f32 v10, v10, v19
    ds_read_b128 a[220:223], v2 offset:7168
    v_cvt_pk_bf16_f32 v125, v18, v19
    v_mfma_f32_32x32x16_bf16 a[80:95], a[244:247], v[108:111], a[80:95]
    s_add_u32 m0, s91, 0
    s_nop 0
    buffer_load_dwordx4 v1, s[8:11], s87 offen sc1 lds
    v_mfma_f32_32x32x16_bf16 a[32:47], a[248:251], v[100:103], a[32:47]
    v_exp_f32 v22, v94
    v_add_f32 v10, v10, v20
    v_exp_f32 v23, v95
    v_add_f32 v10, v10, v21
    v_cvt_pk_bf16_f32 v126, v20, v21
    v_mfma_f32_32x32x16_bf16 a[96:111], a[248:251], v[108:111], a[96:111]
    buffer_load_dwordx4 v1, s[8:11], s87 offen offset:1024 sc1 lds
    v_add_f32 v10, v10, v22
    v_add_f32 v10, v10, v23
    v_mfma_f32_32x32x16_bf16 a[48:63], a[252:255], v[100:103], a[48:63]
    v_cvt_pk_bf16_f32 v127, v22, v23
    v_max_f32 v24, v9, v10
    v_cmp_lt_f32 vcc, s86, v24
    v_mfma_f32_32x32x16_bf16 a[112:127], a[252:255], v[108:111], a[112:127]
    s_add_u32 m0, s92, 0x8000
    s_nop 0
    buffer_load_dwordx4 v1, s[8:11], s89 offen sc1 lds
    buffer_load_dwordx4 v1, s[8:11], s89 offen offset:1024 sc1 lds
    s_cbranch_vccnz L2_s0_ss
    L2_s0_sr:
L2_s1:
    s_waitcnt lgkmcnt(0)
    v_mfma_f32_32x32x16_bf16 v[64:79], a[192:195], a[128:131], v[128:143]
    ds_read_b128 a[224:227], v3
    ds_read_b128 a[228:231], v3 offset:1024
    ds_read_b128 a[232:235], v3 offset:2048
    v_mfma_f32_32x32x16_bf16 v[80:95], a[192:195], a[160:163], v[144:159]
    ds_read_b128 a[236:239], v3 offset:3072
    ds_read_b128 a[240:243], v3 offset:4096
    ds_read_b128 a[244:247], v3 offset:5120
    v_mfma_f32_32x32x16_bf16 v[64:79], a[196:199], a[132:135], v[64:79]
    ds_read_b128 a[248:251], v3 offset:6144
    ds_read_b128 a[252:255], v3 offset:7168
    s_mov_b32 s87, s20
    s_mov_b32 s89, s21
    v_mfma_f32_32x32x16_bf16 v[80:95], a[196:199], a[164:167], v[80:95]
    s_mov_b32 s91, s23
    s_mov_b32 s92, s24
    s_add_u32 s20, s20, 0x2000
    s_add_u32 s21, s21, 0x2000
    s_add_u32 s15, s15, 1
    v_add_f32 v5, v5, v9
    v_mfma_f32_32x32x16_bf16 v[64:79], a[200:203], a[136:139], v[64:79]
    s_add_u32 s23, s23, 0x2000
    s_and_b32 s23, s23, 0x7fff
    s_add_u32 s30, s23, s25
    v_add_u32 v2, s30, v4
    v_add_f32 v6, v6, v10
    v_mfma_f32_32x32x16_bf16 v[80:95], a[200:203], a[168:171], v[80:95]
    v_exp_f32 v16, v32
    v_exp_f32 v17, v33
    v_exp_f32 v18, v34
    v_mfma_f32_32x32x16_bf16 v[64:79], a[204:207], a[140:143], v[64:79]
    v_add_f32 v9, v16, v17
    v_exp_f32 v19, v35
    v_cvt_pk_bf16_f32 v96, v16, v17
    v_exp_f32 v20, v36
    v_mfma_f32_32x32x16_bf16 v[80:95], a[204:207], a[172:175], v[80:95]
    v_add_f32 v9, v9, v18
    v_exp_f32 v21, v37
    v_add_f32 v9, v9, v19
    v_cvt_pk_bf16_f32 v97, v18, v19
    v_mfma_f32_32x32x16_bf16 v[64:79], a[208:211], a[144:147], v[64:79]
    v_exp_f32 v22, v38
    v_add_f32 v9, v9, v20
    v_exp_f32 v23, v39
    v_add_f32 v9, v9, v21
    v_mfma_f32_32x32x16_bf16 v[80:95], a[208:211], a[176:179], v[80:95]
    v_cvt_pk_bf16_f32 v98, v20, v21
    v_exp_f32 v16, v48
    v_add_f32 v9, v9, v22
    v_exp_f32 v17, v49
    v_mfma_f32_32x32x16_bf16 v[64:79], a[212:215], a[148:151], v[64:79]
    v_add_f32 v9, v9, v23
    v_cvt_pk_bf16_f32 v99, v22, v23
    v_exp_f32 v18, v50
    v_add_f32 v10, v16, v17
    v_mfma_f32_32x32x16_bf16 v[80:95], a[212:215], a[180:183], v[80:95]
    v_exp_f32 v19, v51
    v_cvt_pk_bf16_f32 v104, v16, v17
    v_exp_f32 v20, v52
    v_add_f32 v10, v10, v18
    v_mfma_f32_32x32x16_bf16 v[64:79], a[216:219], a[152:155], v[64:79]
    v_exp_f32 v21, v53
    v_add_f32 v10, v10, v19
    v_cvt_pk_bf16_f32 v105, v18, v19
    v_exp_f32 v22, v54
    v_mfma_f32_32x32x16_bf16 v[80:95], a[216:219], a[184:187], v[80:95]
    v_add_f32 v10, v10, v20
    v_exp_f32 v23, v55
    v_add_f32 v10, v10, v21
    v_cvt_pk_bf16_f32 v106, v20, v21
    v_mfma_f32_32x32x16_bf16 v[64:79], a[220:223], a[156:159], v[64:79]
    v_exp_f32 v16, v40
    v_add_f32 v10, v10, v22
    v_exp_f32 v17, v41
    v_add_f32 v10, v10, v23
    v_mfma_f32_32x32x16_bf16 v[80:95], a[220:223], a[188:191], v[80:95]
    v_cvt_pk_bf16_f32 v107, v22, v23
    v_exp_f32 v18, v42
    v_add_f32 v9, v9, v16
    s_waitcnt vmcnt(8) lgkmcnt(0)
    s_barrier
    v_mfma_f32_32x32x16_bf16 a[0:15], a[224:227], v[112:115], a[0:15]
    v_exp_f32 v19, v43
    v_add_f32 v9, v9, v17
    v_cvt_pk_bf16_f32 v100, v16, v17
    v_exp_f32 v20, v44
    v_mfma_f32_32x32x16_bf16 a[64:79], a[224:227], v[120:123], a[64:79]
    v_add_f32 v9, v9, v18
    v_exp_f32 v21, v45
    v_add_f32 v9, v9, v19
    v_cvt_pk_bf16_f32 v101, v18, v19
    v_mfma_f32_32x32x16_bf16 a[16:31], a[228:231], v[112:115], a[16:31]
    v_exp_f32 v22, v46
    v_add_f32 v9, v9, v20
    v_exp_f32 v23, v47
    v_add_f32 v9, v9, v21
    v_mfma_f32_32x32x16_bf16 a[80:95], a[228:231], v[120:123], a[80:95]
    v_cvt_pk_bf16_f32 v102, v20, v21
    s_cmp_ge_i32 s19, 0
    s_cbranch_scc1 L2_s1_ms
    L2_s1_mr:
    s_add_u32 s19, s19, 1
    v_mfma_f32_32x32x16_bf16 a[32:47], a[232:235], v[112:115], a[32:47]
    v_exp_f32 v16, v56
    v_add_f32 v9, v9, v22
    v_exp_f32 v17, v57
    v_add_f32 v9, v9, v23
    v_mfma_f32_32x32x16_bf16 a[96:111], a[232:235], v[120:123], a[96:111]
    ds_read_b128 a[192:195], v2
    v_cvt_pk_bf16_f32 v103, v22, v23
    ds_read_b128 a[196:199], v2 offset:1024
    v_mfma_f32_32x32x16_bf16 a[48:63], a[236:239], v[112:115], a[48:63]
    v_exp_f32 v18, v58
    v_add_f32 v10, v10, v16
    ds_read_b128 a[200:203], v2 offset:2048
    v_mfma_f32_32x32x16_bf16 a[112:127], a[236:239], v[120:123], a[112:127]
    v_exp_f32 v19, v59
    ds_read_b128 a[204:207], v2 offset:3072
    v_add_f32 v10, v10, v17
    v_cvt_pk_bf16_f32 v108, v16, v17
    v_mfma_f32_32x32x16_bf16 a[0:15], a[240:243], v[116:119], a[0:15]
    ds_read_b128 a[208:211], v2 offset:4096
    v_exp_f32 v20, v60
    ds_read_b128 a[212:215], v2 offset:5120
    v_mfma_f32_32x32x16_bf16 a[64:79], a[240:243], v[124:127], a[64:79]
    v_add_f32 v10, v10, v18
    s_xor_b32 s24, s23, 0x4000
    s_add_u32 s30, s24, s26
    v_add_u32 v3, s30, v4
    v_exp_f32 v21, v61
    v_mfma_f32_32x32x16_bf16 a[16:31], a[244:247], v[116:119], a[16:31]
    ds_read_b128 a[216:219], v2 offset:6144
    v_add_f32 v10, v10, v19
    ds_read_b128 a[220:223], v2 offset:7168
    v_cvt_pk_bf16_f32 v109, v18, v19
    v_mfma_f32_32x32x16_bf16 a[80:95], a[244:247], v[124:127], a[80:95]
    s_add_u32 m0, s91, 0
    s_nop 0
    buffer_load_dwordx4 v1, s[8:11], s87 offen sc1 lds
    v_mfma_f32_32x32x16_bf16 a[32:47], a[248:251], v[116:119], a[32:47]
    v_exp_f32 v22, v62
    v_add_f32 v10, v10, v20
    v_exp_f32 v23, v63
    v_add_f32 v10, v10, v21
    v_cvt_pk_bf16_f32 v110, v20, v21
    v_mfma_f32_32x32x16_bf16 a[96:111], a[248:251], v[124:127], a[96:111]
    buffer_load_dwordx4 v1, s[8:11], s87 offen offset:1024 sc1 lds
    v_add_f32 v10, v10, v22
    v_add_f32 v10, v10, v23
    v_mfma_f32_32x32x16_bf16 a[48:63], a[252:255], v[116:119], a[48:63]
    v_cvt_pk_bf16_f32 v111, v22, v23
    v_max_f32 v24, v9, v10
    v_cmp_lt_f32 vcc, s86, v24
    v_mfma_f32_32x32x16_bf16 a[112:127], a[252:255], v[124:127], a[112:127]
    s_add_u32 m0, s92, 0x8000
    s_nop 0
    buffer_load_dwordx4 v1, s[8:11], s89 offen sc1 lds
    buffer_load_dwordx4 v1, s[8:11], s89 offen offset:1024 sc1 lds
    s_cbranch_vccnz L2_s1_ss
    L2_s1_sr:
    s_cmp_lg_u32 s15, 4
    s_cbranch_scc1 L2_s2
L2_s1b:
    s_waitcnt vmcnt(8)
    v_readfirstlane_b32 s27, v235
    s_nop 0
    s_cmp_eq_u32 s27, 0xff
    s_cbranch_scc1 L2_e1_bc
    L2_e1_bcr:
L2_s2:
    s_cmp_lg_u32 s15, s33
    s_cbranch_scc1 L2_s0
L2_tr:
    s_waitcnt vmcnt(4)
L2_g0:
    s_waitcnt lgkmcnt(0)
    v_mfma_f32_32x32x16_bf16 v[32:47], a[192:195], a[128:131], v[128:143]
    ds_read_b128 a[224:227], v3
    ds_read_b128 a[228:231], v3 offset:1024
    ds_read_b128 a[232:235], v3 offset:2048
    v_add_f32 v5, v5, v9
    v_mfma_f32_32x32x16_bf16 v[48:63], a[192:195], a[160:163], v[144:159]
    ds_read_b128 a[236:239], v3 offset:3072
    ds_read_b128 a[240:243], v3 offset:4096
    ds_read_b128 a[244:247], v3 offset:5120
    v_add_f32 v6, v6, v10
    v_mfma_f32_32x32x16_bf16 v[32:47], a[196:199], a[132:135], v[32:47]
    ds_read_b128 a[248:251], v3 offset:6144
    ds_read_b128 a[252:255], v3 offset:7168
    s_cmp_lt_u32 s15, 31
    s_cselect_b32 s87, s20, 0x40000000
    s_add_u32 s88, s87, s22
    v_mfma_f32_32x32x16_bf16 v[48:63], a[196:199], a[164:167], v[48:63]
    s_cmp_ge_u32 s15, s33
    s_cselect_b32 s88, s88, 0x40000000
    s_cmp_lt_u32 s15, 33
    s_cselect_b32 s89, s21, 0x40000000
    s_add_u32 s90, s89, s22
    s_cmp_ge_u32 s15, s16
    s_cselect_b32 s90, s90, 0x40000000
    v_mfma_f32_32x32x16_bf16 v[32:47], a[200:203], a[136:139], v[32:47]
    s_mov_b32 s91, s23
    s_mov_b32 s92, s24
    s_add_u32 s20, s20, 0x2000
    s_add_u32 s21, s21, 0x2000
    s_add_u32 s15, s15, 1
    v_exp_f32 v16, v64
    v_mfma_f32_32x32x16_bf16 v[48:63], a[200:203], a[168:171], v[48:63]
    s_add_u32 s23, s23, 0x2000
    s_and_b32 s23, s23, 0x7fff
    s_add_u32 s30, s23, s25
    v_add_u32 v2, s30, v4
    v_exp_f32 v17, v65
    v_mfma_f32_32x32x16_bf16 v[32:47], a[204:207], a[140:143], v[32:47]
    v_exp_f32 v18, v66
    v_add_f32 v9, v16, v17
    v_exp_f32 v19, v67
    v_cvt_pk_bf16_f32 v112, v16, v17
    v_mfma_f32_32x32x16_bf16 v[48:63], a[204:207], a[172:175], v[48:63]
    v_exp_f32 v20, v68
    v_add_f32 v9, v9, v18
    v_exp_f32 v21, v69
    v_add_f32 v9, v9, v19
    v_cvt_pk_bf16_f32 v113, v18, v19
    v_mfma_f32_32x32x16_bf16 v[32:47], a[208:211], a[144:147], v[32:47]
    v_exp_f32 v22, v70
    v_add_f32 v9, v9, v20
    v_exp_f32 v23, v71
    v_add_f32 v9, v9, v21
    v_cvt_pk_bf16_f32 v114, v20, v21
    v_mfma_f32_32x32x16_bf16 v[48:63], a[208:211], a[176:179], v[48:63]
    v_exp_f32 v16, v80
    v_add_f32 v9, v9, v22
    v_exp_f32 v17, v81
    v_add_f32 v9, v9, v23
    v_cvt_pk_bf16_f32 v115, v22, v23
    v_mfma_f32_32x32x16_bf16 v[32:47], a[212:215], a[148:151], v[32:47]
    v_exp_f32 v18, v82
    v_add_f32 v10, v16, v17
    v_exp_f32 v19, v83
    v_cvt_pk_bf16_f32 v120, v16, v17
    v_mfma_f32_32x32x16_bf16 v[48:63], a[212:215], a[180:183], v[48:63]
    v_exp_f32 v20, v84
    v_add_f32 v10, v10, v18
    v_exp_f32 v21, v85
    v_add_f32 v10, v10, v19
    v_cvt_pk_bf16_f32 v121, v18, v19
    v_mfma_f32_32x32x16_bf16 v[32:47], a[216:219], a[152:155], v[32:47]
    v_exp_f32 v22, v86
    v_add_f32 v10, v10, v20
    v_exp_f32 v23, v87
    v_add_f32 v10, v10, v21
    v_cvt_pk_bf16_f32 v122, v20, v21
    v_mfma_f32_32x32x16_bf16 v[48:63], a[216:219], a[184:187], v[48:63]
    v_exp_f32 v16, v72
    v_add_f32 v10, v10, v22
    v_exp_f32 v17, v73
    v_add_f32 v10, v10, v23
    v_cvt_pk_bf16_f32 v123, v22, v23
    v_mfma_f32_32x32x16_bf16 v[32:47], a[220:223], a[156:159], v[32:47]
    v_exp_f32 v18, v74
    v_add_f32 v9, v9, v16
    v_exp_f32 v19, v75
    v_add_f32 v9, v9, v17
    v_cvt_pk_bf16_f32 v116, v16, v17
    v_mfma_f32_32x32x16_bf16 v[48:63], a[220:223], a[188:191], v[48:63]
    v_exp_f32 v20, v76
    v_add_f32 v9, v9, v18
    v_exp_f32 v21, v77
    s_waitcnt vmcnt(16) lgkmcnt(0)
    s_barrier
    v_mfma_f32_32x32x16_bf16 a[0:15], a[224:227], v[96:99], a[0:15]
    v_add_f32 v9, v9, v19
    v_cvt_pk_bf16_f32 v117, v18, v19
    v_exp_f32 v22, v78
    v_add_f32 v9, v9, v20
    v_exp_f32 v23, v79
    v_mfma_f32_32x32x16_bf16 a[64:79], a[224:227], v[104:107], a[64:79]
    s_xor_b32 s24, s23, 0x4000
    s_add_u32 s30, s24, s26
    v_add_u32 v3, s30, v4
    v_add_f32 v9, v9, v21
    v_cvt_pk_bf16_f32 v118, v20, v21
    v_exp_f32 v16, v88
    v_mfma_f32_32x32x16_bf16 a[16:31], a[228:231], v[96:99], a[16:31]
    s_add_u32 m0, s91, 0
    s_nop 0
    buffer_load_dwordx4 v1, s[8:11], s87 offen sc1 lds
    v_add_f32 v9, v9, v22
    v_mfma_f32_32x32x16_bf16 a[80:95], a[228:231], v[104:107], a[80:95]
    v_exp_f32 v17, v89
    s_cmp_ge_i32 s19, 0
    s_cbranch_scc1 L2_g0_ms
    L2_g0_mr:
    s_add_u32 s19, s19, 1
    v_mfma_f32_32x32x16_bf16 a[32:47], a[232:235], v[96:99], a[32:47]
    v_add_f32 v9, v9, v23
    buffer_load_dwordx4 v1, s[8:11], s87 offen offset:1024 sc1 lds
    ds_read_b128 a[192:195], v2
    v_mfma_f32_32x32x16_bf16 a[96:111], a[232:235], v[104:107], a[96:111]
    v_cvt_pk_bf16_f32 v119, v22, v23
    ds_read_b128 a[196:199], v2 offset:1024
    v_exp_f32 v18, v90
    v_add_f32 v10, v10, v16
    v_mfma_f32_32x32x16_bf16 a[48:63], a[236:239], v[96:99], a[48:63]
    ds_read_b128 a[200:203], v2 offset:2048
    v_exp_f32 v19, v91
    ds_read_b128 a[204:207], v2 offset:3072
    v_add_f32 v10, v10, v17
    v_mfma_f32_32x32x16_bf16 a[112:127], a[236:239], v[104:107], a[112:127]
    s_add_u32 m0, s91, 0x10000
    s_nop 0
    buffer_load_dwordx4 v1, s[8:11], s88 offen sc1 lds
    v_mfma_f32_32x32x16_bf16 a[0:15], a[240:243], v[100:103], a[0:15]
    v_cvt_pk_bf16_f32 v124, v16, v17
    ds_read_b128 a[208:211], v2 offset:4096
    v_exp_f32 v20, v92
    ds_read_b128 a[212:215], v2 offset:5120
    v_mfma_f32_32x32x16_bf16 a[64:79], a[240:243], v[108:111], a[64:79]
    buffer_load_dwordx4 v1, s[8:11], s88 offen offset:1024 sc1 lds
    v_add_f32 v10, v10, v18
    v_mfma_f32_32x32x16_bf16 a[16:31], a[244:247], v[100:103], a[16:31]
    v_exp_f32 v21, v93
    ds_read_b128 a[216:219], v2 offset:6144
    v_add_f32 v10, v10, v19
    ds_read_b128 a[220:223], v2 offset:7168
    v_mfma_f32_32x32x16_bf16 a[80:95], a[244:247], v[108:111], a[80:95]
    s_add_u32 m0, s92, 0x8000
    s_nop 0
    buffer_load_dwordx4 v1, s[8:11], s89 offen sc1 lds
    v_cvt_pk_bf16_f32 v125, v18, v19
    v_mfma_f32_32x32x16_bf16 a[32:47], a[248:251], v[100:103], a[32:47]
    v_exp_f32 v22, v94
    v_add_f32 v10, v10, v20
    v_exp_f32 v23, v95
    v_add_f32 v10, v10, v21
    v_cvt_pk_bf16_f32 v126, v20, v21
    v_mfma_f32_32x32x16_bf16 a[96:111], a[248:251], v[108:111], a[96:111]
    buffer_load_dwordx4 v1, s[8:11], s89 offen offset:1024 sc1 lds
    v_add_f32 v10, v10, v22
    v_add_f32 v10, v10, v23
    v_mfma_f32_32x32x16_bf16 a[48:63], a[252:255], v[100:103], a[48:63]
    v_cvt_pk_bf16_f32 v127, v22, v23
    v_max_f32 v24, v9, v10
    v_cmp_lt_f32 vcc, s86, v24
    v_mfma_f32_32x32x16_bf16 a[112:127], a[252:255], v[108:111], a[112:127]
    s_add_u32 m0, s92, 0x18000
    s_nop 0
    buffer_load_dwordx4 v1, s[8:11], s90 offen sc1 lds
    buffer_load_dwordx4 v1, s[8:11], s90 offen offset:1024 sc1 lds
    s_cbranch_vccnz L2_g0_ss
    L2_g0_sr:
L2_g1:
    s_waitcnt lgkmcnt(0)
    v_mfma_f32_32x32x16_bf16 v[64:79], a[192:195], a[128:131], v[128:143]
    ds_read_b128 a[224:227], v3
    ds_read_b128 a[228:231], v3 offset:1024
    ds_read_b128 a[232:235], v3 offset:2048
    v_add_f32 v5, v5, v9
    v_mfma_f32_32x32x16_bf16 v[80:95], a[192:195], a[160:163], v[144:159]
    ds_read_b128 a[236:239], v3 offset:3072
    ds_read_b128 a[240:243], v3 offset:4096
    ds_read_b128 a[244:247], v3 offset:5120
    v_add_f32 v6, v6, v10
    v_mfma_f32_32x32x16_bf16 v[64:79], a[196:199], a[132:135], v[64:79]
    ds_read_b128 a[248:251], v3 offset:6144
    ds_read_b128 a[252:255], v3 offset:7168
    s_cmp_lt_u32 s15, 31
    s_cselect_b32 s87, s20, 0x40000000
    s_add_u32 s88, s87, s22
    v_mfma_f32_32x32x16_bf16 v[80:95], a[196:199], a[164:167], v[80:95]
    s_cmp_ge_u32 s15, s33
    s_cselect_b32 s88, s88, 0x40000000
    s_cmp_lt_u32 s15, 33
    s_cselect_b32 s89, s21, 0x40000000
    s_add_u32 s90, s89, s22
    s_cmp_ge_u32 s15, s16
    s_cselect_b32 s90, s90, 0x40000000
    v_mfma_f32_32x32x16_bf16 v[64:79], a[200:203], a[136:139], v[64:79]
    s_mov_b32 s91, s23
    s_mov_b32 s92, s24
    s_add_u32 s20, s20, 0x2000
    s_add_u32 s21, s21, 0x2000
    s_add_u32 s15, s15, 1
    v_exp_f32 v16, v32
    v_mfma_f32_32x32x16_bf16 v[80:95], a[200:203], a[168:171], v[80:95]
    s_add_u32 s23, s23, 0x2000
    s_and_b32 s23, s23, 0x7fff
    s_add_u32 s30, s23, s25
    v_add_u32 v2, s30, v4
    v_exp_f32 v17, v33
    v_mfma_f32_32x32x16_bf16 v[64:79], a[204:207], a[140:143], v[64:79]
    v_exp_f32 v18, v34
    v_add_f32 v9, v16, v17
    v_exp_f32 v19, v35
    v_cvt_pk_bf16_f32 v96, v16, v17
    v_mfma_f32_32x32x16_bf16 v[80:95], a[204:207], a[172:175], v[80:95]
    v_exp_f32 v20, v36
    v_add_f32 v9, v9, v18
    v_exp_f32 v21, v37
    v_add_f32 v9, v9, v19
    v_cvt_pk_bf16_f32 v97, v18, v19
    v_mfma_f32_32x32x16_bf16 v[64:79], a[208:211], a[144:147], v[64:79]
    v_exp_f32 v22, v38
    v_add_f32 v9, v9, v20
    v_exp_f32 v23, v39
    v_add_f32 v9, v9, v21
    v_cvt_pk_bf16_f32 v98, v20, v21
    v_mfma_f32_32x32x16_bf16 v[80:95], a[208:211], a[176:179], v[80:95]
    v_exp_f32 v16, v48
    v_add_f32 v9, v9, v22
    v_exp_f32 v17, v49
    v_add_f32 v9, v9, v23
    v_cvt_pk_bf16_f32 v99, v22, v23
    v_mfma_f32_32x32x16_bf16 v[64:79], a[212:215], a[148:151], v[64:79]
    v_exp_f32 v18, v50
    v_add_f32 v10, v16, v17
    v_exp_f32 v19, v51
    v_cvt_pk_bf16_f32 v104, v16, v17
    v_mfma_f32_32x32x16_bf16 v[80:95], a[212:215], a[180:183], v[80:95]
    v_exp_f32 v20, v52
    v_add_f32 v10, v10, v18
    v_exp_f32 v21, v53
    v_add_f32 v10, v10, v19
    v_cvt_pk_bf16_f32 v105, v18, v19
    v_mfma_f32_32x32x16_bf16 v[64:79], a[216:219], a[152:155], v[64:79]
    v_exp_f32 v22, v54
    v_add_f32 v10, v10, v20
    v_exp_f32 v23, v55
    v_add_f32 v10, v10, v21
    v_cvt_pk_bf16_f32 v106, v20, v21
    v_mfma_f32_32x32x16_bf16 v[80:95], a[216:219], a[184:187], v[80:95]
    v_exp_f32 v16, v40
    v_add_f32 v10, v10, v22
    v_exp_f32 v17, v41
    v_add_f32 v10, v10, v23
    v_cvt_pk_bf16_f32 v107, v22, v23
    v_mfma_f32_32x32x16_bf16 v[64:79], a[220:223], a[156:159], v[64:79]
    v_exp_f32 v18, v42
    v_add_f32 v9, v9, v16
    v_exp_f32 v19, v43
    v_add_f32 v9, v9, v17
    v_cvt_pk_bf16_f32 v100, v16, v17
    v_mfma_f32_32x32x16_bf16 v[80:95], a[220:223], a[188:191], v[80:95]
    v_exp_f32 v20, v44
    v_add_f32 v9, v9, v18
    v_exp_f32 v21, v45
    s_waitcnt vmcnt(16) lgkmcnt(0)
    s_barrier
    v_mfma_f32_32x32x16_bf16 a[0:15], a[224:227], v[112:115], a[0:15]
    v_add_f32 v9, v9, v19
    v_cvt_pk_bf16_f32 v101, v18, v19
    v_exp_f32 v22, v46
    v_add_f32 v9, v9, v20
    v_exp_f32 v23, v47
    v_mfma_f32_32x32x16_bf16 a[64:79], a[224:227], v[120:123], a[64:79]
    s_xor_b32 s24, s23, 0x4000
    s_add_u32 s30, s24, s26
    v_add_u32 v3, s30, v4
    v_add_f32 v9, v9, v21
    v_cvt_pk_bf16_f32 v102, v20, v21
    v_exp_f32 v16, v56
    v_mfma_f32_32x32x16_bf16 a[16:31], a[228:231], v[112:115], a[16:31]
    s_add_u32 m0, s91, 0
    s_nop 0
    buffer_load_dwordx4 v1, s[8:11], s87 offen sc1 lds
    v_add_f32 v9, v9, v22
    v_mfma_f32_32x32x16_bf16 a[80:95], a[228:231], v[120:123], a[80:95]
    v_exp_f32 v17, v57
    s_cmp_ge_i32 s19, 0
    s_cbranch_scc1 L2_g1_ms
    L2_g1_mr:
    s_add_u32 s19, s19, 1
    v_mfma_f32_32x32x16_bf16 a[32:47], a[232:235], v[112:115], a[32:47]
    v_add_f32 v9, v9, v23
    buffer_load_dwordx4 v1, s[8:11], s87 offen offset:1024 sc1 lds
    ds_read_b128 a[192:195], v2
    v_mfma_f32_32x32x16_bf16 a[96:111], a[232:235], v[120:123], a[96:111]
    v_cvt_pk_bf16_f32 v103, v22, v23
    ds_read_b128 a[196:199], v2 offset:1024
    v_exp_f32 v18, v58
    v_add_f32 v10, v10, v16
    v_mfma_f32_32x32x16_bf16 a[48:63], a[236:239], v[112:115], a[48:63]
    ds_read_b128 a[200:203], v2 offset:2048
    v_exp_f32 v19, v59
    ds_read_b128 a[204:207], v2 offset:3072
    v_add_f32 v10, v10, v17
    v_mfma_f32_32x32x16_bf16 a[112:127], a[236:239], v[120:123], a[112:127]
    s_add_u32 m0, s91, 0x10000
    s_nop 0
    buffer_load_dwordx4 v1, s[8:11], s88 offen sc1 lds
    v_mfma_f32_32x32x16_bf16 a[0:15], a[240:243], v[116:119], a[0:15]
    v_cvt_pk_bf16_f32 v108, v16, v17
    ds_read_b128 a[208:211], v2 offset:4096
    v_exp_f32 v20, v60
    ds_read_b128 a[212:215], v2 offset:5120
    v_mfma_f32_32x32x16_bf16 a[64:79], a[240:243], v[124:127], a[64:79]
    buffer_load_dwordx4 v1, s[8:11], s88 offen offset:1024 sc1 lds
    v_add_f32 v10, v10, v18
    v_mfma_f32_32x32x16_bf16 a[16:31], a[244:247], v[116:119], a[16:31]
    v_exp_f32 v21, v61
    ds_read_b128 a[216:219], v2 offset:6144
    v_add_f32 v10, v10, v19
    ds_read_b128 a[220:223], v2 offset:7168
    v_mfma_f32_32x32x16_bf16 a[80:95], a[244:247], v[124:127], a[80:95]
    s_add_u32 m0, s92, 0x8000
    s_nop 0
    buffer_load_dwordx4 v1, s[8:11], s89 offen sc1 lds
    v_cvt_pk_bf16_f32 v109, v18, v19
    v_mfma_f32_32x32x16_bf16 a[32:47], a[248:251], v[116:119], a[32:47]
    v_exp_f32 v22, v62
    v_add_f32 v10, v10, v20
    v_exp_f32 v23, v63
    v_add_f32 v10, v10, v21
    v_cvt_pk_bf16_f32 v110, v20, v21
    v_mfma_f32_32x32x16_bf16 a[96:111], a[248:251], v[124:127], a[96:111]
    buffer_load_dwordx4 v1, s[8:11], s89 offen offset:1024 sc1 lds
    v_add_f32 v10, v10, v22
    v_add_f32 v10, v10, v23
    v_mfma_f32_32x32x16_bf16 a[48:63], a[252:255], v[116:119], a[48:63]
    v_cvt_pk_bf16_f32 v111, v22, v23
    v_max_f32 v24, v9, v10
    v_cmp_lt_f32 vcc, s86, v24
    v_mfma_f32_32x32x16_bf16 a[112:127], a[252:255], v[124:127], a[112:127]
    s_add_u32 m0, s92, 0x18000
    s_nop 0
    buffer_load_dwordx4 v1, s[8:11], s90 offen sc1 lds
    buffer_load_dwordx4 v1, s[8:11], s90 offen offset:1024 sc1 lds
    s_cbranch_vccnz L2_g1_ss
    L2_g1_sr:
    s_cmp_lg_u32 s15, s36
    s_cbranch_scc1 L2_g0
L2_ev:
    s_cmp_eq_u32 s15, 36
    s_cbranch_scc1 L2_tail
L2_sw0:
    s_waitcnt lgkmcnt(0)
    ds_read_b128 a[224:227], v3
    ds_read_b128 a[228:231], v3 offset:1024
    ds_read_b128 a[232:235], v3 offset:2048
    ds_read_b128 a[236:239], v3 offset:3072
    ds_read_b128 a[240:243], v3 offset:4096
    ds_read_b128 a[244:247], v3 offset:5120
    ds_read_b128 a[248:251], v3 offset:6144
    ds_read_b128 a[252:255], v3 offset:7168
    s_waitcnt lgkmcnt(7)
    v_mfma_f32_32x32x16_bf16 a[0:15], a[224:227], v[96:99], a[0:15]
    v_add_f32 v5, v5, v9
    v_add_f32 v6, v6, v10
    v_exp_f32 v16, v64
    v_exp_f32 v17, v65
    v_exp_f32 v18, v66
    v_mfma_f32_32x32x16_bf16 a[64:79], a[224:227], v[104:107], a[64:79]
    v_add_f32 v9, v16, v17
    v_exp_f32 v19, v67
    v_cvt_pk_bf16_f32 v112, v16, v17
    v_exp_f32 v20, v68
    v_add_f32 v9, v9, v18
    s_waitcnt lgkmcnt(6)
    v_mfma_f32_32x32x16_bf16 a[16:31], a[228:231], v[96:99], a[16:31]
    v_exp_f32 v21, v69
    v_add_f32 v9, v9, v19
    v_cvt_pk_bf16_f32 v113, v18, v19
    v_exp_f32 v22, v70
    v_add_f32 v9, v9, v20
    v_mfma_f32_32x32x16_bf16 a[80:95], a[228:231], v[104:107], a[80:95]
    v_exp_f32 v23, v71
    v_add_f32 v9, v9, v21
    v_cvt_pk_bf16_f32 v114, v20, v21
    v_exp_f32 v16, v80
    v_add_f32 v9, v9, v22
    v_exp_f32 v17, v81
    s_waitcnt lgkmcnt(5)
    v_mfma_f32_32x32x16_bf16 a[32:47], a[232:235], v[96:99], a[32:47]
    v_add_f32 v9, v9, v23
    v_cvt_pk_bf16_f32 v115, v22, v23
    v_exp_f32 v18, v82
    v_add_f32 v10, v16, v17
    v_exp_f32 v19, v83
    v_cvt_pk_bf16_f32 v120, v16, v17
    v_mfma_f32_32x32x16_bf16 a[96:111], a[232:235], v[104:107], a[96:111]
    v_exp_f32 v20, v84
    v_add_f32 v10, v10, v18
    v_exp_f32 v21, v85
    v_add_f32 v10, v10, v19
    v_cvt_pk_bf16_f32 v121, v18, v19
    v_exp_f32 v22, v86
    s_waitcnt lgkmcnt(4)
    v_mfma_f32_32x32x16_bf16 a[48:63], a[236:239], v[96:99], a[48:63]
    v_add_f32 v10, v10, v20
    v_exp_f32 v23, v87
    v_add_f32 v10, v10, v21
    v_cvt_pk_bf16_f32 v122, v20, v21
    v_exp_f32 v16, v72
    v_add_f32 v10, v10, v22
    v_mfma_f32_32x32x16_bf16 a[112:127], a[236:239], v[104:107], a[112:127]
    v_exp_f32 v17, v73
    v_add_f32 v10, v10, v23
    v_cvt_pk_bf16_f32 v123, v22, v23
    v_exp_f32 v18, v74
    v_add_f32 v9, v9, v16
    v_exp_f32 v19, v75
    s_waitcnt lgkmcnt(3)
    v_mfma_f32_32x32x16_bf16 a[0:15], a[240:243], v[100:103], a[0:15]
    v_add_f32 v9, v9, v17
    v_cvt_pk_bf16_f32 v116, v16, v17
    v_exp_f32 v20, v76
    v_add_f32 v9, v9, v18
    v_exp_f32 v21, v77
    v_add_f32 v9, v9, v19
    v_cvt_pk_bf16_f32 v117, v18, v19
    v_mfma_f32_32x32x16_bf16 a[64:79], a[240:243], v[108:111], a[64:79]
    v_exp_f32 v22, v78
    v_add_f32 v9, v9, v20
    v_exp_f32 v23, v79
    v_add_f32 v9, v9, v21
    v_cvt_pk_bf16_f32 v118, v20, v21
    s_waitcnt lgkmcnt(2)
    v_mfma_f32_32x32x16_bf16 a[16:31], a[244:247], v[100:103], a[16:31]
    v_exp_f32 v16, v88
    v_add_f32 v9, v9, v22
    v_exp_f32 v17, v89
    v_add_f32 v9, v9, v23
    v_cvt_pk_bf16_f32 v119, v22, v23
    v_exp_f32 v18, v90
    v_mfma_f32_32x32x16_bf16 a[80:95], a[244:247], v[108:111], a[80:95]
    v_add_f32 v10, v10, v16
    v_exp_f32 v19, v91
    v_add_f32 v10, v10, v17
    v_cvt_pk_bf16_f32 v124, v16, v17
    v_exp_f32 v20, v92
    v_add_f32 v10, v10, v18
    s_waitcnt lgkmcnt(1)
    v_mfma_f32_32x32x16_bf16 a[32:47], a[248:251], v[100:103], a[32:47]
    v_exp_f32 v21, v93
    v_add_f32 v10, v10, v19
    v_cvt_pk_bf16_f32 v125, v18, v19
    s_cmp_lt_u32 s15, 31
    s_cselect_b32 s87, s20, 0x40000000
    s_add_u32 s88, s87, s22
    v_exp_f32 v22, v94
    v_mfma_f32_32x32x16_bf16 a[96:111], a[248:251], v[108:111], a[96:111]
    v_add_f32 v10, v10, v20
    s_cmp_ge_u32 s15, s33
    s_cselect_b32 s88, s88, 0x40000000
    v_exp_f32 v23, v95
    s_cmp_lt_u32 s15, 33
    s_cselect_b32 s89, s21, 0x40000000
    s_add_u32 s90, s89, s22
    v_add_f32 v10, v10, v21
    s_waitcnt lgkmcnt(0)
    v_mfma_f32_32x32x16_bf16 a[48:63], a[252:255], v[100:103], a[48:63]
    v_cvt_pk_bf16_f32 v126, v20, v21
    v_add_f32 v10, v10, v22
    v_add_f32 v10, v10, v23
    v_cvt_pk_bf16_f32 v127, v22, v23
    v_max_f32 v24, v9, v10
    v_cmp_lt_f32 vcc, s86, v24
    s_cmp_ge_u32 s15, s16
    s_cselect_b32 s90, s90, 0x40000000
    v_mfma_f32_32x32x16_bf16 a[112:127], a[252:255], v[108:111], a[112:127]
    s_mov_b32 s91, s23
    s_mov_b32 s92, s24
    s_add_u32 s20, s20, 0x2000
    s_add_u32 s21, s21, 0x2000
    s_add_u32 s15, s15, 1
    s_add_u32 s23, s23, 0x2000
    s_and_b32 s23, s23, 0x7fff
    s_add_u32 s30, s23, s25
    v_add_u32 v2, s30, v4
    s_waitcnt vmcnt(16) lgkmcnt(0)
    s_barrier
    s_xor_b32 s24, s23, 0x4000
    s_add_u32 s30, s24, s26
    v_add_u32 v3, s30, v4
    s_add_u32 m0, s91, 0
    s_nop 0
    buffer_load_dwordx4 v1, s[8:11], s87 offen sc1 lds
    buffer_load_dwordx4 v1, s[8:11], s87 offen offset:1024 sc1 lds
    s_add_u32 m0, s91, 0x10000
    s_nop 0
    buffer_load_dwordx4 v1, s[8:11], s88 offen sc1 lds
    buffer_load_dwordx4 v1, s[8:11], s88 offen offset:1024 sc1 lds
    s_add_u32 m0, s92, 0x8000
    s_nop 0
    buffer_load_dwordx4 v1, s[8:11], s89 offen sc1 lds
    buffer_load_dwordx4 v1, s[8:11], s89 offen offset:1024 sc1 lds
    s_add_u32 m0, s92, 0x18000
    s_nop 0
    buffer_load_dwordx4 v1, s[8:11], s90 offen sc1 lds
    buffer_load_dwordx4 v1, s[8:11], s90 offen offset:1024 sc1 lds
    v_add_u32 v26, s93, v1
    ds_read_b128 a[128:131], v26
    ds_read_b128 a[132:135], v26 offset:1024
    ds_read_b128 a[136:139], v26 offset:2048
    ds_read_b128 a[140:143], v26 offset:3072
    ds_read_b128 a[144:147], v26 offset:4096
    ds_read_b128 a[148:151], v26 offset:5120
    ds_read_b128 a[152:155], v26 offset:6144
    ds_read_b128 a[156:159], v26 offset:7168
    ds_read_b128 a[160:163], v26 offset:8192
    ds_read_b128 a[164:167], v26 offset:9216
    ds_read_b128 a[168:171], v26 offset:10240
    ds_read_b128 a[172:175], v26 offset:11264
    ds_read_b128 a[176:179], v26 offset:12288
    ds_read_b128 a[180:183], v26 offset:13312
    ds_read_b128 a[184:187], v26 offset:14336
    ds_read_b128 a[188:191], v26 offset:15360
    s_cbranch_vccnz L2_sw0_ss
    L2_sw0_sr:
L2_sw1:
    s_waitcnt lgkmcnt(0)
    s_mov_b32 s25, 0x10000
    s_mul_i32 s82, s32, 0x4e000
    s_lshl_b32 s83, s13, 13
    s_add_u32 s82, s82, s83
    s_add_u32 s82, s82, 0x3000000
    s_add_u32 s83, s82, 0x1000
    s_add_u32 s84, s82, 0x4e000
    s_add_u32 s85, s83, 0x4e000
    v_add_f32 v11, v5, v9
    v_mov_b32 v28, v11
    s_nop 1
    v_permlane32_swap_b32 v28, v11
    v_add_f32 v11, v11, v28
    v_rcp_f32 v11, v11
    s_nop 0
    v_mul_f32 v11, v11, v13
    v_add_f32 v12, v6, v10
    v_mov_b32 v29, v12
    s_nop 1
    v_permlane32_swap_b32 v29, v12
    v_add_f32 v12, v12, v29
    v_rcp_f32 v12, v12
    s_nop 0
    v_mul_f32 v12, v12, v14
    ds_read_b128 a[224:227], v3
    ds_read_b128 a[240:243], v3 offset:4096
    ds_read_b128 a[228:231], v3 offset:1024
    ds_read_b128 a[244:247], v3 offset:5120
    ds_read_b128 a[232:235], v3 offset:2048
    ds_read_b128 a[248:251], v3 offset:6144
    ds_read_b128 a[236:239], v3 offset:3072
    ds_read_b128 a[252:255], v3 offset:7168
    s_waitcnt lgkmcnt(7)
    v_mfma_f32_32x32x16_bf16 a[0:15], a[224:227], v[112:115], a[0:15]
    v_mov_b32 v7, 0
    v_mov_b32 v8, 0
    v_mov_b32 v128, 0
    v_mov_b32 v129, 0
    v_mov_b32 v130, 0
    v_mov_b32 v131, 0
    v_mov_b32 v132, 0
    v_mov_b32 v133, 0
    v_mov_b32 v134, 0
    v_mov_b32 v135, 0
    v_mfma_f32_32x32x16_bf16 a[64:79], a[224:227], v[120:123], a[64:79]
    v_mov_b32 v136, 0
    v_mov_b32 v137, 0
    v_mov_b32 v138, 0
    v_mov_b32 v139, 0
    v_mov_b32 v140, 0
    v_mov_b32 v141, 0
    v_mov_b32 v142, 0
    v_mov_b32 v143, 0
    v_mov_b32 v144, 0
    v_mov_b32 v145, 0
    s_waitcnt lgkmcnt(6)
    v_mfma_f32_32x32x16_bf16 a[0:15], a[240:243], v[116:119], a[0:15]
    v_mov_b32 v146, 0
    v_mov_b32 v147, 0
    v_mov_b32 v148, 0
    v_mov_b32 v149, 0
    v_mov_b32 v150, 0
    v_mov_b32 v151, 0
    v_mov_b32 v152, 0
    v_mov_b32 v153, 0
    v_mov_b32 v154, 0
    v_mov_b32 v155, 0
    v_mfma_f32_32x32x16_bf16 a[64:79], a[240:243], v[124:127], a[64:79]
    v_mov_b32 v156, 0
    v_mov_b32 v157, 0
    v_mov_b32 v158, 0
    v_mov_b32 v159, 0
    s_cmp_lt_u32 s15, 31
    s_cselect_b32 s87, s20, 0x40000000
    s_add_u32 s88, s87, s22
    s_cmp_ge_u32 s15, s33
    s_cselect_b32 s88, s88, 0x40000000
    v_add_f32 v5, v5, v9
    s_waitcnt lgkmcnt(5)
    v_mfma_f32_32x32x16_bf16 a[16:31], a[228:231], v[112:115], a[16:31]
    s_cmp_lt_u32 s15, 33
    s_cselect_b32 s89, s21, 0x40000000
    s_add_u32 s90, s89, s22
    s_cmp_ge_u32 s15, s16
    s_cselect_b32 s90, s90, 0x40000000
    v_add_f32 v6, v6, v10
    s_mov_b32 s91, s23
    s_mov_b32 s92, s24
    v_mov_b32 v9, 0
    v_mov_b32 v10, 0
    v_mfma_f32_32x32x16_bf16 a[80:95], a[228:231], v[120:123], a[80:95]
    s_add_u32 s20, s20, 0x2000
    s_add_u32 s21, s21, 0x2000
    s_add_u32 s15, s15, 1
    s_add_u32 s23, s23, 0x2000
    s_and_b32 s23, s23, 0x7fff
    s_add_u32 s30, s23, s25
    v_add_u32 v2, s30, v4
    s_waitcnt lgkmcnt(4)
    v_mfma_f32_32x32x16_bf16 a[16:31], a[244:247], v[116:119], a[16:31]
    v_mfma_f32_32x32x16_bf16 a[80:95], a[244:247], v[124:127], a[80:95]
    v_accvgpr_read_b32 v240, a0
    v_accvgpr_read_b32 v241, a1
    v_accvgpr_read_b32 v242, a2
    v_accvgpr_read_b32 v243, a3
    v_accvgpr_read_b32 v244, a4
    v_accvgpr_read_b32 v245, a5
    v_accvgpr_read_b32 v246, a6
    v_accvgpr_read_b32 v247, a7
    v_mul_f32 v240, v240, v11
    v_mul_f32 v241, v241, v11
    v_mul_f32 v242, v242, v11
    s_waitcnt lgkmcnt(3)
    v_mfma_f32_32x32x16_bf16 a[32:47], a[232:235], v[112:115], a[32:47]
    v_mul_f32 v243, v243, v11
    v_mul_f32 v244, v244, v11
    v_mul_f32 v245, v245, v11
    v_mul_f32 v246, v246, v11
    v_mul_f32 v247, v247, v11
    v_cvt_pk_bf16_f32 v224, v240, v241
    v_cvt_pk_bf16_f32 v225, v242, v243
    v_cvt_pk_bf16_f32 v226, v244, v245
    v_cvt_pk_bf16_f32 v227, v246, v247
    v_mfma_f32_32x32x16_bf16 a[96:111], a[232:235], v[120:123], a[96:111]
    buffer_store_dwordx4 v[224:227], v1, s[8:11], s82 offen sc1
    v_accvgpr_read_b32 v248, a8
    v_accvgpr_read_b32 v249, a9
    v_accvgpr_read_b32 v250, a10
    v_accvgpr_read_b32 v251, a11
    v_accvgpr_read_b32 v252, a12
    v_accvgpr_read_b32 v253, a13
    v_accvgpr_read_b32 v254, a14
    s_waitcnt lgkmcnt(2)
    v_mfma_f32_32x32x16_bf16 a[32:47], a[248:251], v[116:119], a[32:47]
    v_accvgpr_read_b32 v255, a15
    v_mul_f32 v248, v248, v11
    v_mul_f32 v249, v249, v11
    v_mul_f32 v250, v250, v11
    v_mul_f32 v251, v251, v11
    v_mul_f32 v252, v252, v11
    v_mul_f32 v253, v253, v11
    v_mul_f32 v254, v254, v11
    v_mul_f32 v255, v255, v11
    v_cvt_pk_bf16_f32 v228, v248, v249
    v_cvt_pk_bf16_f32 v229, v250, v251
    v_mfma_f32_32x32x16_bf16 a[96:111], a[248:251], v[124:127], a[96:111]
    v_cvt_pk_bf16_f32 v230, v252, v253
    v_cvt_pk_bf16_f32 v231, v254, v255
    buffer_store_dwordx4 v[228:231], v1, s[8:11], s82 offen offset:1024 sc1
    v_accvgpr_read_b32 v240, a64
    v_accvgpr_read_b32 v241, a65
    v_accvgpr_read_b32 v242, a66
    v_accvgpr_read_b32 v243, a67
    v_accvgpr_read_b32 v244, a68
    s_waitcnt lgkmcnt(1)
    v_mfma_f32_32x32x16_bf16 a[48:63], a[236:239], v[112:115], a[48:63]
    v_accvgpr_read_b32 v245, a69
    v_accvgpr_read_b32 v246, a70
    v_accvgpr_read_b32 v247, a71
    v_mul_f32 v240, v240, v12
    v_mul_f32 v241, v241, v12
    v_mul_f32 v242, v242, v12
    v_mul_f32 v243, v243, v12
    v_mul_f32 v244, v244, v12
    v_mul_f32 v245, v245, v12
    v_mul_f32 v246, v246, v12
    v_mul_f32 v247, v247, v12
    v_mfma_f32_32x32x16_bf16 a[112:127], a[236:239], v[120:123], a[112:127]
    v_cvt_pk_bf16_f32 v224, v240, v241
    v_cvt_pk_bf16_f32 v225, v242, v243
    v_cvt_pk_bf16_f32 v226, v244, v245
    v_cvt_pk_bf16_f32 v227, v246, v247
    buffer_store_dwordx4 v[224:227], v1, s[8:11], s84 offen sc1
    v_accvgpr_read_b32 v248, a72
    v_accvgpr_read_b32 v249, a73
    v_accvgpr_read_b32 v250, a74
    s_waitcnt lgkmcnt(0)
    v_mfma_f32_32x32x16_bf16 a[48:63], a[252:255], v[116:119], a[48:63]
    v_accvgpr_read_b32 v251, a75
    v_accvgpr_read_b32 v252, a76
    v_accvgpr_read_b32 v253, a77
    v_accvgpr_read_b32 v254, a78
    v_accvgpr_read_b32 v255, a79
    v_mul_f32 v248, v248, v12
    v_mul_f32 v249, v249, v12
    v_mul_f32 v250, v250, v12
    v_mul_f32 v251, v251, v12
    v_mul_f32 v252, v252, v12
    v_mul_f32 v253, v253, v12
    v_mfma_f32_32x32x16_bf16 a[112:127], a[252:255], v[124:127], a[112:127]
    v_mul_f32 v254, v254, v12
    v_mul_f32 v255, v255, v12
    v_cvt_pk_bf16_f32 v228, v248, v249
    v_cvt_pk_bf16_f32 v229, v250, v251
    v_cvt_pk_bf16_f32 v230, v252, v253
    v_cvt_pk_bf16_f32 v231, v254, v255
    buffer_store_dwordx4 v[228:231], v1, s[8:11], s84 offen offset:1024 sc1
    s_waitcnt vmcnt(16) lgkmcnt(0)
    s_barrier
    ds_read_b128 a[192:195], v2
    ds_read_b128 a[196:199], v2 offset:1024
    ds_read_b128 a[200:203], v2 offset:2048
    ds_read_b128 a[204:207], v2 offset:3072
    ds_read_b128 a[208:211], v2 offset:4096
    ds_read_b128 a[212:215], v2 offset:5120
    ds_read_b128 a[216:219], v2 offset:6144
    ds_read_b128 a[220:223], v2 offset:7168
    s_xor_b32 s24, s23, 0x4000
    s_add_u32 s30, s24, s26
    v_add_u32 v3, s30, v4
    s_add_u32 m0, s91, 0
    s_nop 0
    buffer_load_dwordx4 v1, s[8:11], s87 offen sc1 lds
    buffer_load_dwordx4 v1, s[8:11], s87 offen offset:1024 sc1 lds
    s_add_u32 m0, s91, 0x10000
    s_nop 0
    buffer_load_dwordx4 v1, s[8:11], s88 offen sc1 lds
    buffer_load_dwordx4 v1, s[8:11], s88 offen offset:1024 sc1 lds
    s_add_u32 m0, s92, 0x8000
    s_nop 0
    buffer_load_dwordx4 v1, s[8:11], s89 offen sc1 lds
    buffer_load_dwordx4 v1, s[8:11], s89 offen offset:1024 sc1 lds
    s_add_u32 m0, s92, 0x18000
    s_nop 0
    buffer_load_dwordx4 v1, s[8:11], s90 offen sc1 lds
    buffer_load_dwordx4 v1, s[8:11], s90 offen offset:1024 sc1 lds
    v_accvgpr_read_b32 v240, a16
    v_accvgpr_read_b32 v241, a17
    v_accvgpr_read_b32 v242, a18
    v_accvgpr_read_b32 v243, a19
    v_accvgpr_read_b32 v244, a20
    v_accvgpr_read_b32 v245, a21
    v_accvgpr_read_b32 v246, a22
    v_accvgpr_read_b32 v247, a23
    v_mul_f32 v240, v240, v11
    v_mul_f32 v241, v241, v11
    v_mul_f32 v242, v242, v11
    v_mul_f32 v243, v243, v11
    v_mul_f32 v244, v244, v11
    v_mul_f32 v245, v245, v11
    v_mul_f32 v246, v246, v11
    v_mul_f32 v247, v247, v11
    v_cvt_pk_bf16_f32 v224, v240, v241
    v_cvt_pk_bf16_f32 v225, v242, v243
    v_cvt_pk_bf16_f32 v226, v244, v245
    v_cvt_pk_bf16_f32 v227, v246, v247
    buffer_store_dwordx4 v[224:227], v1, s[8:11], s82 offen offset:2048 sc1
    v_accvgpr_read_b32 v248, a24
    v_accvgpr_read_b32 v249, a25
    v_accvgpr_read_b32 v250, a26
    v_accvgpr_read_b32 v251, a27
    v_accvgpr_read_b32 v252, a28
    v_accvgpr_read_b32 v253, a29
    v_accvgpr_read_b32 v254, a30
    v_accvgpr_read_b32 v255, a31
    v_mul_f32 v248, v248, v11
    v_mul_f32 v249, v249, v11
    v_mul_f32 v250, v250, v11
    v_mul_f32 v251, v251, v11
    v_mul_f32 v252, v252, v11
    v_mul_f32 v253, v253, v11
    v_mul_f32 v254, v254, v11
    v_mul_f32 v255, v255, v11
    v_cvt_pk_bf16_f32 v228, v248, v249
    v_cvt_pk_bf16_f32 v229, v250, v251
    v_cvt_pk_bf16_f32 v230, v252, v253
    v_cvt_pk_bf16_f32 v231, v254, v255
    buffer_store_dwordx4 v[228:231], v1, s[8:11], s82 offen offset:3072 sc1
    v_accvgpr_read_b32 v240, a80
    v_accvgpr_read_b32 v241, a81
    v_accvgpr_read_b32 v242, a82
    v_accvgpr_read_b32 v243, a83
    v_accvgpr_read_b32 v244, a84
    v_accvgpr_read_b32 v245, a85
    v_accvgpr_read_b32 v246, a86
    v_accvgpr_read_b32 v247, a87
    v_mul_f32 v240, v240, v12
    v_mul_f32 v241, v241, v12
    v_mul_f32 v242, v242, v12
    v_mul_f32 v243, v243, v12
    v_mul_f32 v244, v244, v12
    v_mul_f32 v245, v245, v12
    v_mul_f32 v246, v246, v12
    v_mul_f32 v247, v247, v12
    v_cvt_pk_bf16_f32 v224, v240, v241
    v_cvt_pk_bf16_f32 v225, v242, v243
    v_cvt_pk_bf16_f32 v226, v244, v245
    v_cvt_pk_bf16_f32 v227, v246, v247
    buffer_store_dwordx4 v[224:227], v1, s[8:11], s84 offen offset:2048 sc1
    v_accvgpr_read_b32 v248, a88
    v_accvgpr_read_b32 v249, a89
    v_accvgpr_read_b32 v250, a90
    v_accvgpr_read_b32 v251, a91
    v_accvgpr_read_b32 v252, a92
    v_accvgpr_read_b32 v253, a93
    v_accvgpr_read_b32 v254, a94
    v_accvgpr_read_b32 v255, a95
    v_mul_f32 v248, v248, v12
    v_mul_f32 v249, v249, v12
    v_mul_f32 v250, v250, v12
    v_mul_f32 v251, v251, v12
    v_mul_f32 v252, v252, v12
    v_mul_f32 v253, v253, v12
    v_mul_f32 v254, v254, v12
    v_mul_f32 v255, v255, v12
    v_cvt_pk_bf16_f32 v228, v248, v249
    v_cvt_pk_bf16_f32 v229, v250, v251
    v_cvt_pk_bf16_f32 v230, v252, v253
    v_cvt_pk_bf16_f32 v231, v254, v255
    buffer_store_dwordx4 v[228:231], v1, s[8:11], s84 offen offset:3072 sc1
L2_sw2:
    s_waitcnt lgkmcnt(0)
    s_sub_u32 s19, 35, s35
    s_mov_b32 s32, s35
    v_mov_b32 v5, 0
    v_mov_b32 v6, 0
    v_mfma_f32_32x32x16_bf16 v[32:47], a[192:195], a[128:131], v[128:143]
    v_accvgpr_read_b32 v240, a32
    v_accvgpr_read_b32 v241, a33
    v_accvgpr_read_b32 v242, a34
    v_accvgpr_read_b32 v243, a35
    v_accvgpr_read_b32 v244, a36
    v_accvgpr_read_b32 v245, a37
    v_accvgpr_read_b32 v246, a38
    v_accvgpr_read_b32 v247, a39
    v_mfma_f32_32x32x16_bf16 v[48:63], a[192:195], a[160:163], v[144:159]
    v_mul_f32 v240, v240, v11
    v_mul_f32 v241, v241, v11
    v_mul_f32 v242, v242, v11
    v_mul_f32 v243, v243, v11
    v_mul_f32 v244, v244, v11
    v_mul_f32 v245, v245, v11
    v_mul_f32 v246, v246, v11
    v_mul_f32 v247, v247, v11
    v_mfma_f32_32x32x16_bf16 v[32:47], a[196:199], a[132:135], v[32:47]
    v_cvt_pk_bf16_f32 v224, v240, v241
    v_cvt_pk_bf16_f32 v225, v242, v243
    v_cvt_pk_bf16_f32 v226, v244, v245
    v_cvt_pk_bf16_f32 v227, v246, v247
    s_cmp_lt_u32 s15, 31
    s_cselect_b32 s87, s20, 0x40000000
    s_add_u32 s88, s87, s22
    v_add_f32 v5, v5, v9
    v_mfma_f32_32x32x16_bf16 v[48:63], a[196:199], a[164:167], v[48:63]
    buffer_store_dwordx4 v[224:227], v1, s[8:11], s83 offen sc1
    v_accvgpr_read_b32 v248, a40
    v_accvgpr_read_b32 v249, a41
    v_accvgpr_read_b32 v250, a42
    v_mfma_f32_32x32x16_bf16 v[32:47], a[200:203], a[136:139], v[32:47]
    v_accvgpr_read_b32 v251, a43
    v_accvgpr_read_b32 v252, a44
    v_accvgpr_read_b32 v253, a45
    v_accvgpr_read_b32 v254, a46
    v_accvgpr_read_b32 v255, a47
    v_mul_f32 v248, v248, v11
    v_mul_f32 v249, v249, v11
    v_mfma_f32_32x32x16_bf16 v[48:63], a[200:203], a[168:171], v[48:63]
    v_mul_f32 v250, v250, v11
    v_mul_f32 v251, v251, v11
    v_mul_f32 v252, v252, v11
    v_mul_f32 v253, v253, v11
    v_mul_f32 v254, v254, v11
    v_mul_f32 v255, v255, v11
    v_cvt_pk_bf16_f32 v228, v248, v249
    v_cvt_pk_bf16_f32 v229, v250, v251
    v_mfma_f32_32x32x16_bf16 v[32:47], a[204:207], a[140:143], v[32:47]
    v_cvt_pk_bf16_f32 v230, v252, v253
    v_cvt_pk_bf16_f32 v231, v254, v255
    buffer_store_dwordx4 v[228:231], v1, s[8:11], s83 offen offset:1024 sc1
    v_accvgpr_read_b32 v240, a96
    v_mfma_f32_32x32x16_bf16 v[48:63], a[204:207], a[172:175], v[48:63]
    v_accvgpr_read_b32 v241, a97
    v_accvgpr_read_b32 v242, a98
    v_accvgpr_read_b32 v243, a99
    v_accvgpr_read_b32 v244, a100
    v_accvgpr_read_b32 v245, a101
    v_accvgpr_read_b32 v246, a102
    v_accvgpr_read_b32 v247, a103
    v_mfma_f32_32x32x16_bf16 v[32:47], a[208:211], a[144:147], v[32:47]
    v_mul_f32 v240, v240, v12
    v_mul_f32 v241, v241, v12
    v_mul_f32 v242, v242, v12
    v_mul_f32 v243, v243, v12
    v_mul_f32 v244, v244, v12
    v_mul_f32 v245, v245, v12
    v_mul_f32 v246, v246, v12
    v_mul_f32 v247, v247, v12
    v_mfma_f32_32x32x16_bf16 v[48:63], a[208:211], a[176:179], v[48:63]
    v_cvt_pk_bf16_f32 v224, v240, v241
    v_cvt_pk_bf16_f32 v225, v242, v243
    v_cvt_pk_bf16_f32 v226, v244, v245
    v_cvt_pk_bf16_f32 v227, v246, v247
    s_cmp_ge_u32 s15, s33
    s_cselect_b32 s88, s88, 0x40000000
    v_add_f32 v6, v6, v10
    v_mfma_f32_32x32x16_bf16 v[32:47], a[212:215], a[148:151], v[32:47]
    buffer_store_dwordx4 v[224:227], v1, s[8:11], s85 offen sc1
    v_accvgpr_read_b32 v248, a104
    v_accvgpr_read_b32 v249, a105
    v_accvgpr_read_b32 v250, a106
    v_mfma_f32_32x32x16_bf16 v[48:63], a[212:215], a[180:183], v[48:63]
    v_accvgpr_read_b32 v251, a107
    v_accvgpr_read_b32 v252, a108
    v_accvgpr_read_b32 v253, a109
    v_accvgpr_read_b32 v254, a110
    v_accvgpr_read_b32 v255, a111
    v_mul_f32 v248, v248, v12
    v_mul_f32 v249, v249, v12
    v_mul_f32 v250, v250, v12
    v_mfma_f32_32x32x16_bf16 v[32:47], a[216:219], a[152:155], v[32:47]
    s_cmp_lt_u32 s15, 33
    s_cselect_b32 s89, s21, 0x40000000
    s_add_u32 s90, s89, s22
    v_mul_f32 v251, v251, v12
    v_mul_f32 v252, v252, v12
    v_mul_f32 v253, v253, v12
    v_mul_f32 v254, v254, v12
    v_mfma_f32_32x32x16_bf16 v[48:63], a[216:219], a[184:187], v[48:63]
    s_cmp_ge_u32 s15, s16
    s_cselect_b32 s90, s90, 0x40000000
    v_mul_f32 v255, v255, v12
    s_mov_b32 s91, s23
    s_mov_b32 s92, s24
    v_cvt_pk_bf16_f32 v228, v248, v249
    v_mov_b32 v9, 0
    v_cvt_pk_bf16_f32 v229, v250, v251
    v_mfma_f32_32x32x16_bf16 v[32:47], a[220:223], a[156:159], v[32:47]
    v_mov_b32 v10, 0
    s_add_u32 s20, s20, 0x2000
    s_add_u32 s21, s21, 0x2000
    s_add_u32 s15, s15, 1
    v_cvt_pk_bf16_f32 v230, v252, v253
    v_cvt_pk_bf16_f32 v231, v254, v255
    v_mfma_f32_32x32x16_bf16 v[48:63], a[220:223], a[188:191], v[48:63]
    buffer_store_dwordx4 v[228:231], v1, s[8:11], s85 offen offset:1024 sc1
    s_add_u32 s23, s23, 0x2000
    s_and_b32 s23, s23, 0x7fff
    s_add_u32 s30, s23, s25
    v_add_u32 v2, s30, v4
    s_waitcnt vmcnt(16) lgkmcnt(0)
    s_barrier
    ds_read_b128 a[192:195], v2
    ds_read_b128 a[196:199], v2 offset:1024
    ds_read_b128 a[200:203], v2 offset:2048
    ds_read_b128 a[204:207], v2 offset:3072
    ds_read_b128 a[208:211], v2 offset:4096
    ds_read_b128 a[212:215], v2 offset:5120
    ds_read_b128 a[216:219], v2 offset:6144
    ds_read_b128 a[220:223], v2 offset:7168
    s_xor_b32 s24, s23, 0x4000
    s_add_u32 s30, s24, s26
    v_add_u32 v3, s30, v4
    s_add_u32 m0, s91, 0
    s_nop 0
    buffer_load_dwordx4 v1, s[8:11], s87 offen sc1 lds
    buffer_load_dwordx4 v1, s[8:11], s87 offen offset:1024 sc1 lds
    s_add_u32 m0, s91, 0x10000
    s_nop 0
    buffer_load_dwordx4 v1, s[8:11], s88 offen sc1 lds
    buffer_load_dwordx4 v1, s[8:11], s88 offen offset:1024 sc1 lds
    s_add_u32 m0, s92, 0x8000
    s_nop 0
    buffer_load_dwordx4 v1, s[8:11], s89 offen sc1 lds
    buffer_load_dwordx4 v1, s[8:11], s89 offen offset:1024 sc1 lds
    s_add_u32 m0, s92, 0x18000
    s_nop 0
    buffer_load_dwordx4 v1, s[8:11], s90 offen sc1 lds
    buffer_load_dwordx4 v1, s[8:11], s90 offen offset:1024 sc1 lds
    s_cmp_ge_i32 s19, 0
    s_cbranch_scc1 L2_sw2_ms
    L2_sw2_mr:
    s_add_u32 s19, s19, 1
    v_accvgpr_read_b32 v240, a48
    v_accvgpr_read_b32 v241, a49
    v_accvgpr_read_b32 v242, a50
    v_accvgpr_read_b32 v243, a51
    v_accvgpr_read_b32 v244, a52
    v_accvgpr_read_b32 v245, a53
    v_accvgpr_read_b32 v246, a54
    v_accvgpr_read_b32 v247, a55
    v_mul_f32 v240, v240, v11
    v_mul_f32 v241, v241, v11
    v_mul_f32 v242, v242, v11
    v_mul_f32 v243, v243, v11
    v_mul_f32 v244, v244, v11
    v_mul_f32 v245, v245, v11
    v_mul_f32 v246, v246, v11
    v_mul_f32 v247, v247, v11
    v_cvt_pk_bf16_f32 v224, v240, v241
    v_cvt_pk_bf16_f32 v225, v242, v243
    v_cvt_pk_bf16_f32 v226, v244, v245
    v_cvt_pk_bf16_f32 v227, v246, v247
    buffer_store_dwordx4 v[224:227], v1, s[8:11], s83 offen offset:2048 sc1
    v_accvgpr_read_b32 v248, a56
    v_accvgpr_read_b32 v249, a57
    v_accvgpr_read_b32 v250, a58
    v_accvgpr_read_b32 v251, a59
    v_accvgpr_read_b32 v252, a60
    v_accvgpr_read_b32 v253, a61
    v_accvgpr_read_b32 v254, a62
    v_accvgpr_read_b32 v255, a63
    v_mul_f32 v248, v248, v11
    v_mul_f32 v249, v249, v11
    v_mul_f32 v250, v250, v11
    v_mul_f32 v251, v251, v11
    v_mul_f32 v252, v252, v11
    v_mul_f32 v253, v253, v11
    v_mul_f32 v254, v254, v11
    v_mul_f32 v255, v255, v11
    v_cvt_pk_bf16_f32 v228, v248, v249
    v_cvt_pk_bf16_f32 v229, v250, v251
    v_cvt_pk_bf16_f32 v230, v252, v253
    v_cvt_pk_bf16_f32 v231, v254, v255
    buffer_store_dwordx4 v[228:231], v1, s[8:11], s83 offen offset:3072 sc1
    v_accvgpr_read_b32 v240, a112
    v_accvgpr_read_b32 v241, a113
    v_accvgpr_read_b32 v242, a114
    v_accvgpr_read_b32 v243, a115
    v_accvgpr_read_b32 v244, a116
    v_accvgpr_read_b32 v245, a117
    v_accvgpr_read_b32 v246, a118
    v_accvgpr_read_b32 v247, a119
    v_mul_f32 v240, v240, v12
    v_mul_f32 v241, v241, v12
    v_mul_f32 v242, v242, v12
    v_mul_f32 v243, v243, v12
    v_mul_f32 v244, v244, v12
    v_mul_f32 v245, v245, v12
    v_mul_f32 v246, v246, v12
    v_mul_f32 v247, v247, v12
    v_cvt_pk_bf16_f32 v224, v240, v241
    v_cvt_pk_bf16_f32 v225, v242, v243
    v_cvt_pk_bf16_f32 v226, v244, v245
    v_cvt_pk_bf16_f32 v227, v246, v247
    buffer_store_dwordx4 v[224:227], v1, s[8:11], s85 offen offset:2048 sc1
    v_accvgpr_read_b32 v248, a120
    v_accvgpr_read_b32 v249, a121
    v_accvgpr_read_b32 v250, a122
    v_accvgpr_read_b32 v251, a123
    v_accvgpr_read_b32 v252, a124
    v_accvgpr_read_b32 v253, a125
    v_accvgpr_read_b32 v254, a126
    v_accvgpr_read_b32 v255, a127
    v_mul_f32 v248, v248, v12
    v_mul_f32 v249, v249, v12
    v_mul_f32 v250, v250, v12
    v_mul_f32 v251, v251, v12
    v_mul_f32 v252, v252, v12
    v_mul_f32 v253, v253, v12
    v_mul_f32 v254, v254, v12
    v_mul_f32 v255, v255, v12
    v_cvt_pk_bf16_f32 v228, v248, v249
    v_cvt_pk_bf16_f32 v229, v250, v251
    v_cvt_pk_bf16_f32 v230, v252, v253
    v_cvt_pk_bf16_f32 v231, v254, v255
    buffer_store_dwordx4 v[228:231], v1, s[8:11], s85 offen offset:3072 sc1
    s_lshl_b32 s29, s35, 7
    s_add_u32 s29, s29, 0x4c10000
    v_and_b32 v25, 31, v0
    v_lshlrev_b32 v25, 2, v25
    buffer_load_dword v13, v25, s[8:11], s29 offen sc1
    buffer_load_dword v14, v25, s[8:11], s29 offen offset:128 sc1
L2_sw3:
    s_waitcnt lgkmcnt(0)
    s_mov_b32 s37, 1
    s_mov_b32 s94, 0x2b800000
    s_mov_b32 s95, 0x2b800000
    s_cmp_ge_i32 s19, 2
    s_cselect_b32 s94, -1.0, s94
    s_cmp_ge_i32 s19, 3
    s_cselect_b32 s95, -1.0, s95
    s_mov_b32 s26, 0x18000
    s_mov_b32 s36, 36
    v_mfma_f32_32x32x16_bf16 v[64:79], a[192:195], a[128:131], v[128:143]
    v_add_f32 v5, v5, v9
    v_add_f32 v6, v6, v10
    v_exp_f32 v16, v32
    v_exp_f32 v17, v33
    v_exp_f32 v18, v34
    v_add_f32 v9, v16, v17
    v_mfma_f32_32x32x16_bf16 v[80:95], a[192:195], a[160:163], v[144:159]
    v_exp_f32 v19, v35
    v_cvt_pk_bf16_f32 v96, v16, v17
    v_exp_f32 v20, v36
    v_add_f32 v9, v9, v18
    v_exp_f32 v21, v37
    v_add_f32 v9, v9, v19
    v_mfma_f32_32x32x16_bf16 v[64:79], a[196:199], a[132:135], v[64:79]
    v_cvt_pk_bf16_f32 v97, v18, v19
    v_exp_f32 v22, v38
    v_add_f32 v9, v9, v20
    v_exp_f32 v23, v39
    v_add_f32 v9, v9, v21
    v_cvt_pk_bf16_f32 v98, v20, v21
    v_mfma_f32_32x32x16_bf16 v[80:95], a[196:199], a[164:167], v[80:95]
    v_exp_f32 v16, v48
    v_add_f32 v9, v9, v22
    v_exp_f32 v17, v49
    v_add_f32 v9, v9, v23
    v_cvt_pk_bf16_f32 v99, v22, v23
    v_exp_f32 v18, v50
    v_mfma_f32_32x32x16_bf16 v[64:79], a[200:203], a[136:139], v[64:79]
    v_add_f32 v10, v16, v17
    v_exp_f32 v19, v51
    v_cvt_pk_bf16_f32 v104, v16, v17
    v_exp_f32 v20, v52
    v_add_f32 v10, v10, v18
    v_exp_f32 v21, v53
    v_mfma_f32_32x32x16_bf16 v[80:95], a[200:203], a[168:171], v[80:95]
    v_add_f32 v10, v10, v19
    v_cvt_pk_bf16_f32 v105, v18, v19
    v_exp_f32 v22, v54
    v_add_f32 v10, v10, v20
    v_exp_f32 v23, v55
    v_add_f32 v10, v10, v21
    v_cvt_pk_bf16_f32 v106, v20, v21
    v_mfma_f32_32x32x16_bf16 v[64:79], a[204:207], a[140:143], v[64:79]
    v_exp_f32 v16, v40
    v_add_f32 v10, v10, v22
    v_exp_f32 v17, v41
    v_add_f32 v10, v10, v23
    v_cvt_pk_bf16_f32 v107, v22, v23
    v_exp_f32 v18, v42
    v_mfma_f32_32x32x16_bf16 v[80:95], a[204:207], a[172:175], v[80:95]
    v_add_f32 v9, v9, v16
    v_exp_f32 v19, v43
    v_add_f32 v9, v9, v17
    v_cvt_pk_bf16_f32 v100, v16, v17
    v_exp_f32 v20, v44
    v_add_f32 v9, v9, v18
    v_mfma_f32_32x32x16_bf16 v[64:79], a[208:211], a[144:147], v[64:79]
    s_cmp_lt_u32 s15, 31
    s_cselect_b32 s87, s20, 0x40000000
    s_add_u32 s88, s87, s22
    v_exp_f32 v21, v45
    s_cmp_ge_u32 s15, s33
    s_cselect_b32 s88, s88, 0x40000000
    v_add_f32 v9, v9, v19
    v_cvt_pk_bf16_f32 v101, v18, v19
    v_mfma_f32_32x32x16_bf16 v[80:95], a[208:211], a[176:179], v[80:95]
    s_cmp_lt_u32 s15, 33
    s_cselect_b32 s89, s21, 0x40000000
    s_add_u32 s90, s89, s22
    v_exp_f32 v22, v46
    s_cmp_ge_u32 s15, s16
    s_cselect_b32 s90, s90, 0x40000000
    v_add_f32 v9, v9, v20
    v_mfma_f32_32x32x16_bf16 v[64:79], a[212:215], a[148:151], v[64:79]
    v_exp_f32 v23, v47
    s_mov_b32 s91, s23
    s_mov_b32 s92, s24
    s_add_u32 s20, s20, 0x2000
    s_add_u32 s21, s21, 0x2000
    s_add_u32 s15, s15, 1
    v_add_f32 v9, v9, v21
    v_cvt_pk_bf16_f32 v102, v20, v21
    v_mfma_f32_32x32x16_bf16 v[80:95], a[212:215], a[180:183], v[80:95]
    v_exp_f32 v16, v56
    s_add_u32 s23, s23, 0x2000
    s_and_b32 s23, s23, 0x7fff
    s_add_u32 s30, s23, s25
    v_add_u32 v2, s30, v4
    v_add_f32 v9, v9, v22
    v_exp_f32 v17, v57
    v_mfma_f32_32x32x16_bf16 v[64:79], a[216:219], a[152:155], v[64:79]
    v_add_f32 v9, v9, v23
    v_cvt_pk_bf16_f32 v103, v22, v23
    v_exp_f32 v18, v58
    v_add_f32 v10, v10, v16
    v_exp_f32 v19, v59
    v_add_f32 v10, v10, v17
    v_cvt_pk_bf16_f32 v108, v16, v17
    v_mfma_f32_32x32x16_bf16 v[80:95], a[216:219], a[184:187], v[80:95]
    v_exp_f32 v20, v60
    v_add_f32 v10, v10, v18
    v_exp_f32 v21, v61
    v_add_f32 v10, v10, v19
    v_cvt_pk_bf16_f32 v109, v18, v19
    v_exp_f32 v22, v62
    v_mfma_f32_32x32x16_bf16 v[64:79], a[220:223], a[156:159], v[64:79]
    v_add_f32 v10, v10, v20
    v_exp_f32 v23, v63
    v_add_f32 v10, v10, v21
    v_cvt_pk_bf16_f32 v110, v20, v21
    v_add_f32 v10, v10, v22
    v_add_f32 v10, v10, v23
    v_cvt_pk_bf16_f32 v111, v22, v23
    v_max_f32 v24, v9, v10
    v_mfma_f32_32x32x16_bf16 v[80:95], a[220:223], a[188:191], v[80:95]
    v_cmp_lt_f32 vcc, s86, v24
    v_mov_b32 v25, v9
    v_mov_b32 v28, v25
    s_nop 1
    v_permlane32_swap_b32 v28, v25
    v_add_f32 v25, v25, v28
    v_cmp_gt_f32 s[40:41], s94, v25
    s_waitcnt vmcnt(16) lgkmcnt(0)
    s_barrier
    v_mfma_f32_32x32x16_bf16 a[0:15], v[236:239], v[236:239], 0
    s_xor_b32 s24, s23, 0x4000
    s_add_u32 s30, s24, s26
    v_add_u32 v3, s30, v4
    s_add_u32 m0, s91, 0
    s_nop 0
    buffer_load_dwordx4 v1, s[8:11], s87 offen sc1 lds
    v_mfma_f32_32x32x16_bf16 a[16:31], v[236:239], v[236:239], 0
    buffer_load_dwordx4 v1, s[8:11], s87 offen offset:1024 sc1 lds
    ds_read_b128 a[192:195], v2
    ds_read_b128 a[196:199], v2 offset:1024
    s_or_b64 vcc, vcc, s[40:41]
    v_mfma_f32_32x32x16_bf16 a[32:47], v[236:239], v[236:239], 0
    ds_read_b128 a[200:203], v2 offset:2048
    s_add_u32 m0, s91, 0x10000
    s_nop 0
    buffer_load_dwordx4 v1, s[8:11], s88 offen sc1 lds
    v_mov_b32 v26, v10
    v_mfma_f32_32x32x16_bf16 a[48:63], v[236:239], v[236:239], 0
    ds_read_b128 a[204:207], v2 offset:3072
    ds_read_b128 a[208:211], v2 offset:4096
    v_mov_b32 v29, v26
    s_cmp_ge_i32 s19, 0
    s_cbranch_scc1 L2_sw3_ms
    L2_sw3_mr:
    s_add_u32 s19, s19, 1
    v_mfma_f32_32x32x16_bf16 a[64:79], v[236:239], v[236:239], 0
    ds_read_b128 a[212:215], v2 offset:5120
    ds_read_b128 a[216:219], v2 offset:6144
    ds_read_b128 a[220:223], v2 offset:7168
    v_permlane32_swap_b32 v29, v26
    v_add_f32 v26, v26, v29
    v_mfma_f32_32x32x16_bf16 a[80:95], v[236:239], v[236:239], 0
    buffer_load_dwordx4 v1, s[8:11], s88 offen offset:1024 sc1 lds
    v_cmp_gt_f32 s[40:41], s95, v26
    s_nop 0
    s_or_b64 vcc, vcc, s[40:41]
    v_mfma_f32_32x32x16_bf16 a[96:111], v[236:239], v[236:239], 0
    s_add_u32 m0, s92, 0x8000
    s_nop 0
    buffer_load_dwordx4 v1, s[8:11], s89 offen sc1 lds
    buffer_load_dwordx4 v1, s[8:11], s89 offen offset:1024 sc1 lds
    v_mfma_f32_32x32x16_bf16 a[112:127], v[236:239], v[236:239], 0
    s_add_u32 m0, s92, 0x18000
    s_nop 0
    buffer_load_dwordx4 v1, s[8:11], s90 offen sc1 lds
    buffer_load_dwordx4 v1, s[8:11], s90 offen offset:1024 sc1 lds
    s_cbranch_vccnz L2_sw3_ss
    L2_sw3_sr:
    s_mov_b32 s37, 0
    s_cmp_lg_u32 s15, 36
    s_cbranch_scc1 L2_g0
L2_tail:
    s_mul_i32 s82, s32, 0x4e000
    s_lshl_b32 s83, s13, 13
    s_add_u32 s82, s82, s83
    s_add_u32 s82, s82, 0x3000000
    s_add_u32 s83, s82, 0x1000
    s_add_u32 s84, s82, 0x4e000
    s_add_u32 s85, s83, 0x4e000
    v_add_f32 v5, v5, v9
    v_add_f32 v6, v6, v10
    s_lshl_b32 s27, s2, 8
    s_add_u32 s27, s27, 0x4e10000
    buffer_load_dword v148, v236, s[8:11], s27 offen sc1
    ds_read_b128 a[224:227], v3
    ds_read_b128 a[240:243], v3 offset:4096
    ds_read_b128 a[228:231], v3 offset:1024
    ds_read_b128 a[244:247], v3 offset:5120
    ds_read_b128 a[232:235], v3 offset:2048
    ds_read_b128 a[248:251], v3 offset:6144
    ds_read_b128 a[236:239], v3 offset:3072
    ds_read_b128 a[252:255], v3 offset:7168
    v_mov_b32 v28, v5
    s_nop 1
    v_permlane32_swap_b32 v28, v5
    v_add_f32 v5, v5, v28
    v_mov_b32 v29, v6
    s_nop 1
    v_permlane32_swap_b32 v29, v6
    v_add_f32 v6, v6, v29
    s_lshl_b32 s27, s34, 14
    s_lshl_b32 s28, s17, 16
    s_add_u32 s27, s27, s28
    s_xor_b32 s28, s27, 0x10000
    v_add_u32 v16, s27, v1
    v_add_u32 v17, s28, v1
    s_lshl_b32 s27, s12, 10
    s_add_u32 s27, s27, 0x20000
    s_xor_b32 s28, s27, 0x800
    v_add_u32 v18, s27, v1
    v_add_u32 v19, s28, v1
    v_mov_b32 v24, 0xf149f2ca
    v_cmp_eq_f32 vcc, 0, v5
    s_nop 1
    v_cndmask_b32 v7, v7, v24, vcc
    v_cmp_eq_f32 vcc, 0, v6
    s_nop 1
    v_cndmask_b32 v8, v8, v24, vcc
    v_mov_b32 v20, v7
    v_mov_b32 v21, v8
    v_mov_b32 v22, v5
    v_mov_b32 v23, v6
    s_waitcnt vmcnt(0) lgkmcnt(0)
    s_barrier
    ds_write_b128 v18, v[20:23]
    s_cmp_eq_u32 s17, 1
    s_cbranch_scc1 L2_finA
L2_finB:
    v_mfma_f32_32x32x16_bf16 a[32:47], a[232:235], v[96:99], a[32:47]
    v_mfma_f32_32x32x16_bf16 a[96:111], a[232:235], v[104:107], a[96:111]
    v_mfma_f32_32x32x16_bf16 a[32:47], a[248:251], v[100:103], a[32:47]
    v_mfma_f32_32x32x16_bf16 a[96:111], a[248:251], v[108:111], a[96:111]
    v_mfma_f32_32x32x16_bf16 a[48:63], a[236:239], v[96:99], a[48:63]
    v_mfma_f32_32x32x16_bf16 a[112:127], a[236:239], v[104:107], a[112:127]
    v_mfma_f32_32x32x16_bf16 a[48:63], a[252:255], v[100:103], a[48:63]
    s_nop 7
    ds_write_b128 v16, a[32:35]
    ds_write_b128 v16, a[36:39] offset:1024
    ds_write_b128 v16, a[40:43] offset:2048
    v_mfma_f32_32x32x16_bf16 a[112:127], a[252:255], v[108:111], a[112:127]
    ds_write_b128 v16, a[44:47] offset:3072
    ds_write_b128 v16, a[96:99] offset:8192
    ds_write_b128 v16, a[100:103] offset:9216
    v_mfma_f32_32x32x16_bf16 a[0:15], a[224:227], v[96:99], a[0:15]
    ds_write_b128 v16, a[104:107] offset:10240
    ds_write_b128 v16, a[108:111] offset:11264
    v_mfma_f32_32x32x16_bf16 a[64:79], a[224:227], v[104:107], a[64:79]
    v_mfma_f32_32x32x16_bf16 a[0:15], a[240:243], v[100:103], a[0:15]
    ds_write_b128 v16, a[48:51] offset:4096
    ds_write_b128 v16, a[52:55] offset:5120
    ds_write_b128 v16, a[56:59] offset:6144
    v_mfma_f32_32x32x16_bf16 a[64:79], a[240:243], v[108:111], a[64:79]
    ds_write_b128 v16, a[60:63] offset:7168
    ds_write_b128 v16, a[112:115] offset:12288
    ds_write_b128 v16, a[116:119] offset:13312
    v_mfma_f32_32x32x16_bf16 a[16:31], a[228:231], v[96:99], a[16:31]
    ds_write_b128 v16, a[120:123] offset:14336
    ds_write_b128 v16, a[124:127] offset:15360
    v_mfma_f32_32x32x16_bf16 a[80:95], a[228:231], v[104:107], a[80:95]
    v_mfma_f32_32x32x16_bf16 a[16:31], a[244:247], v[100:103], a[16:31]
    v_mfma_f32_32x32x16_bf16 a[80:95], a[244:247], v[108:111], a[80:95]
    s_waitcnt lgkmcnt(0)
    s_barrier
    ds_read_b128 v[20:23], v19
    ds_read_b128 v[160:163], v17
    ds_read_b128 v[164:167], v17 offset:1024
    ds_read_b128 v[168:171], v17 offset:2048
    ds_read_b128 v[172:175], v17 offset:3072
    ds_read_b128 v[176:179], v17 offset:4096
    ds_read_b128 v[180:183], v17 offset:5120
    ds_read_b128 v[184:187], v17 offset:6144
    ds_read_b128 v[188:191], v17 offset:7168
    ds_read_b128 v[192:195], v17 offset:8192
    ds_read_b128 v[196:199], v17 offset:9216
    ds_read_b128 v[200:203], v17 offset:10240
    ds_read_b128 v[204:207], v17 offset:11264
    ds_read_b128 v[208:211], v17 offset:12288
    ds_read_b128 v[212:215], v17 offset:13312
    ds_read_b128 v[216:219], v17 offset:14336
    ds_read_b128 v[220:223], v17 offset:15360
    s_waitcnt lgkmcnt(15)
    v_max_f32 v28, v7, v20
    v_sub_f32 v24, v7, v28
    v_sub_f32 v26, v20, v28
    v_exp_f32 v24, v24
    v_exp_f32 v26, v26
    v_mul_f32 v28, v5, v24
    v_fmac_f32 v28, v22, v26
    v_rcp_f32 v28, v28
    s_nop 0
    v_mul_f32 v28, v28, v13
    v_mul_f32 v24, v24, v28
    v_mul_f32 v26, v26, v28
    v_max_f32 v29, v8, v21
    v_sub_f32 v25, v8, v29
    v_sub_f32 v27, v21, v29
    v_exp_f32 v25, v25
    v_exp_f32 v27, v27
    v_mul_f32 v29, v6, v25
    v_fmac_f32 v29, v23, v27
    v_rcp_f32 v29, v29
    s_nop 0
    v_mul_f32 v29, v29, v14
    v_mul_f32 v25, v25, v29
    v_mul_f32 v27, v27, v29
    v_accvgpr_read_b32 v240, a0
    v_accvgpr_read_b32 v241, a1
    v_accvgpr_read_b32 v242, a2
    v_accvgpr_read_b32 v243, a3
    v_accvgpr_read_b32 v244, a4
    v_accvgpr_read_b32 v245, a5
    v_accvgpr_read_b32 v246, a6
    v_accvgpr_read_b32 v247, a7
    v_mul_f32 v240, v240, v24
    v_mul_f32 v241, v241, v24
    v_mul_f32 v242, v242, v24
    v_mul_f32 v243, v243, v24
    v_mul_f32 v244, v244, v24
    v_mul_f32 v245, v245, v24
    v_mul_f32 v246, v246, v24
    v_mul_f32 v247, v247, v24
    v_fmac_f32 v240, v160, v26
    v_fmac_f32 v241, v161, v26
    v_fmac_f32 v242, v162, v26
    v_fmac_f32 v243, v163, v26
    s_waitcnt lgkmcnt(14)
    v_fmac_f32 v244, v164, v26
    v_fmac_f32 v245, v165, v26
    v_fmac_f32 v246, v166, v26
    v_fmac_f32 v247, v167, v26
    v_cvt_pk_bf16_f32 v224, v240, v241
    v_cvt_pk_bf16_f32 v225, v242, v243
    v_cvt_pk_bf16_f32 v226, v244, v245
    v_cvt_pk_bf16_f32 v227, v246, v247
    buffer_store_dwordx4 v[224:227], v1, s[8:11], s82 offen sc1
    v_accvgpr_read_b32 v248, a8
    v_accvgpr_read_b32 v249, a9
    v_accvgpr_read_b32 v250, a10
    v_accvgpr_read_b32 v251, a11
    v_accvgpr_read_b32 v252, a12
    v_accvgpr_read_b32 v253, a13
    v_accvgpr_read_b32 v254, a14
    v_accvgpr_read_b32 v255, a15
    v_mul_f32 v248, v248, v24
    v_mul_f32 v249, v249, v24
    v_mul_f32 v250, v250, v24
    v_mul_f32 v251, v251, v24
    v_mul_f32 v252, v252, v24
    v_mul_f32 v253, v253, v24
    v_mul_f32 v254, v254, v24
    v_mul_f32 v255, v255, v24
    s_waitcnt lgkmcnt(13)
    v_fmac_f32 v248, v168, v26
    v_fmac_f32 v249, v169, v26
    v_fmac_f32 v250, v170, v26
    v_fmac_f32 v251, v171, v26
    s_waitcnt lgkmcnt(12)
    v_fmac_f32 v252, v172, v26
    v_fmac_f32 v253, v173, v26
    v_fmac_f32 v254, v174, v26
    v_fmac_f32 v255, v175, v26
    v_cvt_pk_bf16_f32 v228, v248, v249
    v_cvt_pk_bf16_f32 v229, v250, v251
    v_cvt_pk_bf16_f32 v230, v252, v253
    v_cvt_pk_bf16_f32 v231, v254, v255
    buffer_store_dwordx4 v[228:231], v1, s[8:11], s82 offen offset:1024 sc1
    v_accvgpr_read_b32 v240, a16
    v_accvgpr_read_b32 v241, a17
    v_accvgpr_read_b32 v242, a18
    v_accvgpr_read_b32 v243, a19
    v_accvgpr_read_b32 v244, a20
    v_accvgpr_read_b32 v245, a21
    v_accvgpr_read_b32 v246, a22
    v_accvgpr_read_b32 v247, a23
    v_mul_f32 v240, v240, v24
    v_mul_f32 v241, v241, v24
    v_mul_f32 v242, v242, v24
    v_mul_f32 v243, v243, v24
    v_mul_f32 v244, v244, v24
    v_mul_f32 v245, v245, v24
    v_mul_f32 v246, v246, v24
    v_mul_f32 v247, v247, v24
    s_waitcnt lgkmcnt(11)
    v_fmac_f32 v240, v176, v26
    v_fmac_f32 v241, v177, v26
    v_fmac_f32 v242, v178, v26
    v_fmac_f32 v243, v179, v26
    s_waitcnt lgkmcnt(10)
    v_fmac_f32 v244, v180, v26
    v_fmac_f32 v245, v181, v26
    v_fmac_f32 v246, v182, v26
    v_fmac_f32 v247, v183, v26
    v_cvt_pk_bf16_f32 v224, v240, v241
    v_cvt_pk_bf16_f32 v225, v242, v243
    v_cvt_pk_bf16_f32 v226, v244, v245
    v_cvt_pk_bf16_f32 v227, v246, v247
    buffer_store_dwordx4 v[224:227], v1, s[8:11], s82 offen offset:2048 sc1
    v_accvgpr_read_b32 v248, a24
    v_accvgpr_read_b32 v249, a25
    v_accvgpr_read_b32 v250, a26
    v_accvgpr_read_b32 v251, a27
    v_accvgpr_read_b32 v252, a28
    v_accvgpr_read_b32 v253, a29
    v_accvgpr_read_b32 v254, a30
    v_accvgpr_read_b32 v255, a31
    v_mul_f32 v248, v248, v24
    v_mul_f32 v249, v249, v24
    v_mul_f32 v250, v250, v24
    v_mul_f32 v251, v251, v24
    v_mul_f32 v252, v252, v24
    v_mul_f32 v253, v253, v24
    v_mul_f32 v254, v254, v24
    v_mul_f32 v255, v255, v24
    s_waitcnt lgkmcnt(9)
    v_fmac_f32 v248, v184, v26
    v_fmac_f32 v249, v185, v26
    v_fmac_f32 v250, v186, v26
    v_fmac_f32 v251, v187, v26
    s_waitcnt lgkmcnt(8)
    v_fmac_f32 v252, v188, v26
    v_fmac_f32 v253, v189, v26
    v_fmac_f32 v254, v190, v26
    v_fmac_f32 v255, v191, v26
    v_cvt_pk_bf16_f32 v228, v248, v249
    v_cvt_pk_bf16_f32 v229, v250, v251
    v_cvt_pk_bf16_f32 v230, v252, v253
    v_cvt_pk_bf16_f32 v231, v254, v255
    buffer_store_dwordx4 v[228:231], v1, s[8:11], s82 offen offset:3072 sc1
    v_accvgpr_read_b32 v240, a64
    v_accvgpr_read_b32 v241, a65
    v_accvgpr_read_b32 v242, a66
    v_accvgpr_read_b32 v243, a67
    v_accvgpr_read_b32 v244, a68
    v_accvgpr_read_b32 v245, a69
    v_accvgpr_read_b32 v246, a70
    v_accvgpr_read_b32 v247, a71
    v_mul_f32 v240, v240, v25
    v_mul_f32 v241, v241, v25
    v_mul_f32 v242, v242, v25
    v_mul_f32 v243, v243, v25
    v_mul_f32 v244, v244, v25
    v_mul_f32 v245, v245, v25
    v_mul_f32 v246, v246, v25
    v_mul_f32 v247, v247, v25
    s_waitcnt lgkmcnt(7)
    v_fmac_f32 v240, v192, v27
    v_fmac_f32 v241, v193, v27
    v_fmac_f32 v242, v194, v27
    v_fmac_f32 v243, v195, v27
    s_waitcnt lgkmcnt(6)
    v_fmac_f32 v244, v196, v27
    v_fmac_f32 v245, v197, v27
    v_fmac_f32 v246, v198, v27
    v_fmac_f32 v247, v199, v27
    v_cvt_pk_bf16_f32 v224, v240, v241
    v_cvt_pk_bf16_f32 v225, v242, v243
    v_cvt_pk_bf16_f32 v226, v244, v245
    v_cvt_pk_bf16_f32 v227, v246, v247
    buffer_store_dwordx4 v[224:227], v1, s[8:11], s84 offen sc1
    v_accvgpr_read_b32 v248, a72
    v_accvgpr_read_b32 v249, a73
    v_accvgpr_read_b32 v250, a74
    v_accvgpr_read_b32 v251, a75
    v_accvgpr_read_b32 v252, a76
    v_accvgpr_read_b32 v253, a77
    v_accvgpr_read_b32 v254, a78
    v_accvgpr_read_b32 v255, a79
    v_mul_f32 v248, v248, v25
    v_mul_f32 v249, v249, v25
    v_mul_f32 v250, v250, v25
    v_mul_f32 v251, v251, v25
    v_mul_f32 v252, v252, v25
    v_mul_f32 v253, v253, v25
    v_mul_f32 v254, v254, v25
    v_mul_f32 v255, v255, v25
    s_waitcnt lgkmcnt(5)
    v_fmac_f32 v248, v200, v27
    v_fmac_f32 v249, v201, v27
    v_fmac_f32 v250, v202, v27
    v_fmac_f32 v251, v203, v27
    s_waitcnt lgkmcnt(4)
    v_fmac_f32 v252, v204, v27
    v_fmac_f32 v253, v205, v27
    v_fmac_f32 v254, v206, v27
    v_fmac_f32 v255, v207, v27
    v_cvt_pk_bf16_f32 v228, v248, v249
    v_cvt_pk_bf16_f32 v229, v250, v251
    v_cvt_pk_bf16_f32 v230, v252, v253
    v_cvt_pk_bf16_f32 v231, v254, v255
    buffer_store_dwordx4 v[228:231], v1, s[8:11], s84 offen offset:1024 sc1
    v_accvgpr_read_b32 v240, a80
    v_accvgpr_read_b32 v241, a81
    v_accvgpr_read_b32 v242, a82
    v_accvgpr_read_b32 v243, a83
    v_accvgpr_read_b32 v244, a84
    v_accvgpr_read_b32 v245, a85
    v_accvgpr_read_b32 v246, a86
    v_accvgpr_read_b32 v247, a87
    v_mul_f32 v240, v240, v25
    v_mul_f32 v241, v241, v25
    v_mul_f32 v242, v242, v25
    v_mul_f32 v243, v243, v25
    v_mul_f32 v244, v244, v25
    v_mul_f32 v245, v245, v25
    v_mul_f32 v246, v246, v25
    v_mul_f32 v247, v247, v25
    s_waitcnt lgkmcnt(3)
    v_fmac_f32 v240, v208, v27
    v_fmac_f32 v241, v209, v27
    v_fmac_f32 v242, v210, v27
    v_fmac_f32 v243, v211, v27
    s_waitcnt lgkmcnt(2)
    v_fmac_f32 v244, v212, v27
    v_fmac_f32 v245, v213, v27
    v_fmac_f32 v246, v214, v27
    v_fmac_f32 v247, v215, v27
    v_cvt_pk_bf16_f32 v224, v240, v241
    v_cvt_pk_bf16_f32 v225, v242, v243
    v_cvt_pk_bf16_f32 v226, v244, v245
    v_cvt_pk_bf16_f32 v227, v246, v247
    buffer_store_dwordx4 v[224:227], v1, s[8:11], s84 offen offset:2048 sc1
    v_accvgpr_read_b32 v248, a88
    v_accvgpr_read_b32 v249, a89
    v_accvgpr_read_b32 v250, a90
    v_accvgpr_read_b32 v251, a91
    v_accvgpr_read_b32 v252, a92
    v_accvgpr_read_b32 v253, a93
    v_accvgpr_read_b32 v254, a94
    v_accvgpr_read_b32 v255, a95
    v_mul_f32 v248, v248, v25
    v_mul_f32 v249, v249, v25
    v_mul_f32 v250, v250, v25
    v_mul_f32 v251, v251, v25
    v_mul_f32 v252, v252, v25
    v_mul_f32 v253, v253, v25
    v_mul_f32 v254, v254, v25
    v_mul_f32 v255, v255, v25
    s_waitcnt lgkmcnt(1)
    v_fmac_f32 v248, v216, v27
    v_fmac_f32 v249, v217, v27
    v_fmac_f32 v250, v218, v27
    v_fmac_f32 v251, v219, v27
    s_waitcnt lgkmcnt(0)
    v_fmac_f32 v252, v220, v27
    v_fmac_f32 v253, v221, v27
    v_fmac_f32 v254, v222, v27
    v_fmac_f32 v255, v223, v27
    v_cvt_pk_bf16_f32 v228, v248, v249
    v_cvt_pk_bf16_f32 v229, v250, v251
    v_cvt_pk_bf16_f32 v230, v252, v253
    v_cvt_pk_bf16_f32 v231, v254, v255
    buffer_store_dwordx4 v[228:231], v1, s[8:11], s84 offen offset:3072 sc1
    s_branch L2_end
L2_finA:
    v_mfma_f32_32x32x16_bf16 a[0:15], a[224:227], v[96:99], a[0:15]
    v_mfma_f32_32x32x16_bf16 a[64:79], a[224:227], v[104:107], a[64:79]
    v_mfma_f32_32x32x16_bf16 a[0:15], a[240:243], v[100:103], a[0:15]
    v_mfma_f32_32x32x16_bf16 a[64:79], a[240:243], v[108:111], a[64:79]
    v_mfma_f32_32x32x16_bf16 a[16:31], a[228:231], v[96:99], a[16:31]
    v_mfma_f32_32x32x16_bf16 a[80:95], a[228:231], v[104:107], a[80:95]
    v_mfma_f32_32x32x16_bf16 a[16:31], a[244:247], v[100:103], a[16:31]
    s_nop 7
    ds_write_b128 v16, a[0:3]
    ds_write_b128 v16, a[4:7] offset:1024
    ds_write_b128 v16, a[8:11] offset:2048
    v_mfma_f32_32x32x16_bf16 a[80:95], a[244:247], v[108:111], a[80:95]
    ds_write_b128 v16, a[12:15] offset:3072
    ds_write_b128 v16, a[64:67] offset:8192
    ds_write_b128 v16, a[68:71] offset:9216
    v_mfma_f32_32x32x16_bf16 a[32:47], a[232:235], v[96:99], a[32:47]
    ds_write_b128 v16, a[72:75] offset:10240
    ds_write_b128 v16, a[76:79] offset:11264
    v_mfma_f32_32x32x16_bf16 a[96:111], a[232:235], v[104:107], a[96:111]
    v_mfma_f32_32x32x16_bf16 a[32:47], a[248:251], v[100:103], a[32:47]
    ds_write_b128 v16, a[16:19] offset:4096
    ds_write_b128 v16, a[20:23] offset:5120
    ds_write_b128 v16, a[24:27] offset:6144
    v_mfma_f32_32x32x16_bf16 a[96:111], a[248:251], v[108:111], a[96:111]
    ds_write_b128 v16, a[28:31] offset:7168
    ds_write_b128 v16, a[80:83] offset:12288
    ds_write_b128 v16, a[84:87] offset:13312
    v_mfma_f32_32x32x16_bf16 a[48:63], a[236:239], v[96:99], a[48:63]
    ds_write_b128 v16, a[88:91] offset:14336
    ds_write_b128 v16, a[92:95] offset:15360
    v_mfma_f32_32x32x16_bf16 a[112:127], a[236:239], v[104:107], a[112:127]
    v_mfma_f32_32x32x16_bf16 a[48:63], a[252:255], v[100:103], a[48:63]
    v_mfma_f32_32x32x16_bf16 a[112:127], a[252:255], v[108:111], a[112:127]
    s_waitcnt lgkmcnt(0)
    s_barrier
    ds_read_b128 v[20:23], v19
    ds_read_b128 v[160:163], v17
    ds_read_b128 v[164:167], v17 offset:1024
    ds_read_b128 v[168:171], v17 offset:2048
    ds_read_b128 v[172:175], v17 offset:3072
    ds_read_b128 v[176:179], v17 offset:4096
    ds_read_b128 v[180:183], v17 offset:5120
    ds_read_b128 v[184:187], v17 offset:6144
    ds_read_b128 v[188:191], v17 offset:7168
    ds_read_b128 v[192:195], v17 offset:8192
    ds_read_b128 v[196:199], v17 offset:9216
    ds_read_b128 v[200:203], v17 offset:10240
    ds_read_b128 v[204:207], v17 offset:11264
    ds_read_b128 v[208:211], v17 offset:12288
    ds_read_b128 v[212:215], v17 offset:13312
    ds_read_b128 v[216:219], v17 offset:14336
    ds_read_b128 v[220:223], v17 offset:15360
    s_waitcnt lgkmcnt(15)
    v_max_f32 v28, v7, v20
    v_sub_f32 v24, v7, v28
    v_sub_f32 v26, v20, v28
    v_exp_f32 v24, v24
    v_exp_f32 v26, v26
    v_mul_f32 v28, v5, v24
    v_fmac_f32 v28, v22, v26
    v_rcp_f32 v28, v28
    s_nop 0
    v_mul_f32 v28, v28, v13
    v_mul_f32 v24, v24, v28
    v_mul_f32 v26, v26, v28
    v_max_f32 v29, v8, v21
    v_sub_f32 v25, v8, v29
    v_sub_f32 v27, v21, v29
    v_exp_f32 v25, v25
    v_exp_f32 v27, v27
    v_mul_f32 v29, v6, v25
    v_fmac_f32 v29, v23, v27
    v_rcp_f32 v29, v29
    s_nop 0
    v_mul_f32 v29, v29, v14
    v_mul_f32 v25, v25, v29
    v_mul_f32 v27, v27, v29
    v_accvgpr_read_b32 v240, a32
    v_accvgpr_read_b32 v241, a33
    v_accvgpr_read_b32 v242, a34
    v_accvgpr_read_b32 v243, a35
    v_accvgpr_read_b32 v244, a36
    v_accvgpr_read_b32 v245, a37
    v_accvgpr_read_b32 v246, a38
    v_accvgpr_read_b32 v247, a39
    v_mul_f32 v240, v240, v24
    v_mul_f32 v241, v241, v24
    v_mul_f32 v242, v242, v24
    v_mul_f32 v243, v243, v24
    v_mul_f32 v244, v244, v24
    v_mul_f32 v245, v245, v24
    v_mul_f32 v246, v246, v24
    v_mul_f32 v247, v247, v24
    v_fmac_f32 v240, v160, v26
    v_fmac_f32 v241, v161, v26
    v_fmac_f32 v242, v162, v26
    v_fmac_f32 v243, v163, v26
    s_waitcnt lgkmcnt(14)
    v_fmac_f32 v244, v164, v26
    v_fmac_f32 v245, v165, v26
    v_fmac_f32 v246, v166, v26
    v_fmac_f32 v247, v167, v26
    v_cvt_pk_bf16_f32 v224, v240, v241
    v_cvt_pk_bf16_f32 v225, v242, v243
    v_cvt_pk_bf16_f32 v226, v244, v245
    v_cvt_pk_bf16_f32 v227, v246, v247
    buffer_store_dwordx4 v[224:227], v1, s[8:11], s83 offen sc1
    v_accvgpr_read_b32 v248, a40
    v_accvgpr_read_b32 v249, a41
    v_accvgpr_read_b32 v250, a42
    v_accvgpr_read_b32 v251, a43
    v_accvgpr_read_b32 v252, a44
    v_accvgpr_read_b32 v253, a45
    v_accvgpr_read_b32 v254, a46
    v_accvgpr_read_b32 v255, a47
    v_mul_f32 v248, v248, v24
    v_mul_f32 v249, v249, v24
    v_mul_f32 v250, v250, v24
    v_mul_f32 v251, v251, v24
    v_mul_f32 v252, v252, v24
    v_mul_f32 v253, v253, v24
    v_mul_f32 v254, v254, v24
    v_mul_f32 v255, v255, v24
    s_waitcnt lgkmcnt(13)
    v_fmac_f32 v248, v168, v26
    v_fmac_f32 v249, v169, v26
    v_fmac_f32 v250, v170, v26
    v_fmac_f32 v251, v171, v26
    s_waitcnt lgkmcnt(12)
    v_fmac_f32 v252, v172, v26
    v_fmac_f32 v253, v173, v26
    v_fmac_f32 v254, v174, v26
    v_fmac_f32 v255, v175, v26
    v_cvt_pk_bf16_f32 v228, v248, v249
    v_cvt_pk_bf16_f32 v229, v250, v251
    v_cvt_pk_bf16_f32 v230, v252, v253
    v_cvt_pk_bf16_f32 v231, v254, v255
    buffer_store_dwordx4 v[228:231], v1, s[8:11], s83 offen offset:1024 sc1
    v_accvgpr_read_b32 v240, a48
    v_accvgpr_read_b32 v241, a49
    v_accvgpr_read_b32 v242, a50
    v_accvgpr_read_b32 v243, a51
    v_accvgpr_read_b32 v244, a52
    v_accvgpr_read_b32 v245, a53
    v_accvgpr_read_b32 v246, a54
    v_accvgpr_read_b32 v247, a55
    v_mul_f32 v240, v240, v24
    v_mul_f32 v241, v241, v24
    v_mul_f32 v242, v242, v24
    v_mul_f32 v243, v243, v24
    v_mul_f32 v244, v244, v24
    v_mul_f32 v245, v245, v24
    v_mul_f32 v246, v246, v24
    v_mul_f32 v247, v247, v24
    s_waitcnt lgkmcnt(11)
    v_fmac_f32 v240, v176, v26
    v_fmac_f32 v241, v177, v26
    v_fmac_f32 v242, v178, v26
    v_fmac_f32 v243, v179, v26
    s_waitcnt lgkmcnt(10)
    v_fmac_f32 v244, v180, v26
    v_fmac_f32 v245, v181, v26
    v_fmac_f32 v246, v182, v26
    v_fmac_f32 v247, v183, v26
    v_cvt_pk_bf16_f32 v224, v240, v241
    v_cvt_pk_bf16_f32 v225, v242, v243
    v_cvt_pk_bf16_f32 v226, v244, v245
    v_cvt_pk_bf16_f32 v227, v246, v247
    buffer_store_dwordx4 v[224:227], v1, s[8:11], s83 offen offset:2048 sc1
    v_accvgpr_read_b32 v248, a56
    v_accvgpr_read_b32 v249, a57
    v_accvgpr_read_b32 v250, a58
    v_accvgpr_read_b32 v251, a59
    v_accvgpr_read_b32 v252, a60
    v_accvgpr_read_b32 v253, a61
    v_accvgpr_read_b32 v254, a62
    v_accvgpr_read_b32 v255, a63
    v_mul_f32 v248, v248, v24
    v_mul_f32 v249, v249, v24
    v_mul_f32 v250, v250, v24
    v_mul_f32 v251, v251, v24
    v_mul_f32 v252, v252, v24
    v_mul_f32 v253, v253, v24
    v_mul_f32 v254, v254, v24
    v_mul_f32 v255, v255, v24
    s_waitcnt lgkmcnt(9)
    v_fmac_f32 v248, v184, v26
    v_fmac_f32 v249, v185, v26
    v_fmac_f32 v250, v186, v26
    v_fmac_f32 v251, v187, v26
    s_waitcnt lgkmcnt(8)
    v_fmac_f32 v252, v188, v26
    v_fmac_f32 v253, v189, v26
    v_fmac_f32 v254, v190, v26
    v_fmac_f32 v255, v191, v26
    v_cvt_pk_bf16_f32 v228, v248, v249
    v_cvt_pk_bf16_f32 v229, v250, v251
    v_cvt_pk_bf16_f32 v230, v252, v253
    v_cvt_pk_bf16_f32 v231, v254, v255
    buffer_store_dwordx4 v[228:231], v1, s[8:11], s83 offen offset:3072 sc1
    v_accvgpr_read_b32 v240, a96
    v_accvgpr_read_b32 v241, a97
    v_accvgpr_read_b32 v242, a98
    v_accvgpr_read_b32 v243, a99
    v_accvgpr_read_b32 v244, a100
    v_accvgpr_read_b32 v245, a101
    v_accvgpr_read_b32 v246, a102
    v_accvgpr_read_b32 v247, a103
    v_mul_f32 v240, v240, v25
    v_mul_f32 v241, v241, v25
    v_mul_f32 v242, v242, v25
    v_mul_f32 v243, v243, v25
    v_mul_f32 v244, v244, v25
    v_mul_f32 v245, v245, v25
    v_mul_f32 v246, v246, v25
    v_mul_f32 v247, v247, v25
    s_waitcnt lgkmcnt(7)
    v_fmac_f32 v240, v192, v27
    v_fmac_f32 v241, v193, v27
    v_fmac_f32 v242, v194, v27
    v_fmac_f32 v243, v195, v27
    s_waitcnt lgkmcnt(6)
    v_fmac_f32 v244, v196, v27
    v_fmac_f32 v245, v197, v27
    v_fmac_f32 v246, v198, v27
    v_fmac_f32 v247, v199, v27
    v_cvt_pk_bf16_f32 v224, v240, v241
    v_cvt_pk_bf16_f32 v225, v242, v243
    v_cvt_pk_bf16_f32 v226, v244, v245
    v_cvt_pk_bf16_f32 v227, v246, v247
    buffer_store_dwordx4 v[224:227], v1, s[8:11], s85 offen sc1
    v_accvgpr_read_b32 v248, a104
    v_accvgpr_read_b32 v249, a105
    v_accvgpr_read_b32 v250, a106
    v_accvgpr_read_b32 v251, a107
    v_accvgpr_read_b32 v252, a108
    v_accvgpr_read_b32 v253, a109
    v_accvgpr_read_b32 v254, a110
    v_accvgpr_read_b32 v255, a111
    v_mul_f32 v248, v248, v25
    v_mul_f32 v249, v249, v25
    v_mul_f32 v250, v250, v25
    v_mul_f32 v251, v251, v25
    v_mul_f32 v252, v252, v25
    v_mul_f32 v253, v253, v25
    v_mul_f32 v254, v254, v25
    v_mul_f32 v255, v255, v25
    s_waitcnt lgkmcnt(5)
    v_fmac_f32 v248, v200, v27
    v_fmac_f32 v249, v201, v27
    v_fmac_f32 v250, v202, v27
    v_fmac_f32 v251, v203, v27
    s_waitcnt lgkmcnt(4)
    v_fmac_f32 v252, v204, v27
    v_fmac_f32 v253, v205, v27
    v_fmac_f32 v254, v206, v27
    v_fmac_f32 v255, v207, v27
    v_cvt_pk_bf16_f32 v228, v248, v249
    v_cvt_pk_bf16_f32 v229, v250, v251
    v_cvt_pk_bf16_f32 v230, v252, v253
    v_cvt_pk_bf16_f32 v231, v254, v255
    buffer_store_dwordx4 v[228:231], v1, s[8:11], s85 offen offset:1024 sc1
    v_accvgpr_read_b32 v240, a112
    v_accvgpr_read_b32 v241, a113
    v_accvgpr_read_b32 v242, a114
    v_accvgpr_read_b32 v243, a115
    v_accvgpr_read_b32 v244, a116
    v_accvgpr_read_b32 v245, a117
    v_accvgpr_read_b32 v246, a118
    v_accvgpr_read_b32 v247, a119
    v_mul_f32 v240, v240, v25
    v_mul_f32 v241, v241, v25
    v_mul_f32 v242, v242, v25
    v_mul_f32 v243, v243, v25
    v_mul_f32 v244, v244, v25
    v_mul_f32 v245, v245, v25
    v_mul_f32 v246, v246, v25
    v_mul_f32 v247, v247, v25
    s_waitcnt lgkmcnt(3)
    v_fmac_f32 v240, v208, v27
    v_fmac_f32 v241, v209, v27
    v_fmac_f32 v242, v210, v27
    v_fmac_f32 v243, v211, v27
    s_waitcnt lgkmcnt(2)
    v_fmac_f32 v244, v212, v27
    v_fmac_f32 v245, v213, v27
    v_fmac_f32 v246, v214, v27
    v_fmac_f32 v247, v215, v27
    v_cvt_pk_bf16_f32 v224, v240, v241
    v_cvt_pk_bf16_f32 v225, v242, v243
    v_cvt_pk_bf16_f32 v226, v244, v245
    v_cvt_pk_bf16_f32 v227, v246, v247
    buffer_store_dwordx4 v[224:227], v1, s[8:11], s85 offen offset:2048 sc1
    v_accvgpr_read_b32 v248, a120
    v_accvgpr_read_b32 v249, a121
    v_accvgpr_read_b32 v250, a122
    v_accvgpr_read_b32 v251, a123
    v_accvgpr_read_b32 v252, a124
    v_accvgpr_read_b32 v253, a125
    v_accvgpr_read_b32 v254, a126
    v_accvgpr_read_b32 v255, a127
    v_mul_f32 v248, v248, v25
    v_mul_f32 v249, v249, v25
    v_mul_f32 v250, v250, v25
    v_mul_f32 v251, v251, v25
    v_mul_f32 v252, v252, v25
    v_mul_f32 v253, v253, v25
    v_mul_f32 v254, v254, v25
    v_mul_f32 v255, v255, v25
    s_waitcnt lgkmcnt(1)
    v_fmac_f32 v248, v216, v27
    v_fmac_f32 v249, v217, v27
    v_fmac_f32 v250, v218, v27
    v_fmac_f32 v251, v219, v27
    s_waitcnt lgkmcnt(0)
    v_fmac_f32 v252, v220, v27
    v_fmac_f32 v253, v221, v27
    v_fmac_f32 v254, v222, v27
    v_fmac_f32 v255, v223, v27
    v_cvt_pk_bf16_f32 v228, v248, v249
    v_cvt_pk_bf16_f32 v229, v250, v251
    v_cvt_pk_bf16_f32 v230, v252, v253
    v_cvt_pk_bf16_f32 v231, v254, v255
    buffer_store_dwordx4 v[228:231], v1, s[8:11], s85 offen offset:3072 sc1
    s_branch L2_end
L2_c1_spin:
    s_sleep 4
    s_lshl_b32 s27, s2, 8
    s_add_u32 s27, s27, 0x4e00000
    buffer_load_dword v10, v15, s[8:11], s27 offen sc1
    s_waitcnt vmcnt(0)
    s_branch L2_c1
L2_c2_spin:
    s_sleep 4
    s_lshl_b32 s27, s2, 8
    s_add_u32 s27, s27, 0x4e10000
    buffer_load_dword v148, v236, s[8:11], s27 offen sc1
    s_waitcnt vmcnt(0)
    s_branch L2_c2
L2_e0_bc:
    v_lshlrev_b32 v9, 8, v0
    v_mov_b32 v11, 1
    s_mov_b32 s27, 0x4e00000
    buffer_store_dword v11, v9, s[8:11], s27 offen sc1
    s_add_u32 s27, s27, 0x4000
    buffer_store_dword v11, v9, s[8:11], s27 offen sc1
    s_add_u32 s27, s27, 0x4000
    buffer_store_dword v11, v9, s[8:11], s27 offen sc1
    s_add_u32 s27, s27, 0x4000
    buffer_store_dword v11, v9, s[8:11], s27 offen sc1
    s_add_u32 s27, s27, 0x4000
    s_branch L2_e0_bcr
L2_e1_bc:
    v_lshlrev_b32 v234, 8, v0
    v_mov_b32 v235, 1
    s_mov_b32 s27, 0x4e10000
    buffer_store_dword v235, v234, s[8:11], s27 offen sc1
    s_add_u32 s27, s27, 0x4000
    buffer_store_dword v235, v234, s[8:11], s27 offen sc1
    s_add_u32 s27, s27, 0x4000
    buffer_store_dword v235, v234, s[8:11], s27 offen sc1
    s_add_u32 s27, s27, 0x4000
    buffer_store_dword v235, v234, s[8:11], s27 offen sc1
    s_add_u32 s27, s27, 0x4000
    s_branch L2_e1_bcr
L2_e1b_bc:
    v_lshlrev_b32 v234, 8, v0
    v_mov_b32 v235, 1
    s_mov_b32 s27, 0x4e10000
    buffer_store_dword v235, v234, s[8:11], s27 offen sc1
    s_add_u32 s27, s27, 0x4000
    buffer_store_dword v235, v234, s[8:11], s27 offen sc1
    s_add_u32 s27, s27, 0x4000
    buffer_store_dword v235, v234, s[8:11], s27 offen sc1
    s_add_u32 s27, s27, 0x4000
    buffer_store_dword v235, v234, s[8:11], s27 offen sc1
    s_add_u32 s27, s27, 0x4000
    s_branch L2_e1b_bcr
L2_tr0:
    s_waitcnt vmcnt(0)
    v_readfirstlane_b32 s27, v235
    s_nop 0
    s_cmp_eq_u32 s27, 0xff
    s_cbranch_scc1 L2_e1b_bc
    L2_e1b_bcr:
    s_branch L2_tr
L2_h0_ms:
    s_call_b64 s[74:75], L2_mask0
    s_branch L2_h0_mr
L2_h1_ms:
    s_call_b64 s[74:75], L2_mask1
    s_branch L2_h1_mr
L2_h1_ss:
    s_call_b64 s[74:75], L2_slow1
    s_branch L2_h1_sr
L2_s0_ms:
    s_call_b64 s[74:75], L2_mask0
    s_branch L2_s0_mr
L2_s0_ss:
    s_call_b64 s[74:75], L2_slow0
    s_branch L2_s0_sr
L2_s1_ms:
    s_call_b64 s[74:75], L2_mask1
    s_branch L2_s1_mr
L2_s1_ss:
    s_call_b64 s[74:75], L2_slow1
    s_branch L2_s1_sr
L2_g0_ms:
    s_call_b64 s[74:75], L2_mask0
    s_branch L2_g0_mr
L2_g0_ss:
    s_call_b64 s[74:75], L2_slow0
    s_branch L2_g0_sr
L2_g1_ms:
    s_call_b64 s[74:75], L2_mask1
    s_branch L2_g1_mr
L2_g1_ss:
    s_call_b64 s[74:75], L2_slow1
    s_branch L2_g1_sr
L2_sw0_ss:
    s_call_b64 s[74:75], L2_slow0
    s_branch L2_sw0_sr
L2_sw2_ms:
    s_call_b64 s[74:75], L2_mask0
    s_branch L2_sw2_mr
L2_sw3_ms:
    s_call_b64 s[74:75], L2_mask1
    s_branch L2_sw3_mr
L2_sw3_ss:
    s_call_b64 s[74:75], L2_slow1
    s_branch L2_sw3_sr
L2_mask0:
    s_nop 11
    s_cmp_eq_u32 s19, 0
    s_cbranch_scc1 L2_maskA0
L2_mask20:
    v_mov_b32 v32, v15
    v_mov_b32 v33, v15
    v_mov_b32 v34, v15
    v_mov_b32 v35, v15
    v_mov_b32 v36, v15
    v_mov_b32 v37, v15
    v_mov_b32 v38, v15
    v_mov_b32 v39, v15
    v_mov_b32 v40, v15
    v_mov_b32 v41, v15
    v_mov_b32 v42, v15
    v_mov_b32 v43, v15
    v_mov_b32 v44, v15
    v_mov_b32 v45, v15
    v_mov_b32 v46, v15
    v_mov_b32 v47, v15
    s_cmp_eq_u32 s19, 1
    s_cbranch_scc1 L2_maskB0
L2_maskC0:
    v_mov_b32 v48, v15
    v_mov_b32 v49, v15
    v_mov_b32 v50, v15
    v_mov_b32 v51, v15
    v_mov_b32 v52, v15
    v_mov_b32 v53, v15
    v_mov_b32 v54, v15
    v_mov_b32 v55, v15
    v_mov_b32 v56, v15
    v_mov_b32 v57, v15
    v_mov_b32 v58, v15
    v_mov_b32 v59, v15
    v_mov_b32 v60, v15
    v_mov_b32 v61, v15
    v_mov_b32 v62, v15
    v_mov_b32 v63, v15
    s_setpc_b64 s[74:75]
L2_maskA0:
    v_cndmask_b32 v32, v32, v15, s[42:43]
    v_cndmask_b32 v33, v33, v15, s[44:45]
    v_cndmask_b32 v34, v34, v15, s[46:47]
    v_cndmask_b32 v35, v35, v15, s[48:49]
    v_cndmask_b32 v36, v36, v15, s[50:51]
    v_cndmask_b32 v37, v37, v15, s[52:53]
    v_cndmask_b32 v38, v38, v15, s[54:55]
    v_cndmask_b32 v39, v39, v15, s[56:57]
    v_cndmask_b32 v40, v40, v15, s[58:59]
    v_cndmask_b32 v41, v41, v15, s[60:61]
    v_cndmask_b32 v42, v42, v15, s[62:63]
    v_cndmask_b32 v43, v43, v15, s[64:65]
    v_cndmask_b32 v44, v44, v15, s[66:67]
    v_cndmask_b32 v45, v45, v15, s[68:69]
    v_cndmask_b32 v46, v46, v15, s[70:71]
    v_cndmask_b32 v47, v47, v15, s[72:73]
    s_setpc_b64 s[74:75]
L2_maskB0:
    v_cndmask_b32 v48, v48, v15, s[42:43]
    v_cndmask_b32 v49, v49, v15, s[44:45]
    v_cndmask_b32 v50, v50, v15, s[46:47]
    v_cndmask_b32 v51, v51, v15, s[48:49]
    v_cndmask_b32 v52, v52, v15, s[50:51]
    v_cndmask_b32 v53, v53, v15, s[52:53]
    v_cndmask_b32 v54, v54, v15, s[54:55]
    v_cndmask_b32 v55, v55, v15, s[56:57]
    v_cndmask_b32 v56, v56, v15, s[58:59]
    v_cndmask_b32 v57, v57, v15, s[60:61]
    v_cndmask_b32 v58, v58, v15, s[62:63]
    v_cndmask_b32 v59, v59, v15, s[64:65]
    v_cndmask_b32 v60, v60, v15, s[66:67]
    v_cndmask_b32 v61, v61, v15, s[68:69]
    v_cndmask_b32 v62, v62, v15, s[70:71]
    v_cndmask_b32 v63, v63, v15, s[72:73]
    s_setpc_b64 s[74:75]
L2_slow0:
    s_nop 15
    v_max3_f32 v24, v64, v65, v66
    v_max3_f32 v24, v24, v67, v68
    v_max3_f32 v24, v24, v69, v70
    v_max3_f32 v24, v24, v71, v72
    v_max3_f32 v24, v24, v73, v74
    v_max3_f32 v24, v24, v75, v76
    v_max3_f32 v24, v24, v77, v78
    v_max_f32 v24, v24, v79
    v_max3_f32 v25, v80, v81, v82
    v_max3_f32 v25, v25, v83, v84
    v_max3_f32 v25, v25, v85, v86
    v_max3_f32 v25, v25, v87, v88
    v_max3_f32 v25, v25, v89, v90
    v_max3_f32 v25, v25, v91, v92
    v_max3_f32 v25, v25, v93, v94
    v_max_f32 v25, v25, v95
    v_mov_b32 v28, v24
    s_nop 1
    v_permlane32_swap_b32 v28, v24
    v_max_f32 v24, v24, v28
    v_mov_b32 v29, v25
    s_nop 1
    v_permlane32_swap_b32 v29, v25
    v_max_f32 v25, v25, v29
    s_mov_b32 s27, 0
    s_cmp_eq_u32 s37, 1
    s_cselect_b32 s27, 0xf149f2ca, s27
    v_max_f32 v24, s27, v24
    v_max_f32 v26, 0, v24
    v_sub_f32 v26, 0, v26
    v_exp_f32 v26, v26
    v_add_f32 v7, v7, v24
    v_sub_f32 v64, v64, v24
    v_sub_f32 v32, v32, v24
    v_sub_f32 v128, v128, v24
    v_sub_f32 v65, v65, v24
    v_sub_f32 v33, v33, v24
    v_sub_f32 v129, v129, v24
    v_sub_f32 v66, v66, v24
    v_sub_f32 v34, v34, v24
    v_sub_f32 v130, v130, v24
    v_sub_f32 v67, v67, v24
    v_sub_f32 v35, v35, v24
    v_sub_f32 v131, v131, v24
    v_sub_f32 v68, v68, v24
    v_sub_f32 v36, v36, v24
    v_sub_f32 v132, v132, v24
    v_sub_f32 v69, v69, v24
    v_sub_f32 v37, v37, v24
    v_sub_f32 v133, v133, v24
    v_sub_f32 v70, v70, v24
    v_sub_f32 v38, v38, v24
    v_sub_f32 v134, v134, v24
    v_sub_f32 v71, v71, v24
    v_sub_f32 v39, v39, v24
    v_sub_f32 v135, v135, v24
    v_sub_f32 v72, v72, v24
    v_sub_f32 v40, v40, v24
    v_sub_f32 v136, v136, v24
    v_sub_f32 v73, v73, v24
    v_sub_f32 v41, v41, v24
    v_sub_f32 v137, v137, v24
    v_sub_f32 v74, v74, v24
    v_sub_f32 v42, v42, v24
    v_sub_f32 v138, v138, v24
    v_sub_f32 v75, v75, v24
    v_sub_f32 v43, v43, v24
    v_sub_f32 v139, v139, v24
    v_sub_f32 v76, v76, v24
    v_sub_f32 v44, v44, v24
    v_sub_f32 v140, v140, v24
    v_sub_f32 v77, v77, v24
    v_sub_f32 v45, v45, v24
    v_sub_f32 v141, v141, v24
    v_sub_f32 v78, v78, v24
    v_sub_f32 v46, v46, v24
    v_sub_f32 v142, v142, v24
    v_sub_f32 v79, v79, v24
    v_sub_f32 v47, v47, v24
    v_sub_f32 v143, v143, v24
    v_mul_f32 v5, v5, v26
    v_max_f32 v25, s27, v25
    v_max_f32 v27, 0, v25
    v_sub_f32 v27, 0, v27
    v_exp_f32 v27, v27
    v_add_f32 v8, v8, v25
    v_sub_f32 v80, v80, v25
    v_sub_f32 v48, v48, v25
    v_sub_f32 v144, v144, v25
    v_sub_f32 v81, v81, v25
    v_sub_f32 v49, v49, v25
    v_sub_f32 v145, v145, v25
    v_sub_f32 v82, v82, v25
    v_sub_f32 v50, v50, v25
    v_sub_f32 v146, v146, v25
    v_sub_f32 v83, v83, v25
    v_sub_f32 v51, v51, v25
    v_sub_f32 v147, v147, v25
    v_sub_f32 v84, v84, v25
    v_sub_f32 v52, v52, v25
    v_sub_f32 v148, v148, v25
    v_sub_f32 v85, v85, v25
    v_sub_f32 v53, v53, v25
    v_sub_f32 v149, v149, v25
    v_sub_f32 v86, v86, v25
    v_sub_f32 v54, v54, v25
    v_sub_f32 v150, v150, v25
    v_sub_f32 v87, v87, v25
    v_sub_f32 v55, v55, v25
    v_sub_f32 v151, v151, v25
    v_sub_f32 v88, v88, v25
    v_sub_f32 v56, v56, v25
    v_sub_f32 v152, v152, v25
    v_sub_f32 v89, v89, v25
    v_sub_f32 v57, v57, v25
    v_sub_f32 v153, v153, v25
    v_sub_f32 v90, v90, v25
    v_sub_f32 v58, v58, v25
    v_sub_f32 v154, v154, v25
    v_sub_f32 v91, v91, v25
    v_sub_f32 v59, v59, v25
    v_sub_f32 v155, v155, v25
    v_sub_f32 v92, v92, v25
    v_sub_f32 v60, v60, v25
    v_sub_f32 v156, v156, v25
    v_sub_f32 v93, v93, v25
    v_sub_f32 v61, v61, v25
    v_sub_f32 v157, v157, v25
    v_sub_f32 v94, v94, v25
    v_sub_f32 v62, v62, v25
    v_sub_f32 v158, v158, v25
    v_sub_f32 v95, v95, v25
    v_sub_f32 v63, v63, v25
    v_sub_f32 v159, v159, v25
    v_mul_f32 v6, v6, v27
    v_accvgpr_read_b32 v160, a0
    v_accvgpr_read_b32 v161, a1
    v_accvgpr_read_b32 v162, a2
    v_accvgpr_read_b32 v163, a3
    v_accvgpr_read_b32 v164, a4
    v_accvgpr_read_b32 v165, a5
    v_accvgpr_read_b32 v166, a6
    v_accvgpr_read_b32 v167, a7
    v_accvgpr_read_b32 v168, a8
    v_accvgpr_read_b32 v169, a9
    v_accvgpr_read_b32 v170, a10
    v_accvgpr_read_b32 v171, a11
    v_accvgpr_read_b32 v172, a12
    v_accvgpr_read_b32 v173, a13
    v_accvgpr_read_b32 v174, a14
    v_accvgpr_read_b32 v175, a15
    v_mul_f32 v160, v160, v26
    v_mul_f32 v161, v161, v26
    v_mul_f32 v162, v162, v26
    v_mul_f32 v163, v163, v26
    v_mul_f32 v164, v164, v26
    v_mul_f32 v165, v165, v26
    v_mul_f32 v166, v166, v26
    v_mul_f32 v167, v167, v26
    v_mul_f32 v168, v168, v26
    v_mul_f32 v169, v169, v26
    v_mul_f32 v170, v170, v26
    v_mul_f32 v171, v171, v26
    v_mul_f32 v172, v172, v26
    v_mul_f32 v173, v173, v26
    v_mul_f32 v174, v174, v26
    v_mul_f32 v175, v175, v26
    v_accvgpr_write_b32 a0, v160
    v_accvgpr_write_b32 a1, v161
    v_accvgpr_write_b32 a2, v162
    v_accvgpr_write_b32 a3, v163
    v_accvgpr_write_b32 a4, v164
    v_accvgpr_write_b32 a5, v165
    v_accvgpr_write_b32 a6, v166
    v_accvgpr_write_b32 a7, v167
    v_accvgpr_write_b32 a8, v168
    v_accvgpr_write_b32 a9, v169
    v_accvgpr_write_b32 a10, v170
    v_accvgpr_write_b32 a11, v171
    v_accvgpr_write_b32 a12, v172
    v_accvgpr_write_b32 a13, v173
    v_accvgpr_write_b32 a14, v174
    v_accvgpr_write_b32 a15, v175
    v_accvgpr_read_b32 v160, a16
    v_accvgpr_read_b32 v161, a17
    v_accvgpr_read_b32 v162, a18
    v_accvgpr_read_b32 v163, a19
    v_accvgpr_read_b32 v164, a20
    v_accvgpr_read_b32 v165, a21
    v_accvgpr_read_b32 v166, a22
    v_accvgpr_read_b32 v167, a23
    v_accvgpr_read_b32 v168, a24
    v_accvgpr_read_b32 v169, a25
    v_accvgpr_read_b32 v170, a26
    v_accvgpr_read_b32 v171, a27
    v_accvgpr_read_b32 v172, a28
    v_accvgpr_read_b32 v173, a29
    v_accvgpr_read_b32 v174, a30
    v_accvgpr_read_b32 v175, a31
    v_mul_f32 v160, v160, v26
    v_mul_f32 v161, v161, v26
    v_mul_f32 v162, v162, v26
    v_mul_f32 v163, v163, v26
    v_mul_f32 v164, v164, v26
    v_mul_f32 v165, v165, v26
    v_mul_f32 v166, v166, v26
    v_mul_f32 v167, v167, v26
    v_mul_f32 v168, v168, v26
    v_mul_f32 v169, v169, v26
    v_mul_f32 v170, v170, v26
    v_mul_f32 v171, v171, v26
    v_mul_f32 v172, v172, v26
    v_mul_f32 v173, v173, v26
    v_mul_f32 v174, v174, v26
    v_mul_f32 v175, v175, v26
    v_accvgpr_write_b32 a16, v160
    v_accvgpr_write_b32 a17, v161
    v_accvgpr_write_b32 a18, v162
    v_accvgpr_write_b32 a19, v163
    v_accvgpr_write_b32 a20, v164
    v_accvgpr_write_b32 a21, v165
    v_accvgpr_write_b32 a22, v166
    v_accvgpr_write_b32 a23, v167
    v_accvgpr_write_b32 a24, v168
    v_accvgpr_write_b32 a25, v169
    v_accvgpr_write_b32 a26, v170
    v_accvgpr_write_b32 a27, v171
    v_accvgpr_write_b32 a28, v172
    v_accvgpr_write_b32 a29, v173
    v_accvgpr_write_b32 a30, v174
    v_accvgpr_write_b32 a31, v175
    v_accvgpr_read_b32 v160, a32
    v_accvgpr_read_b32 v161, a33
    v_accvgpr_read_b32 v162, a34
    v_accvgpr_read_b32 v163, a35
    v_accvgpr_read_b32 v164, a36
    v_accvgpr_read_b32 v165, a37
    v_accvgpr_read_b32 v166, a38
    v_accvgpr_read_b32 v167, a39
    v_accvgpr_read_b32 v168, a40
    v_accvgpr_read_b32 v169, a41
    v_accvgpr_read_b32 v170, a42
    v_accvgpr_read_b32 v171, a43
    v_accvgpr_read_b32 v172, a44
    v_accvgpr_read_b32 v173, a45
    v_accvgpr_read_b32 v174, a46
    v_accvgpr_read_b32 v175, a47
    v_mul_f32 v160, v160, v26
    v_mul_f32 v161, v161, v26
    v_mul_f32 v162, v162, v26
    v_mul_f32 v163, v163, v26
    v_mul_f32 v164, v164, v26
    v_mul_f32 v165, v165, v26
    v_mul_f32 v166, v166, v26
    v_mul_f32 v167, v167, v26
    v_mul_f32 v168, v168, v26
    v_mul_f32 v169, v169, v26
    v_mul_f32 v170, v170, v26
    v_mul_f32 v171, v171, v26
    v_mul_f32 v172, v172, v26
    v_mul_f32 v173, v173, v26
    v_mul_f32 v174, v174, v26
    v_mul_f32 v175, v175, v26
    v_accvgpr_write_b32 a32, v160
    v_accvgpr_write_b32 a33, v161
    v_accvgpr_write_b32 a34, v162
    v_accvgpr_write_b32 a35, v163
    v_accvgpr_write_b32 a36, v164
    v_accvgpr_write_b32 a37, v165
    v_accvgpr_write_b32 a38, v166
    v_accvgpr_write_b32 a39, v167
    v_accvgpr_write_b32 a40, v168
    v_accvgpr_write_b32 a41, v169
    v_accvgpr_write_b32 a42, v170
    v_accvgpr_write_b32 a43, v171
    v_accvgpr_write_b32 a44, v172
    v_accvgpr_write_b32 a45, v173
    v_accvgpr_write_b32 a46, v174
    v_accvgpr_write_b32 a47, v175
    v_accvgpr_read_b32 v160, a48
    v_accvgpr_read_b32 v161, a49
    v_accvgpr_read_b32 v162, a50
    v_accvgpr_read_b32 v163, a51
    v_accvgpr_read_b32 v164, a52
    v_accvgpr_read_b32 v165, a53
    v_accvgpr_read_b32 v166, a54
    v_accvgpr_read_b32 v167, a55
    v_accvgpr_read_b32 v168, a56
    v_accvgpr_read_b32 v169, a57
    v_accvgpr_read_b32 v170, a58
    v_accvgpr_read_b32 v171, a59
    v_accvgpr_read_b32 v172, a60
    v_accvgpr_read_b32 v173, a61
    v_accvgpr_read_b32 v174, a62
    v_accvgpr_read_b32 v175, a63
    v_mul_f32 v160, v160, v26
    v_mul_f32 v161, v161, v26
    v_mul_f32 v162, v162, v26
    v_mul_f32 v163, v163, v26
    v_mul_f32 v164, v164, v26
    v_mul_f32 v165, v165, v26
    v_mul_f32 v166, v166, v26
    v_mul_f32 v167, v167, v26
    v_mul_f32 v168, v168, v26
    v_mul_f32 v169, v169, v26
    v_mul_f32 v170, v170, v26
    v_mul_f32 v171, v171, v26
    v_mul_f32 v172, v172, v26
    v_mul_f32 v173, v173, v26
    v_mul_f32 v174, v174, v26
    v_mul_f32 v175, v175, v26
    v_accvgpr_write_b32 a48, v160
    v_accvgpr_write_b32 a49, v161
    v_accvgpr_write_b32 a50, v162
    v_accvgpr_write_b32 a51, v163
    v_accvgpr_write_b32 a52, v164
    v_accvgpr_write_b32 a53, v165
    v_accvgpr_write_b32 a54, v166
    v_accvgpr_write_b32 a55, v167
    v_accvgpr_write_b32 a56, v168
    v_accvgpr_write_b32 a57, v169
    v_accvgpr_write_b32 a58, v170
    v_accvgpr_write_b32 a59, v171
    v_accvgpr_write_b32 a60, v172
    v_accvgpr_write_b32 a61, v173
    v_accvgpr_write_b32 a62, v174
    v_accvgpr_write_b32 a63, v175
    v_accvgpr_read_b32 v160, a64
    v_accvgpr_read_b32 v161, a65
    v_accvgpr_read_b32 v162, a66
    v_accvgpr_read_b32 v163, a67
    v_accvgpr_read_b32 v164, a68
    v_accvgpr_read_b32 v165, a69
    v_accvgpr_read_b32 v166, a70
    v_accvgpr_read_b32 v167, a71
    v_accvgpr_read_b32 v168, a72
    v_accvgpr_read_b32 v169, a73
    v_accvgpr_read_b32 v170, a74
    v_accvgpr_read_b32 v171, a75
    v_accvgpr_read_b32 v172, a76
    v_accvgpr_read_b32 v173, a77
    v_accvgpr_read_b32 v174, a78
    v_accvgpr_read_b32 v175, a79
    v_mul_f32 v160, v160, v27
    v_mul_f32 v161, v161, v27
    v_mul_f32 v162, v162, v27
    v_mul_f32 v163, v163, v27
    v_mul_f32 v164, v164, v27
    v_mul_f32 v165, v165, v27
    v_mul_f32 v166, v166, v27
    v_mul_f32 v167, v167, v27
    v_mul_f32 v168, v168, v27
    v_mul_f32 v169, v169, v27
    v_mul_f32 v170, v170, v27
    v_mul_f32 v171, v171, v27
    v_mul_f32 v172, v172, v27
    v_mul_f32 v173, v173, v27
    v_mul_f32 v174, v174, v27
    v_mul_f32 v175, v175, v27
    v_accvgpr_write_b32 a64, v160
    v_accvgpr_write_b32 a65, v161
    v_accvgpr_write_b32 a66, v162
    v_accvgpr_write_b32 a67, v163
    v_accvgpr_write_b32 a68, v164
    v_accvgpr_write_b32 a69, v165
    v_accvgpr_write_b32 a70, v166
    v_accvgpr_write_b32 a71, v167
    v_accvgpr_write_b32 a72, v168
    v_accvgpr_write_b32 a73, v169
    v_accvgpr_write_b32 a74, v170
    v_accvgpr_write_b32 a75, v171
    v_accvgpr_write_b32 a76, v172
    v_accvgpr_write_b32 a77, v173
    v_accvgpr_write_b32 a78, v174
    v_accvgpr_write_b32 a79, v175
    v_accvgpr_read_b32 v160, a80
    v_accvgpr_read_b32 v161, a81
    v_accvgpr_read_b32 v162, a82
    v_accvgpr_read_b32 v163, a83
    v_accvgpr_read_b32 v164, a84
    v_accvgpr_read_b32 v165, a85
    v_accvgpr_read_b32 v166, a86
    v_accvgpr_read_b32 v167, a87
    v_accvgpr_read_b32 v168, a88
    v_accvgpr_read_b32 v169, a89
    v_accvgpr_read_b32 v170, a90
    v_accvgpr_read_b32 v171, a91
    v_accvgpr_read_b32 v172, a92
    v_accvgpr_read_b32 v173, a93
    v_accvgpr_read_b32 v174, a94
    v_accvgpr_read_b32 v175, a95
    v_mul_f32 v160, v160, v27
    v_mul_f32 v161, v161, v27
    v_mul_f32 v162, v162, v27
    v_mul_f32 v163, v163, v27
    v_mul_f32 v164, v164, v27
    v_mul_f32 v165, v165, v27
    v_mul_f32 v166, v166, v27
    v_mul_f32 v167, v167, v27
    v_mul_f32 v168, v168, v27
    v_mul_f32 v169, v169, v27
    v_mul_f32 v170, v170, v27
    v_mul_f32 v171, v171, v27
    v_mul_f32 v172, v172, v27
    v_mul_f32 v173, v173, v27
    v_mul_f32 v174, v174, v27
    v_mul_f32 v175, v175, v27
    v_accvgpr_write_b32 a80, v160
    v_accvgpr_write_b32 a81, v161
    v_accvgpr_write_b32 a82, v162
    v_accvgpr_write_b32 a83, v163
    v_accvgpr_write_b32 a84, v164
    v_accvgpr_write_b32 a85, v165
    v_accvgpr_write_b32 a86, v166
    v_accvgpr_write_b32 a87, v167
    v_accvgpr_write_b32 a88, v168
    v_accvgpr_write_b32 a89, v169
    v_accvgpr_write_b32 a90, v170
    v_accvgpr_write_b32 a91, v171
    v_accvgpr_write_b32 a92, v172
    v_accvgpr_write_b32 a93, v173
    v_accvgpr_write_b32 a94, v174
    v_accvgpr_write_b32 a95, v175
    v_accvgpr_read_b32 v160, a96
    v_accvgpr_read_b32 v161, a97
    v_accvgpr_read_b32 v162, a98
    v_accvgpr_read_b32 v163, a99
    v_accvgpr_read_b32 v164, a100
    v_accvgpr_read_b32 v165, a101
    v_accvgpr_read_b32 v166, a102
    v_accvgpr_read_b32 v167, a103
    v_accvgpr_read_b32 v168, a104
    v_accvgpr_read_b32 v169, a105
    v_accvgpr_read_b32 v170, a106
    v_accvgpr_read_b32 v171, a107
    v_accvgpr_read_b32 v172, a108
    v_accvgpr_read_b32 v173, a109
    v_accvgpr_read_b32 v174, a110
    v_accvgpr_read_b32 v175, a111
    v_mul_f32 v160, v160, v27
    v_mul_f32 v161, v161, v27
    v_mul_f32 v162, v162, v27
    v_mul_f32 v163, v163, v27
    v_mul_f32 v164, v164, v27
    v_mul_f32 v165, v165, v27
    v_mul_f32 v166, v166, v27
    v_mul_f32 v167, v167, v27
    v_mul_f32 v168, v168, v27
    v_mul_f32 v169, v169, v27
    v_mul_f32 v170, v170, v27
    v_mul_f32 v171, v171, v27
    v_mul_f32 v172, v172, v27
    v_mul_f32 v173, v173, v27
    v_mul_f32 v174, v174, v27
    v_mul_f32 v175, v175, v27
    v_accvgpr_write_b32 a96, v160
    v_accvgpr_write_b32 a97, v161
    v_accvgpr_write_b32 a98, v162
    v_accvgpr_write_b32 a99, v163
    v_accvgpr_write_b32 a100, v164
    v_accvgpr_write_b32 a101, v165
    v_accvgpr_write_b32 a102, v166
    v_accvgpr_write_b32 a103, v167
    v_accvgpr_write_b32 a104, v168
    v_accvgpr_write_b32 a105, v169
    v_accvgpr_write_b32 a106, v170
    v_accvgpr_write_b32 a107, v171
    v_accvgpr_write_b32 a108, v172
    v_accvgpr_write_b32 a109, v173
    v_accvgpr_write_b32 a110, v174
    v_accvgpr_write_b32 a111, v175
    v_accvgpr_read_b32 v160, a112
    v_accvgpr_read_b32 v161, a113
    v_accvgpr_read_b32 v162, a114
    v_accvgpr_read_b32 v163, a115
    v_accvgpr_read_b32 v164, a116
    v_accvgpr_read_b32 v165, a117
    v_accvgpr_read_b32 v166, a118
    v_accvgpr_read_b32 v167, a119
    v_accvgpr_read_b32 v168, a120
    v_accvgpr_read_b32 v169, a121
    v_accvgpr_read_b32 v170, a122
    v_accvgpr_read_b32 v171, a123
    v_accvgpr_read_b32 v172, a124
    v_accvgpr_read_b32 v173, a125
    v_accvgpr_read_b32 v174, a126
    v_accvgpr_read_b32 v175, a127
    v_mul_f32 v160, v160, v27
    v_mul_f32 v161, v161, v27
    v_mul_f32 v162, v162, v27
    v_mul_f32 v163, v163, v27
    v_mul_f32 v164, v164, v27
    v_mul_f32 v165, v165, v27
    v_mul_f32 v166, v166, v27
    v_mul_f32 v167, v167, v27
    v_mul_f32 v168, v168, v27
    v_mul_f32 v169, v169, v27
    v_mul_f32 v170, v170, v27
    v_mul_f32 v171, v171, v27
    v_mul_f32 v172, v172, v27
    v_mul_f32 v173, v173, v27
    v_mul_f32 v174, v174, v27
    v_mul_f32 v175, v175, v27
    v_accvgpr_write_b32 a112, v160
    v_accvgpr_write_b32 a113, v161
    v_accvgpr_write_b32 a114, v162
    v_accvgpr_write_b32 a115, v163
    v_accvgpr_write_b32 a116, v164
    v_accvgpr_write_b32 a117, v165
    v_accvgpr_write_b32 a118, v166
    v_accvgpr_write_b32 a119, v167
    v_accvgpr_write_b32 a120, v168
    v_accvgpr_write_b32 a121, v169
    v_accvgpr_write_b32 a122, v170
    v_accvgpr_write_b32 a123, v171
    v_accvgpr_write_b32 a124, v172
    v_accvgpr_write_b32 a125, v173
    v_accvgpr_write_b32 a126, v174
    v_accvgpr_write_b32 a127, v175
    v_exp_f32 v16, v64
    v_exp_f32 v17, v65
    v_exp_f32 v18, v66
    v_add_f32 v9, v16, v17
    v_exp_f32 v19, v67
    v_cvt_pk_bf16_f32 v112, v16, v17
    v_exp_f32 v20, v68
    v_add_f32 v9, v9, v18
    v_exp_f32 v21, v69
    v_add_f32 v9, v9, v19
    v_cvt_pk_bf16_f32 v113, v18, v19
    v_exp_f32 v22, v70
    v_add_f32 v9, v9, v20
    v_exp_f32 v23, v71
    v_add_f32 v9, v9, v21
    v_cvt_pk_bf16_f32 v114, v20, v21
    v_exp_f32 v16, v80
    v_add_f32 v9, v9, v22
    v_exp_f32 v17, v81
    v_add_f32 v9, v9, v23
    v_cvt_pk_bf16_f32 v115, v22, v23
    v_exp_f32 v18, v82
    v_add_f32 v10, v16, v17
    v_exp_f32 v19, v83
    v_cvt_pk_bf16_f32 v120, v16, v17
    v_exp_f32 v20, v84
    v_add_f32 v10, v10, v18
    v_exp_f32 v21, v85
    v_add_f32 v10, v10, v19
    v_cvt_pk_bf16_f32 v121, v18, v19
    v_exp_f32 v22, v86
    v_add_f32 v10, v10, v20
    v_exp_f32 v23, v87
    v_add_f32 v10, v10, v21
    v_cvt_pk_bf16_f32 v122, v20, v21
    v_exp_f32 v16, v72
    v_add_f32 v10, v10, v22
    v_exp_f32 v17, v73
    v_add_f32 v10, v10, v23
    v_cvt_pk_bf16_f32 v123, v22, v23
    v_exp_f32 v18, v74
    v_add_f32 v9, v9, v16
    v_exp_f32 v19, v75
    v_add_f32 v9, v9, v17
    v_cvt_pk_bf16_f32 v116, v16, v17
    v_exp_f32 v20, v76
    v_add_f32 v9, v9, v18
    v_exp_f32 v21, v77
    v_add_f32 v9, v9, v19
    v_cvt_pk_bf16_f32 v117, v18, v19
    v_exp_f32 v22, v78
    v_add_f32 v9, v9, v20
    v_exp_f32 v23, v79
    v_add_f32 v9, v9, v21
    v_cvt_pk_bf16_f32 v118, v20, v21
    v_exp_f32 v16, v88
    v_add_f32 v9, v9, v22
    v_exp_f32 v17, v89
    v_add_f32 v9, v9, v23
    v_cvt_pk_bf16_f32 v119, v22, v23
    v_exp_f32 v18, v90
    v_add_f32 v10, v10, v16
    v_exp_f32 v19, v91
    v_add_f32 v10, v10, v17
    v_cvt_pk_bf16_f32 v124, v16, v17
    v_exp_f32 v20, v92
    v_add_f32 v10, v10, v18
    v_exp_f32 v21, v93
    v_add_f32 v10, v10, v19
    v_cvt_pk_bf16_f32 v125, v18, v19
    v_exp_f32 v22, v94
    v_add_f32 v10, v10, v20
    v_exp_f32 v23, v95
    v_add_f32 v10, v10, v21
    v_cvt_pk_bf16_f32 v126, v20, v21
    v_add_f32 v10, v10, v22
    v_add_f32 v10, v10, v23
    v_cvt_pk_bf16_f32 v127, v22, v23
    s_nop 7
    s_setpc_b64 s[74:75]
L2_mask1:
    s_nop 11
    s_cmp_eq_u32 s19, 0
    s_cbranch_scc1 L2_maskA1
L2_mask21:
    v_mov_b32 v64, v15
    v_mov_b32 v65, v15
    v_mov_b32 v66, v15
    v_mov_b32 v67, v15
    v_mov_b32 v68, v15
    v_mov_b32 v69, v15
    v_mov_b32 v70, v15
    v_mov_b32 v71, v15
    v_mov_b32 v72, v15
    v_mov_b32 v73, v15
    v_mov_b32 v74, v15
    v_mov_b32 v75, v15
    v_mov_b32 v76, v15
    v_mov_b32 v77, v15
    v_mov_b32 v78, v15
    v_mov_b32 v79, v15
    s_cmp_eq_u32 s19, 1
    s_cbranch_scc1 L2_maskB1
L2_maskC1:
    v_mov_b32 v80, v15
    v_mov_b32 v81, v15
    v_mov_b32 v82, v15
    v_mov_b32 v83, v15
    v_mov_b32 v84, v15
    v_mov_b32 v85, v15
    v_mov_b32 v86, v15
    v_mov_b32 v87, v15
    v_mov_b32 v88, v15
    v_mov_b32 v89, v15
    v_mov_b32 v90, v15
    v_mov_b32 v91, v15
    v_mov_b32 v92, v15
    v_mov_b32 v93, v15
    v_mov_b32 v94, v15
    v_mov_b32 v95, v15
    s_setpc_b64 s[74:75]
L2_maskA1:
    v_cndmask_b32 v64, v64, v15, s[42:43]
    v_cndmask_b32 v65, v65, v15, s[44:45]
    v_cndmask_b32 v66, v66, v15, s[46:47]
    v_cndmask_b32 v67, v67, v15, s[48:49]
    v_cndmask_b32 v68, v68, v15, s[50:51]
    v_cndmask_b32 v69, v69, v15, s[52:53]
    v_cndmask_b32 v70, v70, v15, s[54:55]
    v_cndmask_b32 v71, v71, v15, s[56:57]
    v_cndmask_b32 v72, v72, v15, s[58:59]
    v_cndmask_b32 v73, v73, v15, s[60:61]
    v_cndmask_b32 v74, v74, v15, s[62:63]
    v_cndmask_b32 v75, v75, v15, s[64:65]
    v_cndmask_b32 v76, v76, v15, s[66:67]
    v_cndmask_b32 v77, v77, v15, s[68:69]
    v_cndmask_b32 v78, v78, v15, s[70:71]
    v_cndmask_b32 v79, v79, v15, s[72:73]
    s_setpc_b64 s[74:75]
L2_maskB1:
    v_cndmask_b32 v80, v80, v15, s[42:43]
    v_cndmask_b32 v81, v81, v15, s[44:45]
    v_cndmask_b32 v82, v82, v15, s[46:47]
    v_cndmask_b32 v83, v83, v15, s[48:49]
    v_cndmask_b32 v84, v84, v15, s[50:51]
    v_cndmask_b32 v85, v85, v15, s[52:53]
    v_cndmask_b32 v86, v86, v15, s[54:55]
    v_cndmask_b32 v87, v87, v15, s[56:57]
    v_cndmask_b32 v88, v88, v15, s[58:59]
    v_cndmask_b32 v89, v89, v15, s[60:61]
    v_cndmask_b32 v90, v90, v15, s[62:63]
    v_cndmask_b32 v91, v91, v15, s[64:65]
    v_cndmask_b32 v92, v92, v15, s[66:67]
    v_cndmask_b32 v93, v93, v15, s[68:69]
    v_cndmask_b32 v94, v94, v15, s[70:71]
    v_cndmask_b32 v95, v95, v15, s[72:73]
    s_setpc_b64 s[74:75]
L2_slow1:
    s_nop 15
    v_max3_f32 v24, v32, v33, v34
    v_max3_f32 v24, v24, v35, v36
    v_max3_f32 v24, v24, v37, v38
    v_max3_f32 v24, v24, v39, v40
    v_max3_f32 v24, v24, v41, v42
    v_max3_f32 v24, v24, v43, v44
    v_max3_f32 v24, v24, v45, v46
    v_max_f32 v24, v24, v47
    v_max3_f32 v25, v48, v49, v50
    v_max3_f32 v25, v25, v51, v52
    v_max3_f32 v25, v25, v53, v54
    v_max3_f32 v25, v25, v55, v56
    v_max3_f32 v25, v25, v57, v58
    v_max3_f32 v25, v25, v59, v60
    v_max3_f32 v25, v25, v61, v62
    v_max_f32 v25, v25, v63
    v_mov_b32 v28, v24
    s_nop 1
    v_permlane32_swap_b32 v28, v24
    v_max_f32 v24, v24, v28
    v_mov_b32 v29, v25
    s_nop 1
    v_permlane32_swap_b32 v29, v25
    v_max_f32 v25, v25, v29
    s_mov_b32 s27, 0
    s_cmp_eq_u32 s37, 1
    s_cselect_b32 s27, 0xf149f2ca, s27
    v_max_f32 v24, s27, v24
    v_max_f32 v26, 0, v24
    v_sub_f32 v26, 0, v26
    v_exp_f32 v26, v26
    v_add_f32 v7, v7, v24
    v_sub_f32 v32, v32, v24
    v_sub_f32 v64, v64, v24
    v_sub_f32 v128, v128, v24
    v_sub_f32 v33, v33, v24
    v_sub_f32 v65, v65, v24
    v_sub_f32 v129, v129, v24
    v_sub_f32 v34, v34, v24
    v_sub_f32 v66, v66, v24
    v_sub_f32 v130, v130, v24
    v_sub_f32 v35, v35, v24
    v_sub_f32 v67, v67, v24
    v_sub_f32 v131, v131, v24
    v_sub_f32 v36, v36, v24
    v_sub_f32 v68, v68, v24
    v_sub_f32 v132, v132, v24
    v_sub_f32 v37, v37, v24
    v_sub_f32 v69, v69, v24
    v_sub_f32 v133, v133, v24
    v_sub_f32 v38, v38, v24
    v_sub_f32 v70, v70, v24
    v_sub_f32 v134, v134, v24
    v_sub_f32 v39, v39, v24
    v_sub_f32 v71, v71, v24
    v_sub_f32 v135, v135, v24
    v_sub_f32 v40, v40, v24
    v_sub_f32 v72, v72, v24
    v_sub_f32 v136, v136, v24
    v_sub_f32 v41, v41, v24
    v_sub_f32 v73, v73, v24
    v_sub_f32 v137, v137, v24
    v_sub_f32 v42, v42, v24
    v_sub_f32 v74, v74, v24
    v_sub_f32 v138, v138, v24
    v_sub_f32 v43, v43, v24
    v_sub_f32 v75, v75, v24
    v_sub_f32 v139, v139, v24
    v_sub_f32 v44, v44, v24
    v_sub_f32 v76, v76, v24
    v_sub_f32 v140, v140, v24
    v_sub_f32 v45, v45, v24
    v_sub_f32 v77, v77, v24
    v_sub_f32 v141, v141, v24
    v_sub_f32 v46, v46, v24
    v_sub_f32 v78, v78, v24
    v_sub_f32 v142, v142, v24
    v_sub_f32 v47, v47, v24
    v_sub_f32 v79, v79, v24
    v_sub_f32 v143, v143, v24
    v_mul_f32 v5, v5, v26
    v_max_f32 v25, s27, v25
    v_max_f32 v27, 0, v25
    v_sub_f32 v27, 0, v27
    v_exp_f32 v27, v27
    v_add_f32 v8, v8, v25
    v_sub_f32 v48, v48, v25
    v_sub_f32 v80, v80, v25
    v_sub_f32 v144, v144, v25
    v_sub_f32 v49, v49, v25
    v_sub_f32 v81, v81, v25
    v_sub_f32 v145, v145, v25
    v_sub_f32 v50, v50, v25
    v_sub_f32 v82, v82, v25
    v_sub_f32 v146, v146, v25
    v_sub_f32 v51, v51, v25
    v_sub_f32 v83, v83, v25
    v_sub_f32 v147, v147, v25
    v_sub_f32 v52, v52, v25
    v_sub_f32 v84, v84, v25
    v_sub_f32 v148, v148, v25
    v_sub_f32 v53, v53, v25
    v_sub_f32 v85, v85, v25
    v_sub_f32 v149, v149, v25
    v_sub_f32 v54, v54, v25
    v_sub_f32 v86, v86, v25
    v_sub_f32 v150, v150, v25
    v_sub_f32 v55, v55, v25
    v_sub_f32 v87, v87, v25
    v_sub_f32 v151, v151, v25
    v_sub_f32 v56, v56, v25
    v_sub_f32 v88, v88, v25
    v_sub_f32 v152, v152, v25
    v_sub_f32 v57, v57, v25
    v_sub_f32 v89, v89, v25
    v_sub_f32 v153, v153, v25
    v_sub_f32 v58, v58, v25
    v_sub_f32 v90, v90, v25
    v_sub_f32 v154, v154, v25
    v_sub_f32 v59, v59, v25
    v_sub_f32 v91, v91, v25
    v_sub_f32 v155, v155, v25
    v_sub_f32 v60, v60, v25
    v_sub_f32 v92, v92, v25
    v_sub_f32 v156, v156, v25
    v_sub_f32 v61, v61, v25
    v_sub_f32 v93, v93, v25
    v_sub_f32 v157, v157, v25
    v_sub_f32 v62, v62, v25
    v_sub_f32 v94, v94, v25
    v_sub_f32 v158, v158, v25
    v_sub_f32 v63, v63, v25
    v_sub_f32 v95, v95, v25
    v_sub_f32 v159, v159, v25
    v_mul_f32 v6, v6, v27
    v_accvgpr_read_b32 v160, a0
    v_accvgpr_read_b32 v161, a1
    v_accvgpr_read_b32 v162, a2
    v_accvgpr_read_b32 v163, a3
    v_accvgpr_read_b32 v164, a4
    v_accvgpr_read_b32 v165, a5
    v_accvgpr_read_b32 v166, a6
    v_accvgpr_read_b32 v167, a7
    v_accvgpr_read_b32 v168, a8
    v_accvgpr_read_b32 v169, a9
    v_accvgpr_read_b32 v170, a10
    v_accvgpr_read_b32 v171, a11
    v_accvgpr_read_b32 v172, a12
    v_accvgpr_read_b32 v173, a13
    v_accvgpr_read_b32 v174, a14
    v_accvgpr_read_b32 v175, a15
    v_mul_f32 v160, v160, v26
    v_mul_f32 v161, v161, v26
    v_mul_f32 v162, v162, v26
    v_mul_f32 v163, v163, v26
    v_mul_f32 v164, v164, v26
    v_mul_f32 v165, v165, v26
    v_mul_f32 v166, v166, v26
    v_mul_f32 v167, v167, v26
    v_mul_f32 v168, v168, v26
    v_mul_f32 v169, v169, v26
    v_mul_f32 v170, v170, v26
    v_mul_f32 v171, v171, v26
    v_mul_f32 v172, v172, v26
    v_mul_f32 v173, v173, v26
    v_mul_f32 v174, v174, v26
    v_mul_f32 v175, v175, v26
    v_accvgpr_write_b32 a0, v160
    v_accvgpr_write_b32 a1, v161
    v_accvgpr_write_b32 a2, v162
    v_accvgpr_write_b32 a3, v163
    v_accvgpr_write_b32 a4, v164
    v_accvgpr_write_b32 a5, v165
    v_accvgpr_write_b32 a6, v166
    v_accvgpr_write_b32 a7, v167
    v_accvgpr_write_b32 a8, v168
    v_accvgpr_write_b32 a9, v169
    v_accvgpr_write_b32 a10, v170
    v_accvgpr_write_b32 a11, v171
    v_accvgpr_write_b32 a12, v172
    v_accvgpr_write_b32 a13, v173
    v_accvgpr_write_b32 a14, v174
    v_accvgpr_write_b32 a15, v175
    v_accvgpr_read_b32 v160, a16
    v_accvgpr_read_b32 v161, a17
    v_accvgpr_read_b32 v162, a18
    v_accvgpr_read_b32 v163, a19
    v_accvgpr_read_b32 v164, a20
    v_accvgpr_read_b32 v165, a21
    v_accvgpr_read_b32 v166, a22
    v_accvgpr_read_b32 v167, a23
    v_accvgpr_read_b32 v168, a24
    v_accvgpr_read_b32 v169, a25
    v_accvgpr_read_b32 v170, a26
    v_accvgpr_read_b32 v171, a27
    v_accvgpr_read_b32 v172, a28
    v_accvgpr_read_b32 v173, a29
    v_accvgpr_read_b32 v174, a30
    v_accvgpr_read_b32 v175, a31
    v_mul_f32 v160, v160, v26
    v_mul_f32 v161, v161, v26
    v_mul_f32 v162, v162, v26
    v_mul_f32 v163, v163, v26
    v_mul_f32 v164, v164, v26
    v_mul_f32 v165, v165, v26
    v_mul_f32 v166, v166, v26
    v_mul_f32 v167, v167, v26
    v_mul_f32 v168, v168, v26
    v_mul_f32 v169, v169, v26
    v_mul_f32 v170, v170, v26
    v_mul_f32 v171, v171, v26
    v_mul_f32 v172, v172, v26
    v_mul_f32 v173, v173, v26
    v_mul_f32 v174, v174, v26
    v_mul_f32 v175, v175, v26
    v_accvgpr_write_b32 a16, v160
    v_accvgpr_write_b32 a17, v161
    v_accvgpr_write_b32 a18, v162
    v_accvgpr_write_b32 a19, v163
    v_accvgpr_write_b32 a20, v164
    v_accvgpr_write_b32 a21, v165
    v_accvgpr_write_b32 a22, v166
    v_accvgpr_write_b32 a23, v167
    v_accvgpr_write_b32 a24, v168
    v_accvgpr_write_b32 a25, v169
    v_accvgpr_write_b32 a26, v170
    v_accvgpr_write_b32 a27, v171
    v_accvgpr_write_b32 a28, v172
    v_accvgpr_write_b32 a29, v173
    v_accvgpr_write_b32 a30, v174
    v_accvgpr_write_b32 a31, v175
    v_accvgpr_read_b32 v160, a32
    v_accvgpr_read_b32 v161, a33
    v_accvgpr_read_b32 v162, a34
    v_accvgpr_read_b32 v163, a35
    v_accvgpr_read_b32 v164, a36
    v_accvgpr_read_b32 v165, a37
    v_accvgpr_read_b32 v166, a38
    v_accvgpr_read_b32 v167, a39
    v_accvgpr_read_b32 v168, a40
    v_accvgpr_read_b32 v169, a41
    v_accvgpr_read_b32 v170, a42
    v_accvgpr_read_b32 v171, a43
    v_accvgpr_read_b32 v172, a44
    v_accvgpr_read_b32 v173, a45
    v_accvgpr_read_b32 v174, a46
    v_accvgpr_read_b32 v175, a47
    v_mul_f32 v160, v160, v26
    v_mul_f32 v161, v161, v26
    v_mul_f32 v162, v162, v26
    v_mul_f32 v163, v163, v26
    v_mul_f32 v164, v164, v26
    v_mul_f32 v165, v165, v26
    v_mul_f32 v166, v166, v26
    v_mul_f32 v167, v167, v26
    v_mul_f32 v168, v168, v26
    v_mul_f32 v169, v169, v26
    v_mul_f32 v170, v170, v26
    v_mul_f32 v171, v171, v26
    v_mul_f32 v172, v172, v26
    v_mul_f32 v173, v173, v26
    v_mul_f32 v174, v174, v26
    v_mul_f32 v175, v175, v26
    v_accvgpr_write_b32 a32, v160
    v_accvgpr_write_b32 a33, v161
    v_accvgpr_write_b32 a34, v162
    v_accvgpr_write_b32 a35, v163
    v_accvgpr_write_b32 a36, v164
    v_accvgpr_write_b32 a37, v165
    v_accvgpr_write_b32 a38, v166
    v_accvgpr_write_b32 a39, v167
    v_accvgpr_write_b32 a40, v168
    v_accvgpr_write_b32 a41, v169
    v_accvgpr_write_b32 a42, v170
    v_accvgpr_write_b32 a43, v171
    v_accvgpr_write_b32 a44, v172
    v_accvgpr_write_b32 a45, v173
    v_accvgpr_write_b32 a46, v174
    v_accvgpr_write_b32 a47, v175
    v_accvgpr_read_b32 v160, a48
    v_accvgpr_read_b32 v161, a49
    v_accvgpr_read_b32 v162, a50
    v_accvgpr_read_b32 v163, a51
    v_accvgpr_read_b32 v164, a52
    v_accvgpr_read_b32 v165, a53
    v_accvgpr_read_b32 v166, a54
    v_accvgpr_read_b32 v167, a55
    v_accvgpr_read_b32 v168, a56
    v_accvgpr_read_b32 v169, a57
    v_accvgpr_read_b32 v170, a58
    v_accvgpr_read_b32 v171, a59
    v_accvgpr_read_b32 v172, a60
    v_accvgpr_read_b32 v173, a61
    v_accvgpr_read_b32 v174, a62
    v_accvgpr_read_b32 v175, a63
    v_mul_f32 v160, v160, v26
    v_mul_f32 v161, v161, v26
    v_mul_f32 v162, v162, v26
    v_mul_f32 v163, v163, v26
    v_mul_f32 v164, v164, v26
    v_mul_f32 v165, v165, v26
    v_mul_f32 v166, v166, v26
    v_mul_f32 v167, v167, v26
    v_mul_f32 v168, v168, v26
    v_mul_f32 v169, v169, v26
    v_mul_f32 v170, v170, v26
    v_mul_f32 v171, v171, v26
    v_mul_f32 v172, v172, v26
    v_mul_f32 v173, v173, v26
    v_mul_f32 v174, v174, v26
    v_mul_f32 v175, v175, v26
    v_accvgpr_write_b32 a48, v160
    v_accvgpr_write_b32 a49, v161
    v_accvgpr_write_b32 a50, v162
    v_accvgpr_write_b32 a51, v163
    v_accvgpr_write_b32 a52, v164
    v_accvgpr_write_b32 a53, v165
    v_accvgpr_write_b32 a54, v166
    v_accvgpr_write_b32 a55, v167
    v_accvgpr_write_b32 a56, v168
    v_accvgpr_write_b32 a57, v169
    v_accvgpr_write_b32 a58, v170
    v_accvgpr_write_b32 a59, v171
    v_accvgpr_write_b32 a60, v172
    v_accvgpr_write_b32 a61, v173
    v_accvgpr_write_b32 a62, v174
    v_accvgpr_write_b32 a63, v175
    v_accvgpr_read_b32 v160, a64
    v_accvgpr_read_b32 v161, a65
    v_accvgpr_read_b32 v162, a66
    v_accvgpr_read_b32 v163, a67
    v_accvgpr_read_b32 v164, a68
    v_accvgpr_read_b32 v165, a69
    v_accvgpr_read_b32 v166, a70
    v_accvgpr_read_b32 v167, a71
    v_accvgpr_read_b32 v168, a72
    v_accvgpr_read_b32 v169, a73
    v_accvgpr_read_b32 v170, a74
    v_accvgpr_read_b32 v171, a75
    v_accvgpr_read_b32 v172, a76
    v_accvgpr_read_b32 v173, a77
    v_accvgpr_read_b32 v174, a78
    v_accvgpr_read_b32 v175, a79
    v_mul_f32 v160, v160, v27
    v_mul_f32 v161, v161, v27
    v_mul_f32 v162, v162, v27
    v_mul_f32 v163, v163, v27
    v_mul_f32 v164, v164, v27
    v_mul_f32 v165, v165, v27
    v_mul_f32 v166, v166, v27
    v_mul_f32 v167, v167, v27
    v_mul_f32 v168, v168, v27
    v_mul_f32 v169, v169, v27
    v_mul_f32 v170, v170, v27
    v_mul_f32 v171, v171, v27
    v_mul_f32 v172, v172, v27
    v_mul_f32 v173, v173, v27
    v_mul_f32 v174, v174, v27
    v_mul_f32 v175, v175, v27
    v_accvgpr_write_b32 a64, v160
    v_accvgpr_write_b32 a65, v161
    v_accvgpr_write_b32 a66, v162
    v_accvgpr_write_b32 a67, v163
    v_accvgpr_write_b32 a68, v164
    v_accvgpr_write_b32 a69, v165
    v_accvgpr_write_b32 a70, v166
    v_accvgpr_write_b32 a71, v167
    v_accvgpr_write_b32 a72, v168
    v_accvgpr_write_b32 a73, v169
    v_accvgpr_write_b32 a74, v170
    v_accvgpr_write_b32 a75, v171
    v_accvgpr_write_b32 a76, v172
    v_accvgpr_write_b32 a77, v173
    v_accvgpr_write_b32 a78, v174
    v_accvgpr_write_b32 a79, v175
    v_accvgpr_read_b32 v160, a80
    v_accvgpr_read_b32 v161, a81
    v_accvgpr_read_b32 v162, a82
    v_accvgpr_read_b32 v163, a83
    v_accvgpr_read_b32 v164, a84
    v_accvgpr_read_b32 v165, a85
    v_accvgpr_read_b32 v166, a86
    v_accvgpr_read_b32 v167, a87
    v_accvgpr_read_b32 v168, a88
    v_accvgpr_read_b32 v169, a89
    v_accvgpr_read_b32 v170, a90
    v_accvgpr_read_b32 v171, a91
    v_accvgpr_read_b32 v172, a92
    v_accvgpr_read_b32 v173, a93
    v_accvgpr_read_b32 v174, a94
    v_accvgpr_read_b32 v175, a95
    v_mul_f32 v160, v160, v27
    v_mul_f32 v161, v161, v27
    v_mul_f32 v162, v162, v27
    v_mul_f32 v163, v163, v27
    v_mul_f32 v164, v164, v27
    v_mul_f32 v165, v165, v27
    v_mul_f32 v166, v166, v27
    v_mul_f32 v167, v167, v27
    v_mul_f32 v168, v168, v27
    v_mul_f32 v169, v169, v27
    v_mul_f32 v170, v170, v27
    v_mul_f32 v171, v171, v27
    v_mul_f32 v172, v172, v27
    v_mul_f32 v173, v173, v27
    v_mul_f32 v174, v174, v27
    v_mul_f32 v175, v175, v27
    v_accvgpr_write_b32 a80, v160
    v_accvgpr_write_b32 a81, v161
    v_accvgpr_write_b32 a82, v162
    v_accvgpr_write_b32 a83, v163
    v_accvgpr_write_b32 a84, v164
    v_accvgpr_write_b32 a85, v165
    v_accvgpr_write_b32 a86, v166
    v_accvgpr_write_b32 a87, v167
    v_accvgpr_write_b32 a88, v168
    v_accvgpr_write_b32 a89, v169
    v_accvgpr_write_b32 a90, v170
    v_accvgpr_write_b32 a91, v171
    v_accvgpr_write_b32 a92, v172
    v_accvgpr_write_b32 a93, v173
    v_accvgpr_write_b32 a94, v174
    v_accvgpr_write_b32 a95, v175
    v_accvgpr_read_b32 v160, a96
    v_accvgpr_read_b32 v161, a97
    v_accvgpr_read_b32 v162, a98
    v_accvgpr_read_b32 v163, a99
    v_accvgpr_read_b32 v164, a100
    v_accvgpr_read_b32 v165, a101
    v_accvgpr_read_b32 v166, a102
    v_accvgpr_read_b32 v167, a103
    v_accvgpr_read_b32 v168, a104
    v_accvgpr_read_b32 v169, a105
    v_accvgpr_read_b32 v170, a106
    v_accvgpr_read_b32 v171, a107
    v_accvgpr_read_b32 v172, a108
    v_accvgpr_read_b32 v173, a109
    v_accvgpr_read_b32 v174, a110
    v_accvgpr_read_b32 v175, a111
    v_mul_f32 v160, v160, v27
    v_mul_f32 v161, v161, v27
    v_mul_f32 v162, v162, v27
    v_mul_f32 v163, v163, v27
    v_mul_f32 v164, v164, v27
    v_mul_f32 v165, v165, v27
    v_mul_f32 v166, v166, v27
    v_mul_f32 v167, v167, v27
    v_mul_f32 v168, v168, v27
    v_mul_f32 v169, v169, v27
    v_mul_f32 v170, v170, v27
    v_mul_f32 v171, v171, v27
    v_mul_f32 v172, v172, v27
    v_mul_f32 v173, v173, v27
    v_mul_f32 v174, v174, v27
    v_mul_f32 v175, v175, v27
    v_accvgpr_write_b32 a96, v160
    v_accvgpr_write_b32 a97, v161
    v_accvgpr_write_b32 a98, v162
    v_accvgpr_write_b32 a99, v163
    v_accvgpr_write_b32 a100, v164
    v_accvgpr_write_b32 a101, v165
    v_accvgpr_write_b32 a102, v166
    v_accvgpr_write_b32 a103, v167
    v_accvgpr_write_b32 a104, v168
    v_accvgpr_write_b32 a105, v169
    v_accvgpr_write_b32 a106, v170
    v_accvgpr_write_b32 a107, v171
    v_accvgpr_write_b32 a108, v172
    v_accvgpr_write_b32 a109, v173
    v_accvgpr_write_b32 a110, v174
    v_accvgpr_write_b32 a111, v175
    v_accvgpr_read_b32 v160, a112
    v_accvgpr_read_b32 v161, a113
    v_accvgpr_read_b32 v162, a114
    v_accvgpr_read_b32 v163, a115
    v_accvgpr_read_b32 v164, a116
    v_accvgpr_read_b32 v165, a117
    v_accvgpr_read_b32 v166, a118
    v_accvgpr_read_b32 v167, a119
    v_accvgpr_read_b32 v168, a120
    v_accvgpr_read_b32 v169, a121
    v_accvgpr_read_b32 v170, a122
    v_accvgpr_read_b32 v171, a123
    v_accvgpr_read_b32 v172, a124
    v_accvgpr_read_b32 v173, a125
    v_accvgpr_read_b32 v174, a126
    v_accvgpr_read_b32 v175, a127
    v_mul_f32 v160, v160, v27
    v_mul_f32 v161, v161, v27
    v_mul_f32 v162, v162, v27
    v_mul_f32 v163, v163, v27
    v_mul_f32 v164, v164, v27
    v_mul_f32 v165, v165, v27
    v_mul_f32 v166, v166, v27
    v_mul_f32 v167, v167, v27
    v_mul_f32 v168, v168, v27
    v_mul_f32 v169, v169, v27
    v_mul_f32 v170, v170, v27
    v_mul_f32 v171, v171, v27
    v_mul_f32 v172, v172, v27
    v_mul_f32 v173, v173, v27
    v_mul_f32 v174, v174, v27
    v_mul_f32 v175, v175, v27
    v_accvgpr_write_b32 a112, v160
    v_accvgpr_write_b32 a113, v161
    v_accvgpr_write_b32 a114, v162
    v_accvgpr_write_b32 a115, v163
    v_accvgpr_write_b32 a116, v164
    v_accvgpr_write_b32 a117, v165
    v_accvgpr_write_b32 a118, v166
    v_accvgpr_write_b32 a119, v167
    v_accvgpr_write_b32 a120, v168
    v_accvgpr_write_b32 a121, v169
    v_accvgpr_write_b32 a122, v170
    v_accvgpr_write_b32 a123, v171
    v_accvgpr_write_b32 a124, v172
    v_accvgpr_write_b32 a125, v173
    v_accvgpr_write_b32 a126, v174
    v_accvgpr_write_b32 a127, v175
    v_exp_f32 v16, v32
    v_exp_f32 v17, v33
    v_exp_f32 v18, v34
    v_add_f32 v9, v16, v17
    v_exp_f32 v19, v35
    v_cvt_pk_bf16_f32 v96, v16, v17
    v_exp_f32 v20, v36
    v_add_f32 v9, v9, v18
    v_exp_f32 v21, v37
    v_add_f32 v9, v9, v19
    v_cvt_pk_bf16_f32 v97, v18, v19
    v_exp_f32 v22, v38
    v_add_f32 v9, v9, v20
    v_exp_f32 v23, v39
    v_add_f32 v9, v9, v21
    v_cvt_pk_bf16_f32 v98, v20, v21
    v_exp_f32 v16, v48
    v_add_f32 v9, v9, v22
    v_exp_f32 v17, v49
    v_add_f32 v9, v9, v23
    v_cvt_pk_bf16_f32 v99, v22, v23
    v_exp_f32 v18, v50
    v_add_f32 v10, v16, v17
    v_exp_f32 v19, v51
    v_cvt_pk_bf16_f32 v104, v16, v17
    v_exp_f32 v20, v52
    v_add_f32 v10, v10, v18
    v_exp_f32 v21, v53
    v_add_f32 v10, v10, v19
    v_cvt_pk_bf16_f32 v105, v18, v19
    v_exp_f32 v22, v54
    v_add_f32 v10, v10, v20
    v_exp_f32 v23, v55
    v_add_f32 v10, v10, v21
    v_cvt_pk_bf16_f32 v106, v20, v21
    v_exp_f32 v16, v40
    v_add_f32 v10, v10, v22
    v_exp_f32 v17, v41
    v_add_f32 v10, v10, v23
    v_cvt_pk_bf16_f32 v107, v22, v23
    v_exp_f32 v18, v42
    v_add_f32 v9, v9, v16
    v_exp_f32 v19, v43
    v_add_f32 v9, v9, v17
    v_cvt_pk_bf16_f32 v100, v16, v17
    v_exp_f32 v20, v44
    v_add_f32 v9, v9, v18
    v_exp_f32 v21, v45
    v_add_f32 v9, v9, v19
    v_cvt_pk_bf16_f32 v101, v18, v19
    v_exp_f32 v22, v46
    v_add_f32 v9, v9, v20
    v_exp_f32 v23, v47
    v_add_f32 v9, v9, v21
    v_cvt_pk_bf16_f32 v102, v20, v21
    v_exp_f32 v16, v56
    v_add_f32 v9, v9, v22
    v_exp_f32 v17, v57
    v_add_f32 v9, v9, v23
    v_cvt_pk_bf16_f32 v103, v22, v23
    v_exp_f32 v18, v58
    v_add_f32 v10, v10, v16
    v_exp_f32 v19, v59
    v_add_f32 v10, v10, v17
    v_cvt_pk_bf16_f32 v108, v16, v17
    v_exp_f32 v20, v60
    v_add_f32 v10, v10, v18
    v_exp_f32 v21, v61
    v_add_f32 v10, v10, v19
    v_cvt_pk_bf16_f32 v109, v18, v19
    v_exp_f32 v22, v62
    v_add_f32 v10, v10, v20
    v_exp_f32 v23, v63
    v_add_f32 v10, v10, v21
    v_cvt_pk_bf16_f32 v110, v20, v21
    v_add_f32 v10, v10, v22
    v_add_f32 v10, v10, v23
    v_cvt_pk_bf16_f32 v111, v22, v23
    s_nop 7
    s_setpc_b64 s[74:75]
L2_end:
    L2_c2:
    v_readfirstlane_b32 s27, v148
    s_nop 0
    s_cmp_eq_u32 s27, 0
    s_cbranch_scc1 L2_c2_spin
    v_lshl_add_u32 v0, s12, 6, v0
    s_waitcnt lgkmcnt(0)
    s_barrier
tail_kernel:
    s_load_dwordx2 s[46:47], s[0:1], 40
    s_load_dwordx2 s[48:49], s[0:1], 80
    s_load_dwordx2 s[50:51], s[0:1], 96
    s_load_dwordx2 s[52:53], s[0:1], 104
    s_load_dwordx4 s[4:7], s[0:1], 64
    s_load_dwordx2 s[8:9], s[0:1], 112
    v_lshrrev_b32 v1, 6, v0
    s_nop 0
    v_readfirstlane_b32 s24, v1
    v_and_b32 v0, 63, v0
    v_lshlrev_b32 v1, 4, v0
    s_mul_i32 s27, s24, 0x9000
    v_lshrrev_b32 v8, 3, v0
    v_and_b32 v9, 7, v0
    v_lshrrev_b32 v10, 1, v8
    v_xor_b32 v11, v9, v10
    v_lshlrev_b32 v11, 4, v11
    v_lshl_add_u32 v12, v8, 12, v11
    v_xor_b32 v13, 64, v12
    v_add_u32 v13, 0x8000, v13
    v_add_u32 v14, 0x10000, v12
    v_add_u32 v15, 0x10000, v13
    v_and_b32 v9, 31, v0
    v_lshrrev_b32 v10, 5, v0
    v_lshrrev_b32 v8, 1, v9
    v_and_b32 v8, 7, v8
    v_xor_b32 v8, v10, v8
    v_lshlrev_b32 v8, 4, v8
    v_lshl_add_u32 v8, v9, 7, v8
    v_add_u32 v4, s27, v8
    v_xor_b32 v5, 32, v4
    v_xor_b32 v6, 64, v4
    v_xor_b32 v7, 0x60, v4
    v_mov_b32 v2, 0xc0135761
    v_mov_b32 v3, 0xbdd2d3e8
    s_and_b32 s28, s2, 7
    s_lshr_b32 s29, s2, 3
    s_lshr_b32 s25, s28, 1
    s_lshl_b32 s25, s25, 2
    s_and_b32 s32, s29, 3
    s_add_u32 s25, s25, s32
    s_and_b32 s26, s28, 1
    s_mul_i32 s26, s26, 7
    s_lshr_b32 s32, s29, 2
    s_add_u32 s26, s26, s32
    s_lshl_b32 s30, s25, 19
    s_lshl_b32 s28, s24, 10
    s_add_u32 s30, s30, s28
    s_mul_i32 s31, s24, 0xe0000
    s_lshl_b32 s28, s26, 11
    s_add_u32 s31, s31, s28
    s_add_u32 s31, s31, 0x5000000
    s_waitcnt lgkmcnt(0)
    s_mov_b32 s12, s4
    s_mov_b32 s13, s5
    s_mov_b32 s14, 0x800000
    s_mov_b32 s15, 0x20000
    s_mov_b32 s16, s8
    s_mov_b32 s17, s9
    s_mov_b32 s18, 0x10000000
    s_mov_b32 s19, 0x20000
    s_mov_b32 s20, s6
    s_mov_b32 s21, s7
    s_mov_b32 s22, 0x1000
    s_mov_b32 s23, 0x20000
    s_mov_b32 s56, s46
    s_mov_b32 s57, s47
    s_mov_b32 s58, 0x400000
    s_mov_b32 s59, 0x20000
    s_mov_b32 s60, s50
    s_mov_b32 s61, s51
    s_mov_b32 s62, 0x200000
    s_mov_b32 s63, 0x20000
    s_mov_b32 s64, s52
    s_mov_b32 s65, s53
    s_mov_b32 s66, 0x100
    s_mov_b32 s67, 0x20000
    s_and_b32 s82, s2, 7
    s_lshr_b32 s83, s2, 3
    s_and_b32 s68, s82, 3
    s_lshr_b32 s69, s82, 2
    s_lshl_b32 s69, s69, 3
    s_and_b32 s84, s83, 7
    s_add_u32 s69, s69, s84
    s_lshr_b32 s70, s83, 3
    s_lshl_b32 s85, s69, 8
    s_add_u32 s85, s85, 0x4d00000
    s_lshl_b32 s88, s69, 2
    s_add_u32 s88, s88, s70
    s_lshl_b32 s88, s88, 8
    s_add_u32 s88, s88, 0x4d01000
    s_mov_b32 s87, 13
    s_mul_i32 s82, s69, 0x138000
    s_add_u32 s82, s82, 0x3000000
    s_lshl_b32 s83, s24, 10
    s_add_u32 s82, s82, s83
    s_lshl_b32 s83, s68, 16
    s_add_u32 s73, s82, s83
    s_mul_i32 s83, s68, 0x3800
    s_add_u32 s75, s82, s83
    s_add_u32 s75, s75, 0x40000
    s_lshl_b32 s82, s70, 8
    s_lshl_b32 s83, s24, 14
    s_add_u32 s82, s82, s83
    s_lshl_b32 s83, s68, 20
    s_add_u32 s74, s82, s83
    s_mul_i32 s83, s68, 0x38000
    s_add_u32 s76, s82, s83
    s_mov_b32 s71, 0
    s_cmp_lt_u32 s24, 2
    s_cselect_b32 s72, 20, 19
    s_lshl_b32 s79, s24, 13
    s_mov_b32 s80, 0
    s_mov_b32 s81, 20
    v_mov_b32 v227, 0
L5_a:
    s_cmp_ge_u32 s2, 0xe0
    s_cbranch_scc1 L5_nos
L4_main:
    s_add_u32 s32, s30, 0
    s_add_u32 m0, s27, 0
    s_nop 0
    buffer_load_dwordx4 v12, s[12:15], s32 offen lds
    s_add_u32 m0, s27, 0x400
    s_nop 0
    buffer_load_dwordx4 v13, s[12:15], s32 offen lds
    s_add_u32 m0, s27, 0x800
    s_nop 0
    buffer_load_dwordx4 v14, s[12:15], s32 offen lds
    s_add_u32 m0, s27, 0xc00
    s_nop 0
    buffer_load_dwordx4 v15, s[12:15], s32 offen lds
    s_add_u32 s33, s31, 0
    buffer_load_dwordx4 v[16:19], v1, s[16:19], s33 offen sc1
    buffer_load_dwordx4 v[20:23], v1, s[16:19], s33 offen offset:1024 sc1
    s_add_u32 s33, s31, 0x7000
    buffer_load_dwordx4 v[24:27], v1, s[16:19], s33 offen sc1
    buffer_load_dwordx4 v[28:31], v1, s[16:19], s33 offen offset:1024 sc1
    s_add_u32 s33, s31, 0xe000
    buffer_load_dwordx4 v[32:35], v1, s[16:19], s33 offen sc1
    buffer_load_dwordx4 v[36:39], v1, s[16:19], s33 offen offset:1024 sc1
    s_add_u32 s33, s31, 0x15000
    buffer_load_dwordx4 v[40:43], v1, s[16:19], s33 offen sc1
    buffer_load_dwordx4 v[44:47], v1, s[16:19], s33 offen offset:1024 sc1
    s_add_u32 s32, s30, 0x20000
    s_add_u32 m0, s27, 0x1000
    s_nop 0
    buffer_load_dwordx4 v12, s[12:15], s32 offen lds
    s_add_u32 m0, s27, 0x1400
    s_nop 0
    buffer_load_dwordx4 v13, s[12:15], s32 offen lds
    s_add_u32 m0, s27, 0x1800
    s_nop 0
    buffer_load_dwordx4 v14, s[12:15], s32 offen lds
    s_add_u32 m0, s27, 0x1c00
    s_nop 0
    buffer_load_dwordx4 v15, s[12:15], s32 offen lds
    s_add_u32 s32, s30, 0x40000
    s_add_u32 m0, s27, 0x2000
    s_nop 0
    buffer_load_dwordx4 v12, s[12:15], s32 offen lds
    s_add_u32 m0, s27, 0x2400
    s_nop 0
    buffer_load_dwordx4 v13, s[12:15], s32 offen lds
    s_add_u32 m0, s27, 0x2800
    s_nop 0
    buffer_load_dwordx4 v14, s[12:15], s32 offen lds
    s_add_u32 m0, s27, 0x2c00
    s_nop 0
    buffer_load_dwordx4 v15, s[12:15], s32 offen lds
    s_add_u32 s32, s30, 0x60000
    s_add_u32 m0, s27, 0x3000
    s_nop 0
    buffer_load_dwordx4 v12, s[12:15], s32 offen lds
    s_add_u32 m0, s27, 0x3400
    s_nop 0
    buffer_load_dwordx4 v13, s[12:15], s32 offen lds
    s_add_u32 m0, s27, 0x3800
    s_nop 0
    buffer_load_dwordx4 v14, s[12:15], s32 offen lds
    s_add_u32 m0, s27, 0x3c00
    s_nop 0
    buffer_load_dwordx4 v15, s[12:15], s32 offen lds
    s_add_u32 s33, s31, 0x1c000
    buffer_load_dwordx4 v[48:51], v1, s[16:19], s33 offen sc1
    buffer_load_dwordx4 v[52:55], v1, s[16:19], s33 offen offset:1024 sc1
    s_add_u32 s33, s31, 0x23000
    buffer_load_dwordx4 v[56:59], v1, s[16:19], s33 offen sc1
    buffer_load_dwordx4 v[60:63], v1, s[16:19], s33 offen offset:1024 sc1
    s_add_u32 s33, s31, 0x2a000
    buffer_load_dwordx4 v[64:67], v1, s[16:19], s33 offen sc1
    buffer_load_dwordx4 v[68:71], v1, s[16:19], s33 offen offset:1024 sc1
    s_add_u32 s33, s31, 0x31000
    buffer_load_dwordx4 v[72:75], v1, s[16:19], s33 offen sc1
    buffer_load_dwordx4 v[76:79], v1, s[16:19], s33 offen offset:1024 sc1
    s_add_u32 s32, s30, 0x80
    s_add_u32 m0, s27, 0x4000
    s_nop 0
    buffer_load_dwordx4 v12, s[12:15], s32 offen lds
    s_add_u32 m0, s27, 0x4400
    s_nop 0
    buffer_load_dwordx4 v13, s[12:15], s32 offen lds
    s_add_u32 m0, s27, 0x4800
    s_nop 0
    buffer_load_dwordx4 v14, s[12:15], s32 offen lds
    s_add_u32 m0, s27, 0x4c00
    s_nop 0
    buffer_load_dwordx4 v15, s[12:15], s32 offen lds
    s_add_u32 s32, s30, 0x20080
    s_add_u32 m0, s27, 0x5000
    s_nop 0
    buffer_load_dwordx4 v12, s[12:15], s32 offen lds
    s_add_u32 m0, s27, 0x5400
    s_nop 0
    buffer_load_dwordx4 v13, s[12:15], s32 offen lds
    s_add_u32 m0, s27, 0x5800
    s_nop 0
    buffer_load_dwordx4 v14, s[12:15], s32 offen lds
    s_add_u32 m0, s27, 0x5c00
    s_nop 0
    buffer_load_dwordx4 v15, s[12:15], s32 offen lds
    s_add_u32 s32, s30, 0x40080
    s_add_u32 m0, s27, 0x6000
    s_nop 0
    buffer_load_dwordx4 v12, s[12:15], s32 offen lds
    s_add_u32 m0, s27, 0x6400
    s_nop 0
    buffer_load_dwordx4 v13, s[12:15], s32 offen lds
    s_add_u32 m0, s27, 0x6800
    s_nop 0
    buffer_load_dwordx4 v14, s[12:15], s32 offen lds
    s_add_u32 m0, s27, 0x6c00
    s_nop 0
    buffer_load_dwordx4 v15, s[12:15], s32 offen lds
    s_add_u32 s32, s30, 0x60080
    s_add_u32 m0, s27, 0x7000
    s_nop 0
    buffer_load_dwordx4 v12, s[12:15], s32 offen lds
    s_add_u32 m0, s27, 0x7400
    s_nop 0
    buffer_load_dwordx4 v13, s[12:15], s32 offen lds
    s_add_u32 m0, s27, 0x7800
    s_nop 0
    buffer_load_dwordx4 v14, s[12:15], s32 offen lds
    s_add_u32 m0, s27, 0x7c00
    s_nop 0
    buffer_load_dwordx4 v15, s[12:15], s32 offen lds
    s_add_u32 s32, s30, 0x100
    s_add_u32 m0, s27, 0x8000
    s_nop 0
    buffer_load_dwordx4 v12, s[12:15], s32 offen lds
    s_add_u32 m0, s27, 0x8400
    s_nop 0
    buffer_load_dwordx4 v13, s[12:15], s32 offen lds
    s_add_u32 m0, s27, 0x8800
    s_nop 0
    buffer_load_dwordx4 v14, s[12:15], s32 offen lds
    s_add_u32 m0, s27, 0x8c00
    s_nop 0
    buffer_load_dwordx4 v15, s[12:15], s32 offen lds
    s_waitcnt vmcnt(48)
    ds_read_b128 v[144:147], v4
    ds_read_b128 v[148:151], v5
    ds_read_b128 v[152:155], v6
    ds_read_b128 v[156:159], v7
    s_waitcnt vmcnt(36)
    ds_read_b128 v[160:163], v4 offset:4096
    ds_read_b128 v[164:167], v5 offset:4096
    ds_read_b128 v[168:171], v6 offset:4096
    ds_read_b128 v[172:175], v7 offset:4096
    s_waitcnt lgkmcnt(0)
    s_barrier
    s_mov_b32 s38, 0x40000000
    s_cmp_eq_u32 s24, 0
    s_cselect_b32 s38, 0x80, s38
    v_mov_b32 v226, 1
    s_mov_b64 exec, 1
    buffer_atomic_add v226, v227, s[64:67], s38 offen sc0 sc1
    s_mov_b64 exec, -1
    v_mfma_f32_32x32x16_bf16 a[0:15], v[16:19], v[144:147], 0
    s_add_u32 s33, s31, 0x38000
    buffer_load_dwordx4 v[80:83], v1, s[16:19], s33 offen sc1
    v_mfma_f32_32x32x16_bf16 a[64:79], v[20:23], v[144:147], 0
    buffer_load_dwordx4 v[84:87], v1, s[16:19], s33 offen offset:1024 sc1
    s_waitcnt vmcnt(35)
    ds_read_b128 v[176:179], v4 offset:8192
    v_mfma_f32_32x32x16_bf16 a[0:15], v[24:27], v[148:151], a[0:15]
    s_add_u32 s33, s31, 0x3f000
    buffer_load_dwordx4 v[88:91], v1, s[16:19], s33 offen sc1
    v_mfma_f32_32x32x16_bf16 a[64:79], v[28:31], v[148:151], a[64:79]
    ds_read_b128 v[180:183], v5 offset:8192
    ds_read_b128 v[184:187], v6 offset:8192
    ds_read_b128 v[188:191], v7 offset:8192
    v_mfma_f32_32x32x16_bf16 a[0:15], v[32:35], v[152:155], a[0:15]
    buffer_load_dwordx4 v[92:95], v1, s[16:19], s33 offen offset:1024 sc1
    v_mfma_f32_32x32x16_bf16 a[64:79], v[36:39], v[152:155], a[64:79]
    s_add_u32 s33, s31, 0x46000
    buffer_load_dwordx4 v[96:99], v1, s[16:19], s33 offen sc1
    v_mfma_f32_32x32x16_bf16 a[0:15], v[40:43], v[156:159], a[0:15]
    buffer_load_dwordx4 v[100:103], v1, s[16:19], s33 offen offset:1024 sc1
    v_mfma_f32_32x32x16_bf16 a[64:79], v[44:47], v[156:159], a[64:79]
    s_add_u32 s33, s31, 0x4d000
    buffer_load_dwordx4 v[104:107], v1, s[16:19], s33 offen sc1
    v_mfma_f32_32x32x16_bf16 a[16:31], v[16:19], v[160:163], 0
    buffer_load_dwordx4 v[108:111], v1, s[16:19], s33 offen offset:1024 sc1
    s_add_u32 s32, s30, 0x20100
    v_mfma_f32_32x32x16_bf16 a[80:95], v[20:23], v[160:163], 0
    s_add_u32 m0, s27, 0
    s_nop 0
    buffer_load_dwordx4 v12, s[12:15], s32 offen lds
    v_mfma_f32_32x32x16_bf16 a[16:31], v[24:27], v[164:167], a[16:31]
    s_add_u32 m0, s27, 0x400
    s_nop 0
    buffer_load_dwordx4 v13, s[12:15], s32 offen lds
    v_mfma_f32_32x32x16_bf16 a[80:95], v[28:31], v[164:167], a[80:95]
    s_add_u32 m0, s27, 0x800
    s_nop 0
    buffer_load_dwordx4 v14, s[12:15], s32 offen lds
    v_mfma_f32_32x32x16_bf16 a[16:31], v[32:35], v[168:171], a[16:31]
    s_waitcnt vmcnt(40)
    ds_read_b128 v[144:147], v4 offset:12288
    ds_read_b128 v[148:151], v5 offset:12288
    ds_read_b128 v[152:155], v6 offset:12288
    v_mfma_f32_32x32x16_bf16 a[80:95], v[36:39], v[168:171], a[80:95]
    s_add_u32 m0, s27, 0xc00
    s_nop 0
    buffer_load_dwordx4 v15, s[12:15], s32 offen lds
    v_mfma_f32_32x32x16_bf16 a[16:31], v[40:43], v[172:175], a[16:31]
    ds_read_b128 v[156:159], v7 offset:12288
    s_add_u32 s32, s30, 0x40100
    v_mfma_f32_32x32x16_bf16 a[80:95], v[44:47], v[172:175], a[80:95]
    s_add_u32 m0, s27, 0x1000
    s_nop 0
    buffer_load_dwordx4 v12, s[12:15], s32 offen lds
    s_waitcnt lgkmcnt(4)
    v_mfma_f32_32x32x16_bf16 a[32:47], v[16:19], v[176:179], 0
    s_add_u32 m0, s27, 0x1400
    s_nop 0
    buffer_load_dwordx4 v13, s[12:15], s32 offen lds
    v_mfma_f32_32x32x16_bf16 a[96:111], v[20:23], v[176:179], 0
    s_add_u32 m0, s27, 0x1800
    s_nop 0
    buffer_load_dwordx4 v14, s[12:15], s32 offen lds
    v_mfma_f32_32x32x16_bf16 a[32:47], v[24:27], v[180:183], a[32:47]
    s_waitcnt vmcnt(32)
    ds_read_b128 v[160:163], v4 offset:16384
    ds_read_b128 v[164:167], v5 offset:16384
    ds_read_b128 v[168:171], v6 offset:16384
    v_mfma_f32_32x32x16_bf16 a[96:111], v[28:31], v[180:183], a[96:111]
    s_add_u32 m0, s27, 0x1c00
    s_nop 0
    buffer_load_dwordx4 v15, s[12:15], s32 offen lds
    v_mfma_f32_32x32x16_bf16 a[32:47], v[32:35], v[184:187], a[32:47]
    ds_read_b128 v[172:175], v7 offset:16384
    s_add_u32 s32, s30, 0x60100
    v_mfma_f32_32x32x16_bf16 a[96:111], v[36:39], v[184:187], a[96:111]
    s_add_u32 m0, s27, 0x2000
    s_nop 0
    buffer_load_dwordx4 v12, s[12:15], s32 offen lds
    v_mfma_f32_32x32x16_bf16 a[32:47], v[40:43], v[188:191], a[32:47]
    s_add_u32 m0, s27, 0x2400
    s_nop 0
    buffer_load_dwordx4 v13, s[12:15], s32 offen lds
    v_mfma_f32_32x32x16_bf16 a[96:111], v[44:47], v[188:191], a[96:111]
    s_add_u32 m0, s27, 0x2800
    s_nop 0
    buffer_load_dwordx4 v14, s[12:15], s32 offen lds
    s_waitcnt lgkmcnt(4)
    v_mfma_f32_32x32x16_bf16 a[48:63], v[16:19], v[144:147], 0
    s_waitcnt vmcnt(32)
    ds_read_b128 v[176:179], v4 offset:20480
    ds_read_b128 v[180:183], v5 offset:20480
    ds_read_b128 v[184:187], v6 offset:20480
    v_mfma_f32_32x32x16_bf16 a[112:127], v[20:23], v[144:147], 0
    s_add_u32 m0, s27, 0x2c00
    s_nop 0
    buffer_load_dwordx4 v15, s[12:15], s32 offen lds
    v_mfma_f32_32x32x16_bf16 a[48:63], v[24:27], v[148:151], a[48:63]
    ds_read_b128 v[188:191], v7 offset:20480
    s_add_u32 s32, s30, 0x180
    v_mfma_f32_32x32x16_bf16 a[112:127], v[28:31], v[148:151], a[112:127]
    s_add_u32 m0, s27, 0x3000
    s_nop 0
    buffer_load_dwordx4 v12, s[12:15], s32 offen lds
    v_mfma_f32_32x32x16_bf16 a[48:63], v[32:35], v[152:155], a[48:63]
    s_add_u32 m0, s27, 0x3400
    s_nop 0
    buffer_load_dwordx4 v13, s[12:15], s32 offen lds
    v_mfma_f32_32x32x16_bf16 a[112:127], v[36:39], v[152:155], a[112:127]
    s_add_u32 m0, s27, 0x3800
    s_nop 0
    buffer_load_dwordx4 v14, s[12:15], s32 offen lds
    v_mfma_f32_32x32x16_bf16 a[48:63], v[40:43], v[156:159], a[48:63]
    s_add_u32 m0, s27, 0x3c00
    s_nop 0
    buffer_load_dwordx4 v15, s[12:15], s32 offen lds
    v_mfma_f32_32x32x16_bf16 a[112:127], v[44:47], v[156:159], a[112:127]
    s_waitcnt lgkmcnt(4)
    v_mfma_f32_32x32x16_bf16 a[0:15], v[48:51], v[160:163], a[0:15]
    s_add_u32 s33, s31, 0x54000
    buffer_load_dwordx4 v[112:115], v1, s[16:19], s33 offen sc1
    v_mfma_f32_32x32x16_bf16 a[64:79], v[52:55], v[160:163], a[64:79]
    buffer_load_dwordx4 v[116:119], v1, s[16:19], s33 offen offset:1024 sc1
    s_waitcnt vmcnt(35)
    ds_read_b128 v[144:147], v4 offset:24576
    v_mfma_f32_32x32x16_bf16 a[0:15], v[56:59], v[164:167], a[0:15]
    s_add_u32 s33, s31, 0x5b000
    buffer_load_dwordx4 v[120:123], v1, s[16:19], s33 offen sc1
    v_mfma_f32_32x32x16_bf16 a[64:79], v[60:63], v[164:167], a[64:79]
    ds_read_b128 v[148:151], v5 offset:24576
    ds_read_b128 v[152:155], v6 offset:24576
    ds_read_b128 v[156:159], v7 offset:24576
    v_mfma_f32_32x32x16_bf16 a[0:15], v[64:67], v[168:171], a[0:15]
    buffer_load_dwordx4 v[124:127], v1, s[16:19], s33 offen offset:1024 sc1
    v_mfma_f32_32x32x16_bf16 a[64:79], v[68:71], v[168:171], a[64:79]
    s_add_u32 s33, s31, 0x62000
    buffer_load_dwordx4 v[128:131], v1, s[16:19], s33 offen sc1
    v_mfma_f32_32x32x16_bf16 a[0:15], v[72:75], v[172:175], a[0:15]
    buffer_load_dwordx4 v[132:135], v1, s[16:19], s33 offen offset:1024 sc1
    v_mfma_f32_32x32x16_bf16 a[64:79], v[76:79], v[172:175], a[64:79]
    s_add_u32 s33, s31, 0x69000
    buffer_load_dwordx4 v[136:139], v1, s[16:19], s33 offen sc1
    s_waitcnt lgkmcnt(4)
    v_mfma_f32_32x32x16_bf16 a[16:31], v[48:51], v[176:179], a[16:31]
    buffer_load_dwordx4 v[140:143], v1, s[16:19], s33 offen offset:1024 sc1
    s_add_u32 s32, s30, 0x20180
    v_mfma_f32_32x32x16_bf16 a[80:95], v[52:55], v[176:179], a[80:95]
    s_add_u32 m0, s27, 0x4000
    s_nop 0
    buffer_load_dwordx4 v12, s[12:15], s32 offen lds
    v_mfma_f32_32x32x16_bf16 a[16:31], v[56:59], v[180:183], a[16:31]
    s_add_u32 m0, s27, 0x4400
    s_nop 0
    buffer_load_dwordx4 v13, s[12:15], s32 offen lds
    v_mfma_f32_32x32x16_bf16 a[80:95], v[60:63], v[180:183], a[80:95]
    s_waitcnt vmcnt(34)
    v_readfirstlane_b32 s38, v226
    s_nop 0
    s_cmp_eq_u32 s38, 0xff
    s_cbranch_scc1 L4_e2_bc
    L4_e2_bcr:
    ds_read_b128 v[160:163], v4 offset:28672
    v_mfma_f32_32x32x16_bf16 a[16:31], v[64:67], v[184:187], a[16:31]
    s_add_u32 m0, s27, 0x4800
    s_nop 0
    buffer_load_dwordx4 v14, s[12:15], s32 offen lds
    v_mfma_f32_32x32x16_bf16 a[80:95], v[68:71], v[184:187], a[80:95]
    ds_read_b128 v[164:167], v5 offset:28672
    ds_read_b128 v[168:171], v6 offset:28672
    ds_read_b128 v[172:175], v7 offset:28672
    v_mfma_f32_32x32x16_bf16 a[16:31], v[72:75], v[188:191], a[16:31]
    s_add_u32 m0, s27, 0x4c00
    s_nop 0
    buffer_load_dwordx4 v15, s[12:15], s32 offen lds
    v_mfma_f32_32x32x16_bf16 a[80:95], v[76:79], v[188:191], a[80:95]
    s_add_u32 s32, s30, 0x40180
    s_waitcnt lgkmcnt(4)
    v_mfma_f32_32x32x16_bf16 a[32:47], v[48:51], v[144:147], a[32:47]
    s_add_u32 m0, s27, 0x5000
    s_nop 0
    buffer_load_dwordx4 v12, s[12:15], s32 offen lds
    v_mfma_f32_32x32x16_bf16 a[96:111], v[52:55], v[144:147], a[96:111]
    s_add_u32 m0, s27, 0x5400
    s_nop 0
    buffer_load_dwordx4 v13, s[12:15], s32 offen lds
    v_mfma_f32_32x32x16_bf16 a[32:47], v[56:59], v[148:151], a[32:47]
    s_add_u32 m0, s27, 0x5800
    s_nop 0
    buffer_load_dwordx4 v14, s[12:15], s32 offen lds
    v_mfma_f32_32x32x16_bf16 a[96:111], v[60:63], v[148:151], a[96:111]
    ds_read_b128 v[176:179], v4 offset:32768
    ds_read_b128 v[180:183], v5 offset:32768
    ds_read_b128 v[184:187], v6 offset:32768
    v_mfma_f32_32x32x16_bf16 a[32:47], v[64:67], v[152:155], a[32:47]
    s_add_u32 m0, s27, 0x5c00
    s_nop 0
    buffer_load_dwordx4 v15, s[12:15], s32 offen lds
    v_mfma_f32_32x32x16_bf16 a[96:111], v[68:71], v[152:155], a[96:111]
    ds_read_b128 v[188:191], v7 offset:32768
    s_add_u32 s32, s30, 0x60180
    v_mfma_f32_32x32x16_bf16 a[32:47], v[72:75], v[156:159], a[32:47]
    s_add_u32 m0, s27, 0x6000
    s_nop 0
    buffer_load_dwordx4 v12, s[12:15], s32 offen lds
    v_mfma_f32_32x32x16_bf16 a[96:111], v[76:79], v[156:159], a[96:111]
    s_add_u32 m0, s27, 0x6400
    s_nop 0
    buffer_load_dwordx4 v13, s[12:15], s32 offen lds
    s_waitcnt lgkmcnt(4)
    v_mfma_f32_32x32x16_bf16 a[48:63], v[48:51], v[160:163], a[48:63]
    s_add_u32 m0, s27, 0x6800
    s_nop 0
    buffer_load_dwordx4 v14, s[12:15], s32 offen lds
    v_mfma_f32_32x32x16_bf16 a[112:127], v[52:55], v[160:163], a[112:127]
    s_waitcnt vmcnt(31)
    ds_read_b128 v[144:147], v4
    ds_read_b128 v[148:151], v5
    ds_read_b128 v[152:155], v6
    v_mfma_f32_32x32x16_bf16 a[48:63], v[56:59], v[164:167], a[48:63]
    s_add_u32 m0, s27, 0x6c00
    s_nop 0
    buffer_load_dwordx4 v15, s[12:15], s32 offen lds
    v_mfma_f32_32x32x16_bf16 a[112:127], v[60:63], v[164:167], a[112:127]
    ds_read_b128 v[156:159], v7
    s_add_u32 s32, s30, 0x200
    v_mfma_f32_32x32x16_bf16 a[48:63], v[64:67], v[168:171], a[48:63]
    s_add_u32 m0, s27, 0x7000
    s_nop 0
    buffer_load_dwordx4 v12, s[12:15], s32 offen lds
    v_mfma_f32_32x32x16_bf16 a[112:127], v[68:71], v[168:171], a[112:127]
    s_add_u32 m0, s27, 0x7400
    s_nop 0
    buffer_load_dwordx4 v13, s[12:15], s32 offen lds
    v_mfma_f32_32x32x16_bf16 a[48:63], v[72:75], v[172:175], a[48:63]
    s_add_u32 m0, s27, 0x7800
    s_nop 0
    buffer_load_dwordx4 v14, s[12:15], s32 offen lds
    v_mfma_f32_32x32x16_bf16 a[112:127], v[76:79], v[172:175], a[112:127]
    s_add_u32 m0, s27, 0x7c00
    s_nop 0
    buffer_load_dwordx4 v15, s[12:15], s32 offen lds
    s_waitcnt lgkmcnt(4)
    v_mfma_f32_32x32x16_bf16 a[0:15], v[80:83], v[176:179], a[0:15]
    s_add_u32 s33, s31, 0x70000
    buffer_load_dwordx4 v[16:19], v1, s[16:19], s33 offen sc1
    v_mfma_f32_32x32x16_bf16 a[64:79], v[84:87], v[176:179], a[64:79]
    buffer_load_dwordx4 v[20:23], v1, s[16:19], s33 offen offset:1024 sc1
    s_waitcnt vmcnt(34)
    ds_read_b128 v[160:163], v4 offset:4096
    v_mfma_f32_32x32x16_bf16 a[0:15], v[88:91], v[180:183], a[0:15]
    s_add_u32 s33, s31, 0x77000
    buffer_load_dwordx4 v[24:27], v1, s[16:19], s33 offen sc1
    v_mfma_f32_32x32x16_bf16 a[64:79], v[92:95], v[180:183], a[64:79]
    ds_read_b128 v[164:167], v5 offset:4096
    ds_read_b128 v[168:171], v6 offset:4096
    ds_read_b128 v[172:175], v7 offset:4096
    v_mfma_f32_32x32x16_bf16 a[0:15], v[96:99], v[184:187], a[0:15]
    buffer_load_dwordx4 v[28:31], v1, s[16:19], s33 offen offset:1024 sc1
    v_mfma_f32_32x32x16_bf16 a[64:79], v[100:103], v[184:187], a[64:79]
    s_add_u32 s33, s31, 0x7e000
    buffer_load_dwordx4 v[32:35], v1, s[16:19], s33 offen sc1
    v_mfma_f32_32x32x16_bf16 a[0:15], v[104:107], v[188:191], a[0:15]
    buffer_load_dwordx4 v[36:39], v1, s[16:19], s33 offen offset:1024 sc1
    v_mfma_f32_32x32x16_bf16 a[64:79], v[108:111], v[188:191], a[64:79]
    s_add_u32 s33, s31, 0x85000
    buffer_load_dwordx4 v[40:43], v1, s[16:19], s33 offen sc1
    s_waitcnt lgkmcnt(4)
    v_mfma_f32_32x32x16_bf16 a[16:31], v[80:83], v[144:147], a[16:31]
    buffer_load_dwordx4 v[44:47], v1, s[16:19], s33 offen offset:1024 sc1
    s_add_u32 s32, s30, 0x20200
    v_mfma_f32_32x32x16_bf16 a[80:95], v[84:87], v[144:147], a[80:95]
    s_add_u32 m0, s27, 0x8000
    s_nop 0
    buffer_load_dwordx4 v12, s[12:15], s32 offen lds
    v_mfma_f32_32x32x16_bf16 a[16:31], v[88:91], v[148:151], a[16:31]
    s_add_u32 m0, s27, 0x8400
    s_nop 0
    buffer_load_dwordx4 v13, s[12:15], s32 offen lds
    v_mfma_f32_32x32x16_bf16 a[80:95], v[92:95], v[148:151], a[80:95]
    s_add_u32 m0, s27, 0x8800
    s_nop 0
    buffer_load_dwordx4 v14, s[12:15], s32 offen lds
    v_mfma_f32_32x32x16_bf16 a[16:31], v[96:99], v[152:155], a[16:31]
    s_waitcnt vmcnt(39)
    ds_read_b128 v[176:179], v4 offset:8192
    ds_read_b128 v[180:183], v5 offset:8192
    ds_read_b128 v[184:187], v6 offset:8192
    v_mfma_f32_32x32x16_bf16 a[80:95], v[100:103], v[152:155], a[80:95]
    s_add_u32 m0, s27, 0x8c00
    s_nop 0
    buffer_load_dwordx4 v15, s[12:15], s32 offen lds
    v_mfma_f32_32x32x16_bf16 a[16:31], v[104:107], v[156:159], a[16:31]
    ds_read_b128 v[188:191], v7 offset:8192
    s_add_u32 s32, s30, 0x40200
    v_mfma_f32_32x32x16_bf16 a[80:95], v[108:111], v[156:159], a[80:95]
    s_add_u32 m0, s27, 0
    s_nop 0
    buffer_load_dwordx4 v12, s[12:15], s32 offen lds
    s_waitcnt lgkmcnt(4)
    v_mfma_f32_32x32x16_bf16 a[32:47], v[80:83], v[160:163], a[32:47]
    s_add_u32 m0, s27, 0x400
    s_nop 0
    buffer_load_dwordx4 v13, s[12:15], s32 offen lds
    v_mfma_f32_32x32x16_bf16 a[96:111], v[84:87], v[160:163], a[96:111]
    s_add_u32 m0, s27, 0x800
    s_nop 0
    buffer_load_dwordx4 v14, s[12:15], s32 offen lds
    v_mfma_f32_32x32x16_bf16 a[32:47], v[88:91], v[164:167], a[32:47]
    s_waitcnt vmcnt(39)
    ds_read_b128 v[144:147], v4 offset:12288
    ds_read_b128 v[148:151], v5 offset:12288
    ds_read_b128 v[152:155], v6 offset:12288
    v_mfma_f32_32x32x16_bf16 a[96:111], v[92:95], v[164:167], a[96:111]
    s_add_u32 m0, s27, 0xc00
    s_nop 0
    buffer_load_dwordx4 v15, s[12:15], s32 offen lds
    v_mfma_f32_32x32x16_bf16 a[32:47], v[96:99], v[168:171], a[32:47]
    ds_read_b128 v[156:159], v7 offset:12288
    s_add_u32 s32, s30, 0x60200
    v_mfma_f32_32x32x16_bf16 a[96:111], v[100:103], v[168:171], a[96:111]
    s_add_u32 m0, s27, 0x1000
    s_nop 0
    buffer_load_dwordx4 v12, s[12:15], s32 offen lds
    v_mfma_f32_32x32x16_bf16 a[32:47], v[104:107], v[172:175], a[32:47]
    s_add_u32 m0, s27, 0x1400
    s_nop 0
    buffer_load_dwordx4 v13, s[12:15], s32 offen lds
    v_mfma_f32_32x32x16_bf16 a[96:111], v[108:111], v[172:175], a[96:111]
    s_add_u32 m0, s27, 0x1800
    s_nop 0
    buffer_load_dwordx4 v14, s[12:15], s32 offen lds
    s_waitcnt lgkmcnt(4)
    v_mfma_f32_32x32x16_bf16 a[48:63], v[80:83], v[176:179], a[48:63]
    s_waitcnt vmcnt(31)
    ds_read_b128 v[160:163], v4 offset:16384
    ds_read_b128 v[164:167], v5 offset:16384
    ds_read_b128 v[168:171], v6 offset:16384
    v_mfma_f32_32x32x16_bf16 a[112:127], v[84:87], v[176:179], a[112:127]
    s_add_u32 m0, s27, 0x1c00
    s_nop 0
    buffer_load_dwordx4 v15, s[12:15], s32 offen lds
    v_mfma_f32_32x32x16_bf16 a[48:63], v[88:91], v[180:183], a[48:63]
    ds_read_b128 v[172:175], v7 offset:16384
    s_add_u32 s32, s30, 0x280
    v_mfma_f32_32x32x16_bf16 a[112:127], v[92:95], v[180:183], a[112:127]
    s_add_u32 m0, s27, 0x2000
    s_nop 0
    buffer_load_dwordx4 v12, s[12:15], s32 offen lds
    v_mfma_f32_32x32x16_bf16 a[48:63], v[96:99], v[184:187], a[48:63]
    s_add_u32 m0, s27, 0x2400
    s_nop 0
    buffer_load_dwordx4 v13, s[12:15], s32 offen lds
    v_mfma_f32_32x32x16_bf16 a[112:127], v[100:103], v[184:187], a[112:127]
    s_add_u32 m0, s27, 0x2800
    s_nop 0
    buffer_load_dwordx4 v14, s[12:15], s32 offen lds
    v_mfma_f32_32x32x16_bf16 a[48:63], v[104:107], v[188:191], a[48:63]
    s_add_u32 m0, s27, 0x2c00
    s_nop 0
    buffer_load_dwordx4 v15, s[12:15], s32 offen lds
    v_mfma_f32_32x32x16_bf16 a[112:127], v[108:111], v[188:191], a[112:127]
    s_waitcnt lgkmcnt(4)
    v_mfma_f32_32x32x16_bf16 a[0:15], v[112:115], v[144:147], a[0:15]
    s_add_u32 s33, s31, 0x8c000
    buffer_load_dwordx4 v[48:51], v1, s[16:19], s33 offen sc1
    v_mfma_f32_32x32x16_bf16 a[64:79], v[116:119], v[144:147], a[64:79]
    buffer_load_dwordx4 v[52:55], v1, s[16:19], s33 offen offset:1024 sc1
    s_waitcnt vmcnt(34)
    ds_read_b128 v[176:179], v4 offset:20480
    v_mfma_f32_32x32x16_bf16 a[0:15], v[120:123], v[148:151], a[0:15]
    s_add_u32 s33, s31, 0x93000
    buffer_load_dwordx4 v[56:59], v1, s[16:19], s33 offen sc1
    v_mfma_f32_32x32x16_bf16 a[64:79], v[124:127], v[148:151], a[64:79]
    ds_read_b128 v[180:183], v5 offset:20480
    ds_read_b128 v[184:187], v6 offset:20480
    ds_read_b128 v[188:191], v7 offset:20480
    v_mfma_f32_32x32x16_bf16 a[0:15], v[128:131], v[152:155], a[0:15]
    buffer_load_dwordx4 v[60:63], v1, s[16:19], s33 offen offset:1024 sc1
    v_mfma_f32_32x32x16_bf16 a[64:79], v[132:135], v[152:155], a[64:79]
    s_add_u32 s33, s31, 0x9a000
    buffer_load_dwordx4 v[64:67], v1, s[16:19], s33 offen sc1
    v_mfma_f32_32x32x16_bf16 a[0:15], v[136:139], v[156:159], a[0:15]
    buffer_load_dwordx4 v[68:71], v1, s[16:19], s33 offen offset:1024 sc1
    v_mfma_f32_32x32x16_bf16 a[64:79], v[140:143], v[156:159], a[64:79]
    s_add_u32 s33, s31, 0xa1000
    buffer_load_dwordx4 v[72:75], v1, s[16:19], s33 offen sc1
    s_waitcnt lgkmcnt(4)
    v_mfma_f32_32x32x16_bf16 a[16:31], v[112:115], v[160:163], a[16:31]
    buffer_load_dwordx4 v[76:79], v1, s[16:19], s33 offen offset:1024 sc1
    s_add_u32 s32, s30, 0x20280
    v_mfma_f32_32x32x16_bf16 a[80:95], v[116:119], v[160:163], a[80:95]
    s_add_u32 m0, s27, 0x3000
    s_nop 0
    buffer_load_dwordx4 v12, s[12:15], s32 offen lds
    v_mfma_f32_32x32x16_bf16 a[16:31], v[120:123], v[164:167], a[16:31]
    s_add_u32 m0, s27, 0x3400
    s_nop 0
    buffer_load_dwordx4 v13, s[12:15], s32 offen lds
    v_mfma_f32_32x32x16_bf16 a[80:95], v[124:127], v[164:167], a[80:95]
    s_add_u32 m0, s27, 0x3800
    s_nop 0
    buffer_load_dwordx4 v14, s[12:15], s32 offen lds
    v_mfma_f32_32x32x16_bf16 a[16:31], v[128:131], v[168:171], a[16:31]
    s_waitcnt vmcnt(39)
    ds_read_b128 v[144:147], v4 offset:24576
    ds_read_b128 v[148:151], v5 offset:24576
    ds_read_b128 v[152:155], v6 offset:24576
    v_mfma_f32_32x32x16_bf16 a[80:95], v[132:135], v[168:171], a[80:95]
    s_add_u32 m0, s27, 0x3c00
    s_nop 0
    buffer_load_dwordx4 v15, s[12:15], s32 offen lds
    v_mfma_f32_32x32x16_bf16 a[16:31], v[136:139], v[172:175], a[16:31]
    ds_read_b128 v[156:159], v7 offset:24576
    s_add_u32 s32, s30, 0x40280
    v_mfma_f32_32x32x16_bf16 a[80:95], v[140:143], v[172:175], a[80:95]
    s_add_u32 m0, s27, 0x4000
    s_nop 0
    buffer_load_dwordx4 v12, s[12:15], s32 offen lds
    s_waitcnt lgkmcnt(4)
    v_mfma_f32_32x32x16_bf16 a[32:47], v[112:115], v[176:179], a[32:47]
    s_add_u32 m0, s27, 0x4400
    s_nop 0
    buffer_load_dwordx4 v13, s[12:15], s32 offen lds
    v_mfma_f32_32x32x16_bf16 a[96:111], v[116:119], v[176:179], a[96:111]
    s_add_u32 m0, s27, 0x4800
    s_nop 0
    buffer_load_dwordx4 v14, s[12:15], s32 offen lds
    v_mfma_f32_32x32x16_bf16 a[32:47], v[120:123], v[180:183], a[32:47]
    s_waitcnt vmcnt(39)
    ds_read_b128 v[160:163], v4 offset:28672
    ds_read_b128 v[164:167], v5 offset:28672
    ds_read_b128 v[168:171], v6 offset:28672
    v_mfma_f32_32x32x16_bf16 a[96:111], v[124:127], v[180:183], a[96:111]
    s_add_u32 m0, s27, 0x4c00
    s_nop 0
    buffer_load_dwordx4 v15, s[12:15], s32 offen lds
    v_mfma_f32_32x32x16_bf16 a[32:47], v[128:131], v[184:187], a[32:47]
    ds_read_b128 v[172:175], v7 offset:28672
    s_add_u32 s32, s30, 0x60280
    v_mfma_f32_32x32x16_bf16 a[96:111], v[132:135], v[184:187], a[96:111]
    s_add_u32 m0, s27, 0x5000
    s_nop 0
    buffer_load_dwordx4 v12, s[12:15], s32 offen lds
    v_mfma_f32_32x32x16_bf16 a[32:47], v[136:139], v[188:191], a[32:47]
    s_add_u32 m0, s27, 0x5400
    s_nop 0
    buffer_load_dwordx4 v13, s[12:15], s32 offen lds
    v_mfma_f32_32x32x16_bf16 a[96:111], v[140:143], v[188:191], a[96:111]
    s_add_u32 m0, s27, 0x5800
    s_nop 0
    buffer_load_dwordx4 v14, s[12:15], s32 offen lds
    s_waitcnt lgkmcnt(4)
    v_mfma_f32_32x32x16_bf16 a[48:63], v[112:115], v[144:147], a[48:63]
    s_waitcnt vmcnt(31)
    ds_read_b128 v[176:179], v4 offset:32768
    ds_read_b128 v[180:183], v5 offset:32768
    ds_read_b128 v[184:187], v6 offset:32768
    v_mfma_f32_32x32x16_bf16 a[112:127], v[116:119], v[144:147], a[112:127]
    s_add_u32 m0, s27, 0x5c00
    s_nop 0
    buffer_load_dwordx4 v15, s[12:15], s32 offen lds
    v_mfma_f32_32x32x16_bf16 a[48:63], v[120:123], v[148:151], a[48:63]
    ds_read_b128 v[188:191], v7 offset:32768
    s_add_u32 s32, s30, 0x300
    v_mfma_f32_32x32x16_bf16 a[112:127], v[124:127], v[148:151], a[112:127]
    s_add_u32 m0, s27, 0x6000
    s_nop 0
    buffer_load_dwordx4 v12, s[12:15], s32 offen lds
    v_mfma_f32_32x32x16_bf16 a[48:63], v[128:131], v[152:155], a[48:63]
    s_add_u32 m0, s27, 0x6400
    s_nop 0
    buffer_load_dwordx4 v13, s[12:15], s32 offen lds
    v_mfma_f32_32x32x16_bf16 a[112:127], v[132:135], v[152:155], a[112:127]
    s_add_u32 m0, s27, 0x6800
    s_nop 0
    buffer_load_dwordx4 v14, s[12:15], s32 offen lds
    v_mfma_f32_32x32x16_bf16 a[48:63], v[136:139], v[156:159], a[48:63]
    s_add_u32 m0, s27, 0x6c00
    s_nop 0
    buffer_load_dwordx4 v15, s[12:15], s32 offen lds
    v_mfma_f32_32x32x16_bf16 a[112:127], v[140:143], v[156:159], a[112:127]
    s_waitcnt lgkmcnt(4)
    v_mfma_f32_32x32x16_bf16 a[0:15], v[16:19], v[160:163], a[0:15]
    s_add_u32 s33, s31, 0xa8000
    buffer_load_dwordx4 v[80:83], v1, s[16:19], s33 offen sc1
    v_mfma_f32_32x32x16_bf16 a[64:79], v[20:23], v[160:163], a[64:79]
    buffer_load_dwordx4 v[84:87], v1, s[16:19], s33 offen offset:1024 sc1
    s_waitcnt vmcnt(34)
    ds_read_b128 v[144:147], v4
    v_mfma_f32_32x32x16_bf16 a[0:15], v[24:27], v[164:167], a[0:15]
    s_add_u32 s33, s31, 0xaf000
    buffer_load_dwordx4 v[88:91], v1, s[16:19], s33 offen sc1
    v_mfma_f32_32x32x16_bf16 a[64:79], v[28:31], v[164:167], a[64:79]
    ds_read_b128 v[148:151], v5
    ds_read_b128 v[152:155], v6
    ds_read_b128 v[156:159], v7
    v_mfma_f32_32x32x16_bf16 a[0:15], v[32:35], v[168:171], a[0:15]
    buffer_load_dwordx4 v[92:95], v1, s[16:19], s33 offen offset:1024 sc1
    v_mfma_f32_32x32x16_bf16 a[64:79], v[36:39], v[168:171], a[64:79]
    s_add_u32 s33, s31, 0xb6000
    buffer_load_dwordx4 v[96:99], v1, s[16:19], s33 offen sc1
    v_mfma_f32_32x32x16_bf16 a[0:15], v[40:43], v[172:175], a[0:15]
    buffer_load_dwordx4 v[100:103], v1, s[16:19], s33 offen offset:1024 sc1
    v_mfma_f32_32x32x16_bf16 a[64:79], v[44:47], v[172:175], a[64:79]
    s_add_u32 s33, s31, 0xbd000
    buffer_load_dwordx4 v[104:107], v1, s[16:19], s33 offen sc1
    s_waitcnt lgkmcnt(4)
    v_mfma_f32_32x32x16_bf16 a[16:31], v[16:19], v[176:179], a[16:31]
    buffer_load_dwordx4 v[108:111], v1, s[16:19], s33 offen offset:1024 sc1
    s_add_u32 s32, s30, 0x20300
    v_mfma_f32_32x32x16_bf16 a[80:95], v[20:23], v[176:179], a[80:95]
    s_add_u32 m0, s27, 0x7000
    s_nop 0
    buffer_load_dwordx4 v12, s[12:15], s32 offen lds
    v_mfma_f32_32x32x16_bf16 a[16:31], v[24:27], v[180:183], a[16:31]
    s_add_u32 m0, s27, 0x7400
    s_nop 0
    buffer_load_dwordx4 v13, s[12:15], s32 offen lds
    v_mfma_f32_32x32x16_bf16 a[80:95], v[28:31], v[180:183], a[80:95]
    s_add_u32 m0, s27, 0x7800
    s_nop 0
    buffer_load_dwordx4 v14, s[12:15], s32 offen lds
    v_mfma_f32_32x32x16_bf16 a[16:31], v[32:35], v[184:187], a[16:31]
    s_waitcnt vmcnt(39)
    ds_read_b128 v[160:163], v4 offset:4096
    ds_read_b128 v[164:167], v5 offset:4096
    ds_read_b128 v[168:171], v6 offset:4096
    v_mfma_f32_32x32x16_bf16 a[80:95], v[36:39], v[184:187], a[80:95]
    s_add_u32 m0, s27, 0x7c00
    s_nop 0
    buffer_load_dwordx4 v15, s[12:15], s32 offen lds
    v_mfma_f32_32x32x16_bf16 a[16:31], v[40:43], v[188:191], a[16:31]
    ds_read_b128 v[172:175], v7 offset:4096
    s_add_u32 s32, s30, 0x40300
    v_mfma_f32_32x32x16_bf16 a[80:95], v[44:47], v[188:191], a[80:95]
    s_add_u32 m0, s27, 0x8000
    s_nop 0
    buffer_load_dwordx4 v12, s[12:15], s32 offen lds
    s_waitcnt lgkmcnt(4)
    v_mfma_f32_32x32x16_bf16 a[32:47], v[16:19], v[144:147], a[32:47]
    s_add_u32 m0, s27, 0x8400
    s_nop 0
    buffer_load_dwordx4 v13, s[12:15], s32 offen lds
    v_mfma_f32_32x32x16_bf16 a[96:111], v[20:23], v[144:147], a[96:111]
    s_add_u32 m0, s27, 0x8800
    s_nop 0
    buffer_load_dwordx4 v14, s[12:15], s32 offen lds
    v_mfma_f32_32x32x16_bf16 a[32:47], v[24:27], v[148:151], a[32:47]
    s_waitcnt vmcnt(39)
    ds_read_b128 v[176:179], v4 offset:8192
    ds_read_b128 v[180:183], v5 offset:8192
    ds_read_b128 v[184:187], v6 offset:8192
    v_mfma_f32_32x32x16_bf16 a[96:111], v[28:31], v[148:151], a[96:111]
    s_add_u32 m0, s27, 0x8c00
    s_nop 0
    buffer_load_dwordx4 v15, s[12:15], s32 offen lds
    v_mfma_f32_32x32x16_bf16 a[32:47], v[32:35], v[152:155], a[32:47]
    ds_read_b128 v[188:191], v7 offset:8192
    s_add_u32 s32, s30, 0x60300
    v_mfma_f32_32x32x16_bf16 a[96:111], v[36:39], v[152:155], a[96:111]
    s_add_u32 m0, s27, 0
    s_nop 0
    buffer_load_dwordx4 v12, s[12:15], s32 offen lds
    v_mfma_f32_32x32x16_bf16 a[32:47], v[40:43], v[156:159], a[32:47]
    s_add_u32 m0, s27, 0x400
    s_nop 0
    buffer_load_dwordx4 v13, s[12:15], s32 offen lds
    v_mfma_f32_32x32x16_bf16 a[96:111], v[44:47], v[156:159], a[96:111]
    s_add_u32 m0, s27, 0x800
    s_nop 0
    buffer_load_dwordx4 v14, s[12:15], s32 offen lds
    s_waitcnt lgkmcnt(4)
    v_mfma_f32_32x32x16_bf16 a[48:63], v[16:19], v[160:163], a[48:63]
    s_waitcnt vmcnt(31)
    ds_read_b128 v[144:147], v4 offset:12288
    ds_read_b128 v[148:151], v5 offset:12288
    ds_read_b128 v[152:155], v6 offset:12288
    v_mfma_f32_32x32x16_bf16 a[112:127], v[20:23], v[160:163], a[112:127]
    s_add_u32 m0, s27, 0xc00
    s_nop 0
    buffer_load_dwordx4 v15, s[12:15], s32 offen lds
    v_mfma_f32_32x32x16_bf16 a[48:63], v[24:27], v[164:167], a[48:63]
    ds_read_b128 v[156:159], v7 offset:12288
    s_add_u32 s32, s30, 0x380
    v_mfma_f32_32x32x16_bf16 a[112:127], v[28:31], v[164:167], a[112:127]
    s_add_u32 m0, s27, 0x1000
    s_nop 0
    buffer_load_dwordx4 v12, s[12:15], s32 offen lds
    v_mfma_f32_32x32x16_bf16 a[48:63], v[32:35], v[168:171], a[48:63]
    s_add_u32 m0, s27, 0x1400
    s_nop 0
    buffer_load_dwordx4 v13, s[12:15], s32 offen lds
    v_mfma_f32_32x32x16_bf16 a[112:127], v[36:39], v[168:171], a[112:127]
    s_add_u32 m0, s27, 0x1800
    s_nop 0
    buffer_load_dwordx4 v14, s[12:15], s32 offen lds
    v_mfma_f32_32x32x16_bf16 a[48:63], v[40:43], v[172:175], a[48:63]
    s_add_u32 m0, s27, 0x1c00
    s_nop 0
    buffer_load_dwordx4 v15, s[12:15], s32 offen lds
    v_mfma_f32_32x32x16_bf16 a[112:127], v[44:47], v[172:175], a[112:127]
    s_waitcnt lgkmcnt(4)
    v_mfma_f32_32x32x16_bf16 a[0:15], v[48:51], v[176:179], a[0:15]
    s_add_u32 s33, s31, 0xc4000
    buffer_load_dwordx4 v[112:115], v1, s[16:19], s33 offen sc1
    v_mfma_f32_32x32x16_bf16 a[64:79], v[52:55], v[176:179], a[64:79]
    buffer_load_dwordx4 v[116:119], v1, s[16:19], s33 offen offset:1024 sc1
    s_waitcnt vmcnt(34)
    ds_read_b128 v[160:163], v4 offset:16384
    v_mfma_f32_32x32x16_bf16 a[0:15], v[56:59], v[180:183], a[0:15]
    s_add_u32 s33, s31, 0xcb000
    buffer_load_dwordx4 v[120:123], v1, s[16:19], s33 offen sc1
    v_mfma_f32_32x32x16_bf16 a[64:79], v[60:63], v[180:183], a[64:79]
    ds_read_b128 v[164:167], v5 offset:16384
    ds_read_b128 v[168:171], v6 offset:16384
    ds_read_b128 v[172:175], v7 offset:16384
    v_mfma_f32_32x32x16_bf16 a[0:15], v[64:67], v[184:187], a[0:15]
    buffer_load_dwordx4 v[124:127], v1, s[16:19], s33 offen offset:1024 sc1
    v_mfma_f32_32x32x16_bf16 a[64:79], v[68:71], v[184:187], a[64:79]
    s_add_u32 s33, s31, 0xd2000
    buffer_load_dwordx4 v[128:131], v1, s[16:19], s33 offen sc1
    v_mfma_f32_32x32x16_bf16 a[0:15], v[72:75], v[188:191], a[0:15]
    buffer_load_dwordx4 v[132:135], v1, s[16:19], s33 offen offset:1024 sc1
    v_mfma_f32_32x32x16_bf16 a[64:79], v[76:79], v[188:191], a[64:79]
    s_add_u32 s33, s31, 0xd9000
    buffer_load_dwordx4 v[136:139], v1, s[16:19], s33 offen sc1
    s_waitcnt lgkmcnt(4)
    v_mfma_f32_32x32x16_bf16 a[16:31], v[48:51], v[144:147], a[16:31]
    buffer_load_dwordx4 v[140:143], v1, s[16:19], s33 offen offset:1024 sc1
    s_add_u32 s32, s30, 0x20380
    v_mfma_f32_32x32x16_bf16 a[80:95], v[52:55], v[144:147], a[80:95]
    s_add_u32 m0, s27, 0x2000
    s_nop 0
    buffer_load_dwordx4 v12, s[12:15], s32 offen lds
    v_mfma_f32_32x32x16_bf16 a[16:31], v[56:59], v[148:151], a[16:31]
    s_add_u32 m0, s27, 0x2400
    s_nop 0
    buffer_load_dwordx4 v13, s[12:15], s32 offen lds
    v_mfma_f32_32x32x16_bf16 a[80:95], v[60:63], v[148:151], a[80:95]
    s_add_u32 m0, s27, 0x2800
    s_nop 0
    buffer_load_dwordx4 v14, s[12:15], s32 offen lds
    v_mfma_f32_32x32x16_bf16 a[16:31], v[64:67], v[152:155], a[16:31]
    s_waitcnt vmcnt(39)
    ds_read_b128 v[176:179], v4 offset:20480
    ds_read_b128 v[180:183], v5 offset:20480
    ds_read_b128 v[184:187], v6 offset:20480
    v_mfma_f32_32x32x16_bf16 a[80:95], v[68:71], v[152:155], a[80:95]
    s_add_u32 m0, s27, 0x2c00
    s_nop 0
    buffer_load_dwordx4 v15, s[12:15], s32 offen lds
    v_mfma_f32_32x32x16_bf16 a[16:31], v[72:75], v[156:159], a[16:31]
    ds_read_b128 v[188:191], v7 offset:20480
    s_add_u32 s32, s30, 0x40380
    v_mfma_f32_32x32x16_bf16 a[80:95], v[76:79], v[156:159], a[80:95]
    s_add_u32 m0, s27, 0x3000
    s_nop 0
    buffer_load_dwordx4 v12, s[12:15], s32 offen lds
    s_waitcnt lgkmcnt(4)
    v_mfma_f32_32x32x16_bf16 a[32:47], v[48:51], v[160:163], a[32:47]
    s_add_u32 m0, s27, 0x3400
    s_nop 0
    buffer_load_dwordx4 v13, s[12:15], s32 offen lds
    v_mfma_f32_32x32x16_bf16 a[96:111], v[52:55], v[160:163], a[96:111]
    s_add_u32 m0, s27, 0x3800
    s_nop 0
    buffer_load_dwordx4 v14, s[12:15], s32 offen lds
    v_mfma_f32_32x32x16_bf16 a[32:47], v[56:59], v[164:167], a[32:47]
    s_waitcnt vmcnt(39)
    ds_read_b128 v[144:147], v4 offset:24576
    ds_read_b128 v[148:151], v5 offset:24576
    ds_read_b128 v[152:155], v6 offset:24576
    v_mfma_f32_32x32x16_bf16 a[96:111], v[60:63], v[164:167], a[96:111]
    s_add_u32 m0, s27, 0x3c00
    s_nop 0
    buffer_load_dwordx4 v15, s[12:15], s32 offen lds
    v_mfma_f32_32x32x16_bf16 a[32:47], v[64:67], v[168:171], a[32:47]
    ds_read_b128 v[156:159], v7 offset:24576
    s_add_u32 s32, s30, 0x60380
    v_mfma_f32_32x32x16_bf16 a[96:111], v[68:71], v[168:171], a[96:111]
    s_add_u32 m0, s27, 0x4000
    s_nop 0
    buffer_load_dwordx4 v12, s[12:15], s32 offen lds
    v_mfma_f32_32x32x16_bf16 a[32:47], v[72:75], v[172:175], a[32:47]
    s_add_u32 m0, s27, 0x4400
    s_nop 0
    buffer_load_dwordx4 v13, s[12:15], s32 offen lds
    v_mfma_f32_32x32x16_bf16 a[96:111], v[76:79], v[172:175], a[96:111]
    s_add_u32 m0, s27, 0x4800
    s_nop 0
    buffer_load_dwordx4 v14, s[12:15], s32 offen lds
    s_waitcnt lgkmcnt(4)
    v_mfma_f32_32x32x16_bf16 a[48:63], v[48:51], v[176:179], a[48:63]
    s_waitcnt vmcnt(31)
    ds_read_b128 v[160:163], v4 offset:28672
    ds_read_b128 v[164:167], v5 offset:28672
    ds_read_b128 v[168:171], v6 offset:28672
    v_mfma_f32_32x32x16_bf16 a[112:127], v[52:55], v[176:179], a[112:127]
    s_add_u32 m0, s27, 0x4c00
    s_nop 0
    buffer_load_dwordx4 v15, s[12:15], s32 offen lds
    v_mfma_f32_32x32x16_bf16 a[48:63], v[56:59], v[180:183], a[48:63]
    ds_read_b128 v[172:175], v7 offset:28672
    v_mfma_f32_32x32x16_bf16 a[112:127], v[60:63], v[180:183], a[112:127]
    v_mfma_f32_32x32x16_bf16 a[48:63], v[64:67], v[184:187], a[48:63]
    v_mfma_f32_32x32x16_bf16 a[112:127], v[68:71], v[184:187], a[112:127]
    v_mfma_f32_32x32x16_bf16 a[48:63], v[72:75], v[188:191], a[48:63]
    v_mfma_f32_32x32x16_bf16 a[112:127], v[76:79], v[188:191], a[112:127]
    s_waitcnt lgkmcnt(4)
    v_mfma_f32_32x32x16_bf16 a[0:15], v[80:83], v[144:147], a[0:15]
    s_waitcnt vmcnt(28)
    ds_read_b128 v[176:179], v4 offset:32768
    ds_read_b128 v[180:183], v5 offset:32768
    ds_read_b128 v[184:187], v6 offset:32768
    v_mfma_f32_32x32x16_bf16 a[64:79], v[84:87], v[144:147], a[64:79]
    ds_read_b128 v[188:191], v7 offset:32768
    v_mfma_f32_32x32x16_bf16 a[0:15], v[88:91], v[148:151], a[0:15]
    s_lshl_b32 s28, s25, 2
    s_add_u32 s28, s28, s24
    s_mul_i32 s29, s28, 0xe000
    s_lshl_b32 s32, s26, 12
    s_add_u32 s29, s29, s32
    s_add_u32 s29, s29, 0x4400000
    v_mfma_f32_32x32x16_bf16 a[64:79], v[92:95], v[148:151], a[64:79]
    buffer_load_dwordx4 v[208:211], v1, s[16:19], s29 offen sc1
    v_mfma_f32_32x32x16_bf16 a[0:15], v[96:99], v[152:155], a[0:15]
    buffer_load_dwordx4 v[212:215], v1, s[16:19], s29 offen offset:1024 sc1
    v_mfma_f32_32x32x16_bf16 a[64:79], v[100:103], v[152:155], a[64:79]
    buffer_load_dwordx4 v[216:219], v1, s[16:19], s29 offen offset:2048 sc1
    v_mfma_f32_32x32x16_bf16 a[0:15], v[104:107], v[156:159], a[0:15]
    buffer_load_dwordx4 v[220:223], v1, s[16:19], s29 offen offset:3072 sc1
    v_mfma_f32_32x32x16_bf16 a[64:79], v[108:111], v[156:159], a[64:79]
    v_and_b32 v9, 31, v0
    v_lshlrev_b32 v10, 2, v9
    v_lshlrev_b32 v9, 1, v9
    s_lshl_b32 s33, s28, 7
    s_add_u32 s33, s33, 0x4c10000
    s_lshl_b32 s31, s28, 6
    s_waitcnt lgkmcnt(4)
    v_mfma_f32_32x32x16_bf16 a[16:31], v[80:83], v[160:163], a[16:31]
    s_waitcnt vmcnt(28)
    ds_read_b128 v[144:147], v4
    ds_read_b128 v[148:151], v5
    ds_read_b128 v[152:155], v6
    v_mfma_f32_32x32x16_bf16 a[80:95], v[84:87], v[160:163], a[80:95]
    ds_read_b128 v[156:159], v7
    buffer_load_dword v224, v10, s[16:19], s33 offen sc1
    v_mfma_f32_32x32x16_bf16 a[16:31], v[88:91], v[164:167], a[16:31]
    buffer_load_ushort v225, v9, s[20:23], s31 offen
    s_mul_i32 s29, s28, 0x4e000
    s_add_u32 s29, s29, s32
    s_add_u32 s29, s29, 0x3040000
    v_mfma_f32_32x32x16_bf16 a[80:95], v[92:95], v[164:167], a[80:95]
    v_mfma_f32_32x32x16_bf16 a[16:31], v[96:99], v[168:171], a[16:31]
    v_mfma_f32_32x32x16_bf16 a[80:95], v[100:103], v[168:171], a[80:95]
    v_mfma_f32_32x32x16_bf16 a[16:31], v[104:107], v[172:175], a[16:31]
    v_mfma_f32_32x32x16_bf16 a[80:95], v[108:111], v[172:175], a[80:95]
    s_waitcnt lgkmcnt(4)
    v_mfma_f32_32x32x16_bf16 a[32:47], v[80:83], v[176:179], a[32:47]
    s_waitcnt vmcnt(26)
    ds_read_b128 v[160:163], v4 offset:4096
    ds_read_b128 v[164:167], v5 offset:4096
    ds_read_b128 v[168:171], v6 offset:4096
    ds_read_b128 v[172:175], v7 offset:4096
    v_mfma_f32_32x32x16_bf16 a[96:111], v[84:87], v[176:179], a[96:111]
    v_mfma_f32_32x32x16_bf16 a[32:47], v[88:91], v[180:183], a[32:47]
    v_mfma_f32_32x32x16_bf16 a[96:111], v[92:95], v[180:183], a[96:111]
    v_mfma_f32_32x32x16_bf16 a[32:47], v[96:99], v[184:187], a[32:47]
    v_mfma_f32_32x32x16_bf16 a[96:111], v[100:103], v[184:187], a[96:111]
    v_mfma_f32_32x32x16_bf16 a[32:47], v[104:107], v[188:191], a[32:47]
    v_mfma_f32_32x32x16_bf16 a[96:111], v[108:111], v[188:191], a[96:111]
    s_waitcnt lgkmcnt(4)
    v_mfma_f32_32x32x16_bf16 a[48:63], v[80:83], v[144:147], a[48:63]
    s_waitcnt vmcnt(14)
    ds_read_b128 v[176:179], v4 offset:8192
    ds_read_b128 v[180:183], v5 offset:8192
    ds_read_b128 v[184:187], v6 offset:8192
    ds_read_b128 v[188:191], v7 offset:8192
    v_mfma_f32_32x32x16_bf16 a[112:127], v[84:87], v[144:147], a[112:127]
    v_mfma_f32_32x32x16_bf16 a[48:63], v[88:91], v[148:151], a[48:63]
    v_mfma_f32_32x32x16_bf16 a[112:127], v[92:95], v[148:151], a[112:127]
    v_mfma_f32_32x32x16_bf16 a[48:63], v[96:99], v[152:155], a[48:63]
    v_mfma_f32_32x32x16_bf16 a[112:127], v[100:103], v[152:155], a[112:127]
    v_mfma_f32_32x32x16_bf16 a[48:63], v[104:107], v[156:159], a[48:63]
    v_mfma_f32_32x32x16_bf16 a[112:127], v[108:111], v[156:159], a[112:127]
    s_waitcnt lgkmcnt(4)
    v_mfma_f32_32x32x16_bf16 a[0:15], v[112:115], v[160:163], a[0:15]
    s_waitcnt vmcnt(10)
    ds_read_b128 v[144:147], v4 offset:12288
    ds_read_b128 v[148:151], v5 offset:12288
    ds_read_b128 v[152:155], v6 offset:12288
    ds_read_b128 v[156:159], v7 offset:12288
    v_mfma_f32_32x32x16_bf16 a[64:79], v[116:119], v[160:163], a[64:79]
    v_mfma_f32_32x32x16_bf16 a[0:15], v[120:123], v[164:167], a[0:15]
    s_waitcnt vmcnt(5)
    v_lshlrev_b32 v16, 16, v208
    v_and_b32 v17, 0xffff0000, v208
    v_lshlrev_b32 v18, 16, v209
    v_and_b32 v19, 0xffff0000, v209
    v_lshlrev_b32 v20, 16, v210
    v_and_b32 v21, 0xffff0000, v210
    v_lshlrev_b32 v22, 16, v211
    v_and_b32 v23, 0xffff0000, v211
    s_waitcnt vmcnt(4)
    v_lshlrev_b32 v24, 16, v212
    v_and_b32 v25, 0xffff0000, v212
    v_lshlrev_b32 v26, 16, v213
    v_and_b32 v27, 0xffff0000, v213
    v_mfma_f32_32x32x16_bf16 a[64:79], v[124:127], v[164:167], a[64:79]
    v_lshlrev_b32 v28, 16, v214
    v_and_b32 v29, 0xffff0000, v214
    v_lshlrev_b32 v30, 16, v215
    v_and_b32 v31, 0xffff0000, v215
    s_waitcnt vmcnt(3)
    v_lshlrev_b32 v32, 16, v216
    v_and_b32 v33, 0xffff0000, v216
    v_lshlrev_b32 v34, 16, v217
    v_and_b32 v35, 0xffff0000, v217
    v_lshlrev_b32 v36, 16, v218
    v_and_b32 v37, 0xffff0000, v218
    v_lshlrev_b32 v38, 16, v219
    v_and_b32 v39, 0xffff0000, v219
    v_mfma_f32_32x32x16_bf16 a[0:15], v[128:131], v[168:171], a[0:15]
    s_waitcnt vmcnt(2)
    v_lshlrev_b32 v40, 16, v220
    v_and_b32 v41, 0xffff0000, v220
    v_lshlrev_b32 v42, 16, v221
    v_and_b32 v43, 0xffff0000, v221
    v_lshlrev_b32 v44, 16, v222
    v_and_b32 v45, 0xffff0000, v222
    v_lshlrev_b32 v46, 16, v223
    v_and_b32 v47, 0xffff0000, v223
    v_mul_f32 v48, v16, v16
    v_mul_f32 v49, v17, v17
    v_mul_f32 v50, v18, v18
    v_mul_f32 v51, v19, v19
    v_mfma_f32_32x32x16_bf16 a[64:79], v[132:135], v[168:171], a[64:79]
    v_mul_f32 v52, v20, v20
    v_mul_f32 v53, v21, v21
    v_mul_f32 v54, v22, v22
    v_mul_f32 v55, v23, v23
    v_mul_f32 v56, v24, v24
    v_mul_f32 v57, v25, v25
    v_mul_f32 v58, v26, v26
    v_mul_f32 v59, v27, v27
    v_mul_f32 v60, v28, v28
    v_mul_f32 v61, v29, v29
    v_mul_f32 v62, v30, v30
    v_mul_f32 v63, v31, v31
    v_mfma_f32_32x32x16_bf16 a[0:15], v[136:139], v[172:175], a[0:15]
    v_mul_f32 v64, v32, v32
    v_mul_f32 v65, v33, v33
    v_mul_f32 v66, v34, v34
    v_mul_f32 v67, v35, v35
    v_mul_f32 v68, v36, v36
    v_mul_f32 v69, v37, v37
    v_mul_f32 v70, v38, v38
    v_mul_f32 v71, v39, v39
    v_mul_f32 v72, v40, v40
    v_mul_f32 v73, v41, v41
    v_mul_f32 v74, v42, v42
    v_mul_f32 v75, v43, v43
    v_mfma_f32_32x32x16_bf16 a[64:79], v[140:143], v[172:175], a[64:79]
    v_mul_f32 v76, v44, v44
    v_mul_f32 v77, v45, v45
    v_mul_f32 v78, v46, v46
    v_mul_f32 v79, v47, v47
    v_fma_f32 v48, v48, v3, v2
    v_fma_f32 v49, v49, v3, v2
    v_fma_f32 v50, v50, v3, v2
    v_fma_f32 v51, v51, v3, v2
    v_fma_f32 v52, v52, v3, v2
    v_fma_f32 v53, v53, v3, v2
    v_fma_f32 v54, v54, v3, v2
    v_fma_f32 v55, v55, v3, v2
    s_waitcnt lgkmcnt(4)
    v_mfma_f32_32x32x16_bf16 a[16:31], v[112:115], v[176:179], a[16:31]
    ds_read_b128 v[160:163], v4 offset:16384
    ds_read_b128 v[164:167], v5 offset:16384
    ds_read_b128 v[168:171], v6 offset:16384
    ds_read_b128 v[172:175], v7 offset:16384
    v_fma_f32 v56, v56, v3, v2
    v_fma_f32 v57, v57, v3, v2
    v_fma_f32 v58, v58, v3, v2
    v_fma_f32 v59, v59, v3, v2
    v_mfma_f32_32x32x16_bf16 a[80:95], v[116:119], v[176:179], a[80:95]
    v_fma_f32 v60, v60, v3, v2
    v_fma_f32 v61, v61, v3, v2
    v_fma_f32 v62, v62, v3, v2
    v_fma_f32 v63, v63, v3, v2
    v_fma_f32 v64, v64, v3, v2
    v_fma_f32 v65, v65, v3, v2
    v_fma_f32 v66, v66, v3, v2
    v_fma_f32 v67, v67, v3, v2
    v_fma_f32 v68, v68, v3, v2
    v_fma_f32 v69, v69, v3, v2
    v_fma_f32 v70, v70, v3, v2
    v_fma_f32 v71, v71, v3, v2
    v_mfma_f32_32x32x16_bf16 a[16:31], v[120:123], v[180:183], a[16:31]
    v_fma_f32 v72, v72, v3, v2
    v_fma_f32 v73, v73, v3, v2
    v_fma_f32 v74, v74, v3, v2
    v_fma_f32 v75, v75, v3, v2
    v_fma_f32 v76, v76, v3, v2
    v_fma_f32 v77, v77, v3, v2
    v_fma_f32 v78, v78, v3, v2
    v_fma_f32 v79, v79, v3, v2
    v_mul_f32 v48, v16, v48
    v_mul_f32 v49, v17, v49
    v_mul_f32 v50, v18, v50
    v_mul_f32 v51, v19, v51
    v_mfma_f32_32x32x16_bf16 a[80:95], v[124:127], v[180:183], a[80:95]
    v_mul_f32 v52, v20, v52
    v_mul_f32 v53, v21, v53
    v_mul_f32 v54, v22, v54
    v_mul_f32 v55, v23, v55
    v_mul_f32 v56, v24, v56
    v_mul_f32 v57, v25, v57
    v_mul_f32 v58, v26, v58
    v_mul_f32 v59, v27, v59
    v_mul_f32 v60, v28, v60
    v_mul_f32 v61, v29, v61
    v_mul_f32 v62, v30, v62
    v_mul_f32 v63, v31, v63
    v_mfma_f32_32x32x16_bf16 a[16:31], v[128:131], v[184:187], a[16:31]
    v_mul_f32 v64, v32, v64
    v_mul_f32 v65, v33, v65
    v_mul_f32 v66, v34, v66
    v_mul_f32 v67, v35, v67
    v_mul_f32 v68, v36, v68
    v_mul_f32 v69, v37, v69
    v_mul_f32 v70, v38, v70
    v_mul_f32 v71, v39, v71
    v_mul_f32 v72, v40, v72
    v_mul_f32 v73, v41, v73
    v_mul_f32 v74, v42, v74
    v_mul_f32 v75, v43, v75
    v_mfma_f32_32x32x16_bf16 a[80:95], v[132:135], v[184:187], a[80:95]
    v_mul_f32 v76, v44, v76
    v_mul_f32 v77, v45, v77
    v_mul_f32 v78, v46, v78
    v_mul_f32 v79, v47, v79
    v_exp_f32 v48, v48
    v_exp_f32 v49, v49
    v_exp_f32 v50, v50
    v_exp_f32 v51, v51
    v_mfma_f32_32x32x16_bf16 a[16:31], v[136:139], v[188:191], a[16:31]
    v_exp_f32 v52, v52
    v_exp_f32 v53, v53
    v_exp_f32 v54, v54
    v_exp_f32 v55, v55
    v_exp_f32 v56, v56
    v_exp_f32 v57, v57
    v_mfma_f32_32x32x16_bf16 a[80:95], v[140:143], v[188:191], a[80:95]
    v_exp_f32 v58, v58
    v_exp_f32 v59, v59
    v_exp_f32 v60, v60
    v_exp_f32 v61, v61
    v_exp_f32 v62, v62
    v_exp_f32 v63, v63
    s_waitcnt lgkmcnt(4)
    v_mfma_f32_32x32x16_bf16 a[32:47], v[112:115], v[144:147], a[32:47]
    v_exp_f32 v64, v64
    v_exp_f32 v65, v65
    v_exp_f32 v66, v66
    v_exp_f32 v67, v67
    v_exp_f32 v68, v68
    v_exp_f32 v69, v69
    v_mfma_f32_32x32x16_bf16 a[96:111], v[116:119], v[144:147], a[96:111]
    v_exp_f32 v70, v70
    v_exp_f32 v71, v71
    v_exp_f32 v72, v72
    v_exp_f32 v73, v73
    v_exp_f32 v74, v74
    v_exp_f32 v75, v75
    v_mfma_f32_32x32x16_bf16 a[32:47], v[120:123], v[148:151], a[32:47]
    v_exp_f32 v76, v76
    v_exp_f32 v77, v77
    v_exp_f32 v78, v78
    v_exp_f32 v79, v79
    v_add_f32 v48, 1.0, v48
    v_add_f32 v49, 1.0, v49
    v_add_f32 v50, 1.0, v50
    v_add_f32 v51, 1.0, v51
    v_add_f32 v52, 1.0, v52
    v_mfma_f32_32x32x16_bf16 a[96:111], v[124:127], v[148:151], a[96:111]
    v_add_f32 v53, 1.0, v53
    v_add_f32 v54, 1.0, v54
    v_add_f32 v55, 1.0, v55
    v_add_f32 v56, 1.0, v56
    v_add_f32 v57, 1.0, v57
    v_add_f32 v58, 1.0, v58
    v_add_f32 v59, 1.0, v59
    v_add_f32 v60, 1.0, v60
    v_add_f32 v61, 1.0, v61
    v_add_f32 v62, 1.0, v62
    v_add_f32 v63, 1.0, v63
    v_add_f32 v64, 1.0, v64
    v_add_f32 v65, 1.0, v65
    v_mfma_f32_32x32x16_bf16 a[32:47], v[128:131], v[152:155], a[32:47]
    v_add_f32 v66, 1.0, v66
    v_add_f32 v67, 1.0, v67
    v_add_f32 v68, 1.0, v68
    v_add_f32 v69, 1.0, v69
    v_add_f32 v70, 1.0, v70
    v_add_f32 v71, 1.0, v71
    v_add_f32 v72, 1.0, v72
    v_add_f32 v73, 1.0, v73
    v_add_f32 v74, 1.0, v74
    v_add_f32 v75, 1.0, v75
    v_add_f32 v76, 1.0, v76
    v_add_f32 v77, 1.0, v77
    v_add_f32 v78, 1.0, v78
    v_mfma_f32_32x32x16_bf16 a[96:111], v[132:135], v[152:155], a[96:111]
    v_add_f32 v79, 1.0, v79
    v_rcp_f32 v48, v48
    v_rcp_f32 v49, v49
    v_rcp_f32 v50, v50
    v_rcp_f32 v51, v51
    v_rcp_f32 v52, v52
    v_rcp_f32 v53, v53
    v_mfma_f32_32x32x16_bf16 a[32:47], v[136:139], v[156:159], a[32:47]
    v_rcp_f32 v54, v54
    v_rcp_f32 v55, v55
    v_rcp_f32 v56, v56
    v_rcp_f32 v57, v57
    v_rcp_f32 v58, v58
    v_rcp_f32 v59, v59
    v_mfma_f32_32x32x16_bf16 a[96:111], v[140:143], v[156:159], a[96:111]
    v_rcp_f32 v60, v60
    v_rcp_f32 v61, v61
    v_rcp_f32 v62, v62
    v_rcp_f32 v63, v63
    v_rcp_f32 v64, v64
    v_rcp_f32 v65, v65
    s_waitcnt lgkmcnt(0)
    v_mfma_f32_32x32x16_bf16 a[48:63], v[112:115], v[160:163], a[48:63]
    s_lshl_b32 s38, s2, 8
    s_add_u32 s38, s38, 0x4e20000
    buffer_load_dword v228, v227, s[16:19], s38 offen sc1
    v_rcp_f32 v66, v66
    v_rcp_f32 v67, v67
    v_rcp_f32 v68, v68
    v_mfma_f32_32x32x16_bf16 a[112:127], v[116:119], v[160:163], a[112:127]
    v_rcp_f32 v69, v69
    v_rcp_f32 v70, v70
    v_rcp_f32 v71, v71
    v_rcp_f32 v72, v72
    v_rcp_f32 v73, v73
    v_rcp_f32 v74, v74
    v_mfma_f32_32x32x16_bf16 a[48:63], v[120:123], v[164:167], a[48:63]
    v_rcp_f32 v75, v75
    v_rcp_f32 v76, v76
    v_rcp_f32 v77, v77
    v_rcp_f32 v78, v78
    v_rcp_f32 v79, v79
    v_mul_f32 v16, v16, v48
    v_mul_f32 v17, v17, v49
    v_mul_f32 v18, v18, v50
    v_mfma_f32_32x32x16_bf16 a[112:127], v[124:127], v[164:167], a[112:127]
    v_mul_f32 v19, v19, v51
    v_mul_f32 v20, v20, v52
    v_mul_f32 v21, v21, v53
    v_mul_f32 v22, v22, v54
    v_mul_f32 v23, v23, v55
    v_mul_f32 v24, v24, v56
    v_mul_f32 v25, v25, v57
    v_mul_f32 v26, v26, v58
    v_mul_f32 v27, v27, v59
    v_mul_f32 v28, v28, v60
    v_mul_f32 v29, v29, v61
    v_mul_f32 v30, v30, v62
    v_mul_f32 v31, v31, v63
    v_mfma_f32_32x32x16_bf16 a[48:63], v[128:131], v[168:171], a[48:63]
    v_mul_f32 v32, v32, v64
    v_mul_f32 v33, v33, v65
    v_mul_f32 v34, v34, v66
    v_mul_f32 v35, v35, v67
    v_mul_f32 v36, v36, v68
    v_mul_f32 v37, v37, v69
    v_mul_f32 v38, v38, v70
    v_mul_f32 v39, v39, v71
    v_mul_f32 v40, v40, v72
    v_mul_f32 v41, v41, v73
    v_mul_f32 v42, v42, v74
    v_mul_f32 v43, v43, v75
    v_mul_f32 v44, v44, v76
    v_mfma_f32_32x32x16_bf16 a[112:127], v[132:135], v[168:171], a[112:127]
    v_mul_f32 v45, v45, v77
    v_mul_f32 v46, v46, v78
    v_mul_f32 v47, v47, v79
    s_waitcnt vmcnt(2)
    v_sub_f32 v224, 1.0, v224
    s_waitcnt vmcnt(1)
    v_lshlrev_b32 v225, 16, v225
    v_mul_f32 v16, v16, v224
    v_mul_f32 v17, v17, v224
    v_mul_f32 v18, v18, v224
    v_mul_f32 v19, v19, v224
    v_mul_f32 v20, v20, v224
    v_mul_f32 v21, v21, v224
    v_mul_f32 v22, v22, v224
    v_mfma_f32_32x32x16_bf16 a[48:63], v[136:139], v[172:175], a[48:63]
    v_mul_f32 v23, v23, v224
    v_mul_f32 v24, v24, v224
    v_mul_f32 v25, v25, v224
    v_mul_f32 v26, v26, v224
    v_mul_f32 v27, v27, v224
    v_mul_f32 v28, v28, v224
    v_mul_f32 v29, v29, v224
    v_mul_f32 v30, v30, v224
    v_mul_f32 v31, v31, v224
    v_mul_f32 v32, v32, v224
    v_mul_f32 v33, v33, v224
    v_mul_f32 v34, v34, v224
    v_mul_f32 v35, v35, v224
    v_mfma_f32_32x32x16_bf16 a[112:127], v[140:143], v[172:175], a[112:127]
    v_mul_f32 v36, v36, v224
    v_mul_f32 v37, v37, v224
    v_mul_f32 v38, v38, v224
    v_mul_f32 v39, v39, v224
    v_mul_f32 v40, v40, v224
    v_mul_f32 v41, v41, v224
    v_mul_f32 v42, v42, v224
    v_mul_f32 v43, v43, v224
    v_mul_f32 v44, v44, v224
    v_mul_f32 v45, v45, v224
    v_mul_f32 v46, v46, v224
    v_mul_f32 v47, v47, v224
L4_red:
    v_add_u32 v8, s27, v1
    ds_write_b128 v8, a[0:3]
    ds_write_b128 v8, a[4:7] offset:1024
    ds_write_b128 v8, a[8:11] offset:2048
    ds_write_b128 v8, a[12:15] offset:3072
    ds_write_b128 v8, a[64:67] offset:4096
    ds_write_b128 v8, a[68:71] offset:5120
    ds_write_b128 v8, a[72:75] offset:6144
    ds_write_b128 v8, a[76:79] offset:7168
    ds_write_b128 v8, a[16:19] offset:8192
    ds_write_b128 v8, a[20:23] offset:9216
    ds_write_b128 v8, a[24:27] offset:10240
    ds_write_b128 v8, a[28:31] offset:11264
    ds_write_b128 v8, a[80:83] offset:12288
    ds_write_b128 v8, a[84:87] offset:13312
    ds_write_b128 v8, a[88:91] offset:14336
    ds_write_b128 v8, a[92:95] offset:15360
    ds_write_b128 v8, a[32:35] offset:16384
    ds_write_b128 v8, a[36:39] offset:17408
    ds_write_b128 v8, a[40:43] offset:18432
    ds_write_b128 v8, a[44:47] offset:19456
    ds_write_b128 v8, a[96:99] offset:20480
    ds_write_b128 v8, a[100:103] offset:21504
    ds_write_b128 v8, a[104:107] offset:22528
    ds_write_b128 v8, a[108:111] offset:23552
    ds_write_b128 v8, a[48:51] offset:24576
    ds_write_b128 v8, a[52:55] offset:25600
    ds_write_b128 v8, a[56:59] offset:26624
    ds_write_b128 v8, a[60:63] offset:27648
    ds_write_b128 v8, a[112:115] offset:28672
    ds_write_b128 v8, a[116:119] offset:29696
    ds_write_b128 v8, a[120:123] offset:30720
    ds_write_b128 v8, a[124:127] offset:31744
    s_lshl_b32 s28, s24, 13
    v_add_u32 v8, s28, v1
    v_add_u32 v11, 0x12000, v8
    s_waitcnt lgkmcnt(0)
    s_barrier
    ds_read_b128 v[80:83], v8
    ds_read_b128 v[112:115], v8 offset:36864
    ds_read_b128 v[144:147], v11
    ds_read_b128 v[176:179], v11 offset:36864
    ds_read_b128 v[84:87], v8 offset:1024
    ds_read_b128 v[116:119], v8 offset:37888
    ds_read_b128 v[148:151], v11 offset:1024
    ds_read_b128 v[180:183], v11 offset:37888
    ds_read_b128 v[88:91], v8 offset:2048
    ds_read_b128 v[120:123], v8 offset:38912
    ds_read_b128 v[152:155], v11 offset:2048
    ds_read_b128 v[184:187], v11 offset:38912
    ds_read_b128 v[92:95], v8 offset:3072
    ds_read_b128 v[124:127], v8 offset:39936
    ds_read_b128 v[156:159], v11 offset:3072
    ds_read_b128 v[188:191], v11 offset:39936
    ds_read_b128 v[96:99], v8 offset:4096
    ds_read_b128 v[128:131], v8 offset:40960
    ds_read_b128 v[160:163], v11 offset:4096
    ds_read_b128 v[192:195], v11 offset:40960
    ds_read_b128 v[100:103], v8 offset:5120
    ds_read_b128 v[132:135], v8 offset:41984
    ds_read_b128 v[164:167], v11 offset:5120
    ds_read_b128 v[196:199], v11 offset:41984
    ds_read_b128 v[104:107], v8 offset:6144
    ds_read_b128 v[136:139], v8 offset:43008
    ds_read_b128 v[168:171], v11 offset:6144
    ds_read_b128 v[200:203], v11 offset:43008
    ds_read_b128 v[108:111], v8 offset:7168
    ds_read_b128 v[140:143], v8 offset:44032
    ds_read_b128 v[172:175], v11 offset:7168
    ds_read_b128 v[204:207], v11 offset:44032
    s_waitcnt lgkmcnt(15)
    v_add_f32 v80, v80, v112
    v_add_f32 v144, v144, v176
    v_add_f32 v81, v81, v113
    v_add_f32 v145, v145, v177
    v_add_f32 v82, v82, v114
    v_add_f32 v146, v146, v178
    v_add_f32 v83, v83, v115
    v_add_f32 v147, v147, v179
    v_add_f32 v84, v84, v116
    v_add_f32 v148, v148, v180
    v_add_f32 v85, v85, v117
    v_add_f32 v149, v149, v181
    v_add_f32 v86, v86, v118
    v_add_f32 v150, v150, v182
    v_add_f32 v87, v87, v119
    v_add_f32 v151, v151, v183
    v_add_f32 v80, v80, v225
    v_add_f32 v81, v81, v225
    v_add_f32 v82, v82, v225
    v_add_f32 v83, v83, v225
    v_add_f32 v84, v84, v225
    v_add_f32 v85, v85, v225
    v_add_f32 v86, v86, v225
    v_add_f32 v87, v87, v225
    v_add_f32 v80, v80, v144
    v_add_f32 v81, v81, v145
    v_add_f32 v82, v82, v146
    v_add_f32 v83, v83, v147
    v_add_f32 v84, v84, v148
    v_add_f32 v85, v85, v149
    v_add_f32 v86, v86, v150
    v_add_f32 v87, v87, v151
    v_mul_f32 v80, v80, v16
    v_mul_f32 v81, v81, v17
    v_mul_f32 v82, v82, v18
    v_mul_f32 v83, v83, v19
    v_mul_f32 v84, v84, v20
    v_mul_f32 v85, v85, v21
    v_mul_f32 v86, v86, v22
    v_mul_f32 v87, v87, v23
    v_cvt_pk_bf16_f32 v48, v80, v81
    v_cvt_pk_bf16_f32 v49, v82, v83
    v_cvt_pk_bf16_f32 v50, v84, v85
    v_cvt_pk_bf16_f32 v51, v86, v87
    buffer_store_dwordx4 v[48:51], v1, s[16:19], s29 offen sc1
    v_add_f32 v88, v88, v120
    v_add_f32 v152, v152, v184
    v_add_f32 v89, v89, v121
    v_add_f32 v153, v153, v185
    v_add_f32 v90, v90, v122
    v_add_f32 v154, v154, v186
    v_add_f32 v91, v91, v123
    v_add_f32 v155, v155, v187
    v_add_f32 v92, v92, v124
    v_add_f32 v156, v156, v188
    v_add_f32 v93, v93, v125
    v_add_f32 v157, v157, v189
    v_add_f32 v94, v94, v126
    v_add_f32 v158, v158, v190
    v_add_f32 v95, v95, v127
    v_add_f32 v159, v159, v191
    v_add_f32 v88, v88, v225
    v_add_f32 v89, v89, v225
    v_add_f32 v90, v90, v225
    v_add_f32 v91, v91, v225
    v_add_f32 v92, v92, v225
    v_add_f32 v93, v93, v225
    v_add_f32 v94, v94, v225
    v_add_f32 v95, v95, v225
    v_add_f32 v88, v88, v152
    v_add_f32 v89, v89, v153
    v_add_f32 v90, v90, v154
    v_add_f32 v91, v91, v155
    v_add_f32 v92, v92, v156
    v_add_f32 v93, v93, v157
    v_add_f32 v94, v94, v158
    v_add_f32 v95, v95, v159
    v_mul_f32 v88, v88, v24
    v_mul_f32 v89, v89, v25
    v_mul_f32 v90, v90, v26
    v_mul_f32 v91, v91, v27
    v_mul_f32 v92, v92, v28
    v_mul_f32 v93, v93, v29
    v_mul_f32 v94, v94, v30
    v_mul_f32 v95, v95, v31
    v_cvt_pk_bf16_f32 v52, v88, v89
    v_cvt_pk_bf16_f32 v53, v90, v91
    v_cvt_pk_bf16_f32 v54, v92, v93
    v_cvt_pk_bf16_f32 v55, v94, v95
    buffer_store_dwordx4 v[52:55], v1, s[16:19], s29 offen offset:1024 sc1
    s_waitcnt lgkmcnt(14)
    v_add_f32 v96, v96, v128
    s_waitcnt lgkmcnt(12)
    v_add_f32 v160, v160, v192
    v_add_f32 v97, v97, v129
    v_add_f32 v161, v161, v193
    v_add_f32 v98, v98, v130
    v_add_f32 v162, v162, v194
    v_add_f32 v99, v99, v131
    v_add_f32 v163, v163, v195
    s_waitcnt lgkmcnt(10)
    v_add_f32 v100, v100, v132
    s_waitcnt lgkmcnt(8)
    v_add_f32 v164, v164, v196
    v_add_f32 v101, v101, v133
    v_add_f32 v165, v165, v197
    v_add_f32 v102, v102, v134
    v_add_f32 v166, v166, v198
    v_add_f32 v103, v103, v135
    v_add_f32 v167, v167, v199
    v_add_f32 v96, v96, v225
    v_add_f32 v97, v97, v225
    v_add_f32 v98, v98, v225
    v_add_f32 v99, v99, v225
    v_add_f32 v100, v100, v225
    v_add_f32 v101, v101, v225
    v_add_f32 v102, v102, v225
    v_add_f32 v103, v103, v225
    v_add_f32 v96, v96, v160
    v_add_f32 v97, v97, v161
    v_add_f32 v98, v98, v162
    v_add_f32 v99, v99, v163
    v_add_f32 v100, v100, v164
    v_add_f32 v101, v101, v165
    v_add_f32 v102, v102, v166
    v_add_f32 v103, v103, v167
    v_mul_f32 v96, v96, v32
    v_mul_f32 v97, v97, v33
    v_mul_f32 v98, v98, v34
    v_mul_f32 v99, v99, v35
    v_mul_f32 v100, v100, v36
    v_mul_f32 v101, v101, v37
    v_mul_f32 v102, v102, v38
    v_mul_f32 v103, v103, v39
    v_cvt_pk_bf16_f32 v56, v96, v97
    v_cvt_pk_bf16_f32 v57, v98, v99
    v_cvt_pk_bf16_f32 v58, v100, v101
    v_cvt_pk_bf16_f32 v59, v102, v103
    buffer_store_dwordx4 v[56:59], v1, s[16:19], s29 offen offset:2048 sc1
    s_waitcnt lgkmcnt(6)
    v_add_f32 v104, v104, v136
    s_waitcnt lgkmcnt(4)
    v_add_f32 v168, v168, v200
    v_add_f32 v105, v105, v137
    v_add_f32 v169, v169, v201
    v_add_f32 v106, v106, v138
    v_add_f32 v170, v170, v202
    v_add_f32 v107, v107, v139
    v_add_f32 v171, v171, v203
    s_waitcnt lgkmcnt(2)
    v_add_f32 v108, v108, v140
    s_waitcnt lgkmcnt(0)
    v_add_f32 v172, v172, v204
    v_add_f32 v109, v109, v141
    v_add_f32 v173, v173, v205
    v_add_f32 v110, v110, v142
    v_add_f32 v174, v174, v206
    v_add_f32 v111, v111, v143
    v_add_f32 v175, v175, v207
    v_add_f32 v104, v104, v225
    v_add_f32 v105, v105, v225
    v_add_f32 v106, v106, v225
    v_add_f32 v107, v107, v225
    v_add_f32 v108, v108, v225
    v_add_f32 v109, v109, v225
    v_add_f32 v110, v110, v225
    v_add_f32 v111, v111, v225
    v_add_f32 v104, v104, v168
    v_add_f32 v105, v105, v169
    v_add_f32 v106, v106, v170
    v_add_f32 v107, v107, v171
    v_add_f32 v108, v108, v172
    v_add_f32 v109, v109, v173
    v_add_f32 v110, v110, v174
    v_add_f32 v111, v111, v175
    v_mul_f32 v104, v104, v40
    v_mul_f32 v105, v105, v41
    v_mul_f32 v106, v106, v42
    v_mul_f32 v107, v107, v43
    v_mul_f32 v108, v108, v44
    v_mul_f32 v109, v109, v45
    v_mul_f32 v110, v110, v46
    v_mul_f32 v111, v111, v47
    v_cvt_pk_bf16_f32 v60, v104, v105
    v_cvt_pk_bf16_f32 v61, v106, v107
    v_cvt_pk_bf16_f32 v62, v108, v109
    v_cvt_pk_bf16_f32 v63, v110, v111
    buffer_store_dwordx4 v[60:63], v1, s[16:19], s29 offen offset:3072 sc1
    s_waitcnt vmcnt(4)
L5_o:
    L5_c3:
    v_readfirstlane_b32 s38, v228
    s_nop 0
    s_cmp_eq_u32 s38, 0
    s_cbranch_scc1 L5_c3_spin
    v_mov_b32 v15, 0
    v_mov_b32 v14, 0
    v_mov_b32 v2, v1
    v_add_u32 v3, 0x4e000, v1
    v_add_u32 v4, 0x9c000, v1
    v_add_u32 v5, 0xea000, v1
    v_lshrrev_b32 v16, 2, v0
    v_and_b32 v16, 7, v16
    v_lshlrev_b32 v16, 10, v16
    v_lshrrev_b32 v17, 5, v0
    v_lshl_add_u32 v16, v17, 6, v16
    v_and_b32 v17, 3, v0
    v_lshl_add_u32 v6, v17, 4, v16
    v_add_u32 v7, 0x2000, v6
    v_add_u32 v8, 0x80, v6
    v_add_u32 v9, 0x2080, v6
    s_and_b32 s82, s24, 1
    s_lshl_b32 s82, s82, 11
    v_add_u32 v12, s82, v1
    s_lshr_b32 s82, s24, 1
    s_lshl_b32 s82, s82, 11
    s_add_u32 s82, s82, 0x1000
    v_lshrrev_b32 v16, 2, v0
    v_and_b32 v16, 3, v16
    v_lshlrev_b32 v16, 6, v16
    v_lshrrev_b32 v17, 5, v0
    v_lshl_add_u32 v16, v17, 8, v16
    v_lshrrev_b32 v17, 4, v0
    v_and_b32 v17, 1, v17
    v_lshl_add_u32 v16, v17, 5, v16
    v_and_b32 v17, 3, v0
    v_lshl_add_u32 v16, v17, 3, v16
    v_add_u32 v13, s82, v16
    v_mov_b32 v10, v12
    v_mov_b32 v11, v13
    s_waitcnt lgkmcnt(0)
    s_barrier
    s_cmp_lt_u32 s71, s72
    s_cselect_b32 s77, s73, 0x40000000
    s_cselect_b32 s78, s74, 0x40000000
    s_add_u32 m0, s79, 0
    s_nop 0
    buffer_load_dwordx4 v2, s[16:19], s77 offen sc1 lds
    s_add_u32 m0, s79, 0x400
    s_nop 0
    buffer_load_dwordx4 v3, s[16:19], s77 offen sc1 lds
    s_add_u32 m0, s79, 0x800
    s_nop 0
    buffer_load_dwordx4 v4, s[16:19], s77 offen sc1 lds
    s_add_u32 m0, s79, 0xc00
    s_nop 0
    buffer_load_dwordx4 v5, s[16:19], s77 offen sc1 lds
    s_add_u32 m0, s79, 0x1000
    s_nop 0
    buffer_load_dwordx4 v6, s[56:59], s78 offen lds
    s_add_u32 m0, s79, 0x1400
    s_nop 0
    buffer_load_dwordx4 v7, s[56:59], s78 offen lds
    s_add_u32 m0, s79, 0x1800
    s_nop 0
    buffer_load_dwordx4 v8, s[56:59], s78 offen lds
    s_add_u32 m0, s79, 0x1c00
    s_nop 0
    buffer_load_dwordx4 v9, s[56:59], s78 offen lds
    s_add_u32 s73, s73, 0x1000
    s_add_u32 s74, s74, 0x10000
    s_add_u32 s71, s71, 1
    s_add_u32 s79, s79, 0x8000
    s_sub_u32 s84, s79, 0x28000
    s_cmp_ge_u32 s79, 0x28000
    s_cselect_b32 s79, s84, s79
    s_cmp_lt_u32 s71, s72
    s_cselect_b32 s77, s73, 0x40000000
    s_cselect_b32 s78, s74, 0x40000000
    s_add_u32 m0, s79, 0
    s_nop 0
    buffer_load_dwordx4 v2, s[16:19], s77 offen sc1 lds
    s_add_u32 m0, s79, 0x400
    s_nop 0
    buffer_load_dwordx4 v3, s[16:19], s77 offen sc1 lds
    s_add_u32 m0, s79, 0x800
    s_nop 0
    buffer_load_dwordx4 v4, s[16:19], s77 offen sc1 lds
    s_add_u32 m0, s79, 0xc00
    s_nop 0
    buffer_load_dwordx4 v5, s[16:19], s77 offen sc1 lds
    s_add_u32 m0, s79, 0x1000
    s_nop 0
    buffer_load_dwordx4 v6, s[56:59], s78 offen lds
    s_add_u32 m0, s79, 0x1400
    s_nop 0
    buffer_load_dwordx4 v7, s[56:59], s78 offen lds
    s_add_u32 m0, s79, 0x1800
    s_nop 0
    buffer_load_dwordx4 v8, s[56:59], s78 offen lds
    s_add_u32 m0, s79, 0x1c00
    s_nop 0
    buffer_load_dwordx4 v9, s[56:59], s78 offen lds
    s_add_u32 s73, s73, 0x1000
    s_add_u32 s74, s74, 0x10000
    s_add_u32 s71, s71, 1
    s_add_u32 s79, s79, 0x8000
    s_sub_u32 s84, s79, 0x28000
    s_cmp_ge_u32 s79, 0x28000
    s_cselect_b32 s79, s84, s79
    s_cmp_lt_u32 s71, s72
    s_cselect_b32 s77, s73, 0x40000000
    s_cselect_b32 s78, s74, 0x40000000
    s_add_u32 m0, s79, 0
    s_nop 0
    buffer_load_dwordx4 v2, s[16:19], s77 offen sc1 lds
    s_add_u32 m0, s79, 0x400
    s_nop 0
    buffer_load_dwordx4 v3, s[16:19], s77 offen sc1 lds
    s_add_u32 m0, s79, 0x800
    s_nop 0
    buffer_load_dwordx4 v4, s[16:19], s77 offen sc1 lds
    s_add_u32 m0, s79, 0xc00
    s_nop 0
    buffer_load_dwordx4 v5, s[16:19], s77 offen sc1 lds
    s_add_u32 m0, s79, 0x1000
    s_nop 0
    buffer_load_dwordx4 v6, s[56:59], s78 offen lds
    s_add_u32 m0, s79, 0x1400
    s_nop 0
    buffer_load_dwordx4 v7, s[56:59], s78 offen lds
    s_add_u32 m0, s79, 0x1800
    s_nop 0
    buffer_load_dwordx4 v8, s[56:59], s78 offen lds
    s_add_u32 m0, s79, 0x1c00
    s_nop 0
    buffer_load_dwordx4 v9, s[56:59], s78 offen lds
    s_add_u32 s73, s73, 0x1000
    s_add_u32 s74, s74, 0x10000
    s_add_u32 s71, s71, 1
    s_add_u32 s79, s79, 0x8000
    s_sub_u32 s84, s79, 0x28000
    s_cmp_ge_u32 s79, 0x28000
    s_cselect_b32 s79, s84, s79
    s_cmp_lt_u32 s71, s72
    s_cselect_b32 s77, s73, 0x40000000
    s_cselect_b32 s78, s74, 0x40000000
    s_add_u32 m0, s79, 0
    s_nop 0
    buffer_load_dwordx4 v2, s[16:19], s77 offen sc1 lds
    s_add_u32 m0, s79, 0x400
    s_nop 0
    buffer_load_dwordx4 v3, s[16:19], s77 offen sc1 lds
    s_add_u32 m0, s79, 0x800
    s_nop 0
    buffer_load_dwordx4 v4, s[16:19], s77 offen sc1 lds
    s_add_u32 m0, s79, 0xc00
    s_nop 0
    buffer_load_dwordx4 v5, s[16:19], s77 offen sc1 lds
    v_mov_b32 v20, 0
    v_mov_b32 v21, 0
    v_mov_b32 v22, 0
    v_mov_b32 v23, 0
    s_nop 1
    v_mfma_f32_32x32x16_bf16 a[0:15], v[20:23], v[20:23], 0
    v_mfma_f32_32x32x16_bf16 a[16:31], v[20:23], v[20:23], 0
    v_mfma_f32_32x32x16_bf16 a[32:47], v[20:23], v[20:23], 0
    v_mfma_f32_32x32x16_bf16 a[48:63], v[20:23], v[20:23], 0
    s_waitcnt vmcnt(28)
    s_barrier
    s_cmp_ge_u32 s2, 0xe0
    s_cbranch_scc1 L5_np
L5_p0:
    s_cmp_lg_u32 s24, 0
    s_cbranch_scc1 L5_np
L5_p1:
    s_lshl_b32 s82, s25, 8
    s_add_u32 s82, s82, 0x4d00000
    v_mov_b32 v16, 1
    s_mov_b64 exec, 1
    buffer_atomic_add v16, v15, s[16:19], s82 offen sc1
    s_mov_b64 exec, -1
L5_np:
    s_waitcnt vmcnt(20)
    s_barrier
    ds_read_b128 v[32:35], v10
    ds_read_b128 v[36:39], v10 offset:1024
    ds_read_b64_tr_b16 v[40:41], v11
    ds_read_b64_tr_b16 v[42:43], v11 offset:1024
    ds_read_b64_tr_b16 v[44:45], v11 offset:512
    ds_read_b64_tr_b16 v[46:47], v11 offset:1536
    ds_read_b128 v[48:51], v10 offset:8192
    ds_read_b128 v[52:55], v10 offset:9216
    ds_read_b64_tr_b16 v[56:57], v11 offset:8192
    ds_read_b64_tr_b16 v[58:59], v11 offset:9216
    ds_read_b64_tr_b16 v[60:61], v11 offset:8704
    ds_read_b64_tr_b16 v[62:63], v11 offset:9728
    s_waitcnt lgkmcnt(0)
L5_loop:
    s_waitcnt lgkmcnt(6)
    v_mfma_f32_32x32x16_bf16 a[0:15], v[40:43], v[32:35], a[0:15]
    s_add_u32 m0, s79, 0x1000
    s_nop 0
    buffer_load_dwordx4 v6, s[56:59], s78 offen lds
    v_mfma_f32_32x32x16_bf16 a[16:31], v[40:43], v[36:39], a[16:31]
    ds_read_b128 v[64:67], v10 offset:16384
    ds_read_b128 v[68:71], v10 offset:17408
    ds_read_b64_tr_b16 v[72:73], v11 offset:16384
    v_mfma_f32_32x32x16_bf16 a[32:47], v[44:47], v[32:35], a[32:47]
    s_add_u32 m0, s79, 0x1400
    s_nop 0
    buffer_load_dwordx4 v7, s[56:59], s78 offen lds
    ds_read_b64_tr_b16 v[74:75], v11 offset:17408
    v_mfma_f32_32x32x16_bf16 a[48:63], v[44:47], v[36:39], a[48:63]
    ds_read_b64_tr_b16 v[76:77], v11 offset:16896
    ds_read_b64_tr_b16 v[78:79], v11 offset:17920
    s_waitcnt lgkmcnt(6)
    v_mfma_f32_32x32x16_bf16 a[0:15], v[56:59], v[48:51], a[0:15]
    s_add_u32 m0, s79, 0x1800
    s_nop 0
    buffer_load_dwordx4 v8, s[56:59], s78 offen lds
    ds_read_b128 v[80:83], v10 offset:24576
    v_mfma_f32_32x32x16_bf16 a[16:31], v[56:59], v[52:55], a[16:31]
    s_add_u32 m0, s79, 0x1c00
    s_nop 0
    buffer_load_dwordx4 v9, s[56:59], s78 offen lds
    ds_read_b128 v[84:87], v10 offset:25600
    v_mfma_f32_32x32x16_bf16 a[32:47], v[60:63], v[48:51], a[32:47]
    s_add_u32 s73, s73, 0x1000
    s_add_u32 s74, s74, 0x10000
    s_add_u32 s71, s71, 1
    s_add_u32 s79, s79, 0x8000
    s_sub_u32 s84, s79, 0x28000
    s_cmp_ge_u32 s79, 0x28000
    s_cselect_b32 s79, s84, s79
    s_add_u32 s80, s80, 0x8000
    s_cmp_ge_u32 s80, 0x28000
    s_cselect_b32 s80, 0, s80
    v_mfma_f32_32x32x16_bf16 a[48:63], v[60:63], v[52:55], a[48:63]
    ds_read_b64_tr_b16 v[88:89], v11 offset:24576
    ds_read_b64_tr_b16 v[90:91], v11 offset:25600
    ds_read_b64_tr_b16 v[92:93], v11 offset:25088
    ds_read_b64_tr_b16 v[94:95], v11 offset:26112
    s_waitcnt vmcnt(16)
    s_barrier
    v_add_u32 v10, s80, v12
    v_add_u32 v11, s80, v13
    s_cmp_eq_u32 s71, s87
    s_cbranch_scc1 L5_ev
    L5_chkd:
    s_waitcnt lgkmcnt(6)
    v_mfma_f32_32x32x16_bf16 a[0:15], v[72:75], v[64:67], a[0:15]
    ds_read_b128 v[32:35], v10
    ds_read_b128 v[36:39], v10 offset:1024
    ds_read_b64_tr_b16 v[40:41], v11
    v_mfma_f32_32x32x16_bf16 a[16:31], v[72:75], v[68:71], a[16:31]
    ds_read_b64_tr_b16 v[42:43], v11 offset:1024
    ds_read_b64_tr_b16 v[44:45], v11 offset:512
    s_cmp_lt_u32 s71, s72
    s_cselect_b32 s77, s73, 0x40000000
    s_cselect_b32 s78, s74, 0x40000000
    v_mfma_f32_32x32x16_bf16 a[32:47], v[76:79], v[64:67], a[32:47]
    ds_read_b64_tr_b16 v[46:47], v11 offset:1536
    v_mfma_f32_32x32x16_bf16 a[48:63], v[76:79], v[68:71], a[48:63]
    s_add_u32 m0, s79, 0
    s_nop 0
    buffer_load_dwordx4 v2, s[16:19], s77 offen sc1 lds
    s_waitcnt lgkmcnt(6)
    v_mfma_f32_32x32x16_bf16 a[0:15], v[88:91], v[80:83], a[0:15]
    s_add_u32 m0, s79, 0x400
    s_nop 0
    buffer_load_dwordx4 v3, s[16:19], s77 offen sc1 lds
    ds_read_b128 v[48:51], v10 offset:8192
    v_mfma_f32_32x32x16_bf16 a[16:31], v[88:91], v[84:87], a[16:31]
    s_add_u32 m0, s79, 0x800
    s_nop 0
    buffer_load_dwordx4 v4, s[16:19], s77 offen sc1 lds
    ds_read_b128 v[52:55], v10 offset:9216
    v_mfma_f32_32x32x16_bf16 a[32:47], v[92:95], v[80:83], a[32:47]
    ds_read_b64_tr_b16 v[56:57], v11 offset:8192
    s_add_u32 m0, s79, 0xc00
    s_nop 0
    buffer_load_dwordx4 v5, s[16:19], s77 offen sc1 lds
    v_mfma_f32_32x32x16_bf16 a[48:63], v[92:95], v[84:87], a[48:63]
    ds_read_b64_tr_b16 v[58:59], v11 offset:9216
    ds_read_b64_tr_b16 v[60:61], v11 offset:8704
    ds_read_b64_tr_b16 v[62:63], v11 offset:9728
    s_sub_u32 s81, s81, 1
    s_cmp_lg_u32 s81, 0
    s_cbranch_scc1 L5_loop
L5_r:
    s_lshl_b32 s82, s69, 2
    s_add_u32 s82, s82, s70
    s_lshl_b32 s86, s82, 18
    s_add_u32 s86, s86, 0x5400000
    s_lshl_b32 s82, s68, 2
    s_add_u32 s82, s82, s24
    s_lshl_b32 s82, s82, 14
    s_add_u32 s82, s82, s86
    s_cmp_eq_u32 s24, s68
    s_cbranch_scc1 L5_own
L5_st:
    buffer_store_dwordx4 a[0:3], v1, s[16:19], s82 offen sc1
    buffer_store_dwordx4 a[4:7], v1, s[16:19], s82 offen offset:1024 sc1
    buffer_store_dwordx4 a[8:11], v1, s[16:19], s82 offen offset:2048 sc1
    buffer_store_dwordx4 a[12:15], v1, s[16:19], s82 offen offset:3072 sc1
    s_add_u32 s82, s82, 0x1000
    buffer_store_dwordx4 a[16:19], v1, s[16:19], s82 offen sc1
    buffer_store_dwordx4 a[20:23], v1, s[16:19], s82 offen offset:1024 sc1
    buffer_store_dwordx4 a[24:27], v1, s[16:19], s82 offen offset:2048 sc1
    buffer_store_dwordx4 a[28:31], v1, s[16:19], s82 offen offset:3072 sc1
    s_add_u32 s82, s82, 0x1000
    buffer_store_dwordx4 a[32:35], v1, s[16:19], s82 offen sc1
    buffer_store_dwordx4 a[36:39], v1, s[16:19], s82 offen offset:1024 sc1
    buffer_store_dwordx4 a[40:43], v1, s[16:19], s82 offen offset:2048 sc1
    buffer_store_dwordx4 a[44:47], v1, s[16:19], s82 offen offset:3072 sc1
    s_add_u32 s82, s82, 0x1000
    buffer_store_dwordx4 a[48:51], v1, s[16:19], s82 offen sc1
    buffer_store_dwordx4 a[52:55], v1, s[16:19], s82 offen offset:1024 sc1
    buffer_store_dwordx4 a[56:59], v1, s[16:19], s82 offen offset:2048 sc1
    buffer_store_dwordx4 a[60:63], v1, s[16:19], s82 offen offset:3072 sc1
    s_waitcnt vmcnt(16)
    s_barrier
    s_branch L5_st2
L5_own:
    s_waitcnt vmcnt(0)
    s_barrier
    ds_write_b128 v1, a[0:3]
    ds_write_b128 v1, a[4:7] offset:1024
    ds_write_b128 v1, a[8:11] offset:2048
    ds_write_b128 v1, a[12:15] offset:3072
    ds_write_b128 v1, a[16:19] offset:4096
    ds_write_b128 v1, a[20:23] offset:5120
    ds_write_b128 v1, a[24:27] offset:6144
    ds_write_b128 v1, a[28:31] offset:7168
    ds_write_b128 v1, a[32:35] offset:8192
    ds_write_b128 v1, a[36:39] offset:9216
    ds_write_b128 v1, a[40:43] offset:10240
    ds_write_b128 v1, a[44:47] offset:11264
    ds_write_b128 v1, a[48:51] offset:12288
    ds_write_b128 v1, a[52:55] offset:13312
    ds_write_b128 v1, a[56:59] offset:14336
    ds_write_b128 v1, a[60:63] offset:15360
L5_st2:
    v_mov_b32 v16, 1
    v_and_b32 v17, 31, v0
    v_lshlrev_b32 v17, 10, v17
    v_lshrrev_b32 v18, 5, v0
    v_lshl_add_u32 v17, v18, 4, v17
    s_lshl_b32 s77, s69, 17
    s_and_b32 s84, s68, 1
    s_lshl_b32 s84, s84, 16
    s_add_u32 s77, s77, s84
    s_and_b32 s84, s24, 1
    s_lshl_b32 s84, s84, 15
    s_add_u32 s77, s77, s84
    s_lshl_b32 s84, s70, 8
    s_add_u32 s77, s77, s84
    s_lshr_b32 s84, s68, 1
    s_lshl_b32 s84, s84, 7
    s_add_u32 s77, s77, s84
    s_lshr_b32 s84, s24, 1
    s_lshl_b32 s84, s84, 6
    s_add_u32 s77, s77, s84
    s_lshl_b32 s84, s68, 14
    s_add_u32 s78, s86, s84
    s_lshl_b32 s84, s24, 12
    s_add_u32 s78, s78, s84
    s_waitcnt vmcnt(0) lgkmcnt(0)
    s_barrier
    s_lshl_b32 s84, s24, 12
    v_add_u32 v19, s84, v1
    ds_read_b128 v[32:35], v19
    ds_read_b128 v[36:39], v19 offset:1024
    ds_read_b128 v[40:43], v19 offset:2048
    ds_read_b128 v[44:47], v19 offset:3072
    s_cmp_lg_u32 s24, 0
    s_cbranch_scc1 L5_r2
L5_r1:
    s_mov_b64 exec, 1
    buffer_atomic_add v16, v15, s[16:19], s88 offen sc1
L5_poll:
    buffer_load_dword v14, v15, s[16:19], s88 offen sc1
    s_waitcnt vmcnt(0)
    v_readfirstlane_b32 s84, v14
    s_nop 0
    s_cmp_lt_u32 s84, 4
    s_cbranch_scc1 L5_poll
L5_r1b:
    s_mov_b64 exec, -1
L5_r2:
    s_barrier
    s_xor_b32 s84, s68, 1
    s_lshl_b32 s84, s84, 16
    s_add_u32 s84, s84, s78
    buffer_load_dwordx4 v[48:51], v1, s[16:19], s84 offen sc1
    buffer_load_dwordx4 v[52:55], v1, s[16:19], s84 offen offset:1024 sc1
    buffer_load_dwordx4 v[56:59], v1, s[16:19], s84 offen offset:2048 sc1
    buffer_load_dwordx4 v[60:63], v1, s[16:19], s84 offen offset:3072 sc1
    s_xor_b32 s84, s68, 2
    s_lshl_b32 s84, s84, 16
    s_add_u32 s84, s84, s78
    buffer_load_dwordx4 v[64:67], v1, s[16:19], s84 offen sc1
    buffer_load_dwordx4 v[68:71], v1, s[16:19], s84 offen offset:1024 sc1
    buffer_load_dwordx4 v[72:75], v1, s[16:19], s84 offen offset:2048 sc1
    buffer_load_dwordx4 v[76:79], v1, s[16:19], s84 offen offset:3072 sc1
    s_xor_b32 s84, s68, 3
    s_lshl_b32 s84, s84, 16
    s_add_u32 s84, s84, s78
    buffer_load_dwordx4 v[80:83], v1, s[16:19], s84 offen sc1
    buffer_load_dwordx4 v[84:87], v1, s[16:19], s84 offen offset:1024 sc1
    buffer_load_dwordx4 v[88:91], v1, s[16:19], s84 offen offset:2048 sc1
    buffer_load_dwordx4 v[92:95], v1, s[16:19], s84 offen offset:3072 sc1
    s_waitcnt vmcnt(8) lgkmcnt(0)
    v_add_f32 v32, v32, v48
    v_add_f32 v33, v33, v49
    v_add_f32 v34, v34, v50
    v_add_f32 v35, v35, v51
    v_add_f32 v36, v36, v52
    v_add_f32 v37, v37, v53
    v_add_f32 v38, v38, v54
    v_add_f32 v39, v39, v55
    v_add_f32 v40, v40, v56
    v_add_f32 v41, v41, v57
    v_add_f32 v42, v42, v58
    v_add_f32 v43, v43, v59
    v_add_f32 v44, v44, v60
    v_add_f32 v45, v45, v61
    v_add_f32 v46, v46, v62
    v_add_f32 v47, v47, v63
    s_waitcnt vmcnt(0)
    v_add_f32 v64, v64, v80
    v_add_f32 v65, v65, v81
    v_add_f32 v66, v66, v82
    v_add_f32 v67, v67, v83
    v_add_f32 v68, v68, v84
    v_add_f32 v69, v69, v85
    v_add_f32 v70, v70, v86
    v_add_f32 v71, v71, v87
    v_add_f32 v72, v72, v88
    v_add_f32 v73, v73, v89
    v_add_f32 v74, v74, v90
    v_add_f32 v75, v75, v91
    v_add_f32 v76, v76, v92
    v_add_f32 v77, v77, v93
    v_add_f32 v78, v78, v94
    v_add_f32 v79, v79, v95
    v_add_f32 v32, v32, v64
    v_add_f32 v33, v33, v65
    v_add_f32 v34, v34, v66
    v_add_f32 v35, v35, v67
    v_add_f32 v36, v36, v68
    v_add_f32 v37, v37, v69
    v_add_f32 v38, v38, v70
    v_add_f32 v39, v39, v71
    v_add_f32 v40, v40, v72
    v_add_f32 v41, v41, v73
    v_add_f32 v42, v42, v74
    v_add_f32 v43, v43, v75
    v_add_f32 v44, v44, v76
    v_add_f32 v45, v45, v77
    v_add_f32 v46, v46, v78
    v_add_f32 v47, v47, v79
    v_cvt_pk_bf16_f32 v96, v32, v33
    v_cvt_pk_bf16_f32 v97, v34, v35
    v_cvt_pk_bf16_f32 v98, v36, v37
    v_cvt_pk_bf16_f32 v99, v38, v39
    v_cvt_pk_bf16_f32 v100, v40, v41
    v_cvt_pk_bf16_f32 v101, v42, v43
    v_cvt_pk_bf16_f32 v102, v44, v45
    v_cvt_pk_bf16_f32 v103, v46, v47
    v_permlane32_swap_b32 v96, v98
    v_permlane32_swap_b32 v97, v99
    v_permlane32_swap_b32 v100, v102
    v_permlane32_swap_b32 v101, v103
    buffer_store_dwordx4 v[96:99], v17, s[60:63], s77 offen
    buffer_store_dwordx4 v[100:103], v17, s[60:63], s77 offen offset:32
    s_branch L5_end
L5_nos:
    s_waitcnt vmcnt(0)
    s_barrier
    s_mov_b32 s38, 0x40000000
    s_cmp_eq_u32 s24, 0
    s_cselect_b32 s38, 0x80, s38
    v_mov_b32 v226, 1
    s_mov_b64 exec, 1
    buffer_atomic_add v226, v227, s[64:67], s38 offen sc0 sc1
    s_mov_b64 exec, -1
    s_waitcnt vmcnt(0)
    v_readfirstlane_b32 s38, v226
    s_nop 0
    s_cmp_eq_u32 s38, 0xff
    s_cbranch_scc1 L5_e2_bc
    L5_e2_bcr:
    s_lshl_b32 s38, s2, 8
    s_add_u32 s38, s38, 0x4e20000
    buffer_load_dword v228, v227, s[16:19], s38 offen sc1
    s_waitcnt vmcnt(0)
    s_branch L5_o
L5_c3_spin:
    s_sleep 8
    s_lshl_b32 s38, s2, 8
    s_add_u32 s38, s38, 0x4e20000
    buffer_load_dword v228, v227, s[16:19], s38 offen sc1
    s_waitcnt vmcnt(0)
    s_branch L5_c3
L4_e2_bc:
    v_lshlrev_b32 v226, 8, v0
    v_mov_b32 v229, 1
    s_mov_b32 s38, 0x4e20000
    buffer_store_dword v229, v226, s[16:19], s38 offen sc1
    s_add_u32 s38, s38, 0x4000
    buffer_store_dword v229, v226, s[16:19], s38 offen sc1
    s_add_u32 s38, s38, 0x4000
    buffer_store_dword v229, v226, s[16:19], s38 offen sc1
    s_add_u32 s38, s38, 0x4000
    buffer_store_dword v229, v226, s[16:19], s38 offen sc1
    s_add_u32 s38, s38, 0x4000
    s_branch L4_e2_bcr
L5_e2_bc:
    v_lshlrev_b32 v226, 8, v0
    v_mov_b32 v229, 1
    s_mov_b32 s38, 0x4e20000
    buffer_store_dword v229, v226, s[16:19], s38 offen sc1
    s_add_u32 s38, s38, 0x4000
    buffer_store_dword v229, v226, s[16:19], s38 offen sc1
    s_add_u32 s38, s38, 0x4000
    buffer_store_dword v229, v226, s[16:19], s38 offen sc1
    s_add_u32 s38, s38, 0x4000
    buffer_store_dword v229, v226, s[16:19], s38 offen sc1
    s_add_u32 s38, s38, 0x4000
    s_branch L5_e2_bcr
L5_ev:
    s_cmp_eq_u32 s87, 16
    s_cbranch_scc1 L5_chk
L5_ev1:
    buffer_load_dword v14, v15, s[16:19], s85 offen sc1
    s_mov_b32 s87, 16
    s_branch L5_chkd
L5_chk:
    v_readfirstlane_b32 s84, v14
    s_nop 0
    s_cmp_ge_u32 s84, 14
    s_cbranch_scc1 L5_sw
L5_spin:
    s_sleep 32
    buffer_load_dword v14, v15, s[16:19], s85 offen sc1
    s_waitcnt vmcnt(0)
    s_branch L5_chk
L5_sw:
    s_mov_b32 s73, s75
    s_mov_b32 s74, s76
    s_mov_b32 s56, s48
    s_mov_b32 s57, s49
    s_mov_b32 s58, 0xe0000
    s_branch L5_chkd
L5_end:
    s_endpgm
.section .rodata,"a"
.p2align 6
.amdhsa_kernel fused_kernel
  .amdhsa_next_free_vgpr 512
  .amdhsa_next_free_sgpr 102
  .amdhsa_accum_offset 256
  .amdhsa_group_segment_fixed_size 0
  .amdhsa_kernarg_size 120
  .amdhsa_user_sgpr_count 2
  .amdhsa_user_sgpr_kernarg_segment_ptr 1
  .amdhsa_system_sgpr_workgroup_id_x 1
.end_amdhsa_kernel
```
